```python
import torch

def _softmax(x, axis=-1):
    return torch.softmax(x, dim=axis)
def _gelu(x):
    return torch.nn.functional.gelu(x, approximate="tanh")
def _silu(x):
    return torch.nn.functional.silu(x)
def _sigmoid(x):
    return torch.sigmoid(x)
def _layernorm(x, axis=-1, eps=1e-5):
    m = x.mean(dim=axis, keepdim=True)
    v = x.var(dim=axis, keepdim=True, unbiased=False)
    return (x - m) / torch.sqrt(v + eps)
def _scatter_add(tgt, idx, src, axis=0):
    return tgt.clone().index_add_(axis, idx, src)
def _segment_sum(src, seg, n):
    out = torch.zeros((n,) + src.shape[1:], dtype=src.dtype)
    return out.index_add_(0, seg, src)
def _pad(x, pw):
    flat = tuple(v for pair in reversed(pw) for v in pair)
    return torch.nn.functional.pad(x, flat)

kernel_name = 'parallel_sum__spectral_gfnet__glu_gated_bilinear__prompt'

def setup_inputs():

    _w = (lambda a: (lambda t: t.to(torch.bfloat16) if t.is_floating_point() else t)(torch.as_tensor(a)))
    def _A_setup():
        B, S, D = 1, 2048, 576
        Df = D // 2 + 1
        return {
            "x": _w((lambda *s: torch.randn(*s, dtype=torch.bfloat16) * 0.05)(B, S, D)),
            "w_r": _w((lambda *s: torch.randn(*s, dtype=torch.bfloat16) * 0.4)(S, Df) * 0.02),
            "w_i": _w((lambda *s: torch.randn(*s, dtype=torch.bfloat16) * 0.4)(S, Df) * 0.02),
        }
    _A_in = _A_setup()

    def _B_setup():
        B, S, D, F = 1, 2048, 576, 4608
        return {
            "x": _w((lambda *s: torch.randn(*s, dtype=torch.bfloat16) * 0.05)(B, S, D)),
            "w_gate": _w((lambda *s: torch.randn(*s, dtype=torch.bfloat16) * 0.2)(D, F) * (D ** -0.5)),
            "w_up": _w((lambda *s: torch.randn(*s, dtype=torch.bfloat16) * 0.2)(D, F) * (D ** -0.5)),
            "w_down": _w((lambda *s: torch.randn(*s, dtype=torch.bfloat16) * 0.2)(F, D) * (F ** -0.5)),
        }
    _B_in = _B_setup()

    return {
        "A_x": _A_in["x"],
        "A_w_r": _A_in["w_r"],
        "A_w_i": _A_in["w_i"],
        "B_x": _B_in["x"],
        "B_w_gate": _B_in["w_gate"],
        "B_w_up": _B_in["w_up"],
        "B_w_down": _B_in["w_down"],
    }

def reference(A_x, A_w_r, A_w_i, B_x, B_w_gate, B_w_up, B_w_down):
    def _A_ref(x, w_r, w_i):
        B, S, D = x.shape
        X = (lambda x, axes=(-2,-1): torch.fft.rfft2(x.float(), dim=axes))(x, axes=(-2, -1))
        W = w_r + 1j * w_i
        X = X * W
        y = (lambda x, s, axes=(-2,-1): torch.fft.irfft2(x, s=s, dim=axes).to(torch.bfloat16))(X, (S, D), axes=(-2, -1))
        return y

    def _B_ref(x, w_gate, w_up, w_down):
        g = torch.einsum("bsd,df->bsf", x, w_gate)
        u = torch.einsum("bsd,df->bsf", x, w_up)
        h = g * u
        return torch.einsum("bsf,fd->bsd", h, w_down)

    x = A_x
    xn = _layernorm(x, axis=-1)
    return x + _A_ref(xn, A_w_r, A_w_i) + _B_ref(xn, B_w_gate, B_w_up, B_w_down)
```

```asm
; @launch grid=(256,1,1) block=(256,1,1) lds=163840
.amdgcn_target "amdgcn-amd-amdhsa--gfx950"
.text
    .globl parallel_sum__spectral_gfnet__glu_gated_bilinear__prompt_kernel
    .p2align 8
    .type parallel_sum__spectral_gfnet__glu_gated_bilinear__prompt_kernel,@function
parallel_sum__spectral_gfnet__glu_gated_bilinear__prompt_kernel:
L1_START:
    s_cmp_ge_u32 s2, 256
    s_cbranch_scc1 L1_END
    s_load_dwordx2 s[52:53], s[0:1], 0
    s_load_dwordx4 s[48:51], s[0:1], 32
    s_load_dwordx2 s[54:55], s[0:1], 72
    s_load_dwordx2 s[90:91], s[0:1], 64
    s_load_dwordx2 s[88:89], s[0:1], 48
    s_load_dwordx4 s[84:87], s[0:1], 8
    s_getpc_b64 s[96:97]
L1_PC0:
    s_sub_u32 s96, s96, L1_PC0-L1_START
    s_subb_u32 s97, s97, 0
    v_lshlrev_b32 v2, 4, v0
    global_load_dwordx4 v[248:251], v2, s[96:97] offset:0
    v_add_u32 v2, 4096, v2
    global_load_dwordx4 v[252:255], v2, s[96:97] offset:0
    v_lshrrev_b32 v1, 6, v0
    v_and_b32 v0, 63, v0
    s_and_b32 s45, s2, 7
    s_lshr_b32 s46, s2, 3
    v_readfirstlane_b32 s16, v1
    s_and_b32 s17, s45, 3
    s_lshl_b32 s17, s17, 2
    s_and_b32 s47, s46, 3
    s_add_u32 s17, s17, s47
    s_lshr_b32 s18, s45, 2
    s_lshl_b32 s18, s18, 3
    s_lshr_b32 s46, s46, 2
    s_add_u32 s18, s18, s46
    s_lshl_b32 s19, s47, 1
    s_add_u32 s19, s19, s46
    s_sub_u32 s45, s19, 9
    s_cmp_ge_u32 s19, 9
    s_cselect_b32 s19, s45, s19
    s_mov_b32 s40, s19
    s_and_b32 s45, s17, 3
    s_lshr_b32 s46, s17, 2
    s_mul_i32 s98, s46, 3
    s_min_u32 s47, s45, 2
    s_add_u32 s98, s98, s47
    s_lshr_b32 s99, s98, 1
    s_add_u32 s99, s99, 12
    s_and_b32 s94, s98, 1
    s_cmp_eq_u32 s45, 2
    s_cselect_b32 s94, 2, s94
    v_lshrrev_b32 v1, 3, v0
    v_mul_u32_u24 v1, 1152, v1
    v_and_b32 v2, 7, v0
    v_lshrrev_b32 v3, 4, v0
    v_xor_b32 v2, v2, v3
    v_lshlrev_b32 v4, 4, v2
    v_add_u32 v16, v1, v4
    v_xor_b32 v2, 4, v2
    v_lshlrev_b32 v4, 4, v2
    v_add_u32 v17, v1, v4
    v_add_u32 v17, 8192, v17
    v_add_u32 v18, 16384, v16
    v_add_u32 v19, 16384, v17
    s_lshl_b32 s39, s18, 2
    s_add_u32 s39, s39, s16
    s_mul_i32 s39, s39, 36864
    s_mul_i32 s60, s16, 12288
    s_add_u32 s60, s60, 24576
    s_waitcnt lgkmcnt(0)
    s_mov_b32 s4, s52
    s_mov_b32 s5, s53
    s_mov_b32 s6, 2359296
    s_mov_b32 s7, 0x00020000
    s_lshl_b32 s41, s40, 7
    s_add_u32 s41, s41, s39
    s_add_u32 m0, s60, 0
    s_add_u32 s40, s40, 1
    buffer_load_dwordx4 v16, s[4:7], s41 offen offset:0 lds
    buffer_load_dwordx4 v17, s[4:7], s41 offen offset:1024 lds
    buffer_load_dwordx4 v18, s[4:7], s41 offen offset:2048 lds
    buffer_load_dwordx4 v19, s[4:7], s41 offen offset:3072 lds
    s_cmp_eq_u32 s40, 9
    s_cselect_b32 s40, 0, s40
    s_lshl_b32 s41, s40, 7
    s_add_u32 s41, s41, s39
    s_add_u32 m0, s60, 4096
    s_add_u32 s40, s40, 1
    buffer_load_dwordx4 v16, s[4:7], s41 offen offset:0 lds
    buffer_load_dwordx4 v17, s[4:7], s41 offen offset:1024 lds
    buffer_load_dwordx4 v18, s[4:7], s41 offen offset:2048 lds
    buffer_load_dwordx4 v19, s[4:7], s41 offen offset:3072 lds
    s_cmp_eq_u32 s40, 9
    s_cselect_b32 s40, 0, s40
    s_lshl_b32 s41, s40, 7
    s_add_u32 s41, s41, s39
    s_add_u32 m0, s60, 8192
    s_add_u32 s40, s40, 1
    buffer_load_dwordx4 v16, s[4:7], s41 offen offset:0 lds
    buffer_load_dwordx4 v17, s[4:7], s41 offen offset:1024 lds
    buffer_load_dwordx4 v18, s[4:7], s41 offen offset:2048 lds
    buffer_load_dwordx4 v19, s[4:7], s41 offen offset:3072 lds
    s_cmp_eq_u32 s40, 9
    s_cselect_b32 s40, 0, s40
    v_lshlrev_b32 v29, 4, v0
    s_mov_b32 s12, s54
    s_mov_b32 s13, s55
    s_mov_b32 s14, 268435456
    s_mov_b32 s15, 0x00020000
    s_lshr_b32 s45, s16, 1
    s_cmp_eq_u32 s45, 0
    s_cselect_b32 s8, s48, s50
    s_cselect_b32 s9, s49, s51
    s_mul_i32 s46, s17, 576
    s_add_u32 s8, s8, s46
    s_addc_u32 s9, s9, 0
    s_sub_u32 s10, 5308416, s46
    s_mov_b32 s11, 0x00020000
    s_mul_i32 s38, s45, 6144
    s_and_b32 s47, s16, 1
    s_mul_i32 s46, s47, 3072
    s_add_u32 s38, s38, s46
    s_mul_i32 s47, s47, 147456
    s_lshl_b32 s46, s19, 1
    s_mul_i32 s45, s46, 294912
    s_add_u32 s47, s47, s45
    s_sub_u32 s61, s47, 5308416
    s_cmp_ge_u32 s46, 18
    s_cselect_b32 s45, s61, s47
    s_add_u32 s20, s45, 0
    s_cmp_ge_u32 s46, 17
    s_cselect_b32 s45, s61, s47
    s_add_u32 s21, s45, 294912
    s_cmp_ge_u32 s46, 16
    s_cselect_b32 s45, s61, s47
    s_add_u32 s22, s45, 589824
    s_cmp_ge_u32 s46, 15
    s_cselect_b32 s45, s61, s47
    s_add_u32 s23, s45, 884736
    s_cmp_ge_u32 s46, 14
    s_cselect_b32 s45, s61, s47
    s_add_u32 s24, s45, 1179648
    s_cmp_ge_u32 s46, 13
    s_cselect_b32 s45, s61, s47
    s_add_u32 s25, s45, 1474560
    s_cmp_ge_u32 s46, 12
    s_cselect_b32 s45, s61, s47
    s_add_u32 s26, s45, 1769472
    s_cmp_ge_u32 s46, 11
    s_cselect_b32 s45, s61, s47
    s_add_u32 s27, s45, 2064384
    s_cmp_ge_u32 s46, 10
    s_cselect_b32 s45, s61, s47
    s_add_u32 s28, s45, 2359296
    s_cmp_ge_u32 s46, 9
    s_cselect_b32 s45, s61, s47
    s_add_u32 s29, s45, 2654208
    s_cmp_ge_u32 s46, 8
    s_cselect_b32 s45, s61, s47
    s_add_u32 s30, s45, 2949120
    s_cmp_ge_u32 s46, 7
    s_cselect_b32 s45, s61, s47
    s_add_u32 s31, s45, 3244032
    s_cmp_ge_u32 s46, 6
    s_cselect_b32 s45, s61, s47
    s_add_u32 s32, s45, 3538944
    s_cmp_ge_u32 s46, 5
    s_cselect_b32 s45, s61, s47
    s_add_u32 s33, s45, 3833856
    s_cmp_ge_u32 s46, 4
    s_cselect_b32 s45, s61, s47
    s_add_u32 s34, s45, 4128768
    s_cmp_ge_u32 s46, 3
    s_cselect_b32 s45, s61, s47
    s_add_u32 s35, s45, 4423680
    s_cmp_ge_u32 s46, 2
    s_cselect_b32 s45, s61, s47
    s_add_u32 s36, s45, 4718592
    s_cmp_ge_u32 s46, 1
    s_cselect_b32 s45, s61, s47
    s_add_u32 s37, s45, 5013504
    v_add_u32 v1, 0, v0
    v_mul_u32_u24 v2, 5462, v1
    v_lshrrev_b32 v2, 16, v2
    v_mul_u32_u24 v3, 12, v2
    v_sub_u32 v3, v1, v3
    v_lshrrev_b32 v4, 3, v2
    v_lshrrev_b32 v5, 1, v3
    v_xor_b32 v5, v5, v4
    v_and_b32 v3, 1, v3
    v_lshlrev_b32 v5, 5, v5
    v_lshlrev_b32 v3, 4, v3
    v_mul_u32_u24 v2, 9216, v2
    v_add3_u32 v2, v2, v5, v3
    v_subrev_u32 v20, 0, v2
    v_add_u32 v1, 64, v0
    v_mul_u32_u24 v2, 5462, v1
    v_lshrrev_b32 v2, 16, v2
    v_mul_u32_u24 v3, 12, v2
    v_sub_u32 v3, v1, v3
    v_lshrrev_b32 v4, 3, v2
    v_lshrrev_b32 v5, 1, v3
    v_xor_b32 v5, v5, v4
    v_and_b32 v3, 1, v3
    v_lshlrev_b32 v5, 5, v5
    v_lshlrev_b32 v3, 4, v3
    v_mul_u32_u24 v2, 9216, v2
    v_add3_u32 v2, v2, v5, v3
    v_subrev_u32 v21, 1024, v2
    v_add_u32 v1, 128, v0
    v_mul_u32_u24 v2, 5462, v1
    v_lshrrev_b32 v2, 16, v2
    v_mul_u32_u24 v3, 12, v2
    v_sub_u32 v3, v1, v3
    v_lshrrev_b32 v4, 3, v2
    v_lshrrev_b32 v5, 1, v3
    v_xor_b32 v5, v5, v4
    v_and_b32 v3, 1, v3
    v_lshlrev_b32 v5, 5, v5
    v_lshlrev_b32 v3, 4, v3
    v_mul_u32_u24 v2, 9216, v2
    v_add3_u32 v2, v2, v5, v3
    v_subrev_u32 v22, 2048, v2
    v_lshrrev_b32 v1, 4, v0
    v_bfe_u32 v2, v0, 2, 2
    v_lshlrev_b32 v3, 3, v1
    v_mov_b32 v36, v3
    v_add_u32 v3, v3, v2
    v_mul_u32_u24 v3, 192, v3
    v_and_b32 v4, 3, v0
    v_lshlrev_b32 v4, 3, v4
    v_add_u32 v3, v3, v4
    v_and_b32 v4, 1, v1
    v_lshlrev_b32 v4, 5, v4
    v_add_u32 v23, v3, v4
    v_sub_u32 v24, v3, v4
    v_add_u32 v25, 61440, v23
    v_add_u32 v26, 61440, v24
    v_and_b32 v2, 15, v0
    v_lshrrev_b32 v3, 1, v2
    v_xor_b32 v3, v3, v1
    v_lshlrev_b32 v4, 7, v2
    v_add_u32 v4, s60, v4
    v_lshlrev_b32 v5, 4, v3
    v_add_u32 v27, v4, v5
    v_xor_b32 v3, 4, v3
    v_lshlrev_b32 v5, 4, v3
    v_add_u32 v28, v4, v5
    v_add_u32 v37, 86016, v29
    v_add_u32 v46, 122880, v29
    v_lshlrev_b32 v4, 15, v1
    v_lshlrev_b32 v5, 4, v2
    v_add_u32 v47, v4, v5
    s_mul_i32 s43, s18, 144
    s_mul_i32 s45, s17, 9
    s_add_u32 s43, s43, s45
    s_lshl_b32 s43, s43, 3
    s_lshl_b32 s45, s16, 1
    s_add_u32 s43, s43, s45
    s_lshl_b32 s43, s43, 10
    s_lshl_b32 s45, s18, 2
    s_add_u32 s45, s45, s16
    s_lshl_b32 s45, s45, 9
    s_add_u32 s45, s45, 18874368
    s_lshl_b32 s46, s98, 17
    s_add_u32 s44, s45, s46
    s_lshl_b32 s46, s99, 17
    s_add_u32 s62, s45, s46
    s_mov_b32 s42, 0x3f803f80
    s_mov_b32 s95, 36782080
    s_load_dword s101, s[54:55], s95
    s_cmp_eq_u32 s94, 2
    s_cbranch_scc1 L1_NOYZ
    s_lshl_b32 s93, s98, 4
    s_add_u32 s93, s93, s18
    s_lshl_b32 s93, s93, 2
    s_add_u32 s93, s93, s16
    s_mov_b32 s45, s93
    s_cmp_ge_u32 s45, 684
    s_cbranch_scc1 L1_NOIDFT
    s_mul_i32 s46, s45, 1821
    s_lshr_b32 s46, s46, 16
    s_mul_i32 s47, s46, 36
    s_sub_u32 s47, s45, s47
    s_lshl_b32 s45, s45, 10
    s_add_u32 s45, s45, 23658496
    s_lshl_b32 s47, s47, 4
    s_sub_u32 s47, s47, 288
    v_and_b32 v80, 15, v0
    v_add_u32 v80, s47, v80
    v_cvt_f32_i32 v80, v80
    v_mul_f32 v80, 0x3ae38e39, v80
    s_lshl_b32 s47, s46, 4
    v_lshrrev_b32 v81, 1, v36
    v_add_u32 v82, s47, v81
    v_cvt_f32_u32 v83, v82
    v_mul_f32 v84, v83, v80
    v_add_f32 v85, v84, v80
    v_add_f32 v86, v85, v80
    v_add_f32 v87, v86, v80
    v_add_f32 v85, 0.5, v85
    v_add_f32 v87, 0.5, v87
    s_cmp_eq_u32 s46, 18
    s_cselect_b32 s47, 0, 0x35e38e39
    v_mov_b32 v96, s47
    v_mov_b32 v97, 0x35638e39
    v_cmp_eq_u32 vcc, 0, v82
    v_mov_b32 v98, 288
    s_nop 0
    v_cndmask_b32 v96, v96, v97, vcc
    v_cmp_eq_u32 vcc, v98, v82
    s_nop 1
    v_cndmask_b32 v96, v96, v97, vcc
    v_cos_f32 v88, v84
    v_sin_f32 v92, v84
    v_cos_f32 v89, v85
    v_sin_f32 v93, v85
    v_cos_f32 v90, v86
    v_sin_f32 v94, v86
    v_cos_f32 v91, v87
    v_sin_f32 v95, v87
    v_mul_f32 v88, v96, v88
    v_mul_f32 v92, v96, v92
    v_mul_f32 v89, s47, v89
    v_mul_f32 v93, s47, v93
    v_mul_f32 v90, s47, v90
    v_mul_f32 v94, s47, v94
    v_mul_f32 v91, s47, v91
    v_mul_f32 v95, s47, v95
    v_cvt_pk_bf16_f32 v100, v88, v92
    v_cvt_pk_bf16_f32 v101, v89, v93
    v_cvt_pk_bf16_f32 v102, v90, v94
    v_cvt_pk_bf16_f32 v103, v91, v95
    buffer_store_dwordx4 v[100:103], v29, s[12:15], s45 offen sc1
L1_NOIDFT:
    s_sub_u32 s45, s93, 640
    s_cmp_ge_u32 s45, 128
    s_cbranch_scc1 L1_NOYZ
    s_mul_i32 s45, s45, 19456
    s_add_u32 s45, s45, 24398080
    v_mov_b32 v80, 0
    v_mov_b32 v81, 0
    v_mov_b32 v82, 0
    v_mov_b32 v83, 0
    v_mov_b32 v84, 0x10000000
    v_cmp_gt_u32 vcc, 48, v0
    s_nop 1
    v_cndmask_b32 v84, v84, v29, vcc
    buffer_store_dwordx4 v[80:83], v84, s[12:15], s45 offen sc1
L1_NOYZ:
    v_mov_b32 v4, 0x3f803f80
    v_mov_b32 v5, 0x3f803f80
    v_mov_b32 v6, 0x3f803f80
    v_mov_b32 v7, 0x3f803f80
    v_and_b32 v104, 15, v0
    s_lshl_b32 s45, s98, 4
    v_add_u32 v105, s45, v104
    s_and_b32 s46, s16, 1
    s_cmp_eq_u32 s46, 1
    s_cselect_b32 s47, 0x3e800000, 0
    s_cselect_b32 s45, 0, 1
    v_and_b32 v106, 1, v105
    v_cvt_f32_u32 v106, v106
    v_mul_f32 v106, 0.5, v106
    v_add_f32 v35, s47, v106
    v_or_b32 v107, s45, v105
    v_mov_b32 v108, 288
    v_cmp_eq_u32 vcc, 0, v107
    v_mov_b32 v109, 0
    s_nop 0
    v_cndmask_b32 v105, v105, v108, vcc
    v_cndmask_b32 v35, v35, v109, vcc
    v_cvt_f32_u32 v105, v105
    v_mul_f32 v34, 0x3ae38e39, v105
    s_lshr_b32 s93, s16, 1
    s_mul_i32 s93, s93, 9
    s_lshl_b32 s59, s93, 1
    s_add_u32 s59, s59, s46
    s_lshl_b32 s59, s59, 10
    s_add_u32 s59, s59, 86016
    s_lshl_b32 s45, s19, 1
    s_add_u32 s45, s45, s93
    s_sub_u32 s46, s45, 18
    s_cmp_ge_u32 s45, 18
    s_cselect_b32 s45, s46, s45
    s_lshl_b32 s45, s45, 5
    s_sub_u32 s56, s45, 288
    v_and_b32 v104, 15, v0
    s_lshl_b32 s45, s99, 4
    v_add_u32 v105, s45, v104
    s_and_b32 s46, s16, 1
    s_cmp_eq_u32 s46, 1
    s_cselect_b32 s47, 0x3e800000, 0
    s_cselect_b32 s45, 0, 1
    v_and_b32 v106, 1, v105
    v_cvt_f32_u32 v106, v106
    v_mul_f32 v106, 0.5, v106
    v_add_f32 v110, s47, v106
    v_or_b32 v107, s45, v105
    v_mov_b32 v108, 288
    v_cmp_eq_u32 vcc, 0, v107
    v_mov_b32 v109, 0
    s_nop 0
    v_cndmask_b32 v105, v105, v108, vcc
    v_cndmask_b32 v110, v110, v109, vcc
    v_cvt_f32_u32 v105, v105
    v_mul_f32 v109, 0x3ae38e39, v105
    s_lshr_b32 s93, s16, 1
    s_mul_i32 s93, s93, 9
    s_lshl_b32 s58, s93, 1
    s_add_u32 s58, s58, s46
    s_lshl_b32 s58, s58, 10
    s_add_u32 s58, s58, 122880
    s_lshl_b32 s45, s19, 1
    s_add_u32 s45, s45, s93
    s_sub_u32 s46, s45, 18
    s_cmp_ge_u32 s45, 18
    s_cselect_b32 s45, s46, s45
    s_lshl_b32 s45, s45, 5
    s_sub_u32 s57, s45, 288
    v_and_b32 v1, 15, v0
    v_lshrrev_b32 v2, 2, v1
    v_lshrrev_b32 v3, 4, v0
    v_and_b32 v1, 3, v1
    v_cmp_eq_u32 vcc, v2, v3
    v_mov_b32 v2, 7
    s_nop 0
    v_cndmask_b32 v1, v2, v1, vcc
    v_cmp_eq_u32 vcc, 0, v1
    v_mov_b32 v2, 0
    v_mov_b32 v3, 1.0
    v_cndmask_b32 v72, v2, v3, vcc
    v_cmp_eq_u32 vcc, 1, v1
    v_mov_b32 v2, 0
    v_mov_b32 v3, 1.0
    v_cndmask_b32 v73, v2, v3, vcc
    v_cmp_eq_u32 vcc, 2, v1
    v_mov_b32 v2, 0
    v_mov_b32 v3, 1.0
    v_cndmask_b32 v74, v2, v3, vcc
    v_cmp_eq_u32 vcc, 3, v1
    v_mov_b32 v2, 0
    v_mov_b32 v3, 1.0
    v_cndmask_b32 v75, v2, v3, vcc
    s_getpc_b64 s[96:97]
L1_PC:
    s_sub_u32 s96, s96, L1_PC-L1_START
    s_subb_u32 s97, s97, 0
    s_mov_b32 s98, CODE_END-L1_START
    s_mov_b32 s99, 0x00020000
    s_lshr_b32 s45, s2, 3
    s_lshl_b32 s45, s45, 2
    s_add_u32 s45, s45, s16
    s_lshl_b32 s45, s45, 10
    buffer_load_dwordx4 v[244:247], v29, s[96:99], s45 offen
    s_waitcnt vmcnt(9)
    ds_read_b128 v[112:115], v27 offset:0
    ds_read_b128 v[116:119], v27 offset:2048
    ds_read_b128 v[120:123], v28 offset:0
    ds_read_b128 v[124:127], v28 offset:2048
    s_waitcnt lgkmcnt(0)
    s_lshl_b32 s41, s40, 7
    s_add_u32 s41, s41, s39
    s_add_u32 m0, s60, 0
    s_add_u32 s40, s40, 1
    buffer_load_dwordx4 v16, s[4:7], s41 offen offset:0 lds
    buffer_load_dwordx4 v17, s[4:7], s41 offen offset:1024 lds
    buffer_load_dwordx4 v18, s[4:7], s41 offen offset:2048 lds
    buffer_load_dwordx4 v19, s[4:7], s41 offen offset:3072 lds
    s_cmp_eq_u32 s40, 9
    s_cselect_b32 s40, 0, s40
    v_mfma_f32_16x16x32_bf16 v[38:41], v[4:7], v[112:115], 0
    v_mfma_f32_16x16x32_bf16 v[8:11], v[112:115], v[112:115], 0
    v_mfma_f32_16x16x32_bf16 v[42:45], v[4:7], v[116:119], 0
    v_mfma_f32_16x16x32_bf16 v[12:15], v[116:119], v[116:119], 0
    v_mfma_f32_16x16x32_bf16 v[38:41], v[4:7], v[120:123], v[38:41]
    v_mfma_f32_16x16x32_bf16 v[8:11], v[120:123], v[120:123], v[8:11]
    v_mfma_f32_16x16x32_bf16 v[42:45], v[4:7], v[124:127], v[42:45]
    v_mfma_f32_16x16x32_bf16 v[12:15], v[124:127], v[124:127], v[12:15]
    s_waitcnt vmcnt(9)
    ds_read_b128 v[128:131], v27 offset:4096
    ds_read_b128 v[132:135], v27 offset:6144
    ds_read_b128 v[136:139], v28 offset:4096
    ds_read_b128 v[140:143], v28 offset:6144
    s_waitcnt lgkmcnt(0)
    s_lshl_b32 s41, s40, 7
    s_add_u32 s41, s41, s39
    s_add_u32 m0, s60, 4096
    s_add_u32 s40, s40, 1
    buffer_load_dwordx4 v16, s[4:7], s41 offen offset:0 lds
    buffer_load_dwordx4 v17, s[4:7], s41 offen offset:1024 lds
    buffer_load_dwordx4 v18, s[4:7], s41 offen offset:2048 lds
    buffer_load_dwordx4 v19, s[4:7], s41 offen offset:3072 lds
    s_cmp_eq_u32 s40, 9
    s_cselect_b32 s40, 0, s40
    v_mfma_f32_16x16x32_bf16 v[38:41], v[4:7], v[128:131], v[38:41]
    v_mfma_f32_16x16x32_bf16 v[8:11], v[128:131], v[128:131], v[8:11]
    v_mfma_f32_16x16x32_bf16 v[42:45], v[4:7], v[132:135], v[42:45]
    v_mfma_f32_16x16x32_bf16 v[12:15], v[132:135], v[132:135], v[12:15]
    v_mfma_f32_16x16x32_bf16 v[38:41], v[4:7], v[136:139], v[38:41]
    v_mfma_f32_16x16x32_bf16 v[8:11], v[136:139], v[136:139], v[8:11]
    v_mfma_f32_16x16x32_bf16 v[42:45], v[4:7], v[140:143], v[42:45]
    v_mfma_f32_16x16x32_bf16 v[12:15], v[140:143], v[140:143], v[12:15]
    s_waitcnt vmcnt(9)
    ds_read_b128 v[144:147], v27 offset:8192
    ds_read_b128 v[148:151], v27 offset:10240
    ds_read_b128 v[152:155], v28 offset:8192
    ds_read_b128 v[156:159], v28 offset:10240
    s_waitcnt lgkmcnt(0)
    s_lshl_b32 s41, s40, 7
    s_add_u32 s41, s41, s39
    s_add_u32 m0, s60, 8192
    s_add_u32 s40, s40, 1
    buffer_load_dwordx4 v16, s[4:7], s41 offen offset:0 lds
    buffer_load_dwordx4 v17, s[4:7], s41 offen offset:1024 lds
    buffer_load_dwordx4 v18, s[4:7], s41 offen offset:2048 lds
    buffer_load_dwordx4 v19, s[4:7], s41 offen offset:3072 lds
    s_cmp_eq_u32 s40, 9
    s_cselect_b32 s40, 0, s40
    v_mfma_f32_16x16x32_bf16 v[38:41], v[4:7], v[144:147], v[38:41]
    v_mfma_f32_16x16x32_bf16 v[8:11], v[144:147], v[144:147], v[8:11]
    v_mfma_f32_16x16x32_bf16 v[42:45], v[4:7], v[148:151], v[42:45]
    v_mfma_f32_16x16x32_bf16 v[12:15], v[148:151], v[148:151], v[12:15]
    v_mfma_f32_16x16x32_bf16 v[38:41], v[4:7], v[152:155], v[38:41]
    v_mfma_f32_16x16x32_bf16 v[8:11], v[152:155], v[152:155], v[8:11]
    v_mfma_f32_16x16x32_bf16 v[42:45], v[4:7], v[156:159], v[42:45]
    v_mfma_f32_16x16x32_bf16 v[12:15], v[156:159], v[156:159], v[12:15]
    s_waitcnt vmcnt(8)
    ds_read_b128 v[160:163], v27 offset:0
    ds_read_b128 v[164:167], v27 offset:2048
    ds_read_b128 v[168:171], v28 offset:0
    ds_read_b128 v[172:175], v28 offset:2048
    s_waitcnt lgkmcnt(0)
    s_lshl_b32 s41, s40, 7
    s_add_u32 s41, s41, s39
    s_add_u32 m0, s60, 0
    s_add_u32 s40, s40, 1
    buffer_load_dwordx4 v16, s[4:7], s41 offen offset:0 lds
    buffer_load_dwordx4 v17, s[4:7], s41 offen offset:1024 lds
    buffer_load_dwordx4 v18, s[4:7], s41 offen offset:2048 lds
    buffer_load_dwordx4 v19, s[4:7], s41 offen offset:3072 lds
    s_cmp_eq_u32 s40, 9
    s_cselect_b32 s40, 0, s40
    v_mfma_f32_16x16x32_bf16 v[38:41], v[4:7], v[160:163], v[38:41]
    v_mfma_f32_16x16x32_bf16 v[8:11], v[160:163], v[160:163], v[8:11]
    v_mfma_f32_16x16x32_bf16 v[42:45], v[4:7], v[164:167], v[42:45]
    v_mfma_f32_16x16x32_bf16 v[12:15], v[164:167], v[164:167], v[12:15]
    v_mfma_f32_16x16x32_bf16 v[38:41], v[4:7], v[168:171], v[38:41]
    v_mfma_f32_16x16x32_bf16 v[8:11], v[168:171], v[168:171], v[8:11]
    v_mfma_f32_16x16x32_bf16 v[42:45], v[4:7], v[172:175], v[42:45]
    v_mfma_f32_16x16x32_bf16 v[12:15], v[172:175], v[172:175], v[12:15]
    s_waitcnt vmcnt(8)
    ds_read_b128 v[176:179], v27 offset:4096
    ds_read_b128 v[180:183], v27 offset:6144
    ds_read_b128 v[184:187], v28 offset:4096
    ds_read_b128 v[188:191], v28 offset:6144
    s_waitcnt lgkmcnt(0)
    s_lshl_b32 s41, s40, 7
    s_add_u32 s41, s41, s39
    s_add_u32 m0, s60, 4096
    s_add_u32 s40, s40, 1
    buffer_load_dwordx4 v16, s[4:7], s41 offen offset:0 lds
    buffer_load_dwordx4 v17, s[4:7], s41 offen offset:1024 lds
    buffer_load_dwordx4 v18, s[4:7], s41 offen offset:2048 lds
    buffer_load_dwordx4 v19, s[4:7], s41 offen offset:3072 lds
    s_cmp_eq_u32 s40, 9
    s_cselect_b32 s40, 0, s40
    v_mfma_f32_16x16x32_bf16 v[38:41], v[4:7], v[176:179], v[38:41]
    v_mfma_f32_16x16x32_bf16 v[8:11], v[176:179], v[176:179], v[8:11]
    v_mfma_f32_16x16x32_bf16 v[42:45], v[4:7], v[180:183], v[42:45]
    v_mfma_f32_16x16x32_bf16 v[12:15], v[180:183], v[180:183], v[12:15]
    v_mfma_f32_16x16x32_bf16 v[38:41], v[4:7], v[184:187], v[38:41]
    v_mfma_f32_16x16x32_bf16 v[8:11], v[184:187], v[184:187], v[8:11]
    v_mfma_f32_16x16x32_bf16 v[42:45], v[4:7], v[188:191], v[42:45]
    v_mfma_f32_16x16x32_bf16 v[12:15], v[188:191], v[188:191], v[12:15]
    s_waitcnt vmcnt(8)
    ds_read_b128 v[192:195], v27 offset:8192
    ds_read_b128 v[196:199], v27 offset:10240
    ds_read_b128 v[200:203], v28 offset:8192
    ds_read_b128 v[204:207], v28 offset:10240
    s_waitcnt lgkmcnt(0)
    s_lshl_b32 s41, s40, 7
    s_add_u32 s41, s41, s39
    s_add_u32 m0, s60, 8192
    s_add_u32 s40, s40, 1
    buffer_load_dwordx4 v16, s[4:7], s41 offen offset:0 lds
    buffer_load_dwordx4 v17, s[4:7], s41 offen offset:1024 lds
    buffer_load_dwordx4 v18, s[4:7], s41 offen offset:2048 lds
    buffer_load_dwordx4 v19, s[4:7], s41 offen offset:3072 lds
    s_cmp_eq_u32 s40, 9
    s_cselect_b32 s40, 0, s40
    v_mfma_f32_16x16x32_bf16 v[38:41], v[4:7], v[192:195], v[38:41]
    v_mfma_f32_16x16x32_bf16 v[8:11], v[192:195], v[192:195], v[8:11]
    v_mfma_f32_16x16x32_bf16 v[42:45], v[4:7], v[196:199], v[42:45]
    v_mfma_f32_16x16x32_bf16 v[12:15], v[196:199], v[196:199], v[12:15]
    v_mfma_f32_16x16x32_bf16 v[38:41], v[4:7], v[200:203], v[38:41]
    v_mfma_f32_16x16x32_bf16 v[8:11], v[200:203], v[200:203], v[8:11]
    v_mfma_f32_16x16x32_bf16 v[42:45], v[4:7], v[204:207], v[42:45]
    v_mfma_f32_16x16x32_bf16 v[12:15], v[204:207], v[204:207], v[12:15]
    s_waitcnt vmcnt(8)
    ds_read_b128 v[208:211], v27 offset:0
    ds_read_b128 v[212:215], v27 offset:2048
    ds_read_b128 v[216:219], v28 offset:0
    ds_read_b128 v[220:223], v28 offset:2048
    s_waitcnt lgkmcnt(0)
    s_add_u32 m0, s38, 0
    s_nop 0
    buffer_load_dwordx4 v20, s[8:11], s20 offen offset:0  lds
    buffer_load_dwordx4 v21, s[8:11], s20 offen offset:1024  lds
    buffer_load_dwordx4 v22, s[8:11], s20 offen offset:2048  lds
    v_mfma_f32_16x16x32_bf16 v[38:41], v[4:7], v[208:211], v[38:41]
    v_mfma_f32_16x16x32_bf16 v[8:11], v[208:211], v[208:211], v[8:11]
    v_mfma_f32_16x16x32_bf16 v[42:45], v[4:7], v[212:215], v[42:45]
    v_mfma_f32_16x16x32_bf16 v[12:15], v[212:215], v[212:215], v[12:15]
    v_mfma_f32_16x16x32_bf16 v[38:41], v[4:7], v[216:219], v[38:41]
    v_mfma_f32_16x16x32_bf16 v[8:11], v[216:219], v[216:219], v[8:11]
    v_mfma_f32_16x16x32_bf16 v[42:45], v[4:7], v[220:223], v[42:45]
    v_mfma_f32_16x16x32_bf16 v[12:15], v[220:223], v[220:223], v[12:15]
    s_waitcnt vmcnt(7)
    ds_read_b128 v[224:227], v27 offset:4096
    ds_read_b128 v[228:231], v27 offset:6144
    ds_read_b128 v[232:235], v28 offset:4096
    ds_read_b128 v[236:239], v28 offset:6144
    s_waitcnt lgkmcnt(0)
    s_add_u32 m0, s38, 12288
    s_nop 0
    buffer_load_dwordx4 v20, s[8:11], s21 offen offset:0  lds
    buffer_load_dwordx4 v21, s[8:11], s21 offen offset:1024  lds
    buffer_load_dwordx4 v22, s[8:11], s21 offen offset:2048  lds
    v_mfma_f32_16x16x32_bf16 v[38:41], v[4:7], v[224:227], v[38:41]
    v_mfma_f32_16x16x32_bf16 v[8:11], v[224:227], v[224:227], v[8:11]
    v_mfma_f32_16x16x32_bf16 v[42:45], v[4:7], v[228:231], v[42:45]
    v_mfma_f32_16x16x32_bf16 v[12:15], v[228:231], v[228:231], v[12:15]
    v_mfma_f32_16x16x32_bf16 v[38:41], v[4:7], v[232:235], v[38:41]
    v_mfma_f32_16x16x32_bf16 v[8:11], v[232:235], v[232:235], v[8:11]
    v_mfma_f32_16x16x32_bf16 v[42:45], v[4:7], v[236:239], v[42:45]
    v_mfma_f32_16x16x32_bf16 v[12:15], v[236:239], v[236:239], v[12:15]
    s_waitcnt vmcnt(6)
    ds_read_b128 v[240:243], v27 offset:8192
    ds_read_b128 v[244:247], v27 offset:10240
    ds_read_b128 v[248:251], v28 offset:8192
    ds_read_b128 v[252:255], v28 offset:10240
    s_waitcnt lgkmcnt(0)
    v_mfma_f32_16x16x32_bf16 v[38:41], v[4:7], v[240:243], v[38:41]
    v_mfma_f32_16x16x32_bf16 v[8:11], v[240:243], v[240:243], v[8:11]
    v_mfma_f32_16x16x32_bf16 v[42:45], v[4:7], v[244:247], v[42:45]
    v_mfma_f32_16x16x32_bf16 v[12:15], v[244:247], v[244:247], v[12:15]
    v_mfma_f32_16x16x32_bf16 v[38:41], v[4:7], v[248:251], v[38:41]
    v_mfma_f32_16x16x32_bf16 v[8:11], v[248:251], v[248:251], v[8:11]
    v_mfma_f32_16x16x32_bf16 v[42:45], v[4:7], v[252:255], v[42:45]
    v_mfma_f32_16x16x32_bf16 v[12:15], v[252:255], v[252:255], v[12:15]
    s_waitcnt lgkmcnt(0)
    s_barrier
    s_add_u32 s101, s101, 1
    s_nop 3
    v_mul_f32 v8, v8, v72
    v_fma_f32 v8, v9, v73, v8
    v_fma_f32 v8, v10, v74, v8
    v_fma_f32 v8, v11, v75, v8
    v_mul_f32 v12, v12, v72
    v_fma_f32 v12, v13, v73, v12
    v_fma_f32 v12, v14, v74, v12
    v_fma_f32 v12, v15, v75, v12
    v_mov_b32 v80, v8
    v_mov_b32 v81, v12
    s_nop 0
    v_permlane32_swap_b32 v8, v80
    v_permlane32_swap_b32 v12, v81
    s_nop 0
    v_add_f32 v8, v8, v80
    v_add_f32 v12, v12, v81
    v_mov_b32 v80, v8
    v_mov_b32 v81, v12
    s_nop 0
    v_permlane16_swap_b32 v8, v80
    v_permlane16_swap_b32 v12, v81
    s_nop 0
    v_add_f32 v8, v8, v80
    v_add_f32 v12, v12, v81
    s_mov_b32 s45, 0x3ae38e39
    s_mov_b32 s46, 0x3727c5ac
    v_mul_f32 v38, s45, v38
    v_mul_f32 v8, s45, v8
    v_fma_f32 v8, -v38, v38, v8
    v_max_f32 v8, 0, v8
    v_add_f32 v8, s46, v8
    v_rsq_f32 v32, v8
    v_sub_f32 v80, 0, v38
    v_sub_f32 v81, 0, v38
    v_sub_f32 v82, 0, v38
    v_sub_f32 v83, 0, v38
    v_mul_f32 v30, v32, v32
    v_mul_f32 v42, s45, v42
    v_mul_f32 v12, s45, v12
    v_fma_f32 v12, -v42, v42, v12
    v_max_f32 v12, 0, v12
    v_add_f32 v12, s46, v12
    v_rsq_f32 v33, v12
    v_sub_f32 v84, 0, v42
    v_sub_f32 v85, 0, v42
    v_sub_f32 v86, 0, v42
    v_sub_f32 v87, 0, v42
    v_mul_f32 v31, v33, v33
    v_and_b32 v1, 15, v0
    v_lshrrev_b32 v2, 2, v1
    v_lshrrev_b32 v3, 4, v0
    v_and_b32 v4, 3, v1
    v_mov_b32 v5, 0x3f80
    v_lshlrev_b32 v6, 4, v4
    v_and_b32 v6, 16, v6
    v_lshlrev_b32 v5, v6, v5
    v_cmp_eq_u32 vcc, v2, v3
    v_mov_b32 v7, 0
    v_mov_b32 v88, 0
    v_cndmask_b32 v5, v7, v5, vcc
    v_mov_b32 v89, 0
    v_cmp_gt_u32 vcc, 2, v4
    v_mov_b32 v92, 0
    v_mov_b32 v93, 0
    v_cndmask_b32 v90, v7, v5, vcc
    v_cndmask_b32 v91, v5, v7, vcc
    s_nop 1
    v_mfma_f32_16x16x32_bf16 v[48:51], v[90:93], v[112:115], v[80:83]
    s_nop 1
    v_mfma_f32_16x16x32_bf16 v[52:55], v[88:91], v[112:115], v[80:83]
    s_nop 1
    v_mfma_f32_16x16x32_bf16 v[56:59], v[90:93], v[116:119], v[84:87]
    s_nop 1
    v_mfma_f32_16x16x32_bf16 v[60:63], v[88:91], v[116:119], v[84:87]
    s_nop 1
    v_mfma_f32_16x16x32_bf16 v[64:67], v[90:93], v[120:123], v[80:83]
    v_cvt_pk_bf16_f32 v112, v48, v49
    v_cvt_pk_bf16_f32 v113, v50, v51
    v_mfma_f32_16x16x32_bf16 v[68:71], v[88:91], v[120:123], v[80:83]
    v_cvt_pk_bf16_f32 v114, v52, v53
    v_cvt_pk_bf16_f32 v115, v54, v55
    v_mfma_f32_16x16x32_bf16 v[48:51], v[90:93], v[124:127], v[84:87]
    v_cvt_pk_bf16_f32 v116, v56, v57
    v_cvt_pk_bf16_f32 v117, v58, v59
    v_mfma_f32_16x16x32_bf16 v[52:55], v[88:91], v[124:127], v[84:87]
    v_cvt_pk_bf16_f32 v118, v60, v61
    v_cvt_pk_bf16_f32 v119, v62, v63
    s_add_u32 m0, s38, 24576
    v_mfma_f32_16x16x32_bf16 v[56:59], v[90:93], v[128:131], v[80:83]
    v_cvt_pk_bf16_f32 v120, v64, v65
    v_cvt_pk_bf16_f32 v121, v66, v67
    v_mfma_f32_16x16x32_bf16 v[60:63], v[88:91], v[128:131], v[80:83]
    v_cvt_pk_bf16_f32 v122, v68, v69
    v_cvt_pk_bf16_f32 v123, v70, v71
    buffer_load_dwordx4 v20, s[8:11], s22 offen offset:0  lds
    v_mfma_f32_16x16x32_bf16 v[64:67], v[90:93], v[132:135], v[84:87]
    v_cvt_pk_bf16_f32 v124, v48, v49
    v_cvt_pk_bf16_f32 v125, v50, v51
    v_mfma_f32_16x16x32_bf16 v[68:71], v[88:91], v[132:135], v[84:87]
    v_cvt_pk_bf16_f32 v126, v52, v53
    v_cvt_pk_bf16_f32 v127, v54, v55
    v_mfma_f32_16x16x32_bf16 v[48:51], v[90:93], v[136:139], v[80:83]
    v_cvt_pk_bf16_f32 v128, v56, v57
    v_cvt_pk_bf16_f32 v129, v58, v59
    v_mfma_f32_16x16x32_bf16 v[52:55], v[88:91], v[136:139], v[80:83]
    v_cvt_pk_bf16_f32 v130, v60, v61
    v_cvt_pk_bf16_f32 v131, v62, v63
    buffer_load_dwordx4 v21, s[8:11], s22 offen offset:1024  lds
    v_mfma_f32_16x16x32_bf16 v[56:59], v[90:93], v[140:143], v[84:87]
    v_cvt_pk_bf16_f32 v132, v64, v65
    v_cvt_pk_bf16_f32 v133, v66, v67
    v_mfma_f32_16x16x32_bf16 v[60:63], v[88:91], v[140:143], v[84:87]
    v_cvt_pk_bf16_f32 v134, v68, v69
    v_cvt_pk_bf16_f32 v135, v70, v71
    v_mfma_f32_16x16x32_bf16 v[64:67], v[90:93], v[144:147], v[80:83]
    v_cvt_pk_bf16_f32 v136, v48, v49
    v_cvt_pk_bf16_f32 v137, v50, v51
    v_mfma_f32_16x16x32_bf16 v[68:71], v[88:91], v[144:147], v[80:83]
    v_cvt_pk_bf16_f32 v138, v52, v53
    v_cvt_pk_bf16_f32 v139, v54, v55
    buffer_load_dwordx4 v22, s[8:11], s22 offen offset:2048  lds
    v_mfma_f32_16x16x32_bf16 v[48:51], v[90:93], v[148:151], v[84:87]
    v_cvt_pk_bf16_f32 v140, v56, v57
    v_cvt_pk_bf16_f32 v141, v58, v59
    v_mfma_f32_16x16x32_bf16 v[52:55], v[88:91], v[148:151], v[84:87]
    v_cvt_pk_bf16_f32 v142, v60, v61
    v_cvt_pk_bf16_f32 v143, v62, v63
    v_mfma_f32_16x16x32_bf16 v[56:59], v[90:93], v[152:155], v[80:83]
    v_cvt_pk_bf16_f32 v144, v64, v65
    v_cvt_pk_bf16_f32 v145, v66, v67
    v_mfma_f32_16x16x32_bf16 v[60:63], v[88:91], v[152:155], v[80:83]
    v_cvt_pk_bf16_f32 v146, v68, v69
    v_cvt_pk_bf16_f32 v147, v70, v71
    v_mfma_f32_16x16x32_bf16 v[64:67], v[90:93], v[156:159], v[84:87]
    v_cvt_pk_bf16_f32 v148, v48, v49
    v_cvt_pk_bf16_f32 v149, v50, v51
    v_mfma_f32_16x16x32_bf16 v[68:71], v[88:91], v[156:159], v[84:87]
    v_cvt_pk_bf16_f32 v150, v52, v53
    v_cvt_pk_bf16_f32 v151, v54, v55
    v_mfma_f32_16x16x32_bf16 v[48:51], v[90:93], v[160:163], v[80:83]
    v_cvt_pk_bf16_f32 v152, v56, v57
    v_cvt_pk_bf16_f32 v153, v58, v59
    v_mfma_f32_16x16x32_bf16 v[52:55], v[88:91], v[160:163], v[80:83]
    v_cvt_pk_bf16_f32 v154, v60, v61
    v_cvt_pk_bf16_f32 v155, v62, v63
    v_mfma_f32_16x16x32_bf16 v[56:59], v[90:93], v[164:167], v[84:87]
    v_cvt_pk_bf16_f32 v156, v64, v65
    v_cvt_pk_bf16_f32 v157, v66, v67
    v_mfma_f32_16x16x32_bf16 v[60:63], v[88:91], v[164:167], v[84:87]
    v_cvt_pk_bf16_f32 v158, v68, v69
    v_cvt_pk_bf16_f32 v159, v70, v71
    v_mfma_f32_16x16x32_bf16 v[64:67], v[90:93], v[168:171], v[80:83]
    v_cvt_pk_bf16_f32 v160, v48, v49
    v_cvt_pk_bf16_f32 v161, v50, v51
    v_mfma_f32_16x16x32_bf16 v[68:71], v[88:91], v[168:171], v[80:83]
    v_cvt_pk_bf16_f32 v162, v52, v53
    v_cvt_pk_bf16_f32 v163, v54, v55
    s_add_u32 m0, s38, 36864
    v_mfma_f32_16x16x32_bf16 v[48:51], v[90:93], v[172:175], v[84:87]
    v_cvt_pk_bf16_f32 v164, v56, v57
    v_cvt_pk_bf16_f32 v165, v58, v59
    v_mfma_f32_16x16x32_bf16 v[52:55], v[88:91], v[172:175], v[84:87]
    v_cvt_pk_bf16_f32 v166, v60, v61
    v_cvt_pk_bf16_f32 v167, v62, v63
    buffer_load_dwordx4 v20, s[8:11], s23 offen offset:0  lds
    v_mfma_f32_16x16x32_bf16 v[56:59], v[90:93], v[176:179], v[80:83]
    v_cvt_pk_bf16_f32 v168, v64, v65
    v_cvt_pk_bf16_f32 v169, v66, v67
    v_mfma_f32_16x16x32_bf16 v[60:63], v[88:91], v[176:179], v[80:83]
    v_cvt_pk_bf16_f32 v170, v68, v69
    v_cvt_pk_bf16_f32 v171, v70, v71
    v_mfma_f32_16x16x32_bf16 v[64:67], v[90:93], v[180:183], v[84:87]
    v_cvt_pk_bf16_f32 v172, v48, v49
    v_cvt_pk_bf16_f32 v173, v50, v51
    v_mfma_f32_16x16x32_bf16 v[68:71], v[88:91], v[180:183], v[84:87]
    v_cvt_pk_bf16_f32 v174, v52, v53
    v_cvt_pk_bf16_f32 v175, v54, v55
    buffer_load_dwordx4 v21, s[8:11], s23 offen offset:1024  lds
    v_mfma_f32_16x16x32_bf16 v[48:51], v[90:93], v[184:187], v[80:83]
    v_cvt_pk_bf16_f32 v176, v56, v57
    v_cvt_pk_bf16_f32 v177, v58, v59
    v_mfma_f32_16x16x32_bf16 v[52:55], v[88:91], v[184:187], v[80:83]
    v_cvt_pk_bf16_f32 v178, v60, v61
    v_cvt_pk_bf16_f32 v179, v62, v63
    v_mfma_f32_16x16x32_bf16 v[56:59], v[90:93], v[188:191], v[84:87]
    v_cvt_pk_bf16_f32 v180, v64, v65
    v_cvt_pk_bf16_f32 v181, v66, v67
    v_mfma_f32_16x16x32_bf16 v[60:63], v[88:91], v[188:191], v[84:87]
    v_cvt_pk_bf16_f32 v182, v68, v69
    v_cvt_pk_bf16_f32 v183, v70, v71
    buffer_load_dwordx4 v22, s[8:11], s23 offen offset:2048  lds
    v_mfma_f32_16x16x32_bf16 v[64:67], v[90:93], v[192:195], v[80:83]
    v_cvt_pk_bf16_f32 v184, v48, v49
    v_cvt_pk_bf16_f32 v185, v50, v51
    v_mfma_f32_16x16x32_bf16 v[68:71], v[88:91], v[192:195], v[80:83]
    v_cvt_pk_bf16_f32 v186, v52, v53
    v_cvt_pk_bf16_f32 v187, v54, v55
    v_mfma_f32_16x16x32_bf16 v[48:51], v[90:93], v[196:199], v[84:87]
    v_cvt_pk_bf16_f32 v188, v56, v57
    v_cvt_pk_bf16_f32 v189, v58, v59
    v_mfma_f32_16x16x32_bf16 v[52:55], v[88:91], v[196:199], v[84:87]
    v_cvt_pk_bf16_f32 v190, v60, v61
    v_cvt_pk_bf16_f32 v191, v62, v63
    v_mfma_f32_16x16x32_bf16 v[56:59], v[90:93], v[200:203], v[80:83]
    v_cvt_pk_bf16_f32 v192, v64, v65
    v_cvt_pk_bf16_f32 v193, v66, v67
    v_mfma_f32_16x16x32_bf16 v[60:63], v[88:91], v[200:203], v[80:83]
    v_cvt_pk_bf16_f32 v194, v68, v69
    v_cvt_pk_bf16_f32 v195, v70, v71
    v_mfma_f32_16x16x32_bf16 v[64:67], v[90:93], v[204:207], v[84:87]
    v_cvt_pk_bf16_f32 v196, v48, v49
    v_cvt_pk_bf16_f32 v197, v50, v51
    v_mfma_f32_16x16x32_bf16 v[68:71], v[88:91], v[204:207], v[84:87]
    v_cvt_pk_bf16_f32 v198, v52, v53
    v_cvt_pk_bf16_f32 v199, v54, v55
    v_mfma_f32_16x16x32_bf16 v[48:51], v[90:93], v[208:211], v[80:83]
    v_cvt_pk_bf16_f32 v200, v56, v57
    v_cvt_pk_bf16_f32 v201, v58, v59
    v_mfma_f32_16x16x32_bf16 v[52:55], v[88:91], v[208:211], v[80:83]
    v_cvt_pk_bf16_f32 v202, v60, v61
    v_cvt_pk_bf16_f32 v203, v62, v63
    v_mfma_f32_16x16x32_bf16 v[56:59], v[90:93], v[212:215], v[84:87]
    v_cvt_pk_bf16_f32 v204, v64, v65
    v_cvt_pk_bf16_f32 v205, v66, v67
    v_mfma_f32_16x16x32_bf16 v[60:63], v[88:91], v[212:215], v[84:87]
    v_cvt_pk_bf16_f32 v206, v68, v69
    v_cvt_pk_bf16_f32 v207, v70, v71
    s_add_u32 m0, s38, 49152
    v_mfma_f32_16x16x32_bf16 v[64:67], v[90:93], v[216:219], v[80:83]
    v_cvt_pk_bf16_f32 v208, v48, v49
    v_cvt_pk_bf16_f32 v209, v50, v51
    v_mfma_f32_16x16x32_bf16 v[68:71], v[88:91], v[216:219], v[80:83]
    v_cvt_pk_bf16_f32 v210, v52, v53
    v_cvt_pk_bf16_f32 v211, v54, v55
    buffer_load_dwordx4 v20, s[8:11], s24 offen offset:0  lds
    v_mfma_f32_16x16x32_bf16 v[48:51], v[90:93], v[220:223], v[84:87]
    v_cvt_pk_bf16_f32 v212, v56, v57
    v_cvt_pk_bf16_f32 v213, v58, v59
    v_mfma_f32_16x16x32_bf16 v[52:55], v[88:91], v[220:223], v[84:87]
    v_cvt_pk_bf16_f32 v214, v60, v61
    v_cvt_pk_bf16_f32 v215, v62, v63
    v_mfma_f32_16x16x32_bf16 v[56:59], v[90:93], v[224:227], v[80:83]
    v_cvt_pk_bf16_f32 v216, v64, v65
    v_cvt_pk_bf16_f32 v217, v66, v67
    v_mfma_f32_16x16x32_bf16 v[60:63], v[88:91], v[224:227], v[80:83]
    v_cvt_pk_bf16_f32 v218, v68, v69
    v_cvt_pk_bf16_f32 v219, v70, v71
    buffer_load_dwordx4 v21, s[8:11], s24 offen offset:1024  lds
    v_mfma_f32_16x16x32_bf16 v[64:67], v[90:93], v[228:231], v[84:87]
    v_cvt_pk_bf16_f32 v220, v48, v49
    v_cvt_pk_bf16_f32 v221, v50, v51
    v_mfma_f32_16x16x32_bf16 v[68:71], v[88:91], v[228:231], v[84:87]
    v_cvt_pk_bf16_f32 v222, v52, v53
    v_cvt_pk_bf16_f32 v223, v54, v55
    v_mfma_f32_16x16x32_bf16 v[48:51], v[90:93], v[232:235], v[80:83]
    v_cvt_pk_bf16_f32 v224, v56, v57
    v_cvt_pk_bf16_f32 v225, v58, v59
    v_mfma_f32_16x16x32_bf16 v[52:55], v[88:91], v[232:235], v[80:83]
    v_cvt_pk_bf16_f32 v226, v60, v61
    v_cvt_pk_bf16_f32 v227, v62, v63
    buffer_load_dwordx4 v22, s[8:11], s24 offen offset:2048  lds
    v_mfma_f32_16x16x32_bf16 v[56:59], v[90:93], v[236:239], v[84:87]
    v_cvt_pk_bf16_f32 v228, v64, v65
    v_cvt_pk_bf16_f32 v229, v66, v67
    v_mfma_f32_16x16x32_bf16 v[60:63], v[88:91], v[236:239], v[84:87]
    v_cvt_pk_bf16_f32 v230, v68, v69
    v_cvt_pk_bf16_f32 v231, v70, v71
    v_mfma_f32_16x16x32_bf16 v[64:67], v[90:93], v[240:243], v[80:83]
    v_cvt_pk_bf16_f32 v232, v48, v49
    v_cvt_pk_bf16_f32 v233, v50, v51
    v_mfma_f32_16x16x32_bf16 v[68:71], v[88:91], v[240:243], v[80:83]
    v_cvt_pk_bf16_f32 v234, v52, v53
    v_cvt_pk_bf16_f32 v235, v54, v55
    v_mfma_f32_16x16x32_bf16 v[48:51], v[90:93], v[244:247], v[84:87]
    v_cvt_pk_bf16_f32 v236, v56, v57
    v_cvt_pk_bf16_f32 v237, v58, v59
    v_mfma_f32_16x16x32_bf16 v[52:55], v[88:91], v[244:247], v[84:87]
    v_cvt_pk_bf16_f32 v238, v60, v61
    v_cvt_pk_bf16_f32 v239, v62, v63
    v_mfma_f32_16x16x32_bf16 v[56:59], v[90:93], v[248:251], v[80:83]
    v_cvt_pk_bf16_f32 v240, v64, v65
    v_cvt_pk_bf16_f32 v241, v66, v67
    v_mfma_f32_16x16x32_bf16 v[60:63], v[88:91], v[248:251], v[80:83]
    v_cvt_pk_bf16_f32 v242, v68, v69
    v_cvt_pk_bf16_f32 v243, v70, v71
    v_mfma_f32_16x16x32_bf16 v[64:67], v[90:93], v[252:255], v[84:87]
    v_cvt_pk_bf16_f32 v244, v48, v49
    v_cvt_pk_bf16_f32 v245, v50, v51
    v_mfma_f32_16x16x32_bf16 v[68:71], v[88:91], v[252:255], v[84:87]
    v_cvt_pk_bf16_f32 v246, v52, v53
    v_cvt_pk_bf16_f32 v247, v54, v55
    s_nop 3
    v_cvt_pk_bf16_f32 v248, v56, v57
    v_cvt_pk_bf16_f32 v249, v58, v59
    v_cvt_pk_bf16_f32 v250, v60, v61
    v_cvt_pk_bf16_f32 v251, v62, v63
    v_cvt_pk_bf16_f32 v252, v64, v65
    v_cvt_pk_bf16_f32 v253, v66, v67
    v_cvt_pk_bf16_f32 v254, v68, v69
    v_cvt_pk_bf16_f32 v255, v70, v71
    s_waitcnt vmcnt(9)
    s_barrier
    ds_read_b64_tr_b16 v[48:49], v23 offset:0
    ds_read_b64_tr_b16 v[50:51], v23 offset:768
    ds_read_b64_tr_b16 v[52:53], v23 offset:6144
    ds_read_b64_tr_b16 v[54:55], v23 offset:6912
    ds_read_b64_tr_b16 v[56:57], v24 offset:32
    ds_read_b64_tr_b16 v[58:59], v24 offset:800
    ds_read_b64_tr_b16 v[60:61], v24 offset:6176
    ds_read_b64_tr_b16 v[62:63], v24 offset:6944
    ds_read_b64_tr_b16 v[64:65], v23 offset:64
    ds_read_b64_tr_b16 v[66:67], v23 offset:832
    ds_read_b64_tr_b16 v[68:69], v23 offset:6208
    ds_read_b64_tr_b16 v[70:71], v23 offset:6976
    s_waitcnt lgkmcnt(8)
    v_mfma_f32_16x16x32_bf16 a[0:3], v[48:51], v[112:115], 0
    ds_read_b64_tr_b16 v[72:73], v24 offset:96
    v_mfma_f32_16x16x32_bf16 a[4:7], v[48:51], v[116:119], 0
    ds_read_b64_tr_b16 v[74:75], v24 offset:864
    v_mfma_f32_16x16x32_bf16 a[8:11], v[52:55], v[112:115], 0
    ds_read_b64_tr_b16 v[76:77], v24 offset:6240
    v_add_u32 v104, s57, v36
    v_mfma_f32_16x16x32_bf16 a[12:15], v[52:55], v[116:119], 0
    ds_read_b64_tr_b16 v[78:79], v24 offset:7008
    s_waitcnt lgkmcnt(8)
    v_mfma_f32_16x16x32_bf16 a[16:19], v[56:59], v[112:115], 0
    ds_read_b64_tr_b16 v[48:49], v23 offset:128
    v_cvt_f32_i32 v104, v104
    v_mfma_f32_16x16x32_bf16 a[20:23], v[56:59], v[116:119], 0
    ds_read_b64_tr_b16 v[50:51], v23 offset:896
    v_fma_f32 v104, v104, v109, v110
    v_mfma_f32_16x16x32_bf16 a[24:27], v[60:63], v[112:115], 0
    ds_read_b64_tr_b16 v[52:53], v23 offset:6272
    v_add_f32 v105, v104, v109
    v_mfma_f32_16x16x32_bf16 a[28:31], v[60:63], v[116:119], 0
    ds_read_b64_tr_b16 v[54:55], v23 offset:7040
    s_waitcnt lgkmcnt(8)
    v_mfma_f32_16x16x32_bf16 a[32:35], v[64:67], v[112:115], 0
    ds_read_b64_tr_b16 v[56:57], v24 offset:160
    s_waitcnt vmcnt(6)
    v_mfma_f32_16x16x32_bf16 a[36:39], v[64:67], v[116:119], 0
    ds_read_b64_tr_b16 v[58:59], v24 offset:928
    v_mov_b32 v108, 0x42000000
    v_mfma_f32_16x16x32_bf16 a[40:43], v[68:71], v[112:115], 0
    ds_read_b64_tr_b16 v[60:61], v24 offset:6304
    s_barrier
    v_mfma_f32_16x16x32_bf16 a[44:47], v[68:71], v[116:119], 0
    ds_read_b64_tr_b16 v[62:63], v24 offset:7072
    s_waitcnt lgkmcnt(8)
    v_mfma_f32_16x16x32_bf16 a[48:51], v[72:75], v[112:115], 0
    ds_read_b64_tr_b16 v[64:65], v23 offset:12288
    s_add_u32 m0, s38, 61440
    v_mfma_f32_16x16x32_bf16 a[52:55], v[72:75], v[116:119], 0
    ds_read_b64_tr_b16 v[66:67], v23 offset:13056
    buffer_load_dwordx4 v20, s[8:11], s25 offen offset:0  lds
    v_mfma_f32_16x16x32_bf16 a[56:59], v[76:79], v[112:115], 0
    ds_read_b64_tr_b16 v[68:69], v23 offset:18432
    v_mul_f32 v108, v108, v109
    v_mfma_f32_16x16x32_bf16 a[60:63], v[76:79], v[116:119], 0
    ds_read_b64_tr_b16 v[70:71], v23 offset:19200
    s_waitcnt lgkmcnt(8)
    v_mfma_f32_16x16x32_bf16 a[64:67], v[48:51], v[112:115], 0
    ds_read_b64_tr_b16 v[72:73], v24 offset:12320
    buffer_load_dwordx4 v21, s[8:11], s25 offen offset:1024  lds
    v_mfma_f32_16x16x32_bf16 a[68:71], v[48:51], v[116:119], 0
    ds_read_b64_tr_b16 v[74:75], v24 offset:13088
    v_add_f32 v106, v104, v108
    v_mfma_f32_16x16x32_bf16 a[72:75], v[52:55], v[112:115], 0
    ds_read_b64_tr_b16 v[76:77], v24 offset:18464
    v_add_f32 v107, v106, v109
    v_mfma_f32_16x16x32_bf16 a[76:79], v[52:55], v[116:119], 0
    ds_read_b64_tr_b16 v[78:79], v24 offset:19232
    s_waitcnt lgkmcnt(8)
    v_mfma_f32_16x16x32_bf16 a[80:83], v[56:59], v[112:115], 0
    ds_read_b64_tr_b16 v[48:49], v23 offset:12352
    buffer_load_dwordx4 v22, s[8:11], s25 offen offset:2048  lds
    v_mfma_f32_16x16x32_bf16 a[84:87], v[56:59], v[116:119], 0
    ds_read_b64_tr_b16 v[50:51], v23 offset:13120
    v_cos_f32 v101, v109
    v_mfma_f32_16x16x32_bf16 a[88:91], v[60:63], v[112:115], 0
    ds_read_b64_tr_b16 v[52:53], v23 offset:18496
    v_cos_f32 v102, v108
    v_mfma_f32_16x16x32_bf16 a[92:95], v[60:63], v[116:119], 0
    ds_read_b64_tr_b16 v[54:55], v23 offset:19264
    s_waitcnt lgkmcnt(8)
    v_mfma_f32_16x16x32_bf16 a[0:3], v[64:67], v[120:123], a[0:3]
    ds_read_b64_tr_b16 v[56:57], v24 offset:12384
    s_add_u32 m0, s38, 73728
    v_mfma_f32_16x16x32_bf16 a[4:7], v[64:67], v[124:127], a[4:7]
    ds_read_b64_tr_b16 v[58:59], v24 offset:13152
    buffer_load_dwordx4 v20, s[8:11], s26 offen offset:0  lds
    v_mfma_f32_16x16x32_bf16 a[8:11], v[68:71], v[120:123], a[8:11]
    ds_read_b64_tr_b16 v[60:61], v24 offset:18528
    v_cos_f32 v80, v104
    v_mfma_f32_16x16x32_bf16 a[12:15], v[68:71], v[124:127], a[12:15]
    ds_read_b64_tr_b16 v[62:63], v24 offset:19296
    s_waitcnt lgkmcnt(8)
    v_mfma_f32_16x16x32_bf16 a[16:19], v[72:75], v[120:123], a[16:19]
    ds_read_b64_tr_b16 v[64:65], v23 offset:12416
    buffer_load_dwordx4 v21, s[8:11], s26 offen offset:1024  lds
    v_mfma_f32_16x16x32_bf16 a[20:23], v[72:75], v[124:127], a[20:23]
    ds_read_b64_tr_b16 v[66:67], v23 offset:13184
    v_cos_f32 v81, v105
    v_mfma_f32_16x16x32_bf16 a[24:27], v[76:79], v[120:123], a[24:27]
    ds_read_b64_tr_b16 v[68:69], v23 offset:18560
    v_cos_f32 v88, v106
    v_mfma_f32_16x16x32_bf16 a[28:31], v[76:79], v[124:127], a[28:31]
    ds_read_b64_tr_b16 v[70:71], v23 offset:19328
    s_waitcnt lgkmcnt(8)
    v_mfma_f32_16x16x32_bf16 a[32:35], v[48:51], v[120:123], a[32:35]
    ds_read_b64_tr_b16 v[72:73], v24 offset:12448
    buffer_load_dwordx4 v22, s[8:11], s26 offen offset:2048  lds
    v_mfma_f32_16x16x32_bf16 a[36:39], v[48:51], v[124:127], a[36:39]
    ds_read_b64_tr_b16 v[74:75], v24 offset:13216
    v_cos_f32 v89, v107
    v_mfma_f32_16x16x32_bf16 a[40:43], v[52:55], v[120:123], a[40:43]
    ds_read_b64_tr_b16 v[76:77], v24 offset:18592
    v_add_u32 v100, s58, v29
    v_mfma_f32_16x16x32_bf16 a[44:47], v[52:55], v[124:127], a[44:47]
    ds_read_b64_tr_b16 v[78:79], v24 offset:19360
    s_waitcnt lgkmcnt(8)
    v_mfma_f32_16x16x32_bf16 a[48:51], v[56:59], v[120:123], a[48:51]
    ds_read_b64_tr_b16 v[48:49], v23 offset:24576
    v_add_f32 v101, v101, v101
    v_mfma_f32_16x16x32_bf16 a[52:55], v[56:59], v[124:127], a[52:55]
    ds_read_b64_tr_b16 v[50:51], v23 offset:25344
    v_add_f32 v102, v102, v102
    v_mfma_f32_16x16x32_bf16 a[56:59], v[60:63], v[120:123], a[56:59]
    ds_read_b64_tr_b16 v[52:53], v23 offset:30720
    v_fma_f32 v82, v101, v81, -v80
    v_mfma_f32_16x16x32_bf16 a[60:63], v[60:63], v[124:127], a[60:63]
    ds_read_b64_tr_b16 v[54:55], v23 offset:31488
    s_waitcnt lgkmcnt(8)
    v_mfma_f32_16x16x32_bf16 a[64:67], v[64:67], v[120:123], a[64:67]
    ds_read_b64_tr_b16 v[56:57], v24 offset:24608
    v_fma_f32 v83, v101, v82, -v81
    v_mfma_f32_16x16x32_bf16 a[68:71], v[64:67], v[124:127], a[68:71]
    ds_read_b64_tr_b16 v[58:59], v24 offset:25376
    v_fma_f32 v84, v101, v83, -v82
    v_mfma_f32_16x16x32_bf16 a[72:75], v[68:71], v[120:123], a[72:75]
    ds_read_b64_tr_b16 v[60:61], v24 offset:30752
    v_fma_f32 v85, v101, v84, -v83
    v_mfma_f32_16x16x32_bf16 a[76:79], v[68:71], v[124:127], a[76:79]
    ds_read_b64_tr_b16 v[62:63], v24 offset:31520
    s_waitcnt lgkmcnt(8)
    v_mfma_f32_16x16x32_bf16 a[80:83], v[72:75], v[120:123], a[80:83]
    ds_read_b64_tr_b16 v[64:65], v23 offset:24640
    v_fma_f32 v86, v101, v85, -v84
    v_mfma_f32_16x16x32_bf16 a[84:87], v[72:75], v[124:127], a[84:87]
    ds_read_b64_tr_b16 v[66:67], v23 offset:25408
    v_fma_f32 v87, v101, v86, -v85
    v_mfma_f32_16x16x32_bf16 a[88:91], v[76:79], v[120:123], a[88:91]
    ds_read_b64_tr_b16 v[68:69], v23 offset:30784
    v_fma_f32 v90, v101, v89, -v88
    v_mfma_f32_16x16x32_bf16 a[92:95], v[76:79], v[124:127], a[92:95]
    ds_read_b64_tr_b16 v[70:71], v23 offset:31552
    s_waitcnt lgkmcnt(8)
    v_mfma_f32_16x16x32_bf16 a[0:3], v[48:51], v[128:131], a[0:3]
    ds_read_b64_tr_b16 v[72:73], v24 offset:24672
    v_fma_f32 v91, v101, v90, -v89
    v_mfma_f32_16x16x32_bf16 a[4:7], v[48:51], v[132:135], a[4:7]
    ds_read_b64_tr_b16 v[74:75], v24 offset:25440
    v_fma_f32 v92, v101, v91, -v90
    v_mfma_f32_16x16x32_bf16 a[8:11], v[52:55], v[128:131], a[8:11]
    ds_read_b64_tr_b16 v[76:77], v24 offset:30816
    v_fma_f32 v93, v101, v92, -v91
    v_mfma_f32_16x16x32_bf16 a[12:15], v[52:55], v[132:135], a[12:15]
    ds_read_b64_tr_b16 v[78:79], v24 offset:31584
    s_waitcnt lgkmcnt(8)
    v_mfma_f32_16x16x32_bf16 a[16:19], v[56:59], v[128:131], a[16:19]
    ds_read_b64_tr_b16 v[48:49], v23 offset:24704
    v_fma_f32 v94, v101, v93, -v92
    v_mfma_f32_16x16x32_bf16 a[20:23], v[56:59], v[132:135], a[20:23]
    ds_read_b64_tr_b16 v[50:51], v23 offset:25472
    v_fma_f32 v95, v101, v94, -v93
    v_mfma_f32_16x16x32_bf16 a[24:27], v[60:63], v[128:131], a[24:27]
    ds_read_b64_tr_b16 v[52:53], v23 offset:30848
    v_cvt_pk_bf16_f32 v96, v80, v81
    v_mfma_f32_16x16x32_bf16 a[28:31], v[60:63], v[132:135], a[28:31]
    ds_read_b64_tr_b16 v[54:55], v23 offset:31616
    s_waitcnt lgkmcnt(8)
    v_mfma_f32_16x16x32_bf16 a[32:35], v[64:67], v[128:131], a[32:35]
    ds_read_b64_tr_b16 v[56:57], v24 offset:24736
    s_waitcnt vmcnt(6)
    v_mfma_f32_16x16x32_bf16 a[36:39], v[64:67], v[132:135], a[36:39]
    ds_read_b64_tr_b16 v[58:59], v24 offset:25504
    v_cvt_pk_bf16_f32 v97, v82, v83
    v_mfma_f32_16x16x32_bf16 a[40:43], v[68:71], v[128:131], a[40:43]
    ds_read_b64_tr_b16 v[60:61], v24 offset:30880
    s_barrier
    v_mfma_f32_16x16x32_bf16 a[44:47], v[68:71], v[132:135], a[44:47]
    ds_read_b64_tr_b16 v[62:63], v24 offset:31648
    s_waitcnt lgkmcnt(8)
    v_mfma_f32_16x16x32_bf16 a[48:51], v[72:75], v[128:131], a[48:51]
    ds_read_b64_tr_b16 v[64:65], v23 offset:36864
    s_add_u32 m0, s38, 0
    v_mfma_f32_16x16x32_bf16 a[52:55], v[72:75], v[132:135], a[52:55]
    ds_read_b64_tr_b16 v[66:67], v23 offset:37632
    buffer_load_dwordx4 v20, s[8:11], s27 offen offset:0  lds
    v_mfma_f32_16x16x32_bf16 a[56:59], v[76:79], v[128:131], a[56:59]
    ds_read_b64_tr_b16 v[68:69], v23 offset:43008
    v_cvt_pk_bf16_f32 v98, v84, v85
    v_mfma_f32_16x16x32_bf16 a[60:63], v[76:79], v[132:135], a[60:63]
    ds_read_b64_tr_b16 v[70:71], v23 offset:43776
    s_waitcnt lgkmcnt(8)
    v_mfma_f32_16x16x32_bf16 a[64:67], v[48:51], v[128:131], a[64:67]
    ds_read_b64_tr_b16 v[72:73], v24 offset:36896
    buffer_load_dwordx4 v21, s[8:11], s27 offen offset:1024  lds
    v_mfma_f32_16x16x32_bf16 a[68:71], v[48:51], v[132:135], a[68:71]
    ds_read_b64_tr_b16 v[74:75], v24 offset:37664
    v_cvt_pk_bf16_f32 v99, v86, v87
    v_mfma_f32_16x16x32_bf16 a[72:75], v[52:55], v[128:131], a[72:75]
    ds_read_b64_tr_b16 v[76:77], v24 offset:43040
    ds_write_b128 v100, v[96:99] offset:0
    v_mfma_f32_16x16x32_bf16 a[76:79], v[52:55], v[132:135], a[76:79]
    ds_read_b64_tr_b16 v[78:79], v24 offset:43808
    s_waitcnt lgkmcnt(9)
    v_mfma_f32_16x16x32_bf16 a[80:83], v[56:59], v[128:131], a[80:83]
    ds_read_b64_tr_b16 v[48:49], v23 offset:36928
    buffer_load_dwordx4 v22, s[8:11], s27 offen offset:2048  lds
    v_mfma_f32_16x16x32_bf16 a[84:87], v[56:59], v[132:135], a[84:87]
    ds_read_b64_tr_b16 v[50:51], v23 offset:37696
    v_cvt_pk_bf16_f32 v96, v88, v89
    v_mfma_f32_16x16x32_bf16 a[88:91], v[60:63], v[128:131], a[88:91]
    ds_read_b64_tr_b16 v[52:53], v23 offset:43072
    v_cvt_pk_bf16_f32 v97, v90, v91
    v_mfma_f32_16x16x32_bf16 a[92:95], v[60:63], v[132:135], a[92:95]
    ds_read_b64_tr_b16 v[54:55], v23 offset:43840
    s_waitcnt lgkmcnt(9)
    v_mfma_f32_16x16x32_bf16 a[0:3], v[64:67], v[136:139], a[0:3]
    ds_read_b64_tr_b16 v[56:57], v24 offset:36960
    s_add_u32 m0, s38, 12288
    v_mfma_f32_16x16x32_bf16 a[4:7], v[64:67], v[140:143], a[4:7]
    ds_read_b64_tr_b16 v[58:59], v24 offset:37728
    buffer_load_dwordx4 v20, s[8:11], s28 offen offset:0  lds
    v_mfma_f32_16x16x32_bf16 a[8:11], v[68:71], v[136:139], a[8:11]
    ds_read_b64_tr_b16 v[60:61], v24 offset:43104
    v_cvt_pk_bf16_f32 v98, v92, v93
    v_mfma_f32_16x16x32_bf16 a[12:15], v[68:71], v[140:143], a[12:15]
    ds_read_b64_tr_b16 v[62:63], v24 offset:43872
    s_waitcnt lgkmcnt(8)
    v_mfma_f32_16x16x32_bf16 a[16:19], v[72:75], v[136:139], a[16:19]
    ds_read_b64_tr_b16 v[64:65], v23 offset:36992
    buffer_load_dwordx4 v21, s[8:11], s28 offen offset:1024  lds
    v_mfma_f32_16x16x32_bf16 a[20:23], v[72:75], v[140:143], a[20:23]
    ds_read_b64_tr_b16 v[66:67], v23 offset:37760
    v_cvt_pk_bf16_f32 v99, v94, v95
    v_mfma_f32_16x16x32_bf16 a[24:27], v[76:79], v[136:139], a[24:27]
    ds_read_b64_tr_b16 v[68:69], v23 offset:43136
    ds_write_b128 v100, v[96:99] offset:2048
    v_mfma_f32_16x16x32_bf16 a[28:31], v[76:79], v[140:143], a[28:31]
    ds_read_b64_tr_b16 v[70:71], v23 offset:43904
    s_waitcnt lgkmcnt(9)
    v_mfma_f32_16x16x32_bf16 a[32:35], v[48:51], v[136:139], a[32:35]
    ds_read_b64_tr_b16 v[72:73], v24 offset:37024
    buffer_load_dwordx4 v22, s[8:11], s28 offen offset:2048  lds
    v_mfma_f32_16x16x32_bf16 a[36:39], v[48:51], v[140:143], a[36:39]
    ds_read_b64_tr_b16 v[74:75], v24 offset:37792
    v_fma_f32 v80, v102, v88, -v80
    v_mfma_f32_16x16x32_bf16 a[40:43], v[52:55], v[136:139], a[40:43]
    ds_read_b64_tr_b16 v[76:77], v24 offset:43168
    v_fma_f32 v81, v102, v89, -v81
    v_mfma_f32_16x16x32_bf16 a[44:47], v[52:55], v[140:143], a[44:47]
    ds_read_b64_tr_b16 v[78:79], v24 offset:43936
    s_waitcnt lgkmcnt(9)
    v_mfma_f32_16x16x32_bf16 a[48:51], v[56:59], v[136:139], a[48:51]
    ds_read_b64_tr_b16 v[48:49], v23 offset:49152
    v_fma_f32 v82, v102, v90, -v82
    v_mfma_f32_16x16x32_bf16 a[52:55], v[56:59], v[140:143], a[52:55]
    ds_read_b64_tr_b16 v[50:51], v23 offset:49920
    v_fma_f32 v83, v102, v91, -v83
    v_mfma_f32_16x16x32_bf16 a[56:59], v[60:63], v[136:139], a[56:59]
    ds_read_b64_tr_b16 v[52:53], v23 offset:55296
    v_fma_f32 v84, v102, v92, -v84
    v_mfma_f32_16x16x32_bf16 a[60:63], v[60:63], v[140:143], a[60:63]
    ds_read_b64_tr_b16 v[54:55], v23 offset:56064
    s_waitcnt lgkmcnt(8)
    v_mfma_f32_16x16x32_bf16 a[64:67], v[64:67], v[136:139], a[64:67]
    ds_read_b64_tr_b16 v[56:57], v24 offset:49184
    v_fma_f32 v85, v102, v93, -v85
    v_mfma_f32_16x16x32_bf16 a[68:71], v[64:67], v[140:143], a[68:71]
    ds_read_b64_tr_b16 v[58:59], v24 offset:49952
    v_fma_f32 v86, v102, v94, -v86
    v_mfma_f32_16x16x32_bf16 a[72:75], v[68:71], v[136:139], a[72:75]
    ds_read_b64_tr_b16 v[60:61], v24 offset:55328
    v_fma_f32 v87, v102, v95, -v87
    v_mfma_f32_16x16x32_bf16 a[76:79], v[68:71], v[140:143], a[76:79]
    ds_read_b64_tr_b16 v[62:63], v24 offset:56096
    s_waitcnt lgkmcnt(8)
    v_mfma_f32_16x16x32_bf16 a[80:83], v[72:75], v[136:139], a[80:83]
    ds_read_b64_tr_b16 v[64:65], v23 offset:49216
    v_cvt_pk_bf16_f32 v96, v80, v81
    v_mfma_f32_16x16x32_bf16 a[84:87], v[72:75], v[140:143], a[84:87]
    ds_read_b64_tr_b16 v[66:67], v23 offset:49984
    v_cvt_pk_bf16_f32 v97, v82, v83
    v_mfma_f32_16x16x32_bf16 a[88:91], v[76:79], v[136:139], a[88:91]
    ds_read_b64_tr_b16 v[68:69], v23 offset:55360
    v_cvt_pk_bf16_f32 v98, v84, v85
    v_mfma_f32_16x16x32_bf16 a[92:95], v[76:79], v[140:143], a[92:95]
    ds_read_b64_tr_b16 v[70:71], v23 offset:56128
    s_waitcnt lgkmcnt(8)
    v_mfma_f32_16x16x32_bf16 a[0:3], v[48:51], v[144:147], a[0:3]
    ds_read_b64_tr_b16 v[72:73], v24 offset:49248
    v_cvt_pk_bf16_f32 v99, v86, v87
    v_mfma_f32_16x16x32_bf16 a[4:7], v[48:51], v[148:151], a[4:7]
    ds_read_b64_tr_b16 v[74:75], v24 offset:50016
    ds_write_b128 v100, v[96:99] offset:4096
    v_mfma_f32_16x16x32_bf16 a[8:11], v[52:55], v[144:147], a[8:11]
    ds_read_b64_tr_b16 v[76:77], v24 offset:55392
    v_fma_f32 v88, v102, v80, -v88
    v_mfma_f32_16x16x32_bf16 a[12:15], v[52:55], v[148:151], a[12:15]
    ds_read_b64_tr_b16 v[78:79], v24 offset:56160
    s_waitcnt lgkmcnt(9)
    v_mfma_f32_16x16x32_bf16 a[16:19], v[56:59], v[144:147], a[16:19]
    ds_read_b64_tr_b16 v[48:49], v23 offset:49280
    v_fma_f32 v89, v102, v81, -v89
    v_mfma_f32_16x16x32_bf16 a[20:23], v[56:59], v[148:151], a[20:23]
    ds_read_b64_tr_b16 v[50:51], v23 offset:50048
    v_fma_f32 v90, v102, v82, -v90
    v_mfma_f32_16x16x32_bf16 a[24:27], v[60:63], v[144:147], a[24:27]
    ds_read_b64_tr_b16 v[52:53], v23 offset:55424
    v_fma_f32 v91, v102, v83, -v91
    v_mfma_f32_16x16x32_bf16 a[28:31], v[60:63], v[148:151], a[28:31]
    ds_read_b64_tr_b16 v[54:55], v23 offset:56192
    s_waitcnt lgkmcnt(9)
    v_mfma_f32_16x16x32_bf16 a[32:35], v[64:67], v[144:147], a[32:35]
    ds_read_b64_tr_b16 v[56:57], v24 offset:49312
    s_waitcnt vmcnt(6)
    v_mfma_f32_16x16x32_bf16 a[36:39], v[64:67], v[148:151], a[36:39]
    ds_read_b64_tr_b16 v[58:59], v24 offset:50080
    v_fma_f32 v92, v102, v84, -v92
    v_mfma_f32_16x16x32_bf16 a[40:43], v[68:71], v[144:147], a[40:43]
    ds_read_b64_tr_b16 v[60:61], v24 offset:55456
    s_barrier
    v_mfma_f32_16x16x32_bf16 a[44:47], v[68:71], v[148:151], a[44:47]
    ds_read_b64_tr_b16 v[62:63], v24 offset:56224
    s_waitcnt lgkmcnt(8)
    v_mfma_f32_16x16x32_bf16 a[48:51], v[72:75], v[144:147], a[48:51]
    ds_read_b64_tr_b16 v[64:65], v25 offset:0
    s_add_u32 m0, s38, 24576
    v_mfma_f32_16x16x32_bf16 a[52:55], v[72:75], v[148:151], a[52:55]
    ds_read_b64_tr_b16 v[66:67], v25 offset:768
    buffer_load_dwordx4 v20, s[8:11], s29 offen offset:0  lds
    v_mfma_f32_16x16x32_bf16 a[56:59], v[76:79], v[144:147], a[56:59]
    ds_read_b64_tr_b16 v[68:69], v25 offset:6144
    v_fma_f32 v93, v102, v85, -v93
    v_mfma_f32_16x16x32_bf16 a[60:63], v[76:79], v[148:151], a[60:63]
    ds_read_b64_tr_b16 v[70:71], v25 offset:6912
    s_waitcnt lgkmcnt(8)
    v_mfma_f32_16x16x32_bf16 a[64:67], v[48:51], v[144:147], a[64:67]
    ds_read_b64_tr_b16 v[72:73], v26 offset:32
    buffer_load_dwordx4 v21, s[8:11], s29 offen offset:1024  lds
    v_mfma_f32_16x16x32_bf16 a[68:71], v[48:51], v[148:151], a[68:71]
    ds_read_b64_tr_b16 v[74:75], v26 offset:800
    v_fma_f32 v94, v102, v86, -v94
    v_mfma_f32_16x16x32_bf16 a[72:75], v[52:55], v[144:147], a[72:75]
    ds_read_b64_tr_b16 v[76:77], v26 offset:6176
    v_fma_f32 v95, v102, v87, -v95
    v_mfma_f32_16x16x32_bf16 a[76:79], v[52:55], v[148:151], a[76:79]
    ds_read_b64_tr_b16 v[78:79], v26 offset:6944
    s_waitcnt lgkmcnt(8)
    v_mfma_f32_16x16x32_bf16 a[80:83], v[56:59], v[144:147], a[80:83]
    ds_read_b64_tr_b16 v[48:49], v25 offset:64
    buffer_load_dwordx4 v22, s[8:11], s29 offen offset:2048  lds
    v_mfma_f32_16x16x32_bf16 a[84:87], v[56:59], v[148:151], a[84:87]
    ds_read_b64_tr_b16 v[50:51], v25 offset:832
    v_cvt_pk_bf16_f32 v96, v88, v89
    v_mfma_f32_16x16x32_bf16 a[88:91], v[60:63], v[144:147], a[88:91]
    ds_read_b64_tr_b16 v[52:53], v25 offset:6208
    v_cvt_pk_bf16_f32 v97, v90, v91
    v_mfma_f32_16x16x32_bf16 a[92:95], v[60:63], v[148:151], a[92:95]
    ds_read_b64_tr_b16 v[54:55], v25 offset:6976
    s_waitcnt lgkmcnt(8)
    v_mfma_f32_16x16x32_bf16 a[0:3], v[64:67], v[152:155], a[0:3]
    ds_read_b64_tr_b16 v[56:57], v26 offset:96
    s_add_u32 m0, s38, 36864
    v_mfma_f32_16x16x32_bf16 a[4:7], v[64:67], v[156:159], a[4:7]
    ds_read_b64_tr_b16 v[58:59], v26 offset:864
    buffer_load_dwordx4 v20, s[8:11], s30 offen offset:0  lds
    v_mfma_f32_16x16x32_bf16 a[8:11], v[68:71], v[152:155], a[8:11]
    ds_read_b64_tr_b16 v[60:61], v26 offset:6240
    v_cvt_pk_bf16_f32 v98, v92, v93
    v_mfma_f32_16x16x32_bf16 a[12:15], v[68:71], v[156:159], a[12:15]
    ds_read_b64_tr_b16 v[62:63], v26 offset:7008
    s_waitcnt lgkmcnt(8)
    v_mfma_f32_16x16x32_bf16 a[16:19], v[72:75], v[152:155], a[16:19]
    ds_read_b64_tr_b16 v[64:65], v25 offset:128
    buffer_load_dwordx4 v21, s[8:11], s30 offen offset:1024  lds
    v_mfma_f32_16x16x32_bf16 a[20:23], v[72:75], v[156:159], a[20:23]
    ds_read_b64_tr_b16 v[66:67], v25 offset:896
    v_cvt_pk_bf16_f32 v99, v94, v95
    v_mfma_f32_16x16x32_bf16 a[24:27], v[76:79], v[152:155], a[24:27]
    ds_read_b64_tr_b16 v[68:69], v25 offset:6272
    ds_write_b128 v100, v[96:99] offset:6144
    v_mfma_f32_16x16x32_bf16 a[28:31], v[76:79], v[156:159], a[28:31]
    ds_read_b64_tr_b16 v[70:71], v25 offset:7040
    s_waitcnt lgkmcnt(9)
    v_mfma_f32_16x16x32_bf16 a[32:35], v[48:51], v[152:155], a[32:35]
    ds_read_b64_tr_b16 v[72:73], v26 offset:160
    buffer_load_dwordx4 v22, s[8:11], s30 offen offset:2048  lds
    v_mfma_f32_16x16x32_bf16 a[36:39], v[48:51], v[156:159], a[36:39]
    ds_read_b64_tr_b16 v[74:75], v26 offset:928
    v_fma_f32 v80, v102, v88, -v80
    v_mfma_f32_16x16x32_bf16 a[40:43], v[52:55], v[152:155], a[40:43]
    ds_read_b64_tr_b16 v[76:77], v26 offset:6304
    v_fma_f32 v81, v102, v89, -v81
    v_mfma_f32_16x16x32_bf16 a[44:47], v[52:55], v[156:159], a[44:47]
    ds_read_b64_tr_b16 v[78:79], v26 offset:7072
    s_waitcnt lgkmcnt(9)
    v_mfma_f32_16x16x32_bf16 a[48:51], v[56:59], v[152:155], a[48:51]
    ds_read_b64_tr_b16 v[48:49], v25 offset:12288
    v_fma_f32 v82, v102, v90, -v82
    v_mfma_f32_16x16x32_bf16 a[52:55], v[56:59], v[156:159], a[52:55]
    ds_read_b64_tr_b16 v[50:51], v25 offset:13056
    v_fma_f32 v83, v102, v91, -v83
    v_mfma_f32_16x16x32_bf16 a[56:59], v[60:63], v[152:155], a[56:59]
    ds_read_b64_tr_b16 v[52:53], v25 offset:18432
    v_fma_f32 v84, v102, v92, -v84
    v_mfma_f32_16x16x32_bf16 a[60:63], v[60:63], v[156:159], a[60:63]
    ds_read_b64_tr_b16 v[54:55], v25 offset:19200
    s_waitcnt lgkmcnt(8)
    v_mfma_f32_16x16x32_bf16 a[64:67], v[64:67], v[152:155], a[64:67]
    ds_read_b64_tr_b16 v[56:57], v26 offset:12320
    v_fma_f32 v85, v102, v93, -v85
    v_mfma_f32_16x16x32_bf16 a[68:71], v[64:67], v[156:159], a[68:71]
    ds_read_b64_tr_b16 v[58:59], v26 offset:13088
    v_fma_f32 v86, v102, v94, -v86
    v_mfma_f32_16x16x32_bf16 a[72:75], v[68:71], v[152:155], a[72:75]
    ds_read_b64_tr_b16 v[60:61], v26 offset:18464
    v_fma_f32 v87, v102, v95, -v87
    v_mfma_f32_16x16x32_bf16 a[76:79], v[68:71], v[156:159], a[76:79]
    ds_read_b64_tr_b16 v[62:63], v26 offset:19232
    s_waitcnt lgkmcnt(8)
    v_mfma_f32_16x16x32_bf16 a[80:83], v[72:75], v[152:155], a[80:83]
    ds_read_b64_tr_b16 v[64:65], v25 offset:12352
    v_cvt_pk_bf16_f32 v96, v80, v81
    v_mfma_f32_16x16x32_bf16 a[84:87], v[72:75], v[156:159], a[84:87]
    ds_read_b64_tr_b16 v[66:67], v25 offset:13120
    v_cvt_pk_bf16_f32 v97, v82, v83
    v_mfma_f32_16x16x32_bf16 a[88:91], v[76:79], v[152:155], a[88:91]
    ds_read_b64_tr_b16 v[68:69], v25 offset:18496
    v_cvt_pk_bf16_f32 v98, v84, v85
    v_mfma_f32_16x16x32_bf16 a[92:95], v[76:79], v[156:159], a[92:95]
    ds_read_b64_tr_b16 v[70:71], v25 offset:19264
    s_waitcnt lgkmcnt(8)
    v_mfma_f32_16x16x32_bf16 a[0:3], v[48:51], v[160:163], a[0:3]
    ds_read_b64_tr_b16 v[72:73], v26 offset:12384
    v_cvt_pk_bf16_f32 v99, v86, v87
    v_mfma_f32_16x16x32_bf16 a[4:7], v[48:51], v[164:167], a[4:7]
    ds_read_b64_tr_b16 v[74:75], v26 offset:13152
    ds_write_b128 v100, v[96:99] offset:8192
    v_mfma_f32_16x16x32_bf16 a[8:11], v[52:55], v[160:163], a[8:11]
    ds_read_b64_tr_b16 v[76:77], v26 offset:18528
    v_fma_f32 v88, v102, v80, -v88
    v_mfma_f32_16x16x32_bf16 a[12:15], v[52:55], v[164:167], a[12:15]
    ds_read_b64_tr_b16 v[78:79], v26 offset:19296
    s_waitcnt lgkmcnt(9)
    v_mfma_f32_16x16x32_bf16 a[16:19], v[56:59], v[160:163], a[16:19]
    ds_read_b64_tr_b16 v[48:49], v25 offset:12416
    v_fma_f32 v89, v102, v81, -v89
    v_mfma_f32_16x16x32_bf16 a[20:23], v[56:59], v[164:167], a[20:23]
    ds_read_b64_tr_b16 v[50:51], v25 offset:13184
    v_fma_f32 v90, v102, v82, -v90
    v_mfma_f32_16x16x32_bf16 a[24:27], v[60:63], v[160:163], a[24:27]
    ds_read_b64_tr_b16 v[52:53], v25 offset:18560
    v_fma_f32 v91, v102, v83, -v91
    v_mfma_f32_16x16x32_bf16 a[28:31], v[60:63], v[164:167], a[28:31]
    ds_read_b64_tr_b16 v[54:55], v25 offset:19328
    s_waitcnt lgkmcnt(9)
    v_mfma_f32_16x16x32_bf16 a[32:35], v[64:67], v[160:163], a[32:35]
    ds_read_b64_tr_b16 v[56:57], v26 offset:12448
    s_waitcnt vmcnt(6)
    v_mfma_f32_16x16x32_bf16 a[36:39], v[64:67], v[164:167], a[36:39]
    ds_read_b64_tr_b16 v[58:59], v26 offset:13216
    v_fma_f32 v92, v102, v84, -v92
    v_mfma_f32_16x16x32_bf16 a[40:43], v[68:71], v[160:163], a[40:43]
    ds_read_b64_tr_b16 v[60:61], v26 offset:18592
    s_barrier
    v_mfma_f32_16x16x32_bf16 a[44:47], v[68:71], v[164:167], a[44:47]
    ds_read_b64_tr_b16 v[62:63], v26 offset:19360
    s_waitcnt lgkmcnt(8)
    v_mfma_f32_16x16x32_bf16 a[48:51], v[72:75], v[160:163], a[48:51]
    ds_read_b64_tr_b16 v[64:65], v23 offset:0
    s_add_u32 m0, s38, 49152
    v_mfma_f32_16x16x32_bf16 a[52:55], v[72:75], v[164:167], a[52:55]
    ds_read_b64_tr_b16 v[66:67], v23 offset:768
    buffer_load_dwordx4 v20, s[8:11], s31 offen offset:0  lds
    v_mfma_f32_16x16x32_bf16 a[56:59], v[76:79], v[160:163], a[56:59]
    ds_read_b64_tr_b16 v[68:69], v23 offset:6144
    v_fma_f32 v93, v102, v85, -v93
    v_mfma_f32_16x16x32_bf16 a[60:63], v[76:79], v[164:167], a[60:63]
    ds_read_b64_tr_b16 v[70:71], v23 offset:6912
    s_waitcnt lgkmcnt(8)
    v_mfma_f32_16x16x32_bf16 a[64:67], v[48:51], v[160:163], a[64:67]
    ds_read_b64_tr_b16 v[72:73], v24 offset:32
    buffer_load_dwordx4 v21, s[8:11], s31 offen offset:1024  lds
    v_mfma_f32_16x16x32_bf16 a[68:71], v[48:51], v[164:167], a[68:71]
    ds_read_b64_tr_b16 v[74:75], v24 offset:800
    v_fma_f32 v94, v102, v86, -v94
    v_mfma_f32_16x16x32_bf16 a[72:75], v[52:55], v[160:163], a[72:75]
    ds_read_b64_tr_b16 v[76:77], v24 offset:6176
    v_fma_f32 v95, v102, v87, -v95
    v_mfma_f32_16x16x32_bf16 a[76:79], v[52:55], v[164:167], a[76:79]
    ds_read_b64_tr_b16 v[78:79], v24 offset:6944
    s_waitcnt lgkmcnt(8)
    v_mfma_f32_16x16x32_bf16 a[80:83], v[56:59], v[160:163], a[80:83]
    ds_read_b64_tr_b16 v[48:49], v23 offset:64
    buffer_load_dwordx4 v22, s[8:11], s31 offen offset:2048  lds
    v_mfma_f32_16x16x32_bf16 a[84:87], v[56:59], v[164:167], a[84:87]
    ds_read_b64_tr_b16 v[50:51], v23 offset:832
    v_cvt_pk_bf16_f32 v96, v88, v89
    v_mfma_f32_16x16x32_bf16 a[88:91], v[60:63], v[160:163], a[88:91]
    ds_read_b64_tr_b16 v[52:53], v23 offset:6208
    v_cvt_pk_bf16_f32 v97, v90, v91
    v_mfma_f32_16x16x32_bf16 a[92:95], v[60:63], v[164:167], a[92:95]
    ds_read_b64_tr_b16 v[54:55], v23 offset:6976
    s_waitcnt lgkmcnt(8)
    v_mfma_f32_16x16x32_bf16 a[0:3], v[64:67], v[168:171], a[0:3]
    ds_read_b64_tr_b16 v[56:57], v24 offset:96
    s_add_u32 m0, s38, 61440
    v_mfma_f32_16x16x32_bf16 a[4:7], v[64:67], v[172:175], a[4:7]
    ds_read_b64_tr_b16 v[58:59], v24 offset:864
    buffer_load_dwordx4 v20, s[8:11], s32 offen offset:0  lds
    v_mfma_f32_16x16x32_bf16 a[8:11], v[68:71], v[168:171], a[8:11]
    ds_read_b64_tr_b16 v[60:61], v24 offset:6240
    v_cvt_pk_bf16_f32 v98, v92, v93
    v_mfma_f32_16x16x32_bf16 a[12:15], v[68:71], v[172:175], a[12:15]
    ds_read_b64_tr_b16 v[62:63], v24 offset:7008
    s_waitcnt lgkmcnt(8)
    v_mfma_f32_16x16x32_bf16 a[16:19], v[72:75], v[168:171], a[16:19]
    ds_read_b64_tr_b16 v[64:65], v23 offset:128
    buffer_load_dwordx4 v21, s[8:11], s32 offen offset:1024  lds
    v_mfma_f32_16x16x32_bf16 a[20:23], v[72:75], v[172:175], a[20:23]
    ds_read_b64_tr_b16 v[66:67], v23 offset:896
    v_cvt_pk_bf16_f32 v99, v94, v95
    v_mfma_f32_16x16x32_bf16 a[24:27], v[76:79], v[168:171], a[24:27]
    ds_read_b64_tr_b16 v[68:69], v23 offset:6272
    ds_write_b128 v100, v[96:99] offset:10240
    v_mfma_f32_16x16x32_bf16 a[28:31], v[76:79], v[172:175], a[28:31]
    ds_read_b64_tr_b16 v[70:71], v23 offset:7040
    s_waitcnt lgkmcnt(9)
    v_mfma_f32_16x16x32_bf16 a[32:35], v[48:51], v[168:171], a[32:35]
    ds_read_b64_tr_b16 v[72:73], v24 offset:160
    buffer_load_dwordx4 v22, s[8:11], s32 offen offset:2048  lds
    v_mfma_f32_16x16x32_bf16 a[36:39], v[48:51], v[172:175], a[36:39]
    ds_read_b64_tr_b16 v[74:75], v24 offset:928
    v_fma_f32 v80, v102, v88, -v80
    v_mfma_f32_16x16x32_bf16 a[40:43], v[52:55], v[168:171], a[40:43]
    ds_read_b64_tr_b16 v[76:77], v24 offset:6304
    v_fma_f32 v81, v102, v89, -v81
    v_mfma_f32_16x16x32_bf16 a[44:47], v[52:55], v[172:175], a[44:47]
    ds_read_b64_tr_b16 v[78:79], v24 offset:7072
    s_waitcnt lgkmcnt(9)
    v_mfma_f32_16x16x32_bf16 a[48:51], v[56:59], v[168:171], a[48:51]
    ds_read_b64_tr_b16 v[48:49], v23 offset:12288
    v_fma_f32 v82, v102, v90, -v82
    v_mfma_f32_16x16x32_bf16 a[52:55], v[56:59], v[172:175], a[52:55]
    ds_read_b64_tr_b16 v[50:51], v23 offset:13056
    v_fma_f32 v83, v102, v91, -v83
    v_mfma_f32_16x16x32_bf16 a[56:59], v[60:63], v[168:171], a[56:59]
    ds_read_b64_tr_b16 v[52:53], v23 offset:18432
    v_fma_f32 v84, v102, v92, -v84
    v_mfma_f32_16x16x32_bf16 a[60:63], v[60:63], v[172:175], a[60:63]
    ds_read_b64_tr_b16 v[54:55], v23 offset:19200
    s_waitcnt lgkmcnt(8)
    v_mfma_f32_16x16x32_bf16 a[64:67], v[64:67], v[168:171], a[64:67]
    ds_read_b64_tr_b16 v[56:57], v24 offset:12320
    v_fma_f32 v85, v102, v93, -v85
    v_mfma_f32_16x16x32_bf16 a[68:71], v[64:67], v[172:175], a[68:71]
    ds_read_b64_tr_b16 v[58:59], v24 offset:13088
    v_fma_f32 v86, v102, v94, -v86
    v_mfma_f32_16x16x32_bf16 a[72:75], v[68:71], v[168:171], a[72:75]
    ds_read_b64_tr_b16 v[60:61], v24 offset:18464
    v_fma_f32 v87, v102, v95, -v87
    v_mfma_f32_16x16x32_bf16 a[76:79], v[68:71], v[172:175], a[76:79]
    ds_read_b64_tr_b16 v[62:63], v24 offset:19232
    s_waitcnt lgkmcnt(8)
    v_mfma_f32_16x16x32_bf16 a[80:83], v[72:75], v[168:171], a[80:83]
    ds_read_b64_tr_b16 v[64:65], v23 offset:12352
    v_cvt_pk_bf16_f32 v96, v80, v81
    v_mfma_f32_16x16x32_bf16 a[84:87], v[72:75], v[172:175], a[84:87]
    ds_read_b64_tr_b16 v[66:67], v23 offset:13120
    v_cvt_pk_bf16_f32 v97, v82, v83
    v_mfma_f32_16x16x32_bf16 a[88:91], v[76:79], v[168:171], a[88:91]
    ds_read_b64_tr_b16 v[68:69], v23 offset:18496
    v_cvt_pk_bf16_f32 v98, v84, v85
    v_mfma_f32_16x16x32_bf16 a[92:95], v[76:79], v[172:175], a[92:95]
    ds_read_b64_tr_b16 v[70:71], v23 offset:19264
    s_waitcnt lgkmcnt(8)
    v_mfma_f32_16x16x32_bf16 a[0:3], v[48:51], v[176:179], a[0:3]
    ds_read_b64_tr_b16 v[72:73], v24 offset:12384
    v_cvt_pk_bf16_f32 v99, v86, v87
    v_mfma_f32_16x16x32_bf16 a[4:7], v[48:51], v[180:183], a[4:7]
    ds_read_b64_tr_b16 v[74:75], v24 offset:13152
    ds_write_b128 v100, v[96:99] offset:12288
    v_mfma_f32_16x16x32_bf16 a[8:11], v[52:55], v[176:179], a[8:11]
    ds_read_b64_tr_b16 v[76:77], v24 offset:18528
    v_fma_f32 v88, v102, v80, -v88
    v_mfma_f32_16x16x32_bf16 a[12:15], v[52:55], v[180:183], a[12:15]
    ds_read_b64_tr_b16 v[78:79], v24 offset:19296
    s_waitcnt lgkmcnt(9)
    v_mfma_f32_16x16x32_bf16 a[16:19], v[56:59], v[176:179], a[16:19]
    ds_read_b64_tr_b16 v[48:49], v23 offset:12416
    v_fma_f32 v89, v102, v81, -v89
    v_mfma_f32_16x16x32_bf16 a[20:23], v[56:59], v[180:183], a[20:23]
    ds_read_b64_tr_b16 v[50:51], v23 offset:13184
    v_fma_f32 v90, v102, v82, -v90
    v_mfma_f32_16x16x32_bf16 a[24:27], v[60:63], v[176:179], a[24:27]
    ds_read_b64_tr_b16 v[52:53], v23 offset:18560
    v_fma_f32 v91, v102, v83, -v91
    v_mfma_f32_16x16x32_bf16 a[28:31], v[60:63], v[180:183], a[28:31]
    ds_read_b64_tr_b16 v[54:55], v23 offset:19328
    s_waitcnt lgkmcnt(9)
    v_mfma_f32_16x16x32_bf16 a[32:35], v[64:67], v[176:179], a[32:35]
    ds_read_b64_tr_b16 v[56:57], v24 offset:12448
    s_waitcnt vmcnt(6)
    v_mfma_f32_16x16x32_bf16 a[36:39], v[64:67], v[180:183], a[36:39]
    ds_read_b64_tr_b16 v[58:59], v24 offset:13216
    v_fma_f32 v92, v102, v84, -v92
    v_mfma_f32_16x16x32_bf16 a[40:43], v[68:71], v[176:179], a[40:43]
    ds_read_b64_tr_b16 v[60:61], v24 offset:18592
    s_barrier
    v_mfma_f32_16x16x32_bf16 a[44:47], v[68:71], v[180:183], a[44:47]
    ds_read_b64_tr_b16 v[62:63], v24 offset:19360
    s_waitcnt lgkmcnt(8)
    v_mfma_f32_16x16x32_bf16 a[48:51], v[72:75], v[176:179], a[48:51]
    ds_read_b64_tr_b16 v[64:65], v23 offset:24576
    s_add_u32 m0, s38, 73728
    v_mfma_f32_16x16x32_bf16 a[52:55], v[72:75], v[180:183], a[52:55]
    ds_read_b64_tr_b16 v[66:67], v23 offset:25344
    buffer_load_dwordx4 v20, s[8:11], s33 offen offset:0  lds
    v_mfma_f32_16x16x32_bf16 a[56:59], v[76:79], v[176:179], a[56:59]
    ds_read_b64_tr_b16 v[68:69], v23 offset:30720
    v_fma_f32 v93, v102, v85, -v93
    v_mfma_f32_16x16x32_bf16 a[60:63], v[76:79], v[180:183], a[60:63]
    ds_read_b64_tr_b16 v[70:71], v23 offset:31488
    s_waitcnt lgkmcnt(8)
    v_mfma_f32_16x16x32_bf16 a[64:67], v[48:51], v[176:179], a[64:67]
    ds_read_b64_tr_b16 v[72:73], v24 offset:24608
    buffer_load_dwordx4 v21, s[8:11], s33 offen offset:1024  lds
    v_mfma_f32_16x16x32_bf16 a[68:71], v[48:51], v[180:183], a[68:71]
    ds_read_b64_tr_b16 v[74:75], v24 offset:25376
    v_fma_f32 v94, v102, v86, -v94
    v_mfma_f32_16x16x32_bf16 a[72:75], v[52:55], v[176:179], a[72:75]
    ds_read_b64_tr_b16 v[76:77], v24 offset:30752
    v_fma_f32 v95, v102, v87, -v95
    v_mfma_f32_16x16x32_bf16 a[76:79], v[52:55], v[180:183], a[76:79]
    ds_read_b64_tr_b16 v[78:79], v24 offset:31520
    s_waitcnt lgkmcnt(8)
    v_mfma_f32_16x16x32_bf16 a[80:83], v[56:59], v[176:179], a[80:83]
    ds_read_b64_tr_b16 v[48:49], v23 offset:24640
    buffer_load_dwordx4 v22, s[8:11], s33 offen offset:2048  lds
    v_mfma_f32_16x16x32_bf16 a[84:87], v[56:59], v[180:183], a[84:87]
    ds_read_b64_tr_b16 v[50:51], v23 offset:25408
    v_cvt_pk_bf16_f32 v96, v88, v89
    v_mfma_f32_16x16x32_bf16 a[88:91], v[60:63], v[176:179], a[88:91]
    ds_read_b64_tr_b16 v[52:53], v23 offset:30784
    v_cvt_pk_bf16_f32 v97, v90, v91
    v_mfma_f32_16x16x32_bf16 a[92:95], v[60:63], v[180:183], a[92:95]
    ds_read_b64_tr_b16 v[54:55], v23 offset:31552
    s_waitcnt lgkmcnt(8)
    v_mfma_f32_16x16x32_bf16 a[0:3], v[64:67], v[184:187], a[0:3]
    ds_read_b64_tr_b16 v[56:57], v24 offset:24672
    s_add_u32 m0, s38, 0
    v_mfma_f32_16x16x32_bf16 a[4:7], v[64:67], v[188:191], a[4:7]
    ds_read_b64_tr_b16 v[58:59], v24 offset:25440
    buffer_load_dwordx4 v20, s[8:11], s34 offen offset:0  lds
    v_mfma_f32_16x16x32_bf16 a[8:11], v[68:71], v[184:187], a[8:11]
    ds_read_b64_tr_b16 v[60:61], v24 offset:30816
    v_cvt_pk_bf16_f32 v98, v92, v93
    v_mfma_f32_16x16x32_bf16 a[12:15], v[68:71], v[188:191], a[12:15]
    ds_read_b64_tr_b16 v[62:63], v24 offset:31584
    s_waitcnt lgkmcnt(8)
    v_mfma_f32_16x16x32_bf16 a[16:19], v[72:75], v[184:187], a[16:19]
    ds_read_b64_tr_b16 v[64:65], v23 offset:24704
    buffer_load_dwordx4 v21, s[8:11], s34 offen offset:1024  lds
    v_mfma_f32_16x16x32_bf16 a[20:23], v[72:75], v[188:191], a[20:23]
    ds_read_b64_tr_b16 v[66:67], v23 offset:25472
    v_cvt_pk_bf16_f32 v99, v94, v95
    v_mfma_f32_16x16x32_bf16 a[24:27], v[76:79], v[184:187], a[24:27]
    ds_read_b64_tr_b16 v[68:69], v23 offset:30848
    ds_write_b128 v100, v[96:99] offset:14336
    v_mfma_f32_16x16x32_bf16 a[28:31], v[76:79], v[188:191], a[28:31]
    ds_read_b64_tr_b16 v[70:71], v23 offset:31616
    s_waitcnt lgkmcnt(9)
    v_mfma_f32_16x16x32_bf16 a[32:35], v[48:51], v[184:187], a[32:35]
    ds_read_b64_tr_b16 v[72:73], v24 offset:24736
    buffer_load_dwordx4 v22, s[8:11], s34 offen offset:2048  lds
    v_mfma_f32_16x16x32_bf16 a[36:39], v[48:51], v[188:191], a[36:39]
    ds_read_b64_tr_b16 v[74:75], v24 offset:25504
    v_fma_f32 v80, v102, v88, -v80
    v_mfma_f32_16x16x32_bf16 a[40:43], v[52:55], v[184:187], a[40:43]
    ds_read_b64_tr_b16 v[76:77], v24 offset:30880
    v_fma_f32 v81, v102, v89, -v81
    v_mfma_f32_16x16x32_bf16 a[44:47], v[52:55], v[188:191], a[44:47]
    ds_read_b64_tr_b16 v[78:79], v24 offset:31648
    s_waitcnt lgkmcnt(9)
    v_mfma_f32_16x16x32_bf16 a[48:51], v[56:59], v[184:187], a[48:51]
    ds_read_b64_tr_b16 v[48:49], v23 offset:36864
    v_fma_f32 v82, v102, v90, -v82
    v_mfma_f32_16x16x32_bf16 a[52:55], v[56:59], v[188:191], a[52:55]
    ds_read_b64_tr_b16 v[50:51], v23 offset:37632
    v_fma_f32 v83, v102, v91, -v83
    v_mfma_f32_16x16x32_bf16 a[56:59], v[60:63], v[184:187], a[56:59]
    ds_read_b64_tr_b16 v[52:53], v23 offset:43008
    v_fma_f32 v84, v102, v92, -v84
    v_mfma_f32_16x16x32_bf16 a[60:63], v[60:63], v[188:191], a[60:63]
    ds_read_b64_tr_b16 v[54:55], v23 offset:43776
    s_waitcnt lgkmcnt(8)
    v_mfma_f32_16x16x32_bf16 a[64:67], v[64:67], v[184:187], a[64:67]
    ds_read_b64_tr_b16 v[56:57], v24 offset:36896
    v_fma_f32 v85, v102, v93, -v85
    v_mfma_f32_16x16x32_bf16 a[68:71], v[64:67], v[188:191], a[68:71]
    ds_read_b64_tr_b16 v[58:59], v24 offset:37664
    v_fma_f32 v86, v102, v94, -v86
    v_mfma_f32_16x16x32_bf16 a[72:75], v[68:71], v[184:187], a[72:75]
    ds_read_b64_tr_b16 v[60:61], v24 offset:43040
    v_fma_f32 v87, v102, v95, -v87
    v_mfma_f32_16x16x32_bf16 a[76:79], v[68:71], v[188:191], a[76:79]
    ds_read_b64_tr_b16 v[62:63], v24 offset:43808
    s_waitcnt lgkmcnt(8)
    v_mfma_f32_16x16x32_bf16 a[80:83], v[72:75], v[184:187], a[80:83]
    ds_read_b64_tr_b16 v[64:65], v23 offset:36928
    v_cvt_pk_bf16_f32 v96, v80, v81
    v_mfma_f32_16x16x32_bf16 a[84:87], v[72:75], v[188:191], a[84:87]
    ds_read_b64_tr_b16 v[66:67], v23 offset:37696
    v_cvt_pk_bf16_f32 v97, v82, v83
    v_mfma_f32_16x16x32_bf16 a[88:91], v[76:79], v[184:187], a[88:91]
    ds_read_b64_tr_b16 v[68:69], v23 offset:43072
    v_cvt_pk_bf16_f32 v98, v84, v85
    v_mfma_f32_16x16x32_bf16 a[92:95], v[76:79], v[188:191], a[92:95]
    ds_read_b64_tr_b16 v[70:71], v23 offset:43840
    s_waitcnt lgkmcnt(8)
    v_mfma_f32_16x16x32_bf16 a[0:3], v[48:51], v[192:195], a[0:3]
    ds_read_b64_tr_b16 v[72:73], v24 offset:36960
    v_cvt_pk_bf16_f32 v99, v86, v87
    v_mfma_f32_16x16x32_bf16 a[4:7], v[48:51], v[196:199], a[4:7]
    ds_read_b64_tr_b16 v[74:75], v24 offset:37728
    ds_write_b128 v100, v[96:99] offset:16384
    v_mfma_f32_16x16x32_bf16 a[8:11], v[52:55], v[192:195], a[8:11]
    ds_read_b64_tr_b16 v[76:77], v24 offset:43104
    v_add_u32 v104, s56, v36
    v_mfma_f32_16x16x32_bf16 a[12:15], v[52:55], v[196:199], a[12:15]
    ds_read_b64_tr_b16 v[78:79], v24 offset:43872
    s_waitcnt lgkmcnt(9)
    v_mfma_f32_16x16x32_bf16 a[16:19], v[56:59], v[192:195], a[16:19]
    ds_read_b64_tr_b16 v[48:49], v23 offset:36992
    v_cvt_f32_i32 v104, v104
    v_mfma_f32_16x16x32_bf16 a[20:23], v[56:59], v[196:199], a[20:23]
    ds_read_b64_tr_b16 v[50:51], v23 offset:37760
    v_fma_f32 v104, v104, v34, v35
    v_mfma_f32_16x16x32_bf16 a[24:27], v[60:63], v[192:195], a[24:27]
    ds_read_b64_tr_b16 v[52:53], v23 offset:43136
    v_add_f32 v105, v104, v34
    v_mfma_f32_16x16x32_bf16 a[28:31], v[60:63], v[196:199], a[28:31]
    ds_read_b64_tr_b16 v[54:55], v23 offset:43904
    s_waitcnt lgkmcnt(9)
    v_mfma_f32_16x16x32_bf16 a[32:35], v[64:67], v[192:195], a[32:35]
    ds_read_b64_tr_b16 v[56:57], v24 offset:37024
    s_waitcnt vmcnt(6)
    v_mfma_f32_16x16x32_bf16 a[36:39], v[64:67], v[196:199], a[36:39]
    ds_read_b64_tr_b16 v[58:59], v24 offset:37792
    v_mov_b32 v108, 0x42000000
    v_mfma_f32_16x16x32_bf16 a[40:43], v[68:71], v[192:195], a[40:43]
    ds_read_b64_tr_b16 v[60:61], v24 offset:43168
    s_barrier
    v_mfma_f32_16x16x32_bf16 a[44:47], v[68:71], v[196:199], a[44:47]
    ds_read_b64_tr_b16 v[62:63], v24 offset:43936
    s_waitcnt lgkmcnt(8)
    v_mfma_f32_16x16x32_bf16 a[48:51], v[72:75], v[192:195], a[48:51]
    ds_read_b64_tr_b16 v[64:65], v23 offset:49152
    s_add_u32 m0, s38, 12288
    v_mfma_f32_16x16x32_bf16 a[52:55], v[72:75], v[196:199], a[52:55]
    ds_read_b64_tr_b16 v[66:67], v23 offset:49920
    buffer_load_dwordx4 v20, s[8:11], s35 offen offset:0  lds
    v_mfma_f32_16x16x32_bf16 a[56:59], v[76:79], v[192:195], a[56:59]
    ds_read_b64_tr_b16 v[68:69], v23 offset:55296
    v_mul_f32 v108, v108, v34
    v_mfma_f32_16x16x32_bf16 a[60:63], v[76:79], v[196:199], a[60:63]
    ds_read_b64_tr_b16 v[70:71], v23 offset:56064
    s_waitcnt lgkmcnt(8)
    v_mfma_f32_16x16x32_bf16 a[64:67], v[48:51], v[192:195], a[64:67]
    ds_read_b64_tr_b16 v[72:73], v24 offset:49184
    buffer_load_dwordx4 v21, s[8:11], s35 offen offset:1024  lds
    v_mfma_f32_16x16x32_bf16 a[68:71], v[48:51], v[196:199], a[68:71]
    ds_read_b64_tr_b16 v[74:75], v24 offset:49952
    v_add_f32 v106, v104, v108
    v_mfma_f32_16x16x32_bf16 a[72:75], v[52:55], v[192:195], a[72:75]
    ds_read_b64_tr_b16 v[76:77], v24 offset:55328
    v_add_f32 v107, v106, v34
    v_mfma_f32_16x16x32_bf16 a[76:79], v[52:55], v[196:199], a[76:79]
    ds_read_b64_tr_b16 v[78:79], v24 offset:56096
    s_waitcnt lgkmcnt(8)
    v_mfma_f32_16x16x32_bf16 a[80:83], v[56:59], v[192:195], a[80:83]
    ds_read_b64_tr_b16 v[48:49], v23 offset:49216
    buffer_load_dwordx4 v22, s[8:11], s35 offen offset:2048  lds
    v_mfma_f32_16x16x32_bf16 a[84:87], v[56:59], v[196:199], a[84:87]
    ds_read_b64_tr_b16 v[50:51], v23 offset:49984
    v_cos_f32 v101, v34
    v_mfma_f32_16x16x32_bf16 a[88:91], v[60:63], v[192:195], a[88:91]
    ds_read_b64_tr_b16 v[52:53], v23 offset:55360
    v_cos_f32 v102, v108
    v_mfma_f32_16x16x32_bf16 a[92:95], v[60:63], v[196:199], a[92:95]
    ds_read_b64_tr_b16 v[54:55], v23 offset:56128
    s_waitcnt lgkmcnt(8)
    v_mfma_f32_16x16x32_bf16 a[0:3], v[64:67], v[200:203], a[0:3]
    ds_read_b64_tr_b16 v[56:57], v24 offset:49248
    s_add_u32 m0, s38, 24576
    v_mfma_f32_16x16x32_bf16 a[4:7], v[64:67], v[204:207], a[4:7]
    ds_read_b64_tr_b16 v[58:59], v24 offset:50016
    buffer_load_dwordx4 v20, s[8:11], s36 offen offset:0  lds
    v_mfma_f32_16x16x32_bf16 a[8:11], v[68:71], v[200:203], a[8:11]
    ds_read_b64_tr_b16 v[60:61], v24 offset:55392
    v_cos_f32 v80, v104
    v_mfma_f32_16x16x32_bf16 a[12:15], v[68:71], v[204:207], a[12:15]
    ds_read_b64_tr_b16 v[62:63], v24 offset:56160
    s_waitcnt lgkmcnt(8)
    v_mfma_f32_16x16x32_bf16 a[16:19], v[72:75], v[200:203], a[16:19]
    ds_read_b64_tr_b16 v[64:65], v23 offset:49280
    buffer_load_dwordx4 v21, s[8:11], s36 offen offset:1024  lds
    v_mfma_f32_16x16x32_bf16 a[20:23], v[72:75], v[204:207], a[20:23]
    ds_read_b64_tr_b16 v[66:67], v23 offset:50048
    v_cos_f32 v81, v105
    v_mfma_f32_16x16x32_bf16 a[24:27], v[76:79], v[200:203], a[24:27]
    ds_read_b64_tr_b16 v[68:69], v23 offset:55424
    v_cos_f32 v88, v106
    v_mfma_f32_16x16x32_bf16 a[28:31], v[76:79], v[204:207], a[28:31]
    ds_read_b64_tr_b16 v[70:71], v23 offset:56192
    s_waitcnt lgkmcnt(8)
    v_mfma_f32_16x16x32_bf16 a[32:35], v[48:51], v[200:203], a[32:35]
    ds_read_b64_tr_b16 v[72:73], v24 offset:49312
    buffer_load_dwordx4 v22, s[8:11], s36 offen offset:2048  lds
    v_mfma_f32_16x16x32_bf16 a[36:39], v[48:51], v[204:207], a[36:39]
    ds_read_b64_tr_b16 v[74:75], v24 offset:50080
    v_cos_f32 v89, v107
    v_mfma_f32_16x16x32_bf16 a[40:43], v[52:55], v[200:203], a[40:43]
    ds_read_b64_tr_b16 v[76:77], v24 offset:55456
    v_add_u32 v100, s59, v29
    v_mfma_f32_16x16x32_bf16 a[44:47], v[52:55], v[204:207], a[44:47]
    ds_read_b64_tr_b16 v[78:79], v24 offset:56224
    s_waitcnt lgkmcnt(8)
    v_mfma_f32_16x16x32_bf16 a[48:51], v[56:59], v[200:203], a[48:51]
    ds_read_b64_tr_b16 v[48:49], v25 offset:0
    v_add_f32 v101, v101, v101
    v_mfma_f32_16x16x32_bf16 a[52:55], v[56:59], v[204:207], a[52:55]
    ds_read_b64_tr_b16 v[50:51], v25 offset:768
    v_add_f32 v102, v102, v102
    v_mfma_f32_16x16x32_bf16 a[56:59], v[60:63], v[200:203], a[56:59]
    ds_read_b64_tr_b16 v[52:53], v25 offset:6144
    v_fma_f32 v82, v101, v81, -v80
    v_mfma_f32_16x16x32_bf16 a[60:63], v[60:63], v[204:207], a[60:63]
    ds_read_b64_tr_b16 v[54:55], v25 offset:6912
    s_waitcnt lgkmcnt(8)
    v_mfma_f32_16x16x32_bf16 a[64:67], v[64:67], v[200:203], a[64:67]
    ds_read_b64_tr_b16 v[56:57], v26 offset:32
    v_fma_f32 v83, v101, v82, -v81
    v_mfma_f32_16x16x32_bf16 a[68:71], v[64:67], v[204:207], a[68:71]
    ds_read_b64_tr_b16 v[58:59], v26 offset:800
    v_fma_f32 v84, v101, v83, -v82
    v_mfma_f32_16x16x32_bf16 a[72:75], v[68:71], v[200:203], a[72:75]
    ds_read_b64_tr_b16 v[60:61], v26 offset:6176
    v_fma_f32 v85, v101, v84, -v83
    v_mfma_f32_16x16x32_bf16 a[76:79], v[68:71], v[204:207], a[76:79]
    ds_read_b64_tr_b16 v[62:63], v26 offset:6944
    s_waitcnt lgkmcnt(8)
    v_mfma_f32_16x16x32_bf16 a[80:83], v[72:75], v[200:203], a[80:83]
    ds_read_b64_tr_b16 v[64:65], v25 offset:64
    v_fma_f32 v86, v101, v85, -v84
    v_mfma_f32_16x16x32_bf16 a[84:87], v[72:75], v[204:207], a[84:87]
    ds_read_b64_tr_b16 v[66:67], v25 offset:832
    v_fma_f32 v87, v101, v86, -v85
    v_mfma_f32_16x16x32_bf16 a[88:91], v[76:79], v[200:203], a[88:91]
    ds_read_b64_tr_b16 v[68:69], v25 offset:6208
    v_fma_f32 v90, v101, v89, -v88
    v_mfma_f32_16x16x32_bf16 a[92:95], v[76:79], v[204:207], a[92:95]
    ds_read_b64_tr_b16 v[70:71], v25 offset:6976
    s_waitcnt lgkmcnt(8)
    v_mfma_f32_16x16x32_bf16 a[0:3], v[48:51], v[208:211], a[0:3]
    ds_read_b64_tr_b16 v[72:73], v26 offset:96
    v_fma_f32 v91, v101, v90, -v89
    v_mfma_f32_16x16x32_bf16 a[4:7], v[48:51], v[212:215], a[4:7]
    ds_read_b64_tr_b16 v[74:75], v26 offset:864
    v_fma_f32 v92, v101, v91, -v90
    v_mfma_f32_16x16x32_bf16 a[8:11], v[52:55], v[208:211], a[8:11]
    ds_read_b64_tr_b16 v[76:77], v26 offset:6240
    v_fma_f32 v93, v101, v92, -v91
    v_mfma_f32_16x16x32_bf16 a[12:15], v[52:55], v[212:215], a[12:15]
    ds_read_b64_tr_b16 v[78:79], v26 offset:7008
    s_waitcnt lgkmcnt(8)
    v_mfma_f32_16x16x32_bf16 a[16:19], v[56:59], v[208:211], a[16:19]
    ds_read_b64_tr_b16 v[48:49], v25 offset:128
    v_fma_f32 v94, v101, v93, -v92
    v_mfma_f32_16x16x32_bf16 a[20:23], v[56:59], v[212:215], a[20:23]
    ds_read_b64_tr_b16 v[50:51], v25 offset:896
    v_fma_f32 v95, v101, v94, -v93
    v_mfma_f32_16x16x32_bf16 a[24:27], v[60:63], v[208:211], a[24:27]
    ds_read_b64_tr_b16 v[52:53], v25 offset:6272
    v_cvt_pk_bf16_f32 v96, v80, v81
    v_mfma_f32_16x16x32_bf16 a[28:31], v[60:63], v[212:215], a[28:31]
    ds_read_b64_tr_b16 v[54:55], v25 offset:7040
    s_waitcnt lgkmcnt(8)
    v_mfma_f32_16x16x32_bf16 a[32:35], v[64:67], v[208:211], a[32:35]
    ds_read_b64_tr_b16 v[56:57], v26 offset:160
    s_waitcnt vmcnt(6)
    v_mfma_f32_16x16x32_bf16 a[36:39], v[64:67], v[212:215], a[36:39]
    ds_read_b64_tr_b16 v[58:59], v26 offset:928
    v_cvt_pk_bf16_f32 v97, v82, v83
    v_mfma_f32_16x16x32_bf16 a[40:43], v[68:71], v[208:211], a[40:43]
    ds_read_b64_tr_b16 v[60:61], v26 offset:6304
    s_barrier
    v_mfma_f32_16x16x32_bf16 a[44:47], v[68:71], v[212:215], a[44:47]
    ds_read_b64_tr_b16 v[62:63], v26 offset:7072
    s_waitcnt lgkmcnt(8)
    v_mfma_f32_16x16x32_bf16 a[48:51], v[72:75], v[208:211], a[48:51]
    ds_read_b64_tr_b16 v[64:65], v25 offset:12288
    s_add_u32 m0, s38, 36864
    v_mfma_f32_16x16x32_bf16 a[52:55], v[72:75], v[212:215], a[52:55]
    ds_read_b64_tr_b16 v[66:67], v25 offset:13056
    buffer_load_dwordx4 v20, s[8:11], s37 offen offset:0  lds
    v_mfma_f32_16x16x32_bf16 a[56:59], v[76:79], v[208:211], a[56:59]
    ds_read_b64_tr_b16 v[68:69], v25 offset:18432
    v_cvt_pk_bf16_f32 v98, v84, v85
    v_mfma_f32_16x16x32_bf16 a[60:63], v[76:79], v[212:215], a[60:63]
    ds_read_b64_tr_b16 v[70:71], v25 offset:19200
    s_waitcnt lgkmcnt(8)
    v_mfma_f32_16x16x32_bf16 a[64:67], v[48:51], v[208:211], a[64:67]
    ds_read_b64_tr_b16 v[72:73], v26 offset:12320
    buffer_load_dwordx4 v21, s[8:11], s37 offen offset:1024  lds
    v_mfma_f32_16x16x32_bf16 a[68:71], v[48:51], v[212:215], a[68:71]
    ds_read_b64_tr_b16 v[74:75], v26 offset:13088
    v_cvt_pk_bf16_f32 v99, v86, v87
    v_mfma_f32_16x16x32_bf16 a[72:75], v[52:55], v[208:211], a[72:75]
    ds_read_b64_tr_b16 v[76:77], v26 offset:18464
    ds_write_b128 v100, v[96:99] offset:0
    v_mfma_f32_16x16x32_bf16 a[76:79], v[52:55], v[212:215], a[76:79]
    ds_read_b64_tr_b16 v[78:79], v26 offset:19232
    s_waitcnt lgkmcnt(9)
    v_mfma_f32_16x16x32_bf16 a[80:83], v[56:59], v[208:211], a[80:83]
    ds_read_b64_tr_b16 v[48:49], v25 offset:12352
    buffer_load_dwordx4 v22, s[8:11], s37 offen offset:2048  lds
    v_mfma_f32_16x16x32_bf16 a[84:87], v[56:59], v[212:215], a[84:87]
    ds_read_b64_tr_b16 v[50:51], v25 offset:13120
    s_add_u32 s8, s8, 192
    s_addc_u32 s9, s9, 0
    v_mfma_f32_16x16x32_bf16 a[88:91], v[60:63], v[208:211], a[88:91]
    ds_read_b64_tr_b16 v[52:53], v25 offset:18496
    s_sub_u32 s10, s10, 192
    v_mfma_f32_16x16x32_bf16 a[92:95], v[60:63], v[212:215], a[92:95]
    ds_read_b64_tr_b16 v[54:55], v25 offset:19264
    s_waitcnt lgkmcnt(9)
    v_mfma_f32_16x16x32_bf16 a[0:3], v[64:67], v[216:219], a[0:3]
    ds_read_b64_tr_b16 v[56:57], v26 offset:12384
    s_add_u32 m0, s38, 49152
    v_mfma_f32_16x16x32_bf16 a[4:7], v[64:67], v[220:223], a[4:7]
    ds_read_b64_tr_b16 v[58:59], v26 offset:13152
    buffer_load_dwordx4 v20, s[8:11], s20 offen offset:0  lds
    v_mfma_f32_16x16x32_bf16 a[8:11], v[68:71], v[216:219], a[8:11]
    ds_read_b64_tr_b16 v[60:61], v26 offset:18528
    v_cvt_pk_bf16_f32 v96, v88, v89
    v_mfma_f32_16x16x32_bf16 a[12:15], v[68:71], v[220:223], a[12:15]
    ds_read_b64_tr_b16 v[62:63], v26 offset:19296
    s_waitcnt lgkmcnt(8)
    v_mfma_f32_16x16x32_bf16 a[16:19], v[72:75], v[216:219], a[16:19]
    ds_read_b64_tr_b16 v[64:65], v25 offset:12416
    buffer_load_dwordx4 v21, s[8:11], s20 offen offset:1024  lds
    v_mfma_f32_16x16x32_bf16 a[20:23], v[72:75], v[220:223], a[20:23]
    ds_read_b64_tr_b16 v[66:67], v25 offset:13184
    v_cvt_pk_bf16_f32 v97, v90, v91
    v_mfma_f32_16x16x32_bf16 a[24:27], v[76:79], v[216:219], a[24:27]
    ds_read_b64_tr_b16 v[68:69], v25 offset:18560
    v_cvt_pk_bf16_f32 v98, v92, v93
    v_mfma_f32_16x16x32_bf16 a[28:31], v[76:79], v[220:223], a[28:31]
    ds_read_b64_tr_b16 v[70:71], v25 offset:19328
    s_waitcnt lgkmcnt(8)
    v_mfma_f32_16x16x32_bf16 a[32:35], v[48:51], v[216:219], a[32:35]
    ds_read_b64_tr_b16 v[72:73], v26 offset:12448
    buffer_load_dwordx4 v22, s[8:11], s20 offen offset:2048  lds
    v_mfma_f32_16x16x32_bf16 a[36:39], v[48:51], v[220:223], a[36:39]
    ds_read_b64_tr_b16 v[74:75], v26 offset:13216
    v_cvt_pk_bf16_f32 v99, v94, v95
    v_mfma_f32_16x16x32_bf16 a[40:43], v[52:55], v[216:219], a[40:43]
    ds_read_b64_tr_b16 v[76:77], v26 offset:18592
    ds_write_b128 v100, v[96:99] offset:2048
    v_mfma_f32_16x16x32_bf16 a[44:47], v[52:55], v[220:223], a[44:47]
    ds_read_b64_tr_b16 v[78:79], v26 offset:19360
    s_waitcnt lgkmcnt(9)
    v_mfma_f32_16x16x32_bf16 a[48:51], v[56:59], v[216:219], a[48:51]
    ds_read_b64_tr_b16 v[48:49], v23 offset:0
    s_cmp_eq_u32 s94, 2
    s_cbranch_scc0 L1_NOS1
    s_lshr_b32 s45, s2, 5
    s_lshl_b32 s45, s45, 3
    s_and_b32 s46, s2, 7
    s_add_u32 s95, s45, s46
    s_lshr_b32 s46, s95, 2
    s_and_b32 s45, s95, 3
    s_lshl_b32 s47, s46, 7
    s_lshl_b32 s92, s16, 5
    s_add_u32 s47, s47, s92
    s_lshl_b32 s92, s45, 3
    s_add_u32 s47, s47, s92
    s_mul_i32 s93, s47, 578
    s_lshr_b32 s92, s46, 1
    s_lshl_b32 s92, s92, 10
    s_and_b32 s46, s46, 1
    s_lshl_b32 s46, s46, 9
    s_add_u32 s92, s92, s46
    s_lshl_b32 s45, s45, 7
    s_add_u32 s92, s92, s45
    s_add_u32 s92, s92, 21233664
    s_mul_i32 s95, s16, 5120
    s_add_u32 s95, s95, 122880
    s_mov_b32 s4, s84
    s_mov_b32 s5, s85
    s_mov_b32 s6, 1183744
    s_mov_b32 s7, 0x00020000
    s_mov_b32 s84, s86
    s_mov_b32 s85, s87
    s_mov_b32 s86, 1183744
    s_mov_b32 s87, 0x00020000
    s_add_u32 m0, s95, 0
    s_nop 0
    buffer_load_dwordx4 v29, s[4:7], s93 offen lds
    s_add_u32 m0, s95, 20480
    s_nop 0
    buffer_load_dwordx4 v29, s[84:87], s93 offen lds
    s_add_u32 s93, s93, 1024
    s_add_u32 m0, s95, 1024
    s_nop 0
    buffer_load_dwordx4 v29, s[4:7], s93 offen lds
    s_add_u32 m0, s95, 21504
    s_nop 0
    buffer_load_dwordx4 v29, s[84:87], s93 offen lds
    s_add_u32 s93, s93, 1024
    s_add_u32 m0, s95, 2048
    s_nop 0
    buffer_load_dwordx4 v29, s[4:7], s93 offen lds
    s_add_u32 m0, s95, 22528
    s_nop 0
    buffer_load_dwordx4 v29, s[84:87], s93 offen lds
    s_add_u32 s93, s93, 1024
    s_add_u32 m0, s95, 3072
    s_nop 0
    buffer_load_dwordx4 v29, s[4:7], s93 offen lds
    s_add_u32 m0, s95, 23552
    s_nop 0
    buffer_load_dwordx4 v29, s[84:87], s93 offen lds
    s_add_u32 s93, s93, 1024
    s_add_u32 m0, s95, 4096
    s_nop 0
    buffer_load_dwordx4 v29, s[4:7], s93 offen lds
    s_add_u32 m0, s95, 24576
    s_nop 0
    buffer_load_dwordx4 v29, s[84:87], s93 offen lds
    s_add_u32 s93, s93, 1024
L1_NOS1:
    v_mfma_f32_16x16x32_bf16 a[52:55], v[56:59], v[220:223], a[52:55]
    ds_read_b64_tr_b16 v[50:51], v23 offset:768
    v_fma_f32 v80, v102, v88, -v80
    v_mfma_f32_16x16x32_bf16 a[56:59], v[60:63], v[216:219], a[56:59]
    ds_read_b64_tr_b16 v[52:53], v23 offset:6144
    v_fma_f32 v81, v102, v89, -v81
    v_mfma_f32_16x16x32_bf16 a[60:63], v[60:63], v[220:223], a[60:63]
    ds_read_b64_tr_b16 v[54:55], v23 offset:6912
    s_waitcnt lgkmcnt(9)
    v_mfma_f32_16x16x32_bf16 a[64:67], v[64:67], v[216:219], a[64:67]
    ds_read_b64_tr_b16 v[56:57], v24 offset:32
    v_fma_f32 v82, v102, v90, -v82
    v_mfma_f32_16x16x32_bf16 a[68:71], v[64:67], v[220:223], a[68:71]
    ds_read_b64_tr_b16 v[58:59], v24 offset:800
    v_fma_f32 v83, v102, v91, -v83
    v_mfma_f32_16x16x32_bf16 a[72:75], v[68:71], v[216:219], a[72:75]
    ds_read_b64_tr_b16 v[60:61], v24 offset:6176
    v_fma_f32 v84, v102, v92, -v84
    v_mfma_f32_16x16x32_bf16 a[76:79], v[68:71], v[220:223], a[76:79]
    ds_read_b64_tr_b16 v[62:63], v24 offset:6944
    s_waitcnt lgkmcnt(8)
    v_mfma_f32_16x16x32_bf16 a[80:83], v[72:75], v[216:219], a[80:83]
    ds_read_b64_tr_b16 v[64:65], v23 offset:64
    v_fma_f32 v85, v102, v93, -v85
    v_mfma_f32_16x16x32_bf16 a[84:87], v[72:75], v[220:223], a[84:87]
    ds_read_b64_tr_b16 v[66:67], v23 offset:832
    v_fma_f32 v86, v102, v94, -v86
    v_mfma_f32_16x16x32_bf16 a[88:91], v[76:79], v[216:219], a[88:91]
    ds_read_b64_tr_b16 v[68:69], v23 offset:6208
    v_fma_f32 v87, v102, v95, -v87
    v_mfma_f32_16x16x32_bf16 a[92:95], v[76:79], v[220:223], a[92:95]
    ds_read_b64_tr_b16 v[70:71], v23 offset:6976
    s_waitcnt lgkmcnt(8)
    v_mfma_f32_16x16x32_bf16 a[0:3], v[48:51], v[224:227], a[0:3]
    ds_read_b64_tr_b16 v[72:73], v24 offset:96
    v_cvt_pk_bf16_f32 v96, v80, v81
    v_mfma_f32_16x16x32_bf16 a[4:7], v[48:51], v[228:231], a[4:7]
    ds_read_b64_tr_b16 v[74:75], v24 offset:864
    v_cvt_pk_bf16_f32 v97, v82, v83
    v_mfma_f32_16x16x32_bf16 a[8:11], v[52:55], v[224:227], a[8:11]
    ds_read_b64_tr_b16 v[76:77], v24 offset:6240
    v_cvt_pk_bf16_f32 v98, v84, v85
    v_mfma_f32_16x16x32_bf16 a[12:15], v[52:55], v[228:231], a[12:15]
    ds_read_b64_tr_b16 v[78:79], v24 offset:7008
    s_waitcnt lgkmcnt(8)
    v_mfma_f32_16x16x32_bf16 a[16:19], v[56:59], v[224:227], a[16:19]
    ds_read_b64_tr_b16 v[48:49], v23 offset:128
    v_cvt_pk_bf16_f32 v99, v86, v87
    v_mfma_f32_16x16x32_bf16 a[20:23], v[56:59], v[228:231], a[20:23]
    ds_read_b64_tr_b16 v[50:51], v23 offset:896
    ds_write_b128 v100, v[96:99] offset:4096
    v_mfma_f32_16x16x32_bf16 a[24:27], v[60:63], v[224:227], a[24:27]
    ds_read_b64_tr_b16 v[52:53], v23 offset:6272
    v_fma_f32 v88, v102, v80, -v88
    v_mfma_f32_16x16x32_bf16 a[28:31], v[60:63], v[228:231], a[28:31]
    ds_read_b64_tr_b16 v[54:55], v23 offset:7040
    s_waitcnt lgkmcnt(9)
    v_mfma_f32_16x16x32_bf16 a[32:35], v[64:67], v[224:227], a[32:35]
    ds_read_b64_tr_b16 v[56:57], v24 offset:160
    s_waitcnt vmcnt(6)
    v_mfma_f32_16x16x32_bf16 a[36:39], v[64:67], v[228:231], a[36:39]
    ds_read_b64_tr_b16 v[58:59], v24 offset:928
    v_fma_f32 v89, v102, v81, -v89
    v_mfma_f32_16x16x32_bf16 a[40:43], v[68:71], v[224:227], a[40:43]
    ds_read_b64_tr_b16 v[60:61], v24 offset:6304
    s_barrier
    v_mfma_f32_16x16x32_bf16 a[44:47], v[68:71], v[228:231], a[44:47]
    ds_read_b64_tr_b16 v[62:63], v24 offset:7072
    s_waitcnt lgkmcnt(9)
    v_mfma_f32_16x16x32_bf16 a[48:51], v[72:75], v[224:227], a[48:51]
    ds_read_b64_tr_b16 v[64:65], v23 offset:12288
    s_add_u32 m0, s38, 61440
    v_mfma_f32_16x16x32_bf16 a[52:55], v[72:75], v[228:231], a[52:55]
    ds_read_b64_tr_b16 v[66:67], v23 offset:13056
    buffer_load_dwordx4 v20, s[8:11], s21 offen offset:0  lds
    v_mfma_f32_16x16x32_bf16 a[56:59], v[76:79], v[224:227], a[56:59]
    ds_read_b64_tr_b16 v[68:69], v23 offset:18432
    v_fma_f32 v90, v102, v82, -v90
    v_mfma_f32_16x16x32_bf16 a[60:63], v[76:79], v[228:231], a[60:63]
    ds_read_b64_tr_b16 v[70:71], v23 offset:19200
    s_waitcnt lgkmcnt(8)
    v_mfma_f32_16x16x32_bf16 a[64:67], v[48:51], v[224:227], a[64:67]
    ds_read_b64_tr_b16 v[72:73], v24 offset:12320
    buffer_load_dwordx4 v21, s[8:11], s21 offen offset:1024  lds
    v_mfma_f32_16x16x32_bf16 a[68:71], v[48:51], v[228:231], a[68:71]
    ds_read_b64_tr_b16 v[74:75], v24 offset:13088
    v_fma_f32 v91, v102, v83, -v91
    v_mfma_f32_16x16x32_bf16 a[72:75], v[52:55], v[224:227], a[72:75]
    ds_read_b64_tr_b16 v[76:77], v24 offset:18464
    v_fma_f32 v92, v102, v84, -v92
    v_mfma_f32_16x16x32_bf16 a[76:79], v[52:55], v[228:231], a[76:79]
    ds_read_b64_tr_b16 v[78:79], v24 offset:19232
    s_waitcnt lgkmcnt(8)
    v_mfma_f32_16x16x32_bf16 a[80:83], v[56:59], v[224:227], a[80:83]
    ds_read_b64_tr_b16 v[48:49], v23 offset:12352
    buffer_load_dwordx4 v22, s[8:11], s21 offen offset:2048  lds
    v_mfma_f32_16x16x32_bf16 a[84:87], v[56:59], v[228:231], a[84:87]
    ds_read_b64_tr_b16 v[50:51], v23 offset:13120
    v_fma_f32 v93, v102, v85, -v93
    v_mfma_f32_16x16x32_bf16 a[88:91], v[60:63], v[224:227], a[88:91]
    ds_read_b64_tr_b16 v[52:53], v23 offset:18496
    v_fma_f32 v94, v102, v86, -v94
    v_mfma_f32_16x16x32_bf16 a[92:95], v[60:63], v[228:231], a[92:95]
    ds_read_b64_tr_b16 v[54:55], v23 offset:19264
    s_waitcnt lgkmcnt(8)
    v_mfma_f32_16x16x32_bf16 a[0:3], v[64:67], v[232:235], a[0:3]
    ds_read_b64_tr_b16 v[56:57], v24 offset:12384
    s_add_u32 m0, s38, 73728
    v_mfma_f32_16x16x32_bf16 a[4:7], v[64:67], v[236:239], a[4:7]
    ds_read_b64_tr_b16 v[58:59], v24 offset:13152
    buffer_load_dwordx4 v20, s[8:11], s22 offen offset:0  lds
    v_mfma_f32_16x16x32_bf16 a[8:11], v[68:71], v[232:235], a[8:11]
    ds_read_b64_tr_b16 v[60:61], v24 offset:18528
    v_fma_f32 v95, v102, v87, -v95
    v_mfma_f32_16x16x32_bf16 a[12:15], v[68:71], v[236:239], a[12:15]
    ds_read_b64_tr_b16 v[62:63], v24 offset:19296
    s_waitcnt lgkmcnt(8)
    v_mfma_f32_16x16x32_bf16 a[16:19], v[72:75], v[232:235], a[16:19]
    ds_read_b64_tr_b16 v[64:65], v23 offset:12416
    buffer_load_dwordx4 v21, s[8:11], s22 offen offset:1024  lds
    v_mfma_f32_16x16x32_bf16 a[20:23], v[72:75], v[236:239], a[20:23]
    ds_read_b64_tr_b16 v[66:67], v23 offset:13184
    v_cvt_pk_bf16_f32 v96, v88, v89
    v_mfma_f32_16x16x32_bf16 a[24:27], v[76:79], v[232:235], a[24:27]
    ds_read_b64_tr_b16 v[68:69], v23 offset:18560
    v_cvt_pk_bf16_f32 v97, v90, v91
    v_mfma_f32_16x16x32_bf16 a[28:31], v[76:79], v[236:239], a[28:31]
    ds_read_b64_tr_b16 v[70:71], v23 offset:19328
    s_waitcnt lgkmcnt(8)
    v_mfma_f32_16x16x32_bf16 a[32:35], v[48:51], v[232:235], a[32:35]
    ds_read_b64_tr_b16 v[72:73], v24 offset:12448
    buffer_load_dwordx4 v22, s[8:11], s22 offen offset:2048  lds
    v_mfma_f32_16x16x32_bf16 a[36:39], v[48:51], v[236:239], a[36:39]
    ds_read_b64_tr_b16 v[74:75], v24 offset:13216
    v_cvt_pk_bf16_f32 v98, v92, v93
    v_mfma_f32_16x16x32_bf16 a[40:43], v[52:55], v[232:235], a[40:43]
    ds_read_b64_tr_b16 v[76:77], v24 offset:18592
    v_cvt_pk_bf16_f32 v99, v94, v95
    v_mfma_f32_16x16x32_bf16 a[44:47], v[52:55], v[236:239], a[44:47]
    ds_read_b64_tr_b16 v[78:79], v24 offset:19360
    s_waitcnt lgkmcnt(8)
    v_mfma_f32_16x16x32_bf16 a[48:51], v[56:59], v[232:235], a[48:51]
    ds_read_b64_tr_b16 v[48:49], v23 offset:24576
    ds_write_b128 v100, v[96:99] offset:6144
    v_mfma_f32_16x16x32_bf16 a[52:55], v[56:59], v[236:239], a[52:55]
    ds_read_b64_tr_b16 v[50:51], v23 offset:25344
    v_fma_f32 v80, v102, v88, -v80
    v_mfma_f32_16x16x32_bf16 a[56:59], v[60:63], v[232:235], a[56:59]
    ds_read_b64_tr_b16 v[52:53], v23 offset:30720
    v_fma_f32 v81, v102, v89, -v81
    v_mfma_f32_16x16x32_bf16 a[60:63], v[60:63], v[236:239], a[60:63]
    ds_read_b64_tr_b16 v[54:55], v23 offset:31488
    s_waitcnt lgkmcnt(9)
    v_mfma_f32_16x16x32_bf16 a[64:67], v[64:67], v[232:235], a[64:67]
    ds_read_b64_tr_b16 v[56:57], v24 offset:24608
    v_fma_f32 v82, v102, v90, -v82
    v_mfma_f32_16x16x32_bf16 a[68:71], v[64:67], v[236:239], a[68:71]
    ds_read_b64_tr_b16 v[58:59], v24 offset:25376
    v_fma_f32 v83, v102, v91, -v83
    v_mfma_f32_16x16x32_bf16 a[72:75], v[68:71], v[232:235], a[72:75]
    ds_read_b64_tr_b16 v[60:61], v24 offset:30752
    v_fma_f32 v84, v102, v92, -v84
    v_mfma_f32_16x16x32_bf16 a[76:79], v[68:71], v[236:239], a[76:79]
    ds_read_b64_tr_b16 v[62:63], v24 offset:31520
    s_waitcnt lgkmcnt(9)
    v_mfma_f32_16x16x32_bf16 a[80:83], v[72:75], v[232:235], a[80:83]
    ds_read_b64_tr_b16 v[64:65], v23 offset:24640
    v_fma_f32 v85, v102, v93, -v85
    v_mfma_f32_16x16x32_bf16 a[84:87], v[72:75], v[236:239], a[84:87]
    ds_read_b64_tr_b16 v[66:67], v23 offset:25408
    v_fma_f32 v86, v102, v94, -v86
    v_mfma_f32_16x16x32_bf16 a[88:91], v[76:79], v[232:235], a[88:91]
    ds_read_b64_tr_b16 v[68:69], v23 offset:30784
    v_fma_f32 v87, v102, v95, -v87
    v_mfma_f32_16x16x32_bf16 a[92:95], v[76:79], v[236:239], a[92:95]
    ds_read_b64_tr_b16 v[70:71], v23 offset:31552
    s_waitcnt lgkmcnt(8)
    v_mfma_f32_16x16x32_bf16 a[0:3], v[48:51], v[240:243], a[0:3]
    ds_read_b64_tr_b16 v[72:73], v24 offset:24672
    v_cvt_pk_bf16_f32 v96, v80, v81
    v_mfma_f32_16x16x32_bf16 a[4:7], v[48:51], v[244:247], a[4:7]
    ds_read_b64_tr_b16 v[74:75], v24 offset:25440
    v_cvt_pk_bf16_f32 v97, v82, v83
    v_mfma_f32_16x16x32_bf16 a[8:11], v[52:55], v[240:243], a[8:11]
    ds_read_b64_tr_b16 v[76:77], v24 offset:30816
    v_cvt_pk_bf16_f32 v98, v84, v85
    v_mfma_f32_16x16x32_bf16 a[12:15], v[52:55], v[244:247], a[12:15]
    ds_read_b64_tr_b16 v[78:79], v24 offset:31584
    s_waitcnt lgkmcnt(8)
    v_mfma_f32_16x16x32_bf16 a[16:19], v[56:59], v[240:243], a[16:19]
    ds_read_b64_tr_b16 v[48:49], v23 offset:24704
    v_cvt_pk_bf16_f32 v99, v86, v87
    v_mfma_f32_16x16x32_bf16 a[20:23], v[56:59], v[244:247], a[20:23]
    ds_read_b64_tr_b16 v[50:51], v23 offset:25472
    ds_write_b128 v100, v[96:99] offset:8192
    v_mfma_f32_16x16x32_bf16 a[24:27], v[60:63], v[240:243], a[24:27]
    ds_read_b64_tr_b16 v[52:53], v23 offset:30848
    v_fma_f32 v88, v102, v80, -v88
    v_mfma_f32_16x16x32_bf16 a[28:31], v[60:63], v[244:247], a[28:31]
    ds_read_b64_tr_b16 v[54:55], v23 offset:31616
    s_waitcnt lgkmcnt(9)
    v_mfma_f32_16x16x32_bf16 a[32:35], v[64:67], v[240:243], a[32:35]
    ds_read_b64_tr_b16 v[56:57], v24 offset:24736
    s_waitcnt vmcnt(6)
    v_mfma_f32_16x16x32_bf16 a[36:39], v[64:67], v[244:247], a[36:39]
    ds_read_b64_tr_b16 v[58:59], v24 offset:25504
    v_fma_f32 v89, v102, v81, -v89
    v_mfma_f32_16x16x32_bf16 a[40:43], v[68:71], v[240:243], a[40:43]
    ds_read_b64_tr_b16 v[60:61], v24 offset:30880
    s_barrier
    v_mfma_f32_16x16x32_bf16 a[44:47], v[68:71], v[244:247], a[44:47]
    ds_read_b64_tr_b16 v[62:63], v24 offset:31648
    s_waitcnt lgkmcnt(9)
    v_mfma_f32_16x16x32_bf16 a[48:51], v[72:75], v[240:243], a[48:51]
    ds_read_b64_tr_b16 v[64:65], v23 offset:36864
    s_add_u32 m0, s38, 0
    v_mfma_f32_16x16x32_bf16 a[52:55], v[72:75], v[244:247], a[52:55]
    ds_read_b64_tr_b16 v[66:67], v23 offset:37632
    buffer_load_dwordx4 v20, s[8:11], s23 offen offset:0  lds
    v_mfma_f32_16x16x32_bf16 a[56:59], v[76:79], v[240:243], a[56:59]
    ds_read_b64_tr_b16 v[68:69], v23 offset:43008
    v_fma_f32 v90, v102, v82, -v90
    v_mfma_f32_16x16x32_bf16 a[60:63], v[76:79], v[244:247], a[60:63]
    ds_read_b64_tr_b16 v[70:71], v23 offset:43776
    s_waitcnt lgkmcnt(8)
    v_mfma_f32_16x16x32_bf16 a[64:67], v[48:51], v[240:243], a[64:67]
    ds_read_b64_tr_b16 v[72:73], v24 offset:36896
    buffer_load_dwordx4 v21, s[8:11], s23 offen offset:1024  lds
    v_mfma_f32_16x16x32_bf16 a[68:71], v[48:51], v[244:247], a[68:71]
    ds_read_b64_tr_b16 v[74:75], v24 offset:37664
    v_fma_f32 v91, v102, v83, -v91
    v_mfma_f32_16x16x32_bf16 a[72:75], v[52:55], v[240:243], a[72:75]
    ds_read_b64_tr_b16 v[76:77], v24 offset:43040
    v_fma_f32 v92, v102, v84, -v92
    v_mfma_f32_16x16x32_bf16 a[76:79], v[52:55], v[244:247], a[76:79]
    ds_read_b64_tr_b16 v[78:79], v24 offset:43808
    s_waitcnt lgkmcnt(8)
    v_mfma_f32_16x16x32_bf16 a[80:83], v[56:59], v[240:243], a[80:83]
    ds_read_b64_tr_b16 v[48:49], v23 offset:36928
    buffer_load_dwordx4 v22, s[8:11], s23 offen offset:2048  lds
    v_mfma_f32_16x16x32_bf16 a[84:87], v[56:59], v[244:247], a[84:87]
    ds_read_b64_tr_b16 v[50:51], v23 offset:37696
    v_fma_f32 v93, v102, v85, -v93
    v_mfma_f32_16x16x32_bf16 a[88:91], v[60:63], v[240:243], a[88:91]
    ds_read_b64_tr_b16 v[52:53], v23 offset:43072
    v_fma_f32 v94, v102, v86, -v94
    v_mfma_f32_16x16x32_bf16 a[92:95], v[60:63], v[244:247], a[92:95]
    ds_read_b64_tr_b16 v[54:55], v23 offset:43840
    s_waitcnt lgkmcnt(8)
    v_mfma_f32_16x16x32_bf16 a[0:3], v[64:67], v[248:251], a[0:3]
    ds_read_b64_tr_b16 v[56:57], v24 offset:36960
    s_add_u32 m0, s38, 12288
    v_mfma_f32_16x16x32_bf16 a[4:7], v[64:67], v[252:255], a[4:7]
    ds_read_b64_tr_b16 v[58:59], v24 offset:37728
    buffer_load_dwordx4 v20, s[8:11], s24 offen offset:0  lds
    v_mfma_f32_16x16x32_bf16 a[8:11], v[68:71], v[248:251], a[8:11]
    ds_read_b64_tr_b16 v[60:61], v24 offset:43104
    v_fma_f32 v95, v102, v87, -v95
    v_mfma_f32_16x16x32_bf16 a[12:15], v[68:71], v[252:255], a[12:15]
    ds_read_b64_tr_b16 v[62:63], v24 offset:43872
    s_waitcnt lgkmcnt(8)
    v_mfma_f32_16x16x32_bf16 a[16:19], v[72:75], v[248:251], a[16:19]
    ds_read_b64_tr_b16 v[64:65], v23 offset:36992
    buffer_load_dwordx4 v21, s[8:11], s24 offen offset:1024  lds
    v_mfma_f32_16x16x32_bf16 a[20:23], v[72:75], v[252:255], a[20:23]
    ds_read_b64_tr_b16 v[66:67], v23 offset:37760
    v_cvt_pk_bf16_f32 v96, v88, v89
    v_mfma_f32_16x16x32_bf16 a[24:27], v[76:79], v[248:251], a[24:27]
    ds_read_b64_tr_b16 v[68:69], v23 offset:43136
    v_cvt_pk_bf16_f32 v97, v90, v91
    v_mfma_f32_16x16x32_bf16 a[28:31], v[76:79], v[252:255], a[28:31]
    ds_read_b64_tr_b16 v[70:71], v23 offset:43904
    s_waitcnt lgkmcnt(8)
    v_mfma_f32_16x16x32_bf16 a[32:35], v[48:51], v[248:251], a[32:35]
    ds_read_b64_tr_b16 v[72:73], v24 offset:37024
    buffer_load_dwordx4 v22, s[8:11], s24 offen offset:2048  lds
    v_mfma_f32_16x16x32_bf16 a[36:39], v[48:51], v[252:255], a[36:39]
    ds_read_b64_tr_b16 v[74:75], v24 offset:37792
    v_cvt_pk_bf16_f32 v98, v92, v93
    v_mfma_f32_16x16x32_bf16 a[40:43], v[52:55], v[248:251], a[40:43]
    ds_read_b64_tr_b16 v[76:77], v24 offset:43168
    v_cvt_pk_bf16_f32 v99, v94, v95
    v_mfma_f32_16x16x32_bf16 a[44:47], v[52:55], v[252:255], a[44:47]
    ds_read_b64_tr_b16 v[78:79], v24 offset:43936
    s_waitcnt lgkmcnt(8)
    ds_write_b128 v100, v[96:99] offset:10240
    v_fma_f32 v80, v102, v88, -v80
    v_fma_f32 v81, v102, v89, -v81
    v_fma_f32 v82, v102, v90, -v82
    v_fma_f32 v83, v102, v91, -v83
    v_fma_f32 v84, v102, v92, -v84
    v_fma_f32 v85, v102, v93, -v85
    v_fma_f32 v86, v102, v94, -v86
    v_fma_f32 v87, v102, v95, -v87
    v_cvt_pk_bf16_f32 v96, v80, v81
    v_cvt_pk_bf16_f32 v97, v82, v83
    v_cvt_pk_bf16_f32 v98, v84, v85
    v_cvt_pk_bf16_f32 v99, v86, v87
    ds_write_b128 v100, v[96:99] offset:12288
    v_fma_f32 v88, v102, v80, -v88
    v_fma_f32 v89, v102, v81, -v89
    v_fma_f32 v90, v102, v82, -v90
    v_fma_f32 v91, v102, v83, -v91
    v_fma_f32 v92, v102, v84, -v92
    v_fma_f32 v93, v102, v85, -v93
    v_fma_f32 v94, v102, v86, -v94
    v_fma_f32 v95, v102, v87, -v95
    v_cvt_pk_bf16_f32 v96, v88, v89
    v_cvt_pk_bf16_f32 v97, v90, v91
    v_cvt_pk_bf16_f32 v98, v92, v93
    v_cvt_pk_bf16_f32 v99, v94, v95
    ds_write_b128 v100, v[96:99] offset:14336
    v_fma_f32 v80, v102, v88, -v80
    v_fma_f32 v81, v102, v89, -v81
    v_fma_f32 v82, v102, v90, -v82
    v_fma_f32 v83, v102, v91, -v83
    v_fma_f32 v84, v102, v92, -v84
    v_fma_f32 v85, v102, v93, -v85
    v_fma_f32 v86, v102, v94, -v86
    v_fma_f32 v87, v102, v95, -v87
    v_cvt_pk_bf16_f32 v96, v80, v81
    v_cvt_pk_bf16_f32 v97, v82, v83
    v_cvt_pk_bf16_f32 v98, v84, v85
    v_cvt_pk_bf16_f32 v99, v86, v87
    ds_write_b128 v100, v[96:99] offset:16384
    s_cmp_eq_u32 s94, 2
    s_cbranch_scc1 L1_PN
    s_cmp_eq_u32 s94, 1
    s_cbranch_scc1 L1_PD1
    s_waitcnt lgkmcnt(0)
    s_barrier
    v_mfma_f32_16x16x32_bf16 a[48:51], v[56:59], v[248:251], a[48:51]
    ds_read_b128 v[48:51], v37 offset:0
    v_mfma_f32_16x16x32_bf16 a[52:55], v[56:59], v[252:255], a[52:55]
    v_mfma_f32_16x16x32_bf16 a[56:59], v[60:63], v[248:251], a[56:59]
    ds_read_b128 v[52:55], v37 offset:1024
    v_mfma_f32_16x16x32_bf16 a[60:63], v[60:63], v[252:255], a[60:63]
    v_mfma_f32_16x16x32_bf16 a[64:67], v[64:67], v[248:251], a[64:67]
    ds_read_b128 v[56:59], v37 offset:2048
    v_mfma_f32_16x16x32_bf16 a[68:71], v[64:67], v[252:255], a[68:71]
    v_mfma_f32_16x16x32_bf16 a[72:75], v[68:71], v[248:251], a[72:75]
    ds_read_b128 v[60:63], v37 offset:3072
    v_mfma_f32_16x16x32_bf16 a[76:79], v[68:71], v[252:255], a[76:79]
    v_mfma_f32_16x16x32_bf16 a[80:83], v[72:75], v[248:251], a[80:83]
    ds_read_b128 v[64:67], v37 offset:4096
    v_mfma_f32_16x16x32_bf16 a[84:87], v[72:75], v[252:255], a[84:87]
    v_mfma_f32_16x16x32_bf16 a[88:91], v[76:79], v[248:251], a[88:91]
    ds_read_b128 v[68:71], v37 offset:5120
    v_mfma_f32_16x16x32_bf16 a[92:95], v[76:79], v[252:255], a[92:95]
    s_waitcnt lgkmcnt(4)
    v_mfma_f32_16x16x32_bf16 a[192:195], v[48:51], v[112:115], 0
    ds_read_b128 v[72:75], v37 offset:6144
    v_mfma_f32_16x16x32_bf16 a[196:199], v[48:51], v[116:119], 0
    v_mfma_f32_16x16x32_bf16 a[200:203], v[52:55], v[112:115], 0
    ds_read_b128 v[76:79], v37 offset:7168
    v_mfma_f32_16x16x32_bf16 a[204:207], v[52:55], v[116:119], 0
    s_waitcnt lgkmcnt(4)
    v_mfma_f32_16x16x32_bf16 a[192:195], v[56:59], v[120:123], a[192:195]
    ds_read_b128 v[48:51], v37 offset:8192
    v_mfma_f32_16x16x32_bf16 a[196:199], v[56:59], v[124:127], a[196:199]
    v_mfma_f32_16x16x32_bf16 a[200:203], v[60:63], v[120:123], a[200:203]
    ds_read_b128 v[52:55], v37 offset:9216
    v_mfma_f32_16x16x32_bf16 a[204:207], v[60:63], v[124:127], a[204:207]
    s_waitcnt lgkmcnt(4)
    v_mfma_f32_16x16x32_bf16 a[192:195], v[64:67], v[128:131], a[192:195]
    ds_read_b128 v[56:59], v37 offset:10240
    v_mfma_f32_16x16x32_bf16 a[196:199], v[64:67], v[132:135], a[196:199]
    v_mfma_f32_16x16x32_bf16 a[200:203], v[68:71], v[128:131], a[200:203]
    ds_read_b128 v[60:63], v37 offset:11264
    v_mfma_f32_16x16x32_bf16 a[204:207], v[68:71], v[132:135], a[204:207]
    s_waitcnt lgkmcnt(4)
    v_mfma_f32_16x16x32_bf16 a[192:195], v[72:75], v[136:139], a[192:195]
    ds_read_b128 v[64:67], v37 offset:12288
    v_mfma_f32_16x16x32_bf16 a[196:199], v[72:75], v[140:143], a[196:199]
    v_mfma_f32_16x16x32_bf16 a[200:203], v[76:79], v[136:139], a[200:203]
    ds_read_b128 v[68:71], v37 offset:13312
    v_mfma_f32_16x16x32_bf16 a[204:207], v[76:79], v[140:143], a[204:207]
    s_waitcnt lgkmcnt(4)
    v_mfma_f32_16x16x32_bf16 a[192:195], v[48:51], v[144:147], a[192:195]
    ds_read_b128 v[72:75], v37 offset:14336
    v_mfma_f32_16x16x32_bf16 a[196:199], v[48:51], v[148:151], a[196:199]
    v_mfma_f32_16x16x32_bf16 a[200:203], v[52:55], v[144:147], a[200:203]
    ds_read_b128 v[76:79], v37 offset:15360
    v_mfma_f32_16x16x32_bf16 a[204:207], v[52:55], v[148:151], a[204:207]
    s_waitcnt lgkmcnt(4)
    v_mfma_f32_16x16x32_bf16 a[192:195], v[56:59], v[152:155], a[192:195]
    ds_read_b128 v[48:51], v37 offset:16384
    v_mfma_f32_16x16x32_bf16 a[196:199], v[56:59], v[156:159], a[196:199]
    v_mfma_f32_16x16x32_bf16 a[200:203], v[60:63], v[152:155], a[200:203]
    ds_read_b128 v[52:55], v37 offset:17408
    v_mfma_f32_16x16x32_bf16 a[204:207], v[60:63], v[156:159], a[204:207]
    s_waitcnt lgkmcnt(4)
    v_mfma_f32_16x16x32_bf16 a[192:195], v[64:67], v[160:163], a[192:195]
    ds_read_b128 v[56:59], v37 offset:18432
    v_mfma_f32_16x16x32_bf16 a[196:199], v[64:67], v[164:167], a[196:199]
    v_mfma_f32_16x16x32_bf16 a[200:203], v[68:71], v[160:163], a[200:203]
    ds_read_b128 v[60:63], v37 offset:19456
    v_mfma_f32_16x16x32_bf16 a[204:207], v[68:71], v[164:167], a[204:207]
    s_waitcnt lgkmcnt(4)
    v_mfma_f32_16x16x32_bf16 a[192:195], v[72:75], v[168:171], a[192:195]
    ds_read_b128 v[64:67], v37 offset:20480
    v_mfma_f32_16x16x32_bf16 a[196:199], v[72:75], v[172:175], a[196:199]
    v_mfma_f32_16x16x32_bf16 a[200:203], v[76:79], v[168:171], a[200:203]
    ds_read_b128 v[68:71], v37 offset:21504
    v_mfma_f32_16x16x32_bf16 a[204:207], v[76:79], v[172:175], a[204:207]
    s_waitcnt lgkmcnt(4)
    v_mfma_f32_16x16x32_bf16 a[192:195], v[48:51], v[176:179], a[192:195]
    ds_read_b128 v[72:75], v37 offset:22528
    v_mfma_f32_16x16x32_bf16 a[196:199], v[48:51], v[180:183], a[196:199]
    v_mfma_f32_16x16x32_bf16 a[200:203], v[52:55], v[176:179], a[200:203]
    ds_read_b128 v[76:79], v37 offset:23552
    v_mfma_f32_16x16x32_bf16 a[204:207], v[52:55], v[180:183], a[204:207]
    s_waitcnt lgkmcnt(4)
    v_mfma_f32_16x16x32_bf16 a[192:195], v[56:59], v[184:187], a[192:195]
    ds_read_b128 v[48:51], v37 offset:24576
    v_mfma_f32_16x16x32_bf16 a[196:199], v[56:59], v[188:191], a[196:199]
    v_mfma_f32_16x16x32_bf16 a[200:203], v[60:63], v[184:187], a[200:203]
    ds_read_b128 v[52:55], v37 offset:25600
    v_mfma_f32_16x16x32_bf16 a[204:207], v[60:63], v[188:191], a[204:207]
    s_waitcnt lgkmcnt(4)
    v_mfma_f32_16x16x32_bf16 a[192:195], v[64:67], v[192:195], a[192:195]
    ds_read_b128 v[56:59], v37 offset:26624
    v_mfma_f32_16x16x32_bf16 a[196:199], v[64:67], v[196:199], a[196:199]
    v_mfma_f32_16x16x32_bf16 a[200:203], v[68:71], v[192:195], a[200:203]
    ds_read_b128 v[60:63], v37 offset:27648
    v_mfma_f32_16x16x32_bf16 a[204:207], v[68:71], v[196:199], a[204:207]
    s_waitcnt lgkmcnt(4)
    v_mfma_f32_16x16x32_bf16 a[192:195], v[72:75], v[200:203], a[192:195]
    ds_read_b128 v[64:67], v37 offset:28672
    v_mfma_f32_16x16x32_bf16 a[196:199], v[72:75], v[204:207], a[196:199]
    v_mfma_f32_16x16x32_bf16 a[200:203], v[76:79], v[200:203], a[200:203]
    ds_read_b128 v[68:71], v37 offset:29696
    v_mfma_f32_16x16x32_bf16 a[204:207], v[76:79], v[204:207], a[204:207]
    s_waitcnt lgkmcnt(4)
    v_mfma_f32_16x16x32_bf16 a[192:195], v[48:51], v[208:211], a[192:195]
    ds_read_b128 v[72:75], v37 offset:30720
    v_mfma_f32_16x16x32_bf16 a[196:199], v[48:51], v[212:215], a[196:199]
    v_mfma_f32_16x16x32_bf16 a[200:203], v[52:55], v[208:211], a[200:203]
    ds_read_b128 v[76:79], v37 offset:31744
    v_mfma_f32_16x16x32_bf16 a[204:207], v[52:55], v[212:215], a[204:207]
    s_waitcnt lgkmcnt(4)
    v_mfma_f32_16x16x32_bf16 a[192:195], v[56:59], v[216:219], a[192:195]
    ds_read_b128 v[48:51], v37 offset:32768
    v_mfma_f32_16x16x32_bf16 a[196:199], v[56:59], v[220:223], a[196:199]
    v_mfma_f32_16x16x32_bf16 a[200:203], v[60:63], v[216:219], a[200:203]
    ds_read_b128 v[52:55], v37 offset:33792
    v_mfma_f32_16x16x32_bf16 a[204:207], v[60:63], v[220:223], a[204:207]
    s_waitcnt lgkmcnt(4)
    v_mfma_f32_16x16x32_bf16 a[192:195], v[64:67], v[224:227], a[192:195]
    ds_read_b128 v[56:59], v37 offset:34816
    v_mfma_f32_16x16x32_bf16 a[196:199], v[64:67], v[228:231], a[196:199]
    v_mfma_f32_16x16x32_bf16 a[200:203], v[68:71], v[224:227], a[200:203]
    ds_read_b128 v[60:63], v37 offset:35840
    v_mfma_f32_16x16x32_bf16 a[204:207], v[68:71], v[228:231], a[204:207]
    s_waitcnt lgkmcnt(4)
    v_mfma_f32_16x16x32_bf16 a[192:195], v[72:75], v[232:235], a[192:195]
    ds_read_b128 v[64:67], v46 offset:0
    v_mfma_f32_16x16x32_bf16 a[196:199], v[72:75], v[236:239], a[196:199]
    v_mfma_f32_16x16x32_bf16 a[200:203], v[76:79], v[232:235], a[200:203]
    ds_read_b128 v[68:71], v46 offset:1024
    v_mfma_f32_16x16x32_bf16 a[204:207], v[76:79], v[236:239], a[204:207]
    s_waitcnt lgkmcnt(4)
    v_mfma_f32_16x16x32_bf16 a[192:195], v[48:51], v[240:243], a[192:195]
    ds_read_b128 v[72:75], v46 offset:2048
    v_mfma_f32_16x16x32_bf16 a[196:199], v[48:51], v[244:247], a[196:199]
    v_mfma_f32_16x16x32_bf16 a[200:203], v[52:55], v[240:243], a[200:203]
    ds_read_b128 v[76:79], v46 offset:3072
    v_mfma_f32_16x16x32_bf16 a[204:207], v[52:55], v[244:247], a[204:207]
    s_waitcnt lgkmcnt(4)
    v_mfma_f32_16x16x32_bf16 a[192:195], v[56:59], v[248:251], a[192:195]
    ds_read_b128 v[48:51], v46 offset:4096
    v_mfma_f32_16x16x32_bf16 a[196:199], v[56:59], v[252:255], a[196:199]
    v_mfma_f32_16x16x32_bf16 a[200:203], v[60:63], v[248:251], a[200:203]
    ds_read_b128 v[52:55], v46 offset:5120
    v_mfma_f32_16x16x32_bf16 a[204:207], v[60:63], v[252:255], a[204:207]
    s_waitcnt lgkmcnt(4)
    v_mfma_f32_16x16x32_bf16 a[208:211], v[64:67], v[112:115], 0
    ds_read_b128 v[56:59], v46 offset:6144
    v_mfma_f32_16x16x32_bf16 a[216:219], v[68:71], v[112:115], 0
    ds_read_b128 v[60:63], v46 offset:7168
    s_waitcnt lgkmcnt(4)
    v_mfma_f32_16x16x32_bf16 a[208:211], v[72:75], v[120:123], a[208:211]
    ds_read_b128 v[64:67], v46 offset:8192
    v_mfma_f32_16x16x32_bf16 a[216:219], v[76:79], v[120:123], a[216:219]
    ds_read_b128 v[68:71], v46 offset:9216
    s_waitcnt lgkmcnt(4)
    v_mfma_f32_16x16x32_bf16 a[208:211], v[48:51], v[128:131], a[208:211]
    ds_read_b128 v[72:75], v46 offset:10240
    v_mfma_f32_16x16x32_bf16 a[216:219], v[52:55], v[128:131], a[216:219]
    ds_read_b128 v[76:79], v46 offset:11264
    s_waitcnt lgkmcnt(4)
    v_mfma_f32_16x16x32_bf16 a[208:211], v[56:59], v[136:139], a[208:211]
    ds_read_b128 v[48:51], v46 offset:12288
    v_mfma_f32_16x16x32_bf16 a[216:219], v[60:63], v[136:139], a[216:219]
    ds_read_b128 v[52:55], v46 offset:13312
    s_waitcnt lgkmcnt(4)
    v_mfma_f32_16x16x32_bf16 a[208:211], v[64:67], v[144:147], a[208:211]
    ds_read_b128 v[56:59], v46 offset:14336
    v_accvgpr_read_b32 v88, a192
    v_mfma_f32_16x16x32_bf16 a[216:219], v[68:71], v[144:147], a[216:219]
    ds_read_b128 v[60:63], v46 offset:15360
    s_waitcnt lgkmcnt(4)
    v_mfma_f32_16x16x32_bf16 a[208:211], v[72:75], v[152:155], a[208:211]
    ds_read_b128 v[64:67], v46 offset:16384
    v_accvgpr_read_b32 v89, a193
    v_mfma_f32_16x16x32_bf16 a[216:219], v[76:79], v[152:155], a[216:219]
    ds_read_b128 v[68:71], v46 offset:17408
    s_waitcnt lgkmcnt(4)
    v_mfma_f32_16x16x32_bf16 a[208:211], v[48:51], v[160:163], a[208:211]
    ds_read_b128 v[72:75], v46 offset:18432
    v_accvgpr_read_b32 v90, a194
    v_mfma_f32_16x16x32_bf16 a[216:219], v[52:55], v[160:163], a[216:219]
    ds_read_b128 v[76:79], v46 offset:19456
    s_waitcnt lgkmcnt(4)
    v_mfma_f32_16x16x32_bf16 a[208:211], v[56:59], v[168:171], a[208:211]
    ds_read_b128 v[48:51], v46 offset:20480
    v_accvgpr_read_b32 v91, a195
    v_mfma_f32_16x16x32_bf16 a[216:219], v[60:63], v[168:171], a[216:219]
    ds_read_b128 v[52:55], v46 offset:21504
    s_waitcnt lgkmcnt(4)
    v_mfma_f32_16x16x32_bf16 a[208:211], v[64:67], v[176:179], a[208:211]
    ds_read_b128 v[56:59], v46 offset:22528
    v_accvgpr_read_b32 v92, a200
    v_mfma_f32_16x16x32_bf16 a[216:219], v[68:71], v[176:179], a[216:219]
    ds_read_b128 v[60:63], v46 offset:23552
    s_waitcnt lgkmcnt(4)
    v_mfma_f32_16x16x32_bf16 a[208:211], v[72:75], v[184:187], a[208:211]
    ds_read_b128 v[64:67], v46 offset:24576
    v_accvgpr_read_b32 v93, a201
    v_mfma_f32_16x16x32_bf16 a[216:219], v[76:79], v[184:187], a[216:219]
    ds_read_b128 v[68:71], v46 offset:25600
    s_waitcnt lgkmcnt(4)
    v_mfma_f32_16x16x32_bf16 a[208:211], v[48:51], v[192:195], a[208:211]
    ds_read_b128 v[72:75], v46 offset:26624
    v_accvgpr_read_b32 v94, a202
    v_mfma_f32_16x16x32_bf16 a[216:219], v[52:55], v[192:195], a[216:219]
    ds_read_b128 v[76:79], v46 offset:27648
    s_waitcnt lgkmcnt(4)
    v_mfma_f32_16x16x32_bf16 a[208:211], v[56:59], v[200:203], a[208:211]
    ds_read_b128 v[48:51], v46 offset:28672
    v_accvgpr_read_b32 v95, a203
    v_mfma_f32_16x16x32_bf16 a[216:219], v[60:63], v[200:203], a[216:219]
    ds_read_b128 v[52:55], v46 offset:29696
    s_waitcnt lgkmcnt(4)
    v_mfma_f32_16x16x32_bf16 a[208:211], v[64:67], v[208:211], a[208:211]
    ds_read_b128 v[56:59], v46 offset:30720
    v_mul_f32 v88, v88, v32
    v_mfma_f32_16x16x32_bf16 a[216:219], v[68:71], v[208:211], a[216:219]
    ds_read_b128 v[60:63], v46 offset:31744
    s_waitcnt lgkmcnt(4)
    v_mfma_f32_16x16x32_bf16 a[208:211], v[72:75], v[216:219], a[208:211]
    ds_read_b128 v[64:67], v46 offset:32768
    v_mul_f32 v89, v89, v32
    v_mfma_f32_16x16x32_bf16 a[216:219], v[76:79], v[216:219], a[216:219]
    ds_read_b128 v[68:71], v46 offset:33792
    s_waitcnt lgkmcnt(4)
    v_mfma_f32_16x16x32_bf16 a[208:211], v[48:51], v[224:227], a[208:211]
    ds_read_b128 v[72:75], v46 offset:34816
    v_mul_f32 v90, v90, v32
    v_mfma_f32_16x16x32_bf16 a[216:219], v[52:55], v[224:227], a[216:219]
    ds_read_b128 v[76:79], v46 offset:35840
    s_waitcnt lgkmcnt(4)
    v_mfma_f32_16x16x32_bf16 a[208:211], v[56:59], v[232:235], a[208:211]
    ds_read_b64_tr_b16 v[48:49], v23 offset:49152
    ds_read_b64_tr_b16 v[50:51], v23 offset:49920
    v_mfma_f32_16x16x32_bf16 a[216:219], v[60:63], v[232:235], a[216:219]
    ds_read_b64_tr_b16 v[52:53], v23 offset:55296
    ds_read_b64_tr_b16 v[54:55], v23 offset:56064
    s_waitcnt lgkmcnt(6)
    v_mfma_f32_16x16x32_bf16 a[208:211], v[64:67], v[240:243], a[208:211]
    ds_read_b64_tr_b16 v[56:57], v24 offset:49184
    ds_read_b64_tr_b16 v[58:59], v24 offset:49952
    v_mfma_f32_16x16x32_bf16 a[216:219], v[68:71], v[240:243], a[216:219]
    ds_read_b64_tr_b16 v[60:61], v24 offset:55328
    ds_read_b64_tr_b16 v[62:63], v24 offset:56096
    s_waitcnt lgkmcnt(8)
    v_mfma_f32_16x16x32_bf16 a[208:211], v[72:75], v[248:251], a[208:211]
    ds_read_b64_tr_b16 v[64:65], v23 offset:49216
    ds_read_b64_tr_b16 v[66:67], v23 offset:49984
    v_mfma_f32_16x16x32_bf16 a[216:219], v[76:79], v[248:251], a[216:219]
    ds_read_b64_tr_b16 v[68:69], v23 offset:55360
    ds_read_b64_tr_b16 v[70:71], v23 offset:56128
    s_waitcnt lgkmcnt(8)
    v_mul_f32 v91, v91, v32
    v_mul_f32 v92, v92, v32
    v_mul_f32 v93, v93, v32
    v_mul_f32 v94, v94, v32
    v_mul_f32 v95, v95, v32
    v_cvt_pk_bf16_f32 v104, v88, v92
    v_cvt_pk_bf16_f32 v105, v89, v93
    v_cvt_pk_bf16_f32 v106, v90, v94
    v_cvt_pk_bf16_f32 v107, v91, v95
    buffer_store_dwordx4 v[104:107], v47, s[12:15], s44 offen offset:0 sc1
    v_accvgpr_read_b32 v88, a196
    v_accvgpr_read_b32 v89, a197
    v_accvgpr_read_b32 v90, a198
    v_accvgpr_read_b32 v91, a199
    v_accvgpr_read_b32 v92, a204
    v_accvgpr_read_b32 v93, a205
    v_accvgpr_read_b32 v94, a206
    v_accvgpr_read_b32 v95, a207
    v_mul_f32 v88, v88, v33
    v_mul_f32 v89, v89, v33
    v_mul_f32 v90, v90, v33
    v_mul_f32 v91, v91, v33
    v_mul_f32 v92, v92, v33
    v_mul_f32 v93, v93, v33
    v_mul_f32 v94, v94, v33
    v_mul_f32 v95, v95, v33
    v_cvt_pk_bf16_f32 v108, v88, v92
    v_cvt_pk_bf16_f32 v109, v89, v93
    v_cvt_pk_bf16_f32 v110, v90, v94
    v_cvt_pk_bf16_f32 v111, v91, v95
    buffer_store_dwordx4 v[108:111], v47, s[12:15], s44 offen offset:256 sc1
    s_nop 7
    v_accvgpr_read_b32 v88, a208
    v_accvgpr_read_b32 v89, a209
    v_accvgpr_read_b32 v90, a210
    v_accvgpr_read_b32 v91, a211
    v_accvgpr_read_b32 v92, a216
    v_accvgpr_read_b32 v93, a217
    v_accvgpr_read_b32 v94, a218
    v_accvgpr_read_b32 v95, a219
    v_mul_f32 v88, v88, v32
    v_mul_f32 v89, v89, v32
    v_mul_f32 v90, v90, v32
    v_mul_f32 v91, v91, v32
    v_mul_f32 v92, v92, v32
    v_mul_f32 v93, v93, v32
    v_mul_f32 v94, v94, v32
    v_mul_f32 v95, v95, v32
    v_cvt_pk_bf16_f32 v104, v88, v92
    v_cvt_pk_bf16_f32 v105, v89, v93
    v_cvt_pk_bf16_f32 v106, v90, v94
    v_cvt_pk_bf16_f32 v107, v91, v95
    buffer_store_dwordx4 v[104:107], v47, s[12:15], s62 offen offset:0 sc1
    s_waitcnt lgkmcnt(0)
    s_branch L1_S1B
L1_PD1:
    s_waitcnt lgkmcnt(0)
    s_barrier
    v_mfma_f32_16x16x32_bf16 a[48:51], v[56:59], v[248:251], a[48:51]
    ds_read_b128 v[48:51], v37 offset:0
    v_mfma_f32_16x16x32_bf16 a[52:55], v[56:59], v[252:255], a[52:55]
    v_mfma_f32_16x16x32_bf16 a[56:59], v[60:63], v[248:251], a[56:59]
    ds_read_b128 v[52:55], v37 offset:1024
    v_mfma_f32_16x16x32_bf16 a[60:63], v[60:63], v[252:255], a[60:63]
    v_mfma_f32_16x16x32_bf16 a[64:67], v[64:67], v[248:251], a[64:67]
    ds_read_b128 v[56:59], v37 offset:2048
    v_mfma_f32_16x16x32_bf16 a[68:71], v[64:67], v[252:255], a[68:71]
    v_mfma_f32_16x16x32_bf16 a[72:75], v[68:71], v[248:251], a[72:75]
    ds_read_b128 v[60:63], v37 offset:3072
    v_mfma_f32_16x16x32_bf16 a[76:79], v[68:71], v[252:255], a[76:79]
    v_mfma_f32_16x16x32_bf16 a[80:83], v[72:75], v[248:251], a[80:83]
    ds_read_b128 v[64:67], v37 offset:4096
    v_mfma_f32_16x16x32_bf16 a[84:87], v[72:75], v[252:255], a[84:87]
    v_mfma_f32_16x16x32_bf16 a[88:91], v[76:79], v[248:251], a[88:91]
    ds_read_b128 v[68:71], v37 offset:5120
    v_mfma_f32_16x16x32_bf16 a[92:95], v[76:79], v[252:255], a[92:95]
    s_waitcnt lgkmcnt(4)
    v_mfma_f32_16x16x32_bf16 a[192:195], v[48:51], v[112:115], 0
    ds_read_b128 v[72:75], v37 offset:6144
    v_mfma_f32_16x16x32_bf16 a[196:199], v[48:51], v[116:119], 0
    v_mfma_f32_16x16x32_bf16 a[200:203], v[52:55], v[112:115], 0
    ds_read_b128 v[76:79], v37 offset:7168
    v_mfma_f32_16x16x32_bf16 a[204:207], v[52:55], v[116:119], 0
    s_waitcnt lgkmcnt(4)
    v_mfma_f32_16x16x32_bf16 a[192:195], v[56:59], v[120:123], a[192:195]
    ds_read_b128 v[48:51], v37 offset:8192
    v_mfma_f32_16x16x32_bf16 a[196:199], v[56:59], v[124:127], a[196:199]
    v_mfma_f32_16x16x32_bf16 a[200:203], v[60:63], v[120:123], a[200:203]
    ds_read_b128 v[52:55], v37 offset:9216
    v_mfma_f32_16x16x32_bf16 a[204:207], v[60:63], v[124:127], a[204:207]
    s_waitcnt lgkmcnt(4)
    v_mfma_f32_16x16x32_bf16 a[192:195], v[64:67], v[128:131], a[192:195]
    ds_read_b128 v[56:59], v37 offset:10240
    v_mfma_f32_16x16x32_bf16 a[196:199], v[64:67], v[132:135], a[196:199]
    v_mfma_f32_16x16x32_bf16 a[200:203], v[68:71], v[128:131], a[200:203]
    ds_read_b128 v[60:63], v37 offset:11264
    v_mfma_f32_16x16x32_bf16 a[204:207], v[68:71], v[132:135], a[204:207]
    s_waitcnt lgkmcnt(4)
    v_mfma_f32_16x16x32_bf16 a[192:195], v[72:75], v[136:139], a[192:195]
    ds_read_b128 v[64:67], v37 offset:12288
    v_mfma_f32_16x16x32_bf16 a[196:199], v[72:75], v[140:143], a[196:199]
    v_mfma_f32_16x16x32_bf16 a[200:203], v[76:79], v[136:139], a[200:203]
    ds_read_b128 v[68:71], v37 offset:13312
    v_mfma_f32_16x16x32_bf16 a[204:207], v[76:79], v[140:143], a[204:207]
    s_waitcnt lgkmcnt(4)
    v_mfma_f32_16x16x32_bf16 a[192:195], v[48:51], v[144:147], a[192:195]
    ds_read_b128 v[72:75], v37 offset:14336
    v_mfma_f32_16x16x32_bf16 a[196:199], v[48:51], v[148:151], a[196:199]
    v_mfma_f32_16x16x32_bf16 a[200:203], v[52:55], v[144:147], a[200:203]
    ds_read_b128 v[76:79], v37 offset:15360
    v_mfma_f32_16x16x32_bf16 a[204:207], v[52:55], v[148:151], a[204:207]
    s_waitcnt lgkmcnt(4)
    v_mfma_f32_16x16x32_bf16 a[192:195], v[56:59], v[152:155], a[192:195]
    ds_read_b128 v[48:51], v37 offset:16384
    v_mfma_f32_16x16x32_bf16 a[196:199], v[56:59], v[156:159], a[196:199]
    v_mfma_f32_16x16x32_bf16 a[200:203], v[60:63], v[152:155], a[200:203]
    ds_read_b128 v[52:55], v37 offset:17408
    v_mfma_f32_16x16x32_bf16 a[204:207], v[60:63], v[156:159], a[204:207]
    s_waitcnt lgkmcnt(4)
    v_mfma_f32_16x16x32_bf16 a[192:195], v[64:67], v[160:163], a[192:195]
    ds_read_b128 v[56:59], v37 offset:18432
    v_mfma_f32_16x16x32_bf16 a[196:199], v[64:67], v[164:167], a[196:199]
    v_mfma_f32_16x16x32_bf16 a[200:203], v[68:71], v[160:163], a[200:203]
    ds_read_b128 v[60:63], v37 offset:19456
    v_mfma_f32_16x16x32_bf16 a[204:207], v[68:71], v[164:167], a[204:207]
    s_waitcnt lgkmcnt(4)
    v_mfma_f32_16x16x32_bf16 a[192:195], v[72:75], v[168:171], a[192:195]
    ds_read_b128 v[64:67], v37 offset:20480
    v_mfma_f32_16x16x32_bf16 a[196:199], v[72:75], v[172:175], a[196:199]
    v_mfma_f32_16x16x32_bf16 a[200:203], v[76:79], v[168:171], a[200:203]
    ds_read_b128 v[68:71], v37 offset:21504
    v_mfma_f32_16x16x32_bf16 a[204:207], v[76:79], v[172:175], a[204:207]
    s_waitcnt lgkmcnt(4)
    v_mfma_f32_16x16x32_bf16 a[192:195], v[48:51], v[176:179], a[192:195]
    ds_read_b128 v[72:75], v37 offset:22528
    v_mfma_f32_16x16x32_bf16 a[196:199], v[48:51], v[180:183], a[196:199]
    v_mfma_f32_16x16x32_bf16 a[200:203], v[52:55], v[176:179], a[200:203]
    ds_read_b128 v[76:79], v37 offset:23552
    v_mfma_f32_16x16x32_bf16 a[204:207], v[52:55], v[180:183], a[204:207]
    s_waitcnt lgkmcnt(4)
    v_mfma_f32_16x16x32_bf16 a[192:195], v[56:59], v[184:187], a[192:195]
    ds_read_b128 v[48:51], v37 offset:24576
    v_mfma_f32_16x16x32_bf16 a[196:199], v[56:59], v[188:191], a[196:199]
    v_mfma_f32_16x16x32_bf16 a[200:203], v[60:63], v[184:187], a[200:203]
    ds_read_b128 v[52:55], v37 offset:25600
    v_mfma_f32_16x16x32_bf16 a[204:207], v[60:63], v[188:191], a[204:207]
    s_waitcnt lgkmcnt(4)
    v_mfma_f32_16x16x32_bf16 a[192:195], v[64:67], v[192:195], a[192:195]
    ds_read_b128 v[56:59], v37 offset:26624
    v_mfma_f32_16x16x32_bf16 a[196:199], v[64:67], v[196:199], a[196:199]
    v_mfma_f32_16x16x32_bf16 a[200:203], v[68:71], v[192:195], a[200:203]
    ds_read_b128 v[60:63], v37 offset:27648
    v_mfma_f32_16x16x32_bf16 a[204:207], v[68:71], v[196:199], a[204:207]
    s_waitcnt lgkmcnt(4)
    v_mfma_f32_16x16x32_bf16 a[192:195], v[72:75], v[200:203], a[192:195]
    ds_read_b128 v[64:67], v37 offset:28672
    v_mfma_f32_16x16x32_bf16 a[196:199], v[72:75], v[204:207], a[196:199]
    v_mfma_f32_16x16x32_bf16 a[200:203], v[76:79], v[200:203], a[200:203]
    ds_read_b128 v[68:71], v37 offset:29696
    v_mfma_f32_16x16x32_bf16 a[204:207], v[76:79], v[204:207], a[204:207]
    s_waitcnt lgkmcnt(4)
    v_mfma_f32_16x16x32_bf16 a[192:195], v[48:51], v[208:211], a[192:195]
    ds_read_b128 v[72:75], v37 offset:30720
    v_mfma_f32_16x16x32_bf16 a[196:199], v[48:51], v[212:215], a[196:199]
    v_mfma_f32_16x16x32_bf16 a[200:203], v[52:55], v[208:211], a[200:203]
    ds_read_b128 v[76:79], v37 offset:31744
    v_mfma_f32_16x16x32_bf16 a[204:207], v[52:55], v[212:215], a[204:207]
    s_waitcnt lgkmcnt(4)
    v_mfma_f32_16x16x32_bf16 a[192:195], v[56:59], v[216:219], a[192:195]
    ds_read_b128 v[48:51], v37 offset:32768
    v_mfma_f32_16x16x32_bf16 a[196:199], v[56:59], v[220:223], a[196:199]
    v_mfma_f32_16x16x32_bf16 a[200:203], v[60:63], v[216:219], a[200:203]
    ds_read_b128 v[52:55], v37 offset:33792
    v_mfma_f32_16x16x32_bf16 a[204:207], v[60:63], v[220:223], a[204:207]
    s_waitcnt lgkmcnt(4)
    v_mfma_f32_16x16x32_bf16 a[192:195], v[64:67], v[224:227], a[192:195]
    ds_read_b128 v[56:59], v37 offset:34816
    v_mfma_f32_16x16x32_bf16 a[196:199], v[64:67], v[228:231], a[196:199]
    v_mfma_f32_16x16x32_bf16 a[200:203], v[68:71], v[224:227], a[200:203]
    ds_read_b128 v[60:63], v37 offset:35840
    v_mfma_f32_16x16x32_bf16 a[204:207], v[68:71], v[228:231], a[204:207]
    s_waitcnt lgkmcnt(4)
    v_mfma_f32_16x16x32_bf16 a[192:195], v[72:75], v[232:235], a[192:195]
    ds_read_b128 v[64:67], v46 offset:0
    v_mfma_f32_16x16x32_bf16 a[196:199], v[72:75], v[236:239], a[196:199]
    v_mfma_f32_16x16x32_bf16 a[200:203], v[76:79], v[232:235], a[200:203]
    ds_read_b128 v[68:71], v46 offset:1024
    v_mfma_f32_16x16x32_bf16 a[204:207], v[76:79], v[236:239], a[204:207]
    s_waitcnt lgkmcnt(4)
    v_mfma_f32_16x16x32_bf16 a[192:195], v[48:51], v[240:243], a[192:195]
    ds_read_b128 v[72:75], v46 offset:2048
    v_mfma_f32_16x16x32_bf16 a[196:199], v[48:51], v[244:247], a[196:199]
    v_mfma_f32_16x16x32_bf16 a[200:203], v[52:55], v[240:243], a[200:203]
    ds_read_b128 v[76:79], v46 offset:3072
    v_mfma_f32_16x16x32_bf16 a[204:207], v[52:55], v[244:247], a[204:207]
    s_waitcnt lgkmcnt(4)
    v_mfma_f32_16x16x32_bf16 a[192:195], v[56:59], v[248:251], a[192:195]
    ds_read_b128 v[48:51], v46 offset:4096
    v_mfma_f32_16x16x32_bf16 a[196:199], v[56:59], v[252:255], a[196:199]
    v_mfma_f32_16x16x32_bf16 a[200:203], v[60:63], v[248:251], a[200:203]
    ds_read_b128 v[52:55], v46 offset:5120
    v_mfma_f32_16x16x32_bf16 a[204:207], v[60:63], v[252:255], a[204:207]
    s_waitcnt lgkmcnt(4)
    v_mfma_f32_16x16x32_bf16 a[212:215], v[64:67], v[116:119], 0
    ds_read_b128 v[56:59], v46 offset:6144
    v_mfma_f32_16x16x32_bf16 a[220:223], v[68:71], v[116:119], 0
    ds_read_b128 v[60:63], v46 offset:7168
    s_waitcnt lgkmcnt(4)
    v_mfma_f32_16x16x32_bf16 a[212:215], v[72:75], v[124:127], a[212:215]
    ds_read_b128 v[64:67], v46 offset:8192
    v_mfma_f32_16x16x32_bf16 a[220:223], v[76:79], v[124:127], a[220:223]
    ds_read_b128 v[68:71], v46 offset:9216
    s_waitcnt lgkmcnt(4)
    v_mfma_f32_16x16x32_bf16 a[212:215], v[48:51], v[132:135], a[212:215]
    ds_read_b128 v[72:75], v46 offset:10240
    v_mfma_f32_16x16x32_bf16 a[220:223], v[52:55], v[132:135], a[220:223]
    ds_read_b128 v[76:79], v46 offset:11264
    s_waitcnt lgkmcnt(4)
    v_mfma_f32_16x16x32_bf16 a[212:215], v[56:59], v[140:143], a[212:215]
    ds_read_b128 v[48:51], v46 offset:12288
    v_mfma_f32_16x16x32_bf16 a[220:223], v[60:63], v[140:143], a[220:223]
    ds_read_b128 v[52:55], v46 offset:13312
    s_waitcnt lgkmcnt(4)
    v_mfma_f32_16x16x32_bf16 a[212:215], v[64:67], v[148:151], a[212:215]
    ds_read_b128 v[56:59], v46 offset:14336
    v_accvgpr_read_b32 v88, a192
    v_mfma_f32_16x16x32_bf16 a[220:223], v[68:71], v[148:151], a[220:223]
    ds_read_b128 v[60:63], v46 offset:15360
    s_waitcnt lgkmcnt(4)
    v_mfma_f32_16x16x32_bf16 a[212:215], v[72:75], v[156:159], a[212:215]
    ds_read_b128 v[64:67], v46 offset:16384
    v_accvgpr_read_b32 v89, a193
    v_mfma_f32_16x16x32_bf16 a[220:223], v[76:79], v[156:159], a[220:223]
    ds_read_b128 v[68:71], v46 offset:17408
    s_waitcnt lgkmcnt(4)
    v_mfma_f32_16x16x32_bf16 a[212:215], v[48:51], v[164:167], a[212:215]
    ds_read_b128 v[72:75], v46 offset:18432
    v_accvgpr_read_b32 v90, a194
    v_mfma_f32_16x16x32_bf16 a[220:223], v[52:55], v[164:167], a[220:223]
    ds_read_b128 v[76:79], v46 offset:19456
    s_waitcnt lgkmcnt(4)
    v_mfma_f32_16x16x32_bf16 a[212:215], v[56:59], v[172:175], a[212:215]
    ds_read_b128 v[48:51], v46 offset:20480
    v_accvgpr_read_b32 v91, a195
    v_mfma_f32_16x16x32_bf16 a[220:223], v[60:63], v[172:175], a[220:223]
    ds_read_b128 v[52:55], v46 offset:21504
    s_waitcnt lgkmcnt(4)
    v_mfma_f32_16x16x32_bf16 a[212:215], v[64:67], v[180:183], a[212:215]
    ds_read_b128 v[56:59], v46 offset:22528
    v_accvgpr_read_b32 v92, a200
    v_mfma_f32_16x16x32_bf16 a[220:223], v[68:71], v[180:183], a[220:223]
    ds_read_b128 v[60:63], v46 offset:23552
    s_waitcnt lgkmcnt(4)
    v_mfma_f32_16x16x32_bf16 a[212:215], v[72:75], v[188:191], a[212:215]
    ds_read_b128 v[64:67], v46 offset:24576
    v_accvgpr_read_b32 v93, a201
    v_mfma_f32_16x16x32_bf16 a[220:223], v[76:79], v[188:191], a[220:223]
    ds_read_b128 v[68:71], v46 offset:25600
    s_waitcnt lgkmcnt(4)
    v_mfma_f32_16x16x32_bf16 a[212:215], v[48:51], v[196:199], a[212:215]
    ds_read_b128 v[72:75], v46 offset:26624
    v_accvgpr_read_b32 v94, a202
    v_mfma_f32_16x16x32_bf16 a[220:223], v[52:55], v[196:199], a[220:223]
    ds_read_b128 v[76:79], v46 offset:27648
    s_waitcnt lgkmcnt(4)
    v_mfma_f32_16x16x32_bf16 a[212:215], v[56:59], v[204:207], a[212:215]
    ds_read_b128 v[48:51], v46 offset:28672
    v_accvgpr_read_b32 v95, a203
    v_mfma_f32_16x16x32_bf16 a[220:223], v[60:63], v[204:207], a[220:223]
    ds_read_b128 v[52:55], v46 offset:29696
    s_waitcnt lgkmcnt(4)
    v_mfma_f32_16x16x32_bf16 a[212:215], v[64:67], v[212:215], a[212:215]
    ds_read_b128 v[56:59], v46 offset:30720
    v_mul_f32 v88, v88, v32
    v_mfma_f32_16x16x32_bf16 a[220:223], v[68:71], v[212:215], a[220:223]
    ds_read_b128 v[60:63], v46 offset:31744
    s_waitcnt lgkmcnt(4)
    v_mfma_f32_16x16x32_bf16 a[212:215], v[72:75], v[220:223], a[212:215]
    ds_read_b128 v[64:67], v46 offset:32768
    v_mul_f32 v89, v89, v32
    v_mfma_f32_16x16x32_bf16 a[220:223], v[76:79], v[220:223], a[220:223]
    ds_read_b128 v[68:71], v46 offset:33792
    s_waitcnt lgkmcnt(4)
    v_mfma_f32_16x16x32_bf16 a[212:215], v[48:51], v[228:231], a[212:215]
    ds_read_b128 v[72:75], v46 offset:34816
    v_mul_f32 v90, v90, v32
    v_mfma_f32_16x16x32_bf16 a[220:223], v[52:55], v[228:231], a[220:223]
    ds_read_b128 v[76:79], v46 offset:35840
    s_waitcnt lgkmcnt(4)
    v_mfma_f32_16x16x32_bf16 a[212:215], v[56:59], v[236:239], a[212:215]
    ds_read_b64_tr_b16 v[48:49], v23 offset:49152
    ds_read_b64_tr_b16 v[50:51], v23 offset:49920
    v_mfma_f32_16x16x32_bf16 a[220:223], v[60:63], v[236:239], a[220:223]
    ds_read_b64_tr_b16 v[52:53], v23 offset:55296
    ds_read_b64_tr_b16 v[54:55], v23 offset:56064
    s_waitcnt lgkmcnt(6)
    v_mfma_f32_16x16x32_bf16 a[212:215], v[64:67], v[244:247], a[212:215]
    ds_read_b64_tr_b16 v[56:57], v24 offset:49184
    ds_read_b64_tr_b16 v[58:59], v24 offset:49952
    v_mfma_f32_16x16x32_bf16 a[220:223], v[68:71], v[244:247], a[220:223]
    ds_read_b64_tr_b16 v[60:61], v24 offset:55328
    ds_read_b64_tr_b16 v[62:63], v24 offset:56096
    s_waitcnt lgkmcnt(8)
    v_mfma_f32_16x16x32_bf16 a[212:215], v[72:75], v[252:255], a[212:215]
    ds_read_b64_tr_b16 v[64:65], v23 offset:49216
    ds_read_b64_tr_b16 v[66:67], v23 offset:49984
    v_mfma_f32_16x16x32_bf16 a[220:223], v[76:79], v[252:255], a[220:223]
    ds_read_b64_tr_b16 v[68:69], v23 offset:55360
    ds_read_b64_tr_b16 v[70:71], v23 offset:56128
    s_waitcnt lgkmcnt(8)
    v_mul_f32 v91, v91, v32
    v_mul_f32 v92, v92, v32
    v_mul_f32 v93, v93, v32
    v_mul_f32 v94, v94, v32
    v_mul_f32 v95, v95, v32
    v_cvt_pk_bf16_f32 v104, v88, v92
    v_cvt_pk_bf16_f32 v105, v89, v93
    v_cvt_pk_bf16_f32 v106, v90, v94
    v_cvt_pk_bf16_f32 v107, v91, v95
    buffer_store_dwordx4 v[104:107], v47, s[12:15], s44 offen offset:0 sc1
    v_accvgpr_read_b32 v88, a196
    v_accvgpr_read_b32 v89, a197
    v_accvgpr_read_b32 v90, a198
    v_accvgpr_read_b32 v91, a199
    v_accvgpr_read_b32 v92, a204
    v_accvgpr_read_b32 v93, a205
    v_accvgpr_read_b32 v94, a206
    v_accvgpr_read_b32 v95, a207
    v_mul_f32 v88, v88, v33
    v_mul_f32 v89, v89, v33
    v_mul_f32 v90, v90, v33
    v_mul_f32 v91, v91, v33
    v_mul_f32 v92, v92, v33
    v_mul_f32 v93, v93, v33
    v_mul_f32 v94, v94, v33
    v_mul_f32 v95, v95, v33
    v_cvt_pk_bf16_f32 v108, v88, v92
    v_cvt_pk_bf16_f32 v109, v89, v93
    v_cvt_pk_bf16_f32 v110, v90, v94
    v_cvt_pk_bf16_f32 v111, v91, v95
    buffer_store_dwordx4 v[108:111], v47, s[12:15], s44 offen offset:256 sc1
    s_nop 7
    v_accvgpr_read_b32 v88, a212
    v_accvgpr_read_b32 v89, a213
    v_accvgpr_read_b32 v90, a214
    v_accvgpr_read_b32 v91, a215
    v_accvgpr_read_b32 v92, a220
    v_accvgpr_read_b32 v93, a221
    v_accvgpr_read_b32 v94, a222
    v_accvgpr_read_b32 v95, a223
    v_mul_f32 v88, v88, v33
    v_mul_f32 v89, v89, v33
    v_mul_f32 v90, v90, v33
    v_mul_f32 v91, v91, v33
    v_mul_f32 v92, v92, v33
    v_mul_f32 v93, v93, v33
    v_mul_f32 v94, v94, v33
    v_mul_f32 v95, v95, v33
    v_cvt_pk_bf16_f32 v108, v88, v92
    v_cvt_pk_bf16_f32 v109, v89, v93
    v_cvt_pk_bf16_f32 v110, v90, v94
    v_cvt_pk_bf16_f32 v111, v91, v95
    buffer_store_dwordx4 v[108:111], v47, s[12:15], s62 offen offset:256 sc1
    s_waitcnt lgkmcnt(0)
    s_branch L1_S1B
L1_PN:
    v_mfma_f32_16x16x32_bf16 a[48:51], v[56:59], v[248:251], a[48:51]
    ds_read_b64_tr_b16 v[48:49], v23 offset:49152
    v_mfma_f32_16x16x32_bf16 a[52:55], v[56:59], v[252:255], a[52:55]
    ds_read_b64_tr_b16 v[50:51], v23 offset:49920
    v_mfma_f32_16x16x32_bf16 a[56:59], v[60:63], v[248:251], a[56:59]
    ds_read_b64_tr_b16 v[52:53], v23 offset:55296
    v_mfma_f32_16x16x32_bf16 a[60:63], v[60:63], v[252:255], a[60:63]
    ds_read_b64_tr_b16 v[54:55], v23 offset:56064
    s_waitcnt lgkmcnt(12)
    v_mfma_f32_16x16x32_bf16 a[64:67], v[64:67], v[248:251], a[64:67]
    ds_read_b64_tr_b16 v[56:57], v24 offset:49184
    v_mfma_f32_16x16x32_bf16 a[68:71], v[64:67], v[252:255], a[68:71]
    ds_read_b64_tr_b16 v[58:59], v24 offset:49952
    v_mfma_f32_16x16x32_bf16 a[72:75], v[68:71], v[248:251], a[72:75]
    ds_read_b64_tr_b16 v[60:61], v24 offset:55328
    v_mfma_f32_16x16x32_bf16 a[76:79], v[68:71], v[252:255], a[76:79]
    ds_read_b64_tr_b16 v[62:63], v24 offset:56096
    s_waitcnt lgkmcnt(12)
    v_mfma_f32_16x16x32_bf16 a[80:83], v[72:75], v[248:251], a[80:83]
    ds_read_b64_tr_b16 v[64:65], v23 offset:49216
    v_mfma_f32_16x16x32_bf16 a[84:87], v[72:75], v[252:255], a[84:87]
    ds_read_b64_tr_b16 v[66:67], v23 offset:49984
    v_mfma_f32_16x16x32_bf16 a[88:91], v[76:79], v[248:251], a[88:91]
    ds_read_b64_tr_b16 v[68:69], v23 offset:55360
    v_mfma_f32_16x16x32_bf16 a[92:95], v[76:79], v[252:255], a[92:95]
    ds_read_b64_tr_b16 v[70:71], v23 offset:56128
    s_waitcnt lgkmcnt(8)
    s_waitcnt lgkmcnt(0)
    s_barrier
    v_and_b32 v80, 31, v0
    v_cvt_f32_u32 v106, v80
    v_lshrrev_b32 v80, 5, v0
    v_lshlrev_b32 v80, 2, v80
    v_cvt_f32_u32 v107, v80
    v_add_u32 v108, 86016, v29
    s_lshr_b32 s45, s16, 1
    s_lshl_b32 s46, s45, 5
    v_cvt_f32_u32 v80, s46
    v_add_f32 v80, v80, v106
    v_mul_f32 v80, 0x3c800000, v80
    s_and_b32 s47, s16, 1
    s_lshl_b32 s46, s47, 5
    v_cvt_f32_u32 v81, s46
    v_add_f32 v81, v81, v107
    v_mul_f32 v81, v81, v80
    v_mul_f32 v104, 0x41000000, v80
    s_lshl_b32 s45, s45, 4
    s_lshl_b32 s47, s47, 2
    s_add_u32 s45, s45, s47
    s_lshl_b32 s45, s45, 10
    v_add_u32 v86, s45, v108
    v_add_u32 v87, 8192, v86
    v_mov_b32 v82, v81
    v_add_f32 v81, v81, v104
    v_add_f32 v83, v82, v80
    v_add_f32 v84, v83, v80
    v_add_f32 v85, v84, v80
    v_cos_f32 v88, v82
    v_sin_f32 v92, v82
    v_cos_f32 v89, v83
    v_sin_f32 v93, v83
    v_cos_f32 v90, v84
    v_sin_f32 v94, v84
    v_cos_f32 v91, v85
    v_sin_f32 v95, v85
    s_nop 0
    v_cvt_pk_bf16_f32 v96, v88, v92
    v_cvt_pk_bf16_f32 v97, v89, v93
    v_cvt_pk_bf16_f32 v98, v90, v94
    v_cvt_pk_bf16_f32 v99, v91, v95
    v_cvt_pk_bf16_f32 v100, -v92, v88
    v_cvt_pk_bf16_f32 v101, -v93, v89
    v_cvt_pk_bf16_f32 v102, -v94, v90
    v_cvt_pk_bf16_f32 v103, -v95, v91
    ds_write_b128 v86, v[96:99] offset:0
    ds_write_b128 v87, v[100:103] offset:0
    v_mov_b32 v82, v81
    v_add_f32 v81, v81, v104
    v_add_f32 v83, v82, v80
    v_add_f32 v84, v83, v80
    v_add_f32 v85, v84, v80
    v_cos_f32 v88, v82
    v_sin_f32 v92, v82
    v_cos_f32 v89, v83
    v_sin_f32 v93, v83
    v_cos_f32 v90, v84
    v_sin_f32 v94, v84
    v_cos_f32 v91, v85
    v_sin_f32 v95, v85
    s_nop 0
    v_cvt_pk_bf16_f32 v96, v88, v92
    v_cvt_pk_bf16_f32 v97, v89, v93
    v_cvt_pk_bf16_f32 v98, v90, v94
    v_cvt_pk_bf16_f32 v99, v91, v95
    v_cvt_pk_bf16_f32 v100, -v92, v88
    v_cvt_pk_bf16_f32 v101, -v93, v89
    v_cvt_pk_bf16_f32 v102, -v94, v90
    v_cvt_pk_bf16_f32 v103, -v95, v91
    ds_write_b128 v86, v[96:99] offset:1024
    ds_write_b128 v87, v[100:103] offset:1024
    v_mov_b32 v82, v81
    v_add_f32 v81, v81, v104
    v_add_f32 v83, v82, v80
    v_add_f32 v84, v83, v80
    v_add_f32 v85, v84, v80
    v_cos_f32 v88, v82
    v_sin_f32 v92, v82
    v_cos_f32 v89, v83
    v_sin_f32 v93, v83
    v_cos_f32 v90, v84
    v_sin_f32 v94, v84
    v_cos_f32 v91, v85
    v_sin_f32 v95, v85
    s_nop 0
    v_cvt_pk_bf16_f32 v96, v88, v92
    v_cvt_pk_bf16_f32 v97, v89, v93
    v_cvt_pk_bf16_f32 v98, v90, v94
    v_cvt_pk_bf16_f32 v99, v91, v95
    v_cvt_pk_bf16_f32 v100, -v92, v88
    v_cvt_pk_bf16_f32 v101, -v93, v89
    v_cvt_pk_bf16_f32 v102, -v94, v90
    v_cvt_pk_bf16_f32 v103, -v95, v91
    ds_write_b128 v86, v[96:99] offset:2048
    ds_write_b128 v87, v[100:103] offset:2048
    v_mov_b32 v82, v81
    v_add_f32 v83, v82, v80
    v_add_f32 v84, v83, v80
    v_add_f32 v85, v84, v80
    v_cos_f32 v88, v82
    v_sin_f32 v92, v82
    v_cos_f32 v89, v83
    v_sin_f32 v93, v83
    v_cos_f32 v90, v84
    v_sin_f32 v94, v84
    v_cos_f32 v91, v85
    v_sin_f32 v95, v85
    s_nop 0
    v_cvt_pk_bf16_f32 v96, v88, v92
    v_cvt_pk_bf16_f32 v97, v89, v93
    v_cvt_pk_bf16_f32 v98, v90, v94
    v_cvt_pk_bf16_f32 v99, v91, v95
    v_cvt_pk_bf16_f32 v100, -v92, v88
    v_cvt_pk_bf16_f32 v101, -v93, v89
    v_cvt_pk_bf16_f32 v102, -v94, v90
    v_cvt_pk_bf16_f32 v103, -v95, v91
    ds_write_b128 v86, v[96:99] offset:3072
    ds_write_b128 v87, v[100:103] offset:3072
    s_waitcnt vmcnt(0) lgkmcnt(0)
    s_barrier
    v_and_b32 v80, 7, v0
    v_lshrrev_b32 v81, 3, v0
    v_lshlrev_b32 v108, 3, v81
    s_lshl_b32 s45, s16, 1
    v_add_u32 v108, s45, v108
    v_mul_u32_u24 v82, 578, v80
    v_lshlrev_b32 v83, 1, v108
    v_add_u32 v82, v82, v83
    v_add_u32 v104, 122880, v82
    v_lshlrev_b32 v83, 13, v108
    v_lshlrev_b32 v84, 4, v80
    v_add_u32 v105, v83, v84
    v_mov_b32 v85, 0x10000000
    v_cmp_ge_u32 vcc, 32, v108
    s_nop 1
    v_cndmask_b32 v106, v85, v105, vcc
    v_cmp_ge_u32 vcc, 31, v108
    s_nop 1
    v_cndmask_b32 v107, v85, v105, vcc
    ds_read_u16 v80, v104 offset:0
    ds_read_u16 v84, v104 offset:20480
    ds_read_u16 v81, v104 offset:5120
    ds_read_u16 v85, v104 offset:25600
    ds_read_u16 v82, v104 offset:10240
    ds_read_u16 v86, v104 offset:30720
    ds_read_u16 v83, v104 offset:15360
    ds_read_u16 v87, v104 offset:35840
    s_waitcnt lgkmcnt(0)
    ds_read_u16 v88, v104 offset:2
    ds_read_u16 v92, v104 offset:20482
    ds_read_u16 v89, v104 offset:5122
    ds_read_u16 v93, v104 offset:25602
    ds_read_u16 v90, v104 offset:10242
    ds_read_u16 v94, v104 offset:30722
    ds_read_u16 v91, v104 offset:15362
    ds_read_u16 v95, v104 offset:35842
    v_lshl_or_b32 v96, v84, 16, v80
    v_lshl_or_b32 v97, v85, 16, v81
    v_lshl_or_b32 v98, v86, 16, v82
    v_lshl_or_b32 v99, v87, 16, v83
    buffer_store_dwordx4 v[96:99], v105, s[12:15], s92 offen sc1
    s_add_u32 s92, s92, 8192
    s_waitcnt lgkmcnt(0)
    ds_read_u16 v80, v104 offset:128
    ds_read_u16 v84, v104 offset:20608
    ds_read_u16 v81, v104 offset:5248
    ds_read_u16 v85, v104 offset:25728
    ds_read_u16 v82, v104 offset:10368
    ds_read_u16 v86, v104 offset:30848
    ds_read_u16 v83, v104 offset:15488
    ds_read_u16 v87, v104 offset:35968
    v_lshl_or_b32 v100, v92, 16, v88
    v_lshl_or_b32 v101, v93, 16, v89
    v_lshl_or_b32 v102, v94, 16, v90
    v_lshl_or_b32 v103, v95, 16, v91
    buffer_store_dwordx4 v[100:103], v105, s[12:15], s92 offen sc1
    s_add_u32 s92, s92, 516096
    s_waitcnt lgkmcnt(0)
    ds_read_u16 v88, v104 offset:130
    ds_read_u16 v92, v104 offset:20610
    ds_read_u16 v89, v104 offset:5250
    ds_read_u16 v93, v104 offset:25730
    ds_read_u16 v90, v104 offset:10370
    ds_read_u16 v94, v104 offset:30850
    ds_read_u16 v91, v104 offset:15490
    ds_read_u16 v95, v104 offset:35970
    v_lshl_or_b32 v96, v84, 16, v80
    v_lshl_or_b32 v97, v85, 16, v81
    v_lshl_or_b32 v98, v86, 16, v82
    v_lshl_or_b32 v99, v87, 16, v83
    buffer_store_dwordx4 v[96:99], v105, s[12:15], s92 offen sc1
    s_add_u32 s92, s92, 8192
    s_waitcnt lgkmcnt(0)
    ds_read_u16 v80, v104 offset:256
    ds_read_u16 v84, v104 offset:20736
    ds_read_u16 v81, v104 offset:5376
    ds_read_u16 v85, v104 offset:25856
    ds_read_u16 v82, v104 offset:10496
    ds_read_u16 v86, v104 offset:30976
    ds_read_u16 v83, v104 offset:15616
    ds_read_u16 v87, v104 offset:36096
    v_lshl_or_b32 v100, v92, 16, v88
    v_lshl_or_b32 v101, v93, 16, v89
    v_lshl_or_b32 v102, v94, 16, v90
    v_lshl_or_b32 v103, v95, 16, v91
    buffer_store_dwordx4 v[100:103], v105, s[12:15], s92 offen sc1
    s_add_u32 s92, s92, 516096
    s_waitcnt lgkmcnt(0)
    ds_read_u16 v88, v104 offset:258
    ds_read_u16 v92, v104 offset:20738
    ds_read_u16 v89, v104 offset:5378
    ds_read_u16 v93, v104 offset:25858
    ds_read_u16 v90, v104 offset:10498
    ds_read_u16 v94, v104 offset:30978
    ds_read_u16 v91, v104 offset:15618
    ds_read_u16 v95, v104 offset:36098
    v_lshl_or_b32 v96, v84, 16, v80
    v_lshl_or_b32 v97, v85, 16, v81
    v_lshl_or_b32 v98, v86, 16, v82
    v_lshl_or_b32 v99, v87, 16, v83
    buffer_store_dwordx4 v[96:99], v105, s[12:15], s92 offen sc1
    s_add_u32 s92, s92, 8192
    s_waitcnt lgkmcnt(0)
    ds_read_u16 v80, v104 offset:384
    ds_read_u16 v84, v104 offset:20864
    ds_read_u16 v81, v104 offset:5504
    ds_read_u16 v85, v104 offset:25984
    ds_read_u16 v82, v104 offset:10624
    ds_read_u16 v86, v104 offset:31104
    ds_read_u16 v83, v104 offset:15744
    ds_read_u16 v87, v104 offset:36224
    v_lshl_or_b32 v100, v92, 16, v88
    v_lshl_or_b32 v101, v93, 16, v89
    v_lshl_or_b32 v102, v94, 16, v90
    v_lshl_or_b32 v103, v95, 16, v91
    buffer_store_dwordx4 v[100:103], v105, s[12:15], s92 offen sc1
    s_add_u32 s92, s92, 516096
    s_waitcnt lgkmcnt(0)
    ds_read_u16 v88, v104 offset:386
    ds_read_u16 v92, v104 offset:20866
    ds_read_u16 v89, v104 offset:5506
    ds_read_u16 v93, v104 offset:25986
    ds_read_u16 v90, v104 offset:10626
    ds_read_u16 v94, v104 offset:31106
    ds_read_u16 v91, v104 offset:15746
    ds_read_u16 v95, v104 offset:36226
    v_lshl_or_b32 v96, v84, 16, v80
    v_lshl_or_b32 v97, v85, 16, v81
    v_lshl_or_b32 v98, v86, 16, v82
    v_lshl_or_b32 v99, v87, 16, v83
    buffer_store_dwordx4 v[96:99], v105, s[12:15], s92 offen sc1
    s_add_u32 s92, s92, 8192
    s_waitcnt lgkmcnt(0)
    ds_read_u16 v80, v104 offset:512
    ds_read_u16 v84, v104 offset:20992
    ds_read_u16 v81, v104 offset:5632
    ds_read_u16 v85, v104 offset:26112
    ds_read_u16 v82, v104 offset:10752
    ds_read_u16 v86, v104 offset:31232
    ds_read_u16 v83, v104 offset:15872
    ds_read_u16 v87, v104 offset:36352
    v_lshl_or_b32 v100, v92, 16, v88
    v_lshl_or_b32 v101, v93, 16, v89
    v_lshl_or_b32 v102, v94, 16, v90
    v_lshl_or_b32 v103, v95, 16, v91
    buffer_store_dwordx4 v[100:103], v105, s[12:15], s92 offen sc1
    s_add_u32 s92, s92, 516096
    s_waitcnt lgkmcnt(0)
    ds_read_u16 v88, v104 offset:514
    ds_read_u16 v92, v104 offset:20994
    ds_read_u16 v89, v104 offset:5634
    ds_read_u16 v93, v104 offset:26114
    ds_read_u16 v90, v104 offset:10754
    ds_read_u16 v94, v104 offset:31234
    ds_read_u16 v91, v104 offset:15874
    ds_read_u16 v95, v104 offset:36354
    v_lshl_or_b32 v96, v84, 16, v80
    v_lshl_or_b32 v97, v85, 16, v81
    v_lshl_or_b32 v98, v86, 16, v82
    v_lshl_or_b32 v99, v87, 16, v83
    buffer_store_dwordx4 v[96:99], v106, s[12:15], s92 offen sc1
    s_add_u32 s92, s92, 8192
    s_waitcnt lgkmcnt(0)
    v_lshl_or_b32 v100, v92, 16, v88
    v_lshl_or_b32 v101, v93, 16, v89
    v_lshl_or_b32 v102, v94, 16, v90
    v_lshl_or_b32 v103, v95, 16, v91
    buffer_store_dwordx4 v[100:103], v107, s[12:15], s92 offen sc1
    s_waitcnt lgkmcnt(0)
L1_S1B:
    v_mfma_f32_16x16x32_bf16 a[96:99], v[48:51], v[112:115], 0
    ds_read_b64_tr_b16 v[72:73], v24 offset:49248
    v_mfma_f32_16x16x32_bf16 a[100:103], v[48:51], v[116:119], 0
    ds_read_b64_tr_b16 v[74:75], v24 offset:50016
    v_mfma_f32_16x16x32_bf16 a[104:107], v[52:55], v[112:115], 0
    ds_read_b64_tr_b16 v[76:77], v24 offset:55392
    v_mfma_f32_16x16x32_bf16 a[108:111], v[52:55], v[116:119], 0
    ds_read_b64_tr_b16 v[78:79], v24 offset:56160
    v_mfma_f32_16x16x32_bf16 a[112:115], v[56:59], v[112:115], 0
    ds_read_b64_tr_b16 v[48:49], v23 offset:49280
    v_accvgpr_read_b32 v80, a0
    v_mfma_f32_16x16x32_bf16 a[116:119], v[56:59], v[116:119], 0
    ds_read_b64_tr_b16 v[50:51], v23 offset:50048
    v_accvgpr_read_b32 v81, a1
    v_mfma_f32_16x16x32_bf16 a[120:123], v[60:63], v[112:115], 0
    ds_read_b64_tr_b16 v[52:53], v23 offset:55424
    v_accvgpr_read_b32 v82, a2
    v_mfma_f32_16x16x32_bf16 a[124:127], v[60:63], v[116:119], 0
    ds_read_b64_tr_b16 v[54:55], v23 offset:56192
    v_mfma_f32_16x16x32_bf16 a[128:131], v[64:67], v[112:115], 0
    ds_read_b64_tr_b16 v[56:57], v24 offset:49312
    s_waitcnt vmcnt(6)
    v_mfma_f32_16x16x32_bf16 a[132:135], v[64:67], v[116:119], 0
    ds_read_b64_tr_b16 v[58:59], v24 offset:50080
    v_accvgpr_read_b32 v83, a3
    v_mfma_f32_16x16x32_bf16 a[136:139], v[68:71], v[112:115], 0
    ds_read_b64_tr_b16 v[60:61], v24 offset:55456
    s_barrier
    v_mfma_f32_16x16x32_bf16 a[140:143], v[68:71], v[116:119], 0
    ds_read_b64_tr_b16 v[62:63], v24 offset:56224
    s_waitcnt lgkmcnt(8)
    v_mfma_f32_16x16x32_bf16 a[144:147], v[72:75], v[112:115], 0
    ds_read_b64_tr_b16 v[64:65], v25 offset:0
    s_add_u32 m0, s38, 24576
    v_mfma_f32_16x16x32_bf16 a[148:151], v[72:75], v[116:119], 0
    ds_read_b64_tr_b16 v[66:67], v25 offset:768
    buffer_load_dwordx4 v20, s[8:11], s25 offen offset:0  lds
    v_mfma_f32_16x16x32_bf16 a[152:155], v[76:79], v[112:115], 0
    ds_read_b64_tr_b16 v[68:69], v25 offset:6144
    v_accvgpr_read_b32 v84, a8
    v_mfma_f32_16x16x32_bf16 a[156:159], v[76:79], v[116:119], 0
    ds_read_b64_tr_b16 v[70:71], v25 offset:6912
    s_waitcnt lgkmcnt(8)
    v_mfma_f32_16x16x32_bf16 a[160:163], v[48:51], v[112:115], 0
    ds_read_b64_tr_b16 v[72:73], v26 offset:32
    buffer_load_dwordx4 v21, s[8:11], s25 offen offset:1024  lds
    v_mfma_f32_16x16x32_bf16 a[164:167], v[48:51], v[116:119], 0
    ds_read_b64_tr_b16 v[74:75], v26 offset:800
    v_accvgpr_read_b32 v85, a9
    v_mfma_f32_16x16x32_bf16 a[168:171], v[52:55], v[112:115], 0
    ds_read_b64_tr_b16 v[76:77], v26 offset:6176
    v_accvgpr_read_b32 v86, a10
    v_mfma_f32_16x16x32_bf16 a[172:175], v[52:55], v[116:119], 0
    ds_read_b64_tr_b16 v[78:79], v26 offset:6944
    s_waitcnt lgkmcnt(8)
    v_mfma_f32_16x16x32_bf16 a[176:179], v[56:59], v[112:115], 0
    ds_read_b64_tr_b16 v[48:49], v25 offset:64
    buffer_load_dwordx4 v22, s[8:11], s25 offen offset:2048  lds
    v_mfma_f32_16x16x32_bf16 a[180:183], v[56:59], v[116:119], 0
    ds_read_b64_tr_b16 v[50:51], v25 offset:832
    v_accvgpr_read_b32 v87, a11
    v_mfma_f32_16x16x32_bf16 a[184:187], v[60:63], v[112:115], 0
    ds_read_b64_tr_b16 v[52:53], v25 offset:6208
    v_mul_f32 v80, v80, v30
    v_mfma_f32_16x16x32_bf16 a[188:191], v[60:63], v[116:119], 0
    ds_read_b64_tr_b16 v[54:55], v25 offset:6976
    s_waitcnt lgkmcnt(8)
    v_mfma_f32_16x16x32_bf16 a[96:99], v[64:67], v[120:123], a[96:99]
    ds_read_b64_tr_b16 v[56:57], v26 offset:96
    s_add_u32 m0, s38, 36864
    v_mfma_f32_16x16x32_bf16 a[100:103], v[64:67], v[124:127], a[100:103]
    ds_read_b64_tr_b16 v[58:59], v26 offset:864
    buffer_load_dwordx4 v20, s[8:11], s26 offen offset:0  lds
    v_mfma_f32_16x16x32_bf16 a[104:107], v[68:71], v[120:123], a[104:107]
    ds_read_b64_tr_b16 v[60:61], v26 offset:6240
    v_mul_f32 v81, v81, v30
    v_mfma_f32_16x16x32_bf16 a[108:111], v[68:71], v[124:127], a[108:111]
    ds_read_b64_tr_b16 v[62:63], v26 offset:7008
    s_waitcnt lgkmcnt(8)
    v_mfma_f32_16x16x32_bf16 a[112:115], v[72:75], v[120:123], a[112:115]
    ds_read_b64_tr_b16 v[64:65], v25 offset:128
    buffer_load_dwordx4 v21, s[8:11], s26 offen offset:1024  lds
    v_mfma_f32_16x16x32_bf16 a[116:119], v[72:75], v[124:127], a[116:119]
    ds_read_b64_tr_b16 v[66:67], v25 offset:896
    v_mul_f32 v82, v82, v30
    v_mfma_f32_16x16x32_bf16 a[120:123], v[76:79], v[120:123], a[120:123]
    ds_read_b64_tr_b16 v[68:69], v25 offset:6272
    v_mul_f32 v83, v83, v30
    v_mfma_f32_16x16x32_bf16 a[124:127], v[76:79], v[124:127], a[124:127]
    ds_read_b64_tr_b16 v[70:71], v25 offset:7040
    s_waitcnt lgkmcnt(8)
    v_mfma_f32_16x16x32_bf16 a[128:131], v[48:51], v[120:123], a[128:131]
    ds_read_b64_tr_b16 v[72:73], v26 offset:160
    buffer_load_dwordx4 v22, s[8:11], s26 offen offset:2048  lds
    v_mfma_f32_16x16x32_bf16 a[132:135], v[48:51], v[124:127], a[132:135]
    ds_read_b64_tr_b16 v[74:75], v26 offset:928
    v_mul_f32 v80, v80, v84
    v_mfma_f32_16x16x32_bf16 a[136:139], v[52:55], v[120:123], a[136:139]
    ds_read_b64_tr_b16 v[76:77], v26 offset:6304
    v_mul_f32 v81, v81, v85
    v_mfma_f32_16x16x32_bf16 a[140:143], v[52:55], v[124:127], a[140:143]
    ds_read_b64_tr_b16 v[78:79], v26 offset:7072
    s_waitcnt lgkmcnt(8)
    v_mfma_f32_16x16x32_bf16 a[144:147], v[56:59], v[120:123], a[144:147]
    ds_read_b64_tr_b16 v[48:49], v25 offset:12288
    v_mul_f32 v82, v82, v86
    v_mfma_f32_16x16x32_bf16 a[148:151], v[56:59], v[124:127], a[148:151]
    ds_read_b64_tr_b16 v[50:51], v25 offset:13056
    v_mul_f32 v83, v83, v87
    v_mfma_f32_16x16x32_bf16 a[152:155], v[60:63], v[120:123], a[152:155]
    ds_read_b64_tr_b16 v[52:53], v25 offset:18432
    v_cvt_pk_bf16_f32 v96, v80, v81
    v_mfma_f32_16x16x32_bf16 a[156:159], v[60:63], v[124:127], a[156:159]
    ds_read_b64_tr_b16 v[54:55], v25 offset:19200
    s_waitcnt lgkmcnt(8)
    v_mfma_f32_16x16x32_bf16 a[160:163], v[64:67], v[120:123], a[160:163]
    ds_read_b64_tr_b16 v[56:57], v26 offset:12320
    v_cvt_pk_bf16_f32 v97, v82, v83
    v_mfma_f32_16x16x32_bf16 a[164:167], v[64:67], v[124:127], a[164:167]
    ds_read_b64_tr_b16 v[58:59], v26 offset:13088
    v_accvgpr_read_b32 v80, a16
    v_mfma_f32_16x16x32_bf16 a[168:171], v[68:71], v[120:123], a[168:171]
    ds_read_b64_tr_b16 v[60:61], v26 offset:18464
    v_accvgpr_read_b32 v81, a17
    v_mfma_f32_16x16x32_bf16 a[172:175], v[68:71], v[124:127], a[172:175]
    ds_read_b64_tr_b16 v[62:63], v26 offset:19232
    s_waitcnt lgkmcnt(8)
    v_mfma_f32_16x16x32_bf16 a[176:179], v[72:75], v[120:123], a[176:179]
    ds_read_b64_tr_b16 v[64:65], v25 offset:12352
    v_accvgpr_read_b32 v82, a18
    v_mfma_f32_16x16x32_bf16 a[180:183], v[72:75], v[124:127], a[180:183]
    ds_read_b64_tr_b16 v[66:67], v25 offset:13120
    v_accvgpr_read_b32 v83, a19
    v_mfma_f32_16x16x32_bf16 a[184:187], v[76:79], v[120:123], a[184:187]
    ds_read_b64_tr_b16 v[68:69], v25 offset:18496
    v_accvgpr_read_b32 v84, a24
    v_mfma_f32_16x16x32_bf16 a[188:191], v[76:79], v[124:127], a[188:191]
    ds_read_b64_tr_b16 v[70:71], v25 offset:19264
    s_waitcnt lgkmcnt(8)
    v_mfma_f32_16x16x32_bf16 a[96:99], v[48:51], v[128:131], a[96:99]
    ds_read_b64_tr_b16 v[72:73], v26 offset:12384
    v_accvgpr_read_b32 v85, a25
    v_mfma_f32_16x16x32_bf16 a[100:103], v[48:51], v[132:135], a[100:103]
    ds_read_b64_tr_b16 v[74:75], v26 offset:13152
    v_accvgpr_read_b32 v86, a26
    v_mfma_f32_16x16x32_bf16 a[104:107], v[52:55], v[128:131], a[104:107]
    ds_read_b64_tr_b16 v[76:77], v26 offset:18528
    v_accvgpr_read_b32 v87, a27
    v_mfma_f32_16x16x32_bf16 a[108:111], v[52:55], v[132:135], a[108:111]
    ds_read_b64_tr_b16 v[78:79], v26 offset:19296
    s_waitcnt lgkmcnt(8)
    v_mfma_f32_16x16x32_bf16 a[112:115], v[56:59], v[128:131], a[112:115]
    ds_read_b64_tr_b16 v[48:49], v25 offset:12416
    v_mul_f32 v80, v80, v30
    v_mfma_f32_16x16x32_bf16 a[116:119], v[56:59], v[132:135], a[116:119]
    ds_read_b64_tr_b16 v[50:51], v25 offset:13184
    v_mul_f32 v81, v81, v30
    v_mfma_f32_16x16x32_bf16 a[120:123], v[60:63], v[128:131], a[120:123]
    ds_read_b64_tr_b16 v[52:53], v25 offset:18560
    v_mul_f32 v82, v82, v30
    v_mfma_f32_16x16x32_bf16 a[124:127], v[60:63], v[132:135], a[124:127]
    ds_read_b64_tr_b16 v[54:55], v25 offset:19328
    s_waitcnt lgkmcnt(8)
    v_mfma_f32_16x16x32_bf16 a[128:131], v[64:67], v[128:131], a[128:131]
    ds_read_b64_tr_b16 v[56:57], v26 offset:12448
    s_waitcnt vmcnt(6)
    v_mfma_f32_16x16x32_bf16 a[132:135], v[64:67], v[132:135], a[132:135]
    ds_read_b64_tr_b16 v[58:59], v26 offset:13216
    v_mul_f32 v83, v83, v30
    v_mfma_f32_16x16x32_bf16 a[136:139], v[68:71], v[128:131], a[136:139]
    ds_read_b64_tr_b16 v[60:61], v26 offset:18592
    s_barrier
    v_mfma_f32_16x16x32_bf16 a[140:143], v[68:71], v[132:135], a[140:143]
    ds_read_b64_tr_b16 v[62:63], v26 offset:19360
    s_waitcnt lgkmcnt(8)
    v_mfma_f32_16x16x32_bf16 a[144:147], v[72:75], v[128:131], a[144:147]
    ds_read_b64_tr_b16 v[64:65], v23 offset:0
    s_add_u32 m0, s38, 49152
    v_mfma_f32_16x16x32_bf16 a[148:151], v[72:75], v[132:135], a[148:151]
    ds_read_b64_tr_b16 v[66:67], v23 offset:768
    buffer_load_dwordx4 v20, s[8:11], s27 offen offset:0  lds
    v_mfma_f32_16x16x32_bf16 a[152:155], v[76:79], v[128:131], a[152:155]
    ds_read_b64_tr_b16 v[68:69], v23 offset:6144
    v_mul_f32 v80, v80, v84
    v_mfma_f32_16x16x32_bf16 a[156:159], v[76:79], v[132:135], a[156:159]
    ds_read_b64_tr_b16 v[70:71], v23 offset:6912
    s_waitcnt lgkmcnt(8)
    v_mfma_f32_16x16x32_bf16 a[160:163], v[48:51], v[128:131], a[160:163]
    ds_read_b64_tr_b16 v[72:73], v24 offset:32
    buffer_load_dwordx4 v21, s[8:11], s27 offen offset:1024  lds
    v_mfma_f32_16x16x32_bf16 a[164:167], v[48:51], v[132:135], a[164:167]
    ds_read_b64_tr_b16 v[74:75], v24 offset:800
    v_mul_f32 v81, v81, v85
    v_mfma_f32_16x16x32_bf16 a[168:171], v[52:55], v[128:131], a[168:171]
    ds_read_b64_tr_b16 v[76:77], v24 offset:6176
    v_mul_f32 v82, v82, v86
    v_mfma_f32_16x16x32_bf16 a[172:175], v[52:55], v[132:135], a[172:175]
    ds_read_b64_tr_b16 v[78:79], v24 offset:6944
    s_waitcnt lgkmcnt(8)
    v_mfma_f32_16x16x32_bf16 a[176:179], v[56:59], v[128:131], a[176:179]
    ds_read_b64_tr_b16 v[48:49], v23 offset:64
    buffer_load_dwordx4 v22, s[8:11], s27 offen offset:2048  lds
    v_mfma_f32_16x16x32_bf16 a[180:183], v[56:59], v[132:135], a[180:183]
    ds_read_b64_tr_b16 v[50:51], v23 offset:832
    v_mul_f32 v83, v83, v87
    v_mfma_f32_16x16x32_bf16 a[184:187], v[60:63], v[128:131], a[184:187]
    ds_read_b64_tr_b16 v[52:53], v23 offset:6208
    v_cvt_pk_bf16_f32 v98, v80, v81
    v_mfma_f32_16x16x32_bf16 a[188:191], v[60:63], v[132:135], a[188:191]
    ds_read_b64_tr_b16 v[54:55], v23 offset:6976
    s_waitcnt lgkmcnt(8)
    v_mfma_f32_16x16x32_bf16 a[96:99], v[64:67], v[136:139], a[96:99]
    ds_read_b64_tr_b16 v[56:57], v24 offset:96
    s_add_u32 m0, s38, 61440
    v_mfma_f32_16x16x32_bf16 a[100:103], v[64:67], v[140:143], a[100:103]
    ds_read_b64_tr_b16 v[58:59], v24 offset:864
    buffer_load_dwordx4 v20, s[8:11], s28 offen offset:0  lds
    v_mfma_f32_16x16x32_bf16 a[104:107], v[68:71], v[136:139], a[104:107]
    ds_read_b64_tr_b16 v[60:61], v24 offset:6240
    v_cvt_pk_bf16_f32 v99, v82, v83
    v_mfma_f32_16x16x32_bf16 a[108:111], v[68:71], v[140:143], a[108:111]
    ds_read_b64_tr_b16 v[62:63], v24 offset:7008
    s_waitcnt lgkmcnt(8)
    v_mfma_f32_16x16x32_bf16 a[112:115], v[72:75], v[136:139], a[112:115]
    ds_read_b64_tr_b16 v[64:65], v23 offset:128
    buffer_load_dwordx4 v21, s[8:11], s28 offen offset:1024  lds
    v_mfma_f32_16x16x32_bf16 a[116:119], v[72:75], v[140:143], a[116:119]
    ds_read_b64_tr_b16 v[66:67], v23 offset:896
    s_add_u32 s61, s43, 0
    v_mfma_f32_16x16x32_bf16 a[120:123], v[76:79], v[136:139], a[120:123]
    ds_read_b64_tr_b16 v[68:69], v23 offset:6272
    v_accvgpr_read_b32 v80, a4
    v_mfma_f32_16x16x32_bf16 a[124:127], v[76:79], v[140:143], a[124:127]
    ds_read_b64_tr_b16 v[70:71], v23 offset:7040
    s_waitcnt lgkmcnt(8)
    v_mfma_f32_16x16x32_bf16 a[128:131], v[48:51], v[136:139], a[128:131]
    ds_read_b64_tr_b16 v[72:73], v24 offset:160
    buffer_load_dwordx4 v22, s[8:11], s28 offen offset:2048  lds
    v_mfma_f32_16x16x32_bf16 a[132:135], v[48:51], v[140:143], a[132:135]
    ds_read_b64_tr_b16 v[74:75], v24 offset:928
    v_accvgpr_read_b32 v81, a5
    v_mfma_f32_16x16x32_bf16 a[136:139], v[52:55], v[136:139], a[136:139]
    ds_read_b64_tr_b16 v[76:77], v24 offset:6304
    buffer_store_dwordx4 v[96:99], v29, s[12:15], s61 offen offset:0 sc1
    v_mfma_f32_16x16x32_bf16 a[140:143], v[52:55], v[140:143], a[140:143]
    ds_read_b64_tr_b16 v[78:79], v24 offset:7072
    s_waitcnt lgkmcnt(8)
    v_mfma_f32_16x16x32_bf16 a[144:147], v[56:59], v[136:139], a[144:147]
    ds_read_b64_tr_b16 v[48:49], v23 offset:12288
    v_accvgpr_read_b32 v82, a6
    v_mfma_f32_16x16x32_bf16 a[148:151], v[56:59], v[140:143], a[148:151]
    ds_read_b64_tr_b16 v[50:51], v23 offset:13056
    v_accvgpr_read_b32 v83, a7
    v_mfma_f32_16x16x32_bf16 a[152:155], v[60:63], v[136:139], a[152:155]
    ds_read_b64_tr_b16 v[52:53], v23 offset:18432
    v_accvgpr_read_b32 v84, a12
    v_mfma_f32_16x16x32_bf16 a[156:159], v[60:63], v[140:143], a[156:159]
    ds_read_b64_tr_b16 v[54:55], v23 offset:19200
    s_waitcnt lgkmcnt(8)
    v_mfma_f32_16x16x32_bf16 a[160:163], v[64:67], v[136:139], a[160:163]
    ds_read_b64_tr_b16 v[56:57], v24 offset:12320
    v_accvgpr_read_b32 v85, a13
    v_mfma_f32_16x16x32_bf16 a[164:167], v[64:67], v[140:143], a[164:167]
    ds_read_b64_tr_b16 v[58:59], v24 offset:13088
    v_accvgpr_read_b32 v86, a14
    v_mfma_f32_16x16x32_bf16 a[168:171], v[68:71], v[136:139], a[168:171]
    ds_read_b64_tr_b16 v[60:61], v24 offset:18464
    v_accvgpr_read_b32 v87, a15
    v_mfma_f32_16x16x32_bf16 a[172:175], v[68:71], v[140:143], a[172:175]
    ds_read_b64_tr_b16 v[62:63], v24 offset:19232
    s_waitcnt lgkmcnt(8)
    v_mfma_f32_16x16x32_bf16 a[176:179], v[72:75], v[136:139], a[176:179]
    ds_read_b64_tr_b16 v[64:65], v23 offset:12352
    v_mul_f32 v80, v80, v31
    v_mfma_f32_16x16x32_bf16 a[180:183], v[72:75], v[140:143], a[180:183]
    ds_read_b64_tr_b16 v[66:67], v23 offset:13120
    v_mul_f32 v81, v81, v31
    v_mfma_f32_16x16x32_bf16 a[184:187], v[76:79], v[136:139], a[184:187]
    ds_read_b64_tr_b16 v[68:69], v23 offset:18496
    v_mul_f32 v82, v82, v31
    v_mfma_f32_16x16x32_bf16 a[188:191], v[76:79], v[140:143], a[188:191]
    ds_read_b64_tr_b16 v[70:71], v23 offset:19264
    s_waitcnt lgkmcnt(8)
    v_mfma_f32_16x16x32_bf16 a[96:99], v[48:51], v[144:147], a[96:99]
    ds_read_b64_tr_b16 v[72:73], v24 offset:12384
    v_mul_f32 v83, v83, v31
    v_mfma_f32_16x16x32_bf16 a[100:103], v[48:51], v[148:151], a[100:103]
    ds_read_b64_tr_b16 v[74:75], v24 offset:13152
    v_mul_f32 v80, v80, v84
    v_mfma_f32_16x16x32_bf16 a[104:107], v[52:55], v[144:147], a[104:107]
    ds_read_b64_tr_b16 v[76:77], v24 offset:18528
    v_mul_f32 v81, v81, v85
    v_mfma_f32_16x16x32_bf16 a[108:111], v[52:55], v[148:151], a[108:111]
    ds_read_b64_tr_b16 v[78:79], v24 offset:19296
    s_waitcnt lgkmcnt(8)
    v_mfma_f32_16x16x32_bf16 a[112:115], v[56:59], v[144:147], a[112:115]
    ds_read_b64_tr_b16 v[48:49], v23 offset:12416
    v_mul_f32 v82, v82, v86
    v_mfma_f32_16x16x32_bf16 a[116:119], v[56:59], v[148:151], a[116:119]
    ds_read_b64_tr_b16 v[50:51], v23 offset:13184
    v_mul_f32 v83, v83, v87
    v_mfma_f32_16x16x32_bf16 a[120:123], v[60:63], v[144:147], a[120:123]
    ds_read_b64_tr_b16 v[52:53], v23 offset:18560
    v_cvt_pk_bf16_f32 v100, v80, v81
    v_mfma_f32_16x16x32_bf16 a[124:127], v[60:63], v[148:151], a[124:127]
    ds_read_b64_tr_b16 v[54:55], v23 offset:19328
    s_waitcnt lgkmcnt(8)
    v_mfma_f32_16x16x32_bf16 a[128:131], v[64:67], v[144:147], a[128:131]
    ds_read_b64_tr_b16 v[56:57], v24 offset:12448
    s_waitcnt vmcnt(7)
    v_mfma_f32_16x16x32_bf16 a[132:135], v[64:67], v[148:151], a[132:135]
    ds_read_b64_tr_b16 v[58:59], v24 offset:13216
    v_cvt_pk_bf16_f32 v101, v82, v83
    v_mfma_f32_16x16x32_bf16 a[136:139], v[68:71], v[144:147], a[136:139]
    ds_read_b64_tr_b16 v[60:61], v24 offset:18592
    s_barrier
    v_mfma_f32_16x16x32_bf16 a[140:143], v[68:71], v[148:151], a[140:143]
    ds_read_b64_tr_b16 v[62:63], v24 offset:19360
    s_waitcnt lgkmcnt(8)
    v_mfma_f32_16x16x32_bf16 a[144:147], v[72:75], v[144:147], a[144:147]
    ds_read_b64_tr_b16 v[64:65], v23 offset:24576
    s_add_u32 m0, s38, 73728
    v_mfma_f32_16x16x32_bf16 a[148:151], v[72:75], v[148:151], a[148:151]
    ds_read_b64_tr_b16 v[66:67], v23 offset:25344
    buffer_load_dwordx4 v20, s[8:11], s29 offen offset:0  lds
    v_mfma_f32_16x16x32_bf16 a[152:155], v[76:79], v[144:147], a[152:155]
    ds_read_b64_tr_b16 v[68:69], v23 offset:30720
    v_accvgpr_read_b32 v80, a20
    v_mfma_f32_16x16x32_bf16 a[156:159], v[76:79], v[148:151], a[156:159]
    ds_read_b64_tr_b16 v[70:71], v23 offset:31488
    s_waitcnt lgkmcnt(8)
    v_mfma_f32_16x16x32_bf16 a[160:163], v[48:51], v[144:147], a[160:163]
    ds_read_b64_tr_b16 v[72:73], v24 offset:24608
    buffer_load_dwordx4 v21, s[8:11], s29 offen offset:1024  lds
    v_mfma_f32_16x16x32_bf16 a[164:167], v[48:51], v[148:151], a[164:167]
    ds_read_b64_tr_b16 v[74:75], v24 offset:25376
    v_accvgpr_read_b32 v81, a21
    v_mfma_f32_16x16x32_bf16 a[168:171], v[52:55], v[144:147], a[168:171]
    ds_read_b64_tr_b16 v[76:77], v24 offset:30752
    v_accvgpr_read_b32 v82, a22
    v_mfma_f32_16x16x32_bf16 a[172:175], v[52:55], v[148:151], a[172:175]
    ds_read_b64_tr_b16 v[78:79], v24 offset:31520
    s_waitcnt lgkmcnt(8)
    v_mfma_f32_16x16x32_bf16 a[176:179], v[56:59], v[144:147], a[176:179]
    ds_read_b64_tr_b16 v[48:49], v23 offset:24640
    buffer_load_dwordx4 v22, s[8:11], s29 offen offset:2048  lds
    v_mfma_f32_16x16x32_bf16 a[180:183], v[56:59], v[148:151], a[180:183]
    ds_read_b64_tr_b16 v[50:51], v23 offset:25408
    v_accvgpr_read_b32 v83, a23
    v_mfma_f32_16x16x32_bf16 a[184:187], v[60:63], v[144:147], a[184:187]
    ds_read_b64_tr_b16 v[52:53], v23 offset:30784
    v_accvgpr_read_b32 v84, a28
    v_mfma_f32_16x16x32_bf16 a[188:191], v[60:63], v[148:151], a[188:191]
    ds_read_b64_tr_b16 v[54:55], v23 offset:31552
    s_waitcnt lgkmcnt(8)
    v_mfma_f32_16x16x32_bf16 a[96:99], v[64:67], v[152:155], a[96:99]
    ds_read_b64_tr_b16 v[56:57], v24 offset:24672
    s_add_u32 m0, s38, 0
    v_mfma_f32_16x16x32_bf16 a[100:103], v[64:67], v[156:159], a[100:103]
    ds_read_b64_tr_b16 v[58:59], v24 offset:25440
    buffer_load_dwordx4 v20, s[8:11], s30 offen offset:0  lds
    v_mfma_f32_16x16x32_bf16 a[104:107], v[68:71], v[152:155], a[104:107]
    ds_read_b64_tr_b16 v[60:61], v24 offset:30816
    v_accvgpr_read_b32 v85, a29
    v_mfma_f32_16x16x32_bf16 a[108:111], v[68:71], v[156:159], a[108:111]
    ds_read_b64_tr_b16 v[62:63], v24 offset:31584
    s_waitcnt lgkmcnt(8)
    v_mfma_f32_16x16x32_bf16 a[112:115], v[72:75], v[152:155], a[112:115]
    ds_read_b64_tr_b16 v[64:65], v23 offset:24704
    buffer_load_dwordx4 v21, s[8:11], s30 offen offset:1024  lds
    v_mfma_f32_16x16x32_bf16 a[116:119], v[72:75], v[156:159], a[116:119]
    ds_read_b64_tr_b16 v[66:67], v23 offset:25472
    v_accvgpr_read_b32 v86, a30
    v_mfma_f32_16x16x32_bf16 a[120:123], v[76:79], v[152:155], a[120:123]
    ds_read_b64_tr_b16 v[68:69], v23 offset:30848
    v_accvgpr_read_b32 v87, a31
    v_mfma_f32_16x16x32_bf16 a[124:127], v[76:79], v[156:159], a[124:127]
    ds_read_b64_tr_b16 v[70:71], v23 offset:31616
    s_waitcnt lgkmcnt(8)
    v_mfma_f32_16x16x32_bf16 a[128:131], v[48:51], v[152:155], a[128:131]
    ds_read_b64_tr_b16 v[72:73], v24 offset:24736
    buffer_load_dwordx4 v22, s[8:11], s30 offen offset:2048  lds
    v_mfma_f32_16x16x32_bf16 a[132:135], v[48:51], v[156:159], a[132:135]
    ds_read_b64_tr_b16 v[74:75], v24 offset:25504
    v_mul_f32 v80, v80, v31
    v_mfma_f32_16x16x32_bf16 a[136:139], v[52:55], v[152:155], a[136:139]
    ds_read_b64_tr_b16 v[76:77], v24 offset:30880
    v_mul_f32 v81, v81, v31
    v_mfma_f32_16x16x32_bf16 a[140:143], v[52:55], v[156:159], a[140:143]
    ds_read_b64_tr_b16 v[78:79], v24 offset:31648
    s_waitcnt lgkmcnt(8)
    v_mfma_f32_16x16x32_bf16 a[144:147], v[56:59], v[152:155], a[144:147]
    ds_read_b64_tr_b16 v[48:49], v23 offset:36864
    v_mul_f32 v82, v82, v31
    v_mfma_f32_16x16x32_bf16 a[148:151], v[56:59], v[156:159], a[148:151]
    ds_read_b64_tr_b16 v[50:51], v23 offset:37632
    v_mul_f32 v83, v83, v31
    v_mfma_f32_16x16x32_bf16 a[152:155], v[60:63], v[152:155], a[152:155]
    ds_read_b64_tr_b16 v[52:53], v23 offset:43008
    v_mul_f32 v80, v80, v84
    v_mfma_f32_16x16x32_bf16 a[156:159], v[60:63], v[156:159], a[156:159]
    ds_read_b64_tr_b16 v[54:55], v23 offset:43776
    s_waitcnt lgkmcnt(8)
    v_mfma_f32_16x16x32_bf16 a[160:163], v[64:67], v[152:155], a[160:163]
    ds_read_b64_tr_b16 v[56:57], v24 offset:36896
    v_mul_f32 v81, v81, v85
    v_mfma_f32_16x16x32_bf16 a[164:167], v[64:67], v[156:159], a[164:167]
    ds_read_b64_tr_b16 v[58:59], v24 offset:37664
    v_mul_f32 v82, v82, v86
    v_mfma_f32_16x16x32_bf16 a[168:171], v[68:71], v[152:155], a[168:171]
    ds_read_b64_tr_b16 v[60:61], v24 offset:43040
    v_mul_f32 v83, v83, v87
    v_mfma_f32_16x16x32_bf16 a[172:175], v[68:71], v[156:159], a[172:175]
    ds_read_b64_tr_b16 v[62:63], v24 offset:43808
    s_waitcnt lgkmcnt(8)
    v_mfma_f32_16x16x32_bf16 a[176:179], v[72:75], v[152:155], a[176:179]
    ds_read_b64_tr_b16 v[64:65], v23 offset:36928
    v_cvt_pk_bf16_f32 v102, v80, v81
    v_mfma_f32_16x16x32_bf16 a[180:183], v[72:75], v[156:159], a[180:183]
    ds_read_b64_tr_b16 v[66:67], v23 offset:37696
    v_cvt_pk_bf16_f32 v103, v82, v83
    v_mfma_f32_16x16x32_bf16 a[184:187], v[76:79], v[152:155], a[184:187]
    ds_read_b64_tr_b16 v[68:69], v23 offset:43072
    buffer_store_dwordx4 v[100:103], v29, s[12:15], s61 offen offset:1024 sc1
    v_mfma_f32_16x16x32_bf16 a[188:191], v[76:79], v[156:159], a[188:191]
    ds_read_b64_tr_b16 v[70:71], v23 offset:43840
    s_waitcnt lgkmcnt(8)
    v_mfma_f32_16x16x32_bf16 a[96:99], v[48:51], v[160:163], a[96:99]
    ds_read_b64_tr_b16 v[72:73], v24 offset:36960
    v_accvgpr_read_b32 v80, a32
    v_mfma_f32_16x16x32_bf16 a[100:103], v[48:51], v[164:167], a[100:103]
    ds_read_b64_tr_b16 v[74:75], v24 offset:37728
    v_accvgpr_read_b32 v81, a33
    v_mfma_f32_16x16x32_bf16 a[104:107], v[52:55], v[160:163], a[104:107]
    ds_read_b64_tr_b16 v[76:77], v24 offset:43104
    v_accvgpr_read_b32 v82, a34
    v_mfma_f32_16x16x32_bf16 a[108:111], v[52:55], v[164:167], a[108:111]
    ds_read_b64_tr_b16 v[78:79], v24 offset:43872
    s_waitcnt lgkmcnt(8)
    v_mfma_f32_16x16x32_bf16 a[112:115], v[56:59], v[160:163], a[112:115]
    ds_read_b64_tr_b16 v[48:49], v23 offset:36992
    v_accvgpr_read_b32 v83, a35
    v_mfma_f32_16x16x32_bf16 a[116:119], v[56:59], v[164:167], a[116:119]
    ds_read_b64_tr_b16 v[50:51], v23 offset:37760
    v_accvgpr_read_b32 v84, a40
    v_mfma_f32_16x16x32_bf16 a[120:123], v[60:63], v[160:163], a[120:123]
    ds_read_b64_tr_b16 v[52:53], v23 offset:43136
    v_accvgpr_read_b32 v85, a41
    v_mfma_f32_16x16x32_bf16 a[124:127], v[60:63], v[164:167], a[124:127]
    ds_read_b64_tr_b16 v[54:55], v23 offset:43904
    s_waitcnt lgkmcnt(8)
    v_mfma_f32_16x16x32_bf16 a[128:131], v[64:67], v[160:163], a[128:131]
    ds_read_b64_tr_b16 v[56:57], v24 offset:37024
    s_waitcnt vmcnt(8)
    v_mfma_f32_16x16x32_bf16 a[132:135], v[64:67], v[164:167], a[132:135]
    ds_read_b64_tr_b16 v[58:59], v24 offset:37792
    v_accvgpr_read_b32 v86, a42
    v_mfma_f32_16x16x32_bf16 a[136:139], v[68:71], v[160:163], a[136:139]
    ds_read_b64_tr_b16 v[60:61], v24 offset:43168
    s_barrier
    v_mfma_f32_16x16x32_bf16 a[140:143], v[68:71], v[164:167], a[140:143]
    ds_read_b64_tr_b16 v[62:63], v24 offset:43936
    s_waitcnt lgkmcnt(8)
    v_mfma_f32_16x16x32_bf16 a[144:147], v[72:75], v[160:163], a[144:147]
    ds_read_b64_tr_b16 v[64:65], v23 offset:49152
    s_add_u32 m0, s38, 12288
    v_mfma_f32_16x16x32_bf16 a[148:151], v[72:75], v[164:167], a[148:151]
    ds_read_b64_tr_b16 v[66:67], v23 offset:49920
    buffer_load_dwordx4 v20, s[8:11], s31 offen offset:0  lds
    s_cmp_eq_u32 s94, 2
    s_cbranch_scc1 L1_SIGZ
    s_cmp_eq_u32 s16, 0
    s_cbranch_scc0 L1_SIGZ
    v_mov_b32 v88, 0
    v_mov_b32 v89, 1
    s_mov_b64 exec, 1
    global_atomic_add v88, v89, s[90:91] sc1
    s_mov_b64 exec, -1
L1_SIGZ:
    v_mfma_f32_16x16x32_bf16 a[152:155], v[76:79], v[160:163], a[152:155]
    ds_read_b64_tr_b16 v[68:69], v23 offset:55296
    v_accvgpr_read_b32 v87, a43
    v_mfma_f32_16x16x32_bf16 a[156:159], v[76:79], v[164:167], a[156:159]
    ds_read_b64_tr_b16 v[70:71], v23 offset:56064
    s_waitcnt lgkmcnt(8)
    v_mfma_f32_16x16x32_bf16 a[160:163], v[48:51], v[160:163], a[160:163]
    ds_read_b64_tr_b16 v[72:73], v24 offset:49184
    buffer_load_dwordx4 v21, s[8:11], s31 offen offset:1024  lds
    v_mfma_f32_16x16x32_bf16 a[164:167], v[48:51], v[164:167], a[164:167]
    ds_read_b64_tr_b16 v[74:75], v24 offset:49952
    v_mul_f32 v80, v80, v30
    v_mfma_f32_16x16x32_bf16 a[168:171], v[52:55], v[160:163], a[168:171]
    ds_read_b64_tr_b16 v[76:77], v24 offset:55328
    v_mul_f32 v81, v81, v30
    v_mfma_f32_16x16x32_bf16 a[172:175], v[52:55], v[164:167], a[172:175]
    ds_read_b64_tr_b16 v[78:79], v24 offset:56096
    s_waitcnt lgkmcnt(8)
    v_mfma_f32_16x16x32_bf16 a[176:179], v[56:59], v[160:163], a[176:179]
    ds_read_b64_tr_b16 v[48:49], v23 offset:49216
    buffer_load_dwordx4 v22, s[8:11], s31 offen offset:2048  lds
    v_mfma_f32_16x16x32_bf16 a[180:183], v[56:59], v[164:167], a[180:183]
    ds_read_b64_tr_b16 v[50:51], v23 offset:49984
    v_mul_f32 v82, v82, v30
    v_mfma_f32_16x16x32_bf16 a[184:187], v[60:63], v[160:163], a[184:187]
    ds_read_b64_tr_b16 v[52:53], v23 offset:55360
    v_mul_f32 v83, v83, v30
    v_mfma_f32_16x16x32_bf16 a[188:191], v[60:63], v[164:167], a[188:191]
    ds_read_b64_tr_b16 v[54:55], v23 offset:56128
    s_waitcnt lgkmcnt(8)
    v_mfma_f32_16x16x32_bf16 a[96:99], v[64:67], v[168:171], a[96:99]
    ds_read_b64_tr_b16 v[56:57], v24 offset:49248
    s_add_u32 m0, s38, 24576
    v_mfma_f32_16x16x32_bf16 a[100:103], v[64:67], v[172:175], a[100:103]
    ds_read_b64_tr_b16 v[58:59], v24 offset:50016
    buffer_load_dwordx4 v20, s[8:11], s32 offen offset:0  lds
    v_mfma_f32_16x16x32_bf16 a[104:107], v[68:71], v[168:171], a[104:107]
    ds_read_b64_tr_b16 v[60:61], v24 offset:55392
    v_mul_f32 v80, v80, v84
    v_mfma_f32_16x16x32_bf16 a[108:111], v[68:71], v[172:175], a[108:111]
    ds_read_b64_tr_b16 v[62:63], v24 offset:56160
    s_waitcnt lgkmcnt(8)
    v_mfma_f32_16x16x32_bf16 a[112:115], v[72:75], v[168:171], a[112:115]
    ds_read_b64_tr_b16 v[64:65], v23 offset:49280
    buffer_load_dwordx4 v21, s[8:11], s32 offen offset:1024  lds
    v_mfma_f32_16x16x32_bf16 a[116:119], v[72:75], v[172:175], a[116:119]
    ds_read_b64_tr_b16 v[66:67], v23 offset:50048
    v_mul_f32 v81, v81, v85
    v_mfma_f32_16x16x32_bf16 a[120:123], v[76:79], v[168:171], a[120:123]
    ds_read_b64_tr_b16 v[68:69], v23 offset:55424
    v_mul_f32 v82, v82, v86
    v_mfma_f32_16x16x32_bf16 a[124:127], v[76:79], v[172:175], a[124:127]
    ds_read_b64_tr_b16 v[70:71], v23 offset:56192
    s_waitcnt lgkmcnt(8)
    v_mfma_f32_16x16x32_bf16 a[128:131], v[48:51], v[168:171], a[128:131]
    ds_read_b64_tr_b16 v[72:73], v24 offset:49312
    buffer_load_dwordx4 v22, s[8:11], s32 offen offset:2048  lds
    v_mfma_f32_16x16x32_bf16 a[132:135], v[48:51], v[172:175], a[132:135]
    ds_read_b64_tr_b16 v[74:75], v24 offset:50080
    v_mul_f32 v83, v83, v87
    v_mfma_f32_16x16x32_bf16 a[136:139], v[52:55], v[168:171], a[136:139]
    ds_read_b64_tr_b16 v[76:77], v24 offset:55456
    v_cvt_pk_bf16_f32 v96, v80, v81
    v_mfma_f32_16x16x32_bf16 a[140:143], v[52:55], v[172:175], a[140:143]
    ds_read_b64_tr_b16 v[78:79], v24 offset:56224
    s_waitcnt lgkmcnt(8)
    v_mfma_f32_16x16x32_bf16 a[144:147], v[56:59], v[168:171], a[144:147]
    ds_read_b64_tr_b16 v[48:49], v25 offset:0
    s_mul_i32 s93, s2, 20736
    s_mul_i32 s95, s16, 5184
    s_add_u32 s93, s93, s95
    s_mov_b32 s96, s88
    s_mov_b32 s97, s89
    s_mov_b32 s98, 5308416
    s_mov_b32 s99, 0x00020000
    buffer_load_dwordx4 a[228:231], v29, s[96:99], s93 offen
    s_add_u32 s93, s93, 1024
    buffer_load_dwordx4 a[232:235], v29, s[96:99], s93 offen
    s_add_u32 s93, s93, 1024
    buffer_load_dwordx4 a[236:239], v29, s[96:99], s93 offen
    s_add_u32 s93, s93, 1024
    buffer_load_dwordx4 a[240:243], v29, s[96:99], s93 offen
    s_add_u32 s93, s93, 1024
    buffer_load_dwordx4 a[244:247], v29, s[96:99], s93 offen
    s_add_u32 s93, s93, 1024
    buffer_load_dword a248, v29, s[96:99], s93 offen
    v_mfma_f32_16x16x32_bf16 a[148:151], v[56:59], v[172:175], a[148:151]
    ds_read_b64_tr_b16 v[50:51], v25 offset:768
    v_cvt_pk_bf16_f32 v97, v82, v83
    v_mfma_f32_16x16x32_bf16 a[152:155], v[60:63], v[168:171], a[152:155]
    ds_read_b64_tr_b16 v[52:53], v25 offset:6144
    v_accvgpr_read_b32 v80, a48
    v_mfma_f32_16x16x32_bf16 a[156:159], v[60:63], v[172:175], a[156:159]
    ds_read_b64_tr_b16 v[54:55], v25 offset:6912
    s_waitcnt lgkmcnt(8)
    v_mfma_f32_16x16x32_bf16 a[160:163], v[64:67], v[168:171], a[160:163]
    ds_read_b64_tr_b16 v[56:57], v26 offset:32
    v_accvgpr_read_b32 v81, a49
    v_mfma_f32_16x16x32_bf16 a[164:167], v[64:67], v[172:175], a[164:167]
    ds_read_b64_tr_b16 v[58:59], v26 offset:800
    v_accvgpr_read_b32 v82, a50
    v_mfma_f32_16x16x32_bf16 a[168:171], v[68:71], v[168:171], a[168:171]
    ds_read_b64_tr_b16 v[60:61], v26 offset:6176
    v_accvgpr_read_b32 v83, a51
    v_mfma_f32_16x16x32_bf16 a[172:175], v[68:71], v[172:175], a[172:175]
    ds_read_b64_tr_b16 v[62:63], v26 offset:6944
    s_waitcnt lgkmcnt(8)
    v_mfma_f32_16x16x32_bf16 a[176:179], v[72:75], v[168:171], a[176:179]
    ds_read_b64_tr_b16 v[64:65], v25 offset:64
    v_accvgpr_read_b32 v84, a56
    v_mfma_f32_16x16x32_bf16 a[180:183], v[72:75], v[172:175], a[180:183]
    ds_read_b64_tr_b16 v[66:67], v25 offset:832
    v_accvgpr_read_b32 v85, a57
    v_mfma_f32_16x16x32_bf16 a[184:187], v[76:79], v[168:171], a[184:187]
    ds_read_b64_tr_b16 v[68:69], v25 offset:6208
    v_accvgpr_read_b32 v86, a58
    v_mfma_f32_16x16x32_bf16 a[188:191], v[76:79], v[172:175], a[188:191]
    ds_read_b64_tr_b16 v[70:71], v25 offset:6976
    s_waitcnt lgkmcnt(8)
    v_mfma_f32_16x16x32_bf16 a[96:99], v[48:51], v[176:179], a[96:99]
    ds_read_b64_tr_b16 v[72:73], v26 offset:96
    v_accvgpr_read_b32 v87, a59
    v_mfma_f32_16x16x32_bf16 a[100:103], v[48:51], v[180:183], a[100:103]
    ds_read_b64_tr_b16 v[74:75], v26 offset:864
    v_mul_f32 v80, v80, v30
    v_mfma_f32_16x16x32_bf16 a[104:107], v[52:55], v[176:179], a[104:107]
    ds_read_b64_tr_b16 v[76:77], v26 offset:6240
    v_mul_f32 v81, v81, v30
    v_mfma_f32_16x16x32_bf16 a[108:111], v[52:55], v[180:183], a[108:111]
    ds_read_b64_tr_b16 v[78:79], v26 offset:7008
    s_waitcnt lgkmcnt(8)
    v_mfma_f32_16x16x32_bf16 a[112:115], v[56:59], v[176:179], a[112:115]
    ds_read_b64_tr_b16 v[48:49], v25 offset:128
    v_mul_f32 v82, v82, v30
    v_mfma_f32_16x16x32_bf16 a[116:119], v[56:59], v[180:183], a[116:119]
    ds_read_b64_tr_b16 v[50:51], v25 offset:896
    v_mul_f32 v83, v83, v30
    v_mfma_f32_16x16x32_bf16 a[120:123], v[60:63], v[176:179], a[120:123]
    ds_read_b64_tr_b16 v[52:53], v25 offset:6272
    v_mul_f32 v80, v80, v84
    v_mfma_f32_16x16x32_bf16 a[124:127], v[60:63], v[180:183], a[124:127]
    ds_read_b64_tr_b16 v[54:55], v25 offset:7040
    s_waitcnt lgkmcnt(8)
    v_mfma_f32_16x16x32_bf16 a[128:131], v[64:67], v[176:179], a[128:131]
    ds_read_b64_tr_b16 v[56:57], v26 offset:160
    s_waitcnt vmcnt(7)
    v_mfma_f32_16x16x32_bf16 a[132:135], v[64:67], v[180:183], a[132:135]
    ds_read_b64_tr_b16 v[58:59], v26 offset:928
    v_mul_f32 v81, v81, v85
    v_mfma_f32_16x16x32_bf16 a[136:139], v[68:71], v[176:179], a[136:139]
    ds_read_b64_tr_b16 v[60:61], v26 offset:6304
    s_barrier
    v_mfma_f32_16x16x32_bf16 a[140:143], v[68:71], v[180:183], a[140:143]
    ds_read_b64_tr_b16 v[62:63], v26 offset:7072
    s_waitcnt lgkmcnt(8)
    v_mfma_f32_16x16x32_bf16 a[144:147], v[72:75], v[176:179], a[144:147]
    ds_read_b64_tr_b16 v[64:65], v25 offset:12288
    s_add_u32 m0, s38, 36864
    v_mfma_f32_16x16x32_bf16 a[148:151], v[72:75], v[180:183], a[148:151]
    ds_read_b64_tr_b16 v[66:67], v25 offset:13056
    buffer_load_dwordx4 v20, s[8:11], s33 offen offset:0  lds
    v_mfma_f32_16x16x32_bf16 a[152:155], v[76:79], v[176:179], a[152:155]
    ds_read_b64_tr_b16 v[68:69], v25 offset:18432
    v_mul_f32 v82, v82, v86
    v_mfma_f32_16x16x32_bf16 a[156:159], v[76:79], v[180:183], a[156:159]
    ds_read_b64_tr_b16 v[70:71], v25 offset:19200
    s_waitcnt lgkmcnt(8)
    v_mfma_f32_16x16x32_bf16 a[160:163], v[48:51], v[176:179], a[160:163]
    ds_read_b64_tr_b16 v[72:73], v26 offset:12320
    buffer_load_dwordx4 v21, s[8:11], s33 offen offset:1024  lds
    v_mfma_f32_16x16x32_bf16 a[164:167], v[48:51], v[180:183], a[164:167]
    ds_read_b64_tr_b16 v[74:75], v26 offset:13088
    v_mul_f32 v83, v83, v87
    v_mfma_f32_16x16x32_bf16 a[168:171], v[52:55], v[176:179], a[168:171]
    ds_read_b64_tr_b16 v[76:77], v26 offset:18464
    v_cvt_pk_bf16_f32 v98, v80, v81
    v_mfma_f32_16x16x32_bf16 a[172:175], v[52:55], v[180:183], a[172:175]
    ds_read_b64_tr_b16 v[78:79], v26 offset:19232
    s_waitcnt lgkmcnt(8)
    v_mfma_f32_16x16x32_bf16 a[176:179], v[56:59], v[176:179], a[176:179]
    ds_read_b64_tr_b16 v[48:49], v25 offset:12352
    buffer_load_dwordx4 v22, s[8:11], s33 offen offset:2048  lds
    v_mfma_f32_16x16x32_bf16 a[180:183], v[56:59], v[180:183], a[180:183]
    ds_read_b64_tr_b16 v[50:51], v25 offset:13120
    v_cvt_pk_bf16_f32 v99, v82, v83
    v_mfma_f32_16x16x32_bf16 a[184:187], v[60:63], v[176:179], a[184:187]
    ds_read_b64_tr_b16 v[52:53], v25 offset:18496
    s_add_u32 s63, s43, 8192
    v_mfma_f32_16x16x32_bf16 a[188:191], v[60:63], v[180:183], a[188:191]
    ds_read_b64_tr_b16 v[54:55], v25 offset:19264
    s_waitcnt lgkmcnt(8)
    v_mfma_f32_16x16x32_bf16 a[96:99], v[64:67], v[184:187], a[96:99]
    ds_read_b64_tr_b16 v[56:57], v26 offset:12384
    s_add_u32 m0, s38, 49152
    v_mfma_f32_16x16x32_bf16 a[100:103], v[64:67], v[188:191], a[100:103]
    ds_read_b64_tr_b16 v[58:59], v26 offset:13152
    buffer_load_dwordx4 v20, s[8:11], s34 offen offset:0  lds
    v_mfma_f32_16x16x32_bf16 a[104:107], v[68:71], v[184:187], a[104:107]
    ds_read_b64_tr_b16 v[60:61], v26 offset:18528
    v_accvgpr_read_b32 v80, a36
    v_mfma_f32_16x16x32_bf16 a[108:111], v[68:71], v[188:191], a[108:111]
    ds_read_b64_tr_b16 v[62:63], v26 offset:19296
    s_waitcnt lgkmcnt(8)
    v_mfma_f32_16x16x32_bf16 a[112:115], v[72:75], v[184:187], a[112:115]
    ds_read_b64_tr_b16 v[64:65], v25 offset:12416
    buffer_load_dwordx4 v21, s[8:11], s34 offen offset:1024  lds
    v_mfma_f32_16x16x32_bf16 a[116:119], v[72:75], v[188:191], a[116:119]
    ds_read_b64_tr_b16 v[66:67], v25 offset:13184
    v_accvgpr_read_b32 v81, a37
    v_mfma_f32_16x16x32_bf16 a[120:123], v[76:79], v[184:187], a[120:123]
    ds_read_b64_tr_b16 v[68:69], v25 offset:18560
    v_accvgpr_read_b32 v82, a38
    v_mfma_f32_16x16x32_bf16 a[124:127], v[76:79], v[188:191], a[124:127]
    ds_read_b64_tr_b16 v[70:71], v25 offset:19328
    s_waitcnt lgkmcnt(8)
    v_mfma_f32_16x16x32_bf16 a[128:131], v[48:51], v[184:187], a[128:131]
    ds_read_b64_tr_b16 v[72:73], v26 offset:12448
    buffer_load_dwordx4 v22, s[8:11], s34 offen offset:2048  lds
    v_mfma_f32_16x16x32_bf16 a[132:135], v[48:51], v[188:191], a[132:135]
    ds_read_b64_tr_b16 v[74:75], v26 offset:13216
    v_accvgpr_read_b32 v83, a39
    v_mfma_f32_16x16x32_bf16 a[136:139], v[52:55], v[184:187], a[136:139]
    ds_read_b64_tr_b16 v[76:77], v26 offset:18592
    buffer_store_dwordx4 v[96:99], v29, s[12:15], s63 offen offset:0 sc1
    v_mfma_f32_16x16x32_bf16 a[140:143], v[52:55], v[188:191], a[140:143]
    ds_read_b64_tr_b16 v[78:79], v26 offset:19360
    s_waitcnt lgkmcnt(8)
    v_mfma_f32_16x16x32_bf16 a[144:147], v[56:59], v[184:187], a[144:147]
    ds_read_b64_tr_b16 v[48:49], v23 offset:0
    v_accvgpr_read_b32 v84, a44
    v_mfma_f32_16x16x32_bf16 a[148:151], v[56:59], v[188:191], a[148:151]
    ds_read_b64_tr_b16 v[50:51], v23 offset:768
    v_accvgpr_read_b32 v85, a45
    v_mfma_f32_16x16x32_bf16 a[152:155], v[60:63], v[184:187], a[152:155]
    ds_read_b64_tr_b16 v[52:53], v23 offset:6144
    v_accvgpr_read_b32 v86, a46
    v_mfma_f32_16x16x32_bf16 a[156:159], v[60:63], v[188:191], a[156:159]
    ds_read_b64_tr_b16 v[54:55], v23 offset:6912
    s_waitcnt lgkmcnt(8)
    v_mfma_f32_16x16x32_bf16 a[160:163], v[64:67], v[184:187], a[160:163]
    ds_read_b64_tr_b16 v[56:57], v24 offset:32
    v_accvgpr_read_b32 v87, a47
    v_mfma_f32_16x16x32_bf16 a[164:167], v[64:67], v[188:191], a[164:167]
    ds_read_b64_tr_b16 v[58:59], v24 offset:800
    v_mul_f32 v80, v80, v31
    v_mfma_f32_16x16x32_bf16 a[168:171], v[68:71], v[184:187], a[168:171]
    ds_read_b64_tr_b16 v[60:61], v24 offset:6176
    v_mul_f32 v81, v81, v31
    v_mfma_f32_16x16x32_bf16 a[172:175], v[68:71], v[188:191], a[172:175]
    ds_read_b64_tr_b16 v[62:63], v24 offset:6944
    s_waitcnt lgkmcnt(8)
    v_mfma_f32_16x16x32_bf16 a[176:179], v[72:75], v[184:187], a[176:179]
    ds_read_b64_tr_b16 v[64:65], v23 offset:64
    v_mul_f32 v82, v82, v31
    v_mfma_f32_16x16x32_bf16 a[180:183], v[72:75], v[188:191], a[180:183]
    ds_read_b64_tr_b16 v[66:67], v23 offset:832
    v_mul_f32 v83, v83, v31
    v_mfma_f32_16x16x32_bf16 a[184:187], v[76:79], v[184:187], a[184:187]
    ds_read_b64_tr_b16 v[68:69], v23 offset:6208
    v_mul_f32 v80, v80, v84
    v_mfma_f32_16x16x32_bf16 a[188:191], v[76:79], v[188:191], a[188:191]
    ds_read_b64_tr_b16 v[70:71], v23 offset:6976
    s_waitcnt lgkmcnt(8)
    v_mfma_f32_16x16x32_bf16 a[96:99], v[48:51], v[192:195], a[96:99]
    ds_read_b64_tr_b16 v[72:73], v24 offset:96
    v_mul_f32 v81, v81, v85
    v_mfma_f32_16x16x32_bf16 a[100:103], v[48:51], v[196:199], a[100:103]
    ds_read_b64_tr_b16 v[74:75], v24 offset:864
    v_mul_f32 v82, v82, v86
    v_mfma_f32_16x16x32_bf16 a[104:107], v[52:55], v[192:195], a[104:107]
    ds_read_b64_tr_b16 v[76:77], v24 offset:6240
    v_mul_f32 v83, v83, v87
    v_mfma_f32_16x16x32_bf16 a[108:111], v[52:55], v[196:199], a[108:111]
    ds_read_b64_tr_b16 v[78:79], v24 offset:7008
    s_waitcnt lgkmcnt(8)
    v_mfma_f32_16x16x32_bf16 a[112:115], v[56:59], v[192:195], a[112:115]
    ds_read_b64_tr_b16 v[48:49], v23 offset:128
    v_cvt_pk_bf16_f32 v100, v80, v81
    v_mfma_f32_16x16x32_bf16 a[116:119], v[56:59], v[196:199], a[116:119]
    ds_read_b64_tr_b16 v[50:51], v23 offset:896
    v_cvt_pk_bf16_f32 v101, v82, v83
    v_mfma_f32_16x16x32_bf16 a[120:123], v[60:63], v[192:195], a[120:123]
    ds_read_b64_tr_b16 v[52:53], v23 offset:6272
    v_accvgpr_read_b32 v80, a52
    v_mfma_f32_16x16x32_bf16 a[124:127], v[60:63], v[196:199], a[124:127]
    ds_read_b64_tr_b16 v[54:55], v23 offset:7040
    s_waitcnt lgkmcnt(8)
    v_mfma_f32_16x16x32_bf16 a[128:131], v[64:67], v[192:195], a[128:131]
    ds_read_b64_tr_b16 v[56:57], v24 offset:160
    s_waitcnt vmcnt(7)
    v_mfma_f32_16x16x32_bf16 a[132:135], v[64:67], v[196:199], a[132:135]
    ds_read_b64_tr_b16 v[58:59], v24 offset:928
    v_accvgpr_read_b32 v81, a53
    v_mfma_f32_16x16x32_bf16 a[136:139], v[68:71], v[192:195], a[136:139]
    ds_read_b64_tr_b16 v[60:61], v24 offset:6304
    s_barrier
    v_mfma_f32_16x16x32_bf16 a[140:143], v[68:71], v[196:199], a[140:143]
    ds_read_b64_tr_b16 v[62:63], v24 offset:7072
    s_waitcnt lgkmcnt(8)
    v_mfma_f32_16x16x32_bf16 a[144:147], v[72:75], v[192:195], a[144:147]
    ds_read_b64_tr_b16 v[64:65], v23 offset:12288
    s_add_u32 m0, s38, 61440
    v_mfma_f32_16x16x32_bf16 a[148:151], v[72:75], v[196:199], a[148:151]
    ds_read_b64_tr_b16 v[66:67], v23 offset:13056
    buffer_load_dwordx4 v20, s[8:11], s35 offen offset:0  lds
    s_cmp_eq_u32 s94, 2
    s_cbranch_scc0 L1_SIGW
    s_cmp_eq_u32 s16, 0
    s_cbranch_scc0 L1_SIGW
    v_mov_b32 v88, 64
    v_mov_b32 v89, 1
    s_mov_b64 exec, 1
    global_atomic_add v88, v89, s[90:91] sc1
    s_mov_b64 exec, -1
L1_SIGW:
    v_mfma_f32_16x16x32_bf16 a[152:155], v[76:79], v[192:195], a[152:155]
    ds_read_b64_tr_b16 v[68:69], v23 offset:18432
    v_accvgpr_read_b32 v82, a54
    v_mfma_f32_16x16x32_bf16 a[156:159], v[76:79], v[196:199], a[156:159]
    ds_read_b64_tr_b16 v[70:71], v23 offset:19200
    s_waitcnt lgkmcnt(8)
    v_mfma_f32_16x16x32_bf16 a[160:163], v[48:51], v[192:195], a[160:163]
    ds_read_b64_tr_b16 v[72:73], v24 offset:12320
    buffer_load_dwordx4 v21, s[8:11], s35 offen offset:1024  lds
    v_mfma_f32_16x16x32_bf16 a[164:167], v[48:51], v[196:199], a[164:167]
    ds_read_b64_tr_b16 v[74:75], v24 offset:13088
    v_accvgpr_read_b32 v83, a55
    v_mfma_f32_16x16x32_bf16 a[168:171], v[52:55], v[192:195], a[168:171]
    ds_read_b64_tr_b16 v[76:77], v24 offset:18464
    v_accvgpr_read_b32 v84, a60
    v_mfma_f32_16x16x32_bf16 a[172:175], v[52:55], v[196:199], a[172:175]
    ds_read_b64_tr_b16 v[78:79], v24 offset:19232
    s_waitcnt lgkmcnt(8)
    v_mfma_f32_16x16x32_bf16 a[176:179], v[56:59], v[192:195], a[176:179]
    ds_read_b64_tr_b16 v[48:49], v23 offset:12352
    buffer_load_dwordx4 v22, s[8:11], s35 offen offset:2048  lds
    v_mfma_f32_16x16x32_bf16 a[180:183], v[56:59], v[196:199], a[180:183]
    ds_read_b64_tr_b16 v[50:51], v23 offset:13120
    v_accvgpr_read_b32 v85, a61
    v_mfma_f32_16x16x32_bf16 a[184:187], v[60:63], v[192:195], a[184:187]
    ds_read_b64_tr_b16 v[52:53], v23 offset:18496
    v_accvgpr_read_b32 v86, a62
    v_mfma_f32_16x16x32_bf16 a[188:191], v[60:63], v[196:199], a[188:191]
    ds_read_b64_tr_b16 v[54:55], v23 offset:19264
    s_waitcnt lgkmcnt(8)
    v_mfma_f32_16x16x32_bf16 a[96:99], v[64:67], v[200:203], a[96:99]
    ds_read_b64_tr_b16 v[56:57], v24 offset:12384
    s_add_u32 m0, s38, 73728
    v_mfma_f32_16x16x32_bf16 a[100:103], v[64:67], v[204:207], a[100:103]
    ds_read_b64_tr_b16 v[58:59], v24 offset:13152
    buffer_load_dwordx4 v20, s[8:11], s36 offen offset:0  lds
    v_mfma_f32_16x16x32_bf16 a[104:107], v[68:71], v[200:203], a[104:107]
    ds_read_b64_tr_b16 v[60:61], v24 offset:18528
    v_accvgpr_read_b32 v87, a63
    v_mfma_f32_16x16x32_bf16 a[108:111], v[68:71], v[204:207], a[108:111]
    ds_read_b64_tr_b16 v[62:63], v24 offset:19296
    s_waitcnt lgkmcnt(8)
    v_mfma_f32_16x16x32_bf16 a[112:115], v[72:75], v[200:203], a[112:115]
    ds_read_b64_tr_b16 v[64:65], v23 offset:12416
    buffer_load_dwordx4 v21, s[8:11], s36 offen offset:1024  lds
    v_mfma_f32_16x16x32_bf16 a[116:119], v[72:75], v[204:207], a[116:119]
    ds_read_b64_tr_b16 v[66:67], v23 offset:13184
    v_mul_f32 v80, v80, v31
    v_mfma_f32_16x16x32_bf16 a[120:123], v[76:79], v[200:203], a[120:123]
    ds_read_b64_tr_b16 v[68:69], v23 offset:18560
    v_mul_f32 v81, v81, v31
    v_mfma_f32_16x16x32_bf16 a[124:127], v[76:79], v[204:207], a[124:127]
    ds_read_b64_tr_b16 v[70:71], v23 offset:19328
    s_waitcnt lgkmcnt(8)
    v_mfma_f32_16x16x32_bf16 a[128:131], v[48:51], v[200:203], a[128:131]
    ds_read_b64_tr_b16 v[72:73], v24 offset:12448
    buffer_load_dwordx4 v22, s[8:11], s36 offen offset:2048  lds
    v_mfma_f32_16x16x32_bf16 a[132:135], v[48:51], v[204:207], a[132:135]
    ds_read_b64_tr_b16 v[74:75], v24 offset:13216
    v_mul_f32 v82, v82, v31
    v_mfma_f32_16x16x32_bf16 a[136:139], v[52:55], v[200:203], a[136:139]
    ds_read_b64_tr_b16 v[76:77], v24 offset:18592
    v_mul_f32 v83, v83, v31
    v_mfma_f32_16x16x32_bf16 a[140:143], v[52:55], v[204:207], a[140:143]
    ds_read_b64_tr_b16 v[78:79], v24 offset:19360
    s_waitcnt lgkmcnt(8)
    v_mfma_f32_16x16x32_bf16 a[144:147], v[56:59], v[200:203], a[144:147]
    ds_read_b64_tr_b16 v[48:49], v23 offset:24576
    v_mul_f32 v80, v80, v84
    v_mfma_f32_16x16x32_bf16 a[148:151], v[56:59], v[204:207], a[148:151]
    ds_read_b64_tr_b16 v[50:51], v23 offset:25344
    v_mul_f32 v81, v81, v85
    v_mfma_f32_16x16x32_bf16 a[152:155], v[60:63], v[200:203], a[152:155]
    ds_read_b64_tr_b16 v[52:53], v23 offset:30720
    v_mul_f32 v82, v82, v86
    v_mfma_f32_16x16x32_bf16 a[156:159], v[60:63], v[204:207], a[156:159]
    ds_read_b64_tr_b16 v[54:55], v23 offset:31488
    s_waitcnt lgkmcnt(8)
    v_mfma_f32_16x16x32_bf16 a[160:163], v[64:67], v[200:203], a[160:163]
    ds_read_b64_tr_b16 v[56:57], v24 offset:24608
    v_mul_f32 v83, v83, v87
    v_mfma_f32_16x16x32_bf16 a[164:167], v[64:67], v[204:207], a[164:167]
    ds_read_b64_tr_b16 v[58:59], v24 offset:25376
    v_cvt_pk_bf16_f32 v102, v80, v81
    v_mfma_f32_16x16x32_bf16 a[168:171], v[68:71], v[200:203], a[168:171]
    ds_read_b64_tr_b16 v[60:61], v24 offset:30752
    v_cvt_pk_bf16_f32 v103, v82, v83
    v_mfma_f32_16x16x32_bf16 a[172:175], v[68:71], v[204:207], a[172:175]
    ds_read_b64_tr_b16 v[62:63], v24 offset:31520
    s_waitcnt lgkmcnt(8)
    v_mfma_f32_16x16x32_bf16 a[176:179], v[72:75], v[200:203], a[176:179]
    ds_read_b64_tr_b16 v[64:65], v23 offset:24640
    buffer_store_dwordx4 v[100:103], v29, s[12:15], s63 offen offset:1024 sc1
    v_mfma_f32_16x16x32_bf16 a[180:183], v[72:75], v[204:207], a[180:183]
    ds_read_b64_tr_b16 v[66:67], v23 offset:25408
    v_accvgpr_read_b32 v80, a64
    v_mfma_f32_16x16x32_bf16 a[184:187], v[76:79], v[200:203], a[184:187]
    ds_read_b64_tr_b16 v[68:69], v23 offset:30784
    v_accvgpr_read_b32 v81, a65
    v_mfma_f32_16x16x32_bf16 a[188:191], v[76:79], v[204:207], a[188:191]
    ds_read_b64_tr_b16 v[70:71], v23 offset:31552
    s_waitcnt lgkmcnt(8)
    v_mfma_f32_16x16x32_bf16 a[96:99], v[48:51], v[208:211], a[96:99]
    ds_read_b64_tr_b16 v[72:73], v24 offset:24672
    v_accvgpr_read_b32 v82, a66
    v_mfma_f32_16x16x32_bf16 a[100:103], v[48:51], v[212:215], a[100:103]
    ds_read_b64_tr_b16 v[74:75], v24 offset:25440
    v_accvgpr_read_b32 v83, a67
    v_mfma_f32_16x16x32_bf16 a[104:107], v[52:55], v[208:211], a[104:107]
    ds_read_b64_tr_b16 v[76:77], v24 offset:30816
    v_accvgpr_read_b32 v84, a72
    v_mfma_f32_16x16x32_bf16 a[108:111], v[52:55], v[212:215], a[108:111]
    ds_read_b64_tr_b16 v[78:79], v24 offset:31584
    s_waitcnt lgkmcnt(8)
    v_mfma_f32_16x16x32_bf16 a[112:115], v[56:59], v[208:211], a[112:115]
    ds_read_b64_tr_b16 v[48:49], v23 offset:24704
    v_accvgpr_read_b32 v85, a73
    v_mfma_f32_16x16x32_bf16 a[116:119], v[56:59], v[212:215], a[116:119]
    ds_read_b64_tr_b16 v[50:51], v23 offset:25472
    v_accvgpr_read_b32 v86, a74
    v_mfma_f32_16x16x32_bf16 a[120:123], v[60:63], v[208:211], a[120:123]
    ds_read_b64_tr_b16 v[52:53], v23 offset:30848
    v_accvgpr_read_b32 v87, a75
    v_mfma_f32_16x16x32_bf16 a[124:127], v[60:63], v[212:215], a[124:127]
    ds_read_b64_tr_b16 v[54:55], v23 offset:31616
    s_waitcnt lgkmcnt(8)
    v_mfma_f32_16x16x32_bf16 a[128:131], v[64:67], v[208:211], a[128:131]
    ds_read_b64_tr_b16 v[56:57], v24 offset:24736
    s_waitcnt vmcnt(8)
    v_mfma_f32_16x16x32_bf16 a[132:135], v[64:67], v[212:215], a[132:135]
    ds_read_b64_tr_b16 v[58:59], v24 offset:25504
    v_mul_f32 v80, v80, v30
    v_mfma_f32_16x16x32_bf16 a[136:139], v[68:71], v[208:211], a[136:139]
    ds_read_b64_tr_b16 v[60:61], v24 offset:30880
    s_barrier
    v_mfma_f32_16x16x32_bf16 a[140:143], v[68:71], v[212:215], a[140:143]
    ds_read_b64_tr_b16 v[62:63], v24 offset:31648
    s_waitcnt lgkmcnt(8)
    v_mfma_f32_16x16x32_bf16 a[144:147], v[72:75], v[208:211], a[144:147]
    ds_read_b64_tr_b16 v[64:65], v23 offset:36864
    s_add_u32 m0, s38, 0
    v_mfma_f32_16x16x32_bf16 a[148:151], v[72:75], v[212:215], a[148:151]
    ds_read_b64_tr_b16 v[66:67], v23 offset:37632
    buffer_load_dwordx4 v20, s[8:11], s37 offen offset:0  lds
    v_mfma_f32_16x16x32_bf16 a[152:155], v[76:79], v[208:211], a[152:155]
    ds_read_b64_tr_b16 v[68:69], v23 offset:43008
    v_mul_f32 v81, v81, v30
    v_mfma_f32_16x16x32_bf16 a[156:159], v[76:79], v[212:215], a[156:159]
    ds_read_b64_tr_b16 v[70:71], v23 offset:43776
    s_waitcnt lgkmcnt(8)
    v_mfma_f32_16x16x32_bf16 a[160:163], v[48:51], v[208:211], a[160:163]
    ds_read_b64_tr_b16 v[72:73], v24 offset:36896
    buffer_load_dwordx4 v21, s[8:11], s37 offen offset:1024  lds
    v_mfma_f32_16x16x32_bf16 a[164:167], v[48:51], v[212:215], a[164:167]
    ds_read_b64_tr_b16 v[74:75], v24 offset:37664
    v_mul_f32 v82, v82, v30
    v_mfma_f32_16x16x32_bf16 a[168:171], v[52:55], v[208:211], a[168:171]
    ds_read_b64_tr_b16 v[76:77], v24 offset:43040
    v_mul_f32 v83, v83, v30
    v_mfma_f32_16x16x32_bf16 a[172:175], v[52:55], v[212:215], a[172:175]
    ds_read_b64_tr_b16 v[78:79], v24 offset:43808
    s_waitcnt lgkmcnt(8)
    v_mfma_f32_16x16x32_bf16 a[176:179], v[56:59], v[208:211], a[176:179]
    ds_read_b64_tr_b16 v[48:49], v23 offset:36928
    buffer_load_dwordx4 v22, s[8:11], s37 offen offset:2048  lds
    v_mfma_f32_16x16x32_bf16 a[180:183], v[56:59], v[212:215], a[180:183]
    ds_read_b64_tr_b16 v[50:51], v23 offset:37696
    s_add_u32 s8, s8, 192
    s_addc_u32 s9, s9, 0
    v_mfma_f32_16x16x32_bf16 a[184:187], v[60:63], v[208:211], a[184:187]
    ds_read_b64_tr_b16 v[52:53], v23 offset:43072
    s_sub_u32 s10, s10, 192
    v_mfma_f32_16x16x32_bf16 a[188:191], v[60:63], v[212:215], a[188:191]
    ds_read_b64_tr_b16 v[54:55], v23 offset:43840
    s_waitcnt lgkmcnt(8)
    v_mfma_f32_16x16x32_bf16 a[96:99], v[64:67], v[216:219], a[96:99]
    ds_read_b64_tr_b16 v[56:57], v24 offset:36960
    s_add_u32 m0, s38, 12288
    v_mfma_f32_16x16x32_bf16 a[100:103], v[64:67], v[220:223], a[100:103]
    ds_read_b64_tr_b16 v[58:59], v24 offset:37728
    buffer_load_dwordx4 v20, s[8:11], s20 offen offset:0  lds
    v_mfma_f32_16x16x32_bf16 a[104:107], v[68:71], v[216:219], a[104:107]
    ds_read_b64_tr_b16 v[60:61], v24 offset:43104
    v_mul_f32 v80, v80, v84
    v_mfma_f32_16x16x32_bf16 a[108:111], v[68:71], v[220:223], a[108:111]
    ds_read_b64_tr_b16 v[62:63], v24 offset:43872
    s_waitcnt lgkmcnt(8)
    v_mfma_f32_16x16x32_bf16 a[112:115], v[72:75], v[216:219], a[112:115]
    ds_read_b64_tr_b16 v[64:65], v23 offset:36992
    buffer_load_dwordx4 v21, s[8:11], s20 offen offset:1024  lds
    v_mfma_f32_16x16x32_bf16 a[116:119], v[72:75], v[220:223], a[116:119]
    ds_read_b64_tr_b16 v[66:67], v23 offset:37760
    v_mul_f32 v81, v81, v85
    v_mfma_f32_16x16x32_bf16 a[120:123], v[76:79], v[216:219], a[120:123]
    ds_read_b64_tr_b16 v[68:69], v23 offset:43136
    v_mul_f32 v82, v82, v86
    v_mfma_f32_16x16x32_bf16 a[124:127], v[76:79], v[220:223], a[124:127]
    ds_read_b64_tr_b16 v[70:71], v23 offset:43904
    s_waitcnt lgkmcnt(8)
    v_mfma_f32_16x16x32_bf16 a[128:131], v[48:51], v[216:219], a[128:131]
    ds_read_b64_tr_b16 v[72:73], v24 offset:37024
    buffer_load_dwordx4 v22, s[8:11], s20 offen offset:2048  lds
    v_mfma_f32_16x16x32_bf16 a[132:135], v[48:51], v[220:223], a[132:135]
    ds_read_b64_tr_b16 v[74:75], v24 offset:37792
    v_mul_f32 v83, v83, v87
    v_mfma_f32_16x16x32_bf16 a[136:139], v[52:55], v[216:219], a[136:139]
    ds_read_b64_tr_b16 v[76:77], v24 offset:43168
    v_cvt_pk_bf16_f32 v96, v80, v81
    v_mfma_f32_16x16x32_bf16 a[140:143], v[52:55], v[220:223], a[140:143]
    ds_read_b64_tr_b16 v[78:79], v24 offset:43936
    s_waitcnt lgkmcnt(8)
    v_mfma_f32_16x16x32_bf16 a[144:147], v[56:59], v[216:219], a[144:147]
    ds_read_b64_tr_b16 v[48:49], v23 offset:49152
    v_cvt_pk_bf16_f32 v97, v82, v83
    v_mfma_f32_16x16x32_bf16 a[148:151], v[56:59], v[220:223], a[148:151]
    ds_read_b64_tr_b16 v[50:51], v23 offset:49920
    v_accvgpr_read_b32 v80, a80
    v_mfma_f32_16x16x32_bf16 a[152:155], v[60:63], v[216:219], a[152:155]
    ds_read_b64_tr_b16 v[52:53], v23 offset:55296
    v_accvgpr_read_b32 v81, a81
    v_mfma_f32_16x16x32_bf16 a[156:159], v[60:63], v[220:223], a[156:159]
    ds_read_b64_tr_b16 v[54:55], v23 offset:56064
    s_waitcnt lgkmcnt(8)
    v_mfma_f32_16x16x32_bf16 a[160:163], v[64:67], v[216:219], a[160:163]
    ds_read_b64_tr_b16 v[56:57], v24 offset:49184
    v_accvgpr_read_b32 v82, a82
    v_mfma_f32_16x16x32_bf16 a[164:167], v[64:67], v[220:223], a[164:167]
    ds_read_b64_tr_b16 v[58:59], v24 offset:49952
    v_accvgpr_read_b32 v83, a83
    v_mfma_f32_16x16x32_bf16 a[168:171], v[68:71], v[216:219], a[168:171]
    ds_read_b64_tr_b16 v[60:61], v24 offset:55328
    v_accvgpr_read_b32 v84, a88
    v_mfma_f32_16x16x32_bf16 a[172:175], v[68:71], v[220:223], a[172:175]
    ds_read_b64_tr_b16 v[62:63], v24 offset:56096
    s_waitcnt lgkmcnt(8)
    v_mfma_f32_16x16x32_bf16 a[176:179], v[72:75], v[216:219], a[176:179]
    ds_read_b64_tr_b16 v[64:65], v23 offset:49216
    v_accvgpr_read_b32 v85, a89
    v_mfma_f32_16x16x32_bf16 a[180:183], v[72:75], v[220:223], a[180:183]
    ds_read_b64_tr_b16 v[66:67], v23 offset:49984
    v_accvgpr_read_b32 v86, a90
    v_mfma_f32_16x16x32_bf16 a[184:187], v[76:79], v[216:219], a[184:187]
    ds_read_b64_tr_b16 v[68:69], v23 offset:55360
    v_accvgpr_read_b32 v87, a91
    v_mfma_f32_16x16x32_bf16 a[188:191], v[76:79], v[220:223], a[188:191]
    ds_read_b64_tr_b16 v[70:71], v23 offset:56128
    s_waitcnt lgkmcnt(8)
    v_mfma_f32_16x16x32_bf16 a[96:99], v[48:51], v[224:227], a[96:99]
    ds_read_b64_tr_b16 v[72:73], v24 offset:49248
    v_mul_f32 v80, v80, v30
    v_mfma_f32_16x16x32_bf16 a[100:103], v[48:51], v[228:231], a[100:103]
    ds_read_b64_tr_b16 v[74:75], v24 offset:50016
    v_mul_f32 v81, v81, v30
    v_mfma_f32_16x16x32_bf16 a[104:107], v[52:55], v[224:227], a[104:107]
    ds_read_b64_tr_b16 v[76:77], v24 offset:55392
    v_mul_f32 v82, v82, v30
    v_mfma_f32_16x16x32_bf16 a[108:111], v[52:55], v[228:231], a[108:111]
    ds_read_b64_tr_b16 v[78:79], v24 offset:56160
    s_waitcnt lgkmcnt(8)
    v_mfma_f32_16x16x32_bf16 a[112:115], v[56:59], v[224:227], a[112:115]
    ds_read_b64_tr_b16 v[48:49], v23 offset:49280
    v_mul_f32 v83, v83, v30
    v_mfma_f32_16x16x32_bf16 a[116:119], v[56:59], v[228:231], a[116:119]
    ds_read_b64_tr_b16 v[50:51], v23 offset:50048
    v_mul_f32 v80, v80, v84
    v_mfma_f32_16x16x32_bf16 a[120:123], v[60:63], v[224:227], a[120:123]
    ds_read_b64_tr_b16 v[52:53], v23 offset:55424
    v_mul_f32 v81, v81, v85
    v_mfma_f32_16x16x32_bf16 a[124:127], v[60:63], v[228:231], a[124:127]
    ds_read_b64_tr_b16 v[54:55], v23 offset:56192
    s_waitcnt lgkmcnt(8)
    v_mfma_f32_16x16x32_bf16 a[128:131], v[64:67], v[224:227], a[128:131]
    ds_read_b64_tr_b16 v[56:57], v24 offset:49312
    s_waitcnt vmcnt(7)
    v_mfma_f32_16x16x32_bf16 a[132:135], v[64:67], v[228:231], a[132:135]
    ds_read_b64_tr_b16 v[58:59], v24 offset:50080
    v_mul_f32 v82, v82, v86
    v_mfma_f32_16x16x32_bf16 a[136:139], v[68:71], v[224:227], a[136:139]
    ds_read_b64_tr_b16 v[60:61], v24 offset:55456
    s_barrier
    v_mfma_f32_16x16x32_bf16 a[140:143], v[68:71], v[228:231], a[140:143]
    ds_read_b64_tr_b16 v[62:63], v24 offset:56224
    s_waitcnt lgkmcnt(8)
    v_mfma_f32_16x16x32_bf16 a[144:147], v[72:75], v[224:227], a[144:147]
    ds_read_b64_tr_b16 v[64:65], v25 offset:0
    s_add_u32 m0, s38, 24576
    v_mfma_f32_16x16x32_bf16 a[148:151], v[72:75], v[228:231], a[148:151]
    ds_read_b64_tr_b16 v[66:67], v25 offset:768
    buffer_load_dwordx4 v20, s[8:11], s21 offen offset:0  lds
    v_mfma_f32_16x16x32_bf16 a[152:155], v[76:79], v[224:227], a[152:155]
    ds_read_b64_tr_b16 v[68:69], v25 offset:6144
    v_mul_f32 v83, v83, v87
    v_mfma_f32_16x16x32_bf16 a[156:159], v[76:79], v[228:231], a[156:159]
    ds_read_b64_tr_b16 v[70:71], v25 offset:6912
    s_waitcnt lgkmcnt(8)
    v_mfma_f32_16x16x32_bf16 a[160:163], v[48:51], v[224:227], a[160:163]
    ds_read_b64_tr_b16 v[72:73], v26 offset:32
    buffer_load_dwordx4 v21, s[8:11], s21 offen offset:1024  lds
    v_mfma_f32_16x16x32_bf16 a[164:167], v[48:51], v[228:231], a[164:167]
    ds_read_b64_tr_b16 v[74:75], v26 offset:800
    v_cvt_pk_bf16_f32 v98, v80, v81
    v_mfma_f32_16x16x32_bf16 a[168:171], v[52:55], v[224:227], a[168:171]
    ds_read_b64_tr_b16 v[76:77], v26 offset:6176
    v_cvt_pk_bf16_f32 v99, v82, v83
    v_mfma_f32_16x16x32_bf16 a[172:175], v[52:55], v[228:231], a[172:175]
    ds_read_b64_tr_b16 v[78:79], v26 offset:6944
    s_waitcnt lgkmcnt(8)
    v_mfma_f32_16x16x32_bf16 a[176:179], v[56:59], v[224:227], a[176:179]
    ds_read_b64_tr_b16 v[48:49], v25 offset:64
    buffer_load_dwordx4 v22, s[8:11], s21 offen offset:2048  lds
    v_mfma_f32_16x16x32_bf16 a[180:183], v[56:59], v[228:231], a[180:183]
    ds_read_b64_tr_b16 v[50:51], v25 offset:832
    s_add_u32 s61, s43, 16384
    v_mfma_f32_16x16x32_bf16 a[184:187], v[60:63], v[224:227], a[184:187]
    ds_read_b64_tr_b16 v[52:53], v25 offset:6208
    v_accvgpr_read_b32 v80, a68
    v_mfma_f32_16x16x32_bf16 a[188:191], v[60:63], v[228:231], a[188:191]
    ds_read_b64_tr_b16 v[54:55], v25 offset:6976
    s_waitcnt lgkmcnt(8)
    v_mfma_f32_16x16x32_bf16 a[96:99], v[64:67], v[232:235], a[96:99]
    ds_read_b64_tr_b16 v[56:57], v26 offset:96
    s_add_u32 m0, s38, 36864
    v_mfma_f32_16x16x32_bf16 a[100:103], v[64:67], v[236:239], a[100:103]
    ds_read_b64_tr_b16 v[58:59], v26 offset:864
    buffer_load_dwordx4 v20, s[8:11], s22 offen offset:0  lds
    v_mfma_f32_16x16x32_bf16 a[104:107], v[68:71], v[232:235], a[104:107]
    ds_read_b64_tr_b16 v[60:61], v26 offset:6240
    v_accvgpr_read_b32 v81, a69
    v_mfma_f32_16x16x32_bf16 a[108:111], v[68:71], v[236:239], a[108:111]
    ds_read_b64_tr_b16 v[62:63], v26 offset:7008
    s_waitcnt lgkmcnt(8)
    v_mfma_f32_16x16x32_bf16 a[112:115], v[72:75], v[232:235], a[112:115]
    ds_read_b64_tr_b16 v[64:65], v25 offset:128
    buffer_load_dwordx4 v21, s[8:11], s22 offen offset:1024  lds
    v_mfma_f32_16x16x32_bf16 a[116:119], v[72:75], v[236:239], a[116:119]
    ds_read_b64_tr_b16 v[66:67], v25 offset:896
    v_accvgpr_read_b32 v82, a70
    v_mfma_f32_16x16x32_bf16 a[120:123], v[76:79], v[232:235], a[120:123]
    ds_read_b64_tr_b16 v[68:69], v25 offset:6272
    v_accvgpr_read_b32 v83, a71
    v_mfma_f32_16x16x32_bf16 a[124:127], v[76:79], v[236:239], a[124:127]
    ds_read_b64_tr_b16 v[70:71], v25 offset:7040
    s_waitcnt lgkmcnt(8)
    v_mfma_f32_16x16x32_bf16 a[128:131], v[48:51], v[232:235], a[128:131]
    ds_read_b64_tr_b16 v[72:73], v26 offset:160
    buffer_load_dwordx4 v22, s[8:11], s22 offen offset:2048  lds
    v_mfma_f32_16x16x32_bf16 a[132:135], v[48:51], v[236:239], a[132:135]
    ds_read_b64_tr_b16 v[74:75], v26 offset:928
    v_accvgpr_read_b32 v84, a76
    v_mfma_f32_16x16x32_bf16 a[136:139], v[52:55], v[232:235], a[136:139]
    ds_read_b64_tr_b16 v[76:77], v26 offset:6304
    buffer_store_dwordx4 v[96:99], v29, s[12:15], s61 offen offset:0 sc1
    v_mfma_f32_16x16x32_bf16 a[140:143], v[52:55], v[236:239], a[140:143]
    ds_read_b64_tr_b16 v[78:79], v26 offset:7072
    s_waitcnt lgkmcnt(8)
    v_mfma_f32_16x16x32_bf16 a[144:147], v[56:59], v[232:235], a[144:147]
    ds_read_b64_tr_b16 v[48:49], v25 offset:12288
    v_accvgpr_read_b32 v85, a77
    v_mfma_f32_16x16x32_bf16 a[148:151], v[56:59], v[236:239], a[148:151]
    ds_read_b64_tr_b16 v[50:51], v25 offset:13056
    v_accvgpr_read_b32 v86, a78
    v_mfma_f32_16x16x32_bf16 a[152:155], v[60:63], v[232:235], a[152:155]
    ds_read_b64_tr_b16 v[52:53], v25 offset:18432
    v_accvgpr_read_b32 v87, a79
    v_mfma_f32_16x16x32_bf16 a[156:159], v[60:63], v[236:239], a[156:159]
    ds_read_b64_tr_b16 v[54:55], v25 offset:19200
    s_waitcnt lgkmcnt(8)
    v_mfma_f32_16x16x32_bf16 a[160:163], v[64:67], v[232:235], a[160:163]
    ds_read_b64_tr_b16 v[56:57], v26 offset:12320
    v_mul_f32 v80, v80, v31
    v_mfma_f32_16x16x32_bf16 a[164:167], v[64:67], v[236:239], a[164:167]
    ds_read_b64_tr_b16 v[58:59], v26 offset:13088
    v_mul_f32 v81, v81, v31
    v_mfma_f32_16x16x32_bf16 a[168:171], v[68:71], v[232:235], a[168:171]
    ds_read_b64_tr_b16 v[60:61], v26 offset:18464
    v_mul_f32 v82, v82, v31
    v_mfma_f32_16x16x32_bf16 a[172:175], v[68:71], v[236:239], a[172:175]
    ds_read_b64_tr_b16 v[62:63], v26 offset:19232
    s_waitcnt lgkmcnt(8)
    v_mfma_f32_16x16x32_bf16 a[176:179], v[72:75], v[232:235], a[176:179]
    ds_read_b64_tr_b16 v[64:65], v25 offset:12352
    v_mul_f32 v83, v83, v31
    v_mfma_f32_16x16x32_bf16 a[180:183], v[72:75], v[236:239], a[180:183]
    ds_read_b64_tr_b16 v[66:67], v25 offset:13120
    v_mul_f32 v80, v80, v84
    v_mfma_f32_16x16x32_bf16 a[184:187], v[76:79], v[232:235], a[184:187]
    ds_read_b64_tr_b16 v[68:69], v25 offset:18496
    v_mul_f32 v81, v81, v85
    v_mfma_f32_16x16x32_bf16 a[188:191], v[76:79], v[236:239], a[188:191]
    ds_read_b64_tr_b16 v[70:71], v25 offset:19264
    s_waitcnt lgkmcnt(8)
    v_mfma_f32_16x16x32_bf16 a[96:99], v[48:51], v[240:243], a[96:99]
    ds_read_b64_tr_b16 v[72:73], v26 offset:12384
    v_mul_f32 v82, v82, v86
    v_mfma_f32_16x16x32_bf16 a[100:103], v[48:51], v[244:247], a[100:103]
    ds_read_b64_tr_b16 v[74:75], v26 offset:13152
    v_mul_f32 v83, v83, v87
    v_mfma_f32_16x16x32_bf16 a[104:107], v[52:55], v[240:243], a[104:107]
    ds_read_b64_tr_b16 v[76:77], v26 offset:18528
    v_cvt_pk_bf16_f32 v100, v80, v81
    v_mfma_f32_16x16x32_bf16 a[108:111], v[52:55], v[244:247], a[108:111]
    ds_read_b64_tr_b16 v[78:79], v26 offset:19296
    s_waitcnt lgkmcnt(8)
    v_mfma_f32_16x16x32_bf16 a[112:115], v[56:59], v[240:243], a[112:115]
    ds_read_b64_tr_b16 v[48:49], v25 offset:12416
    v_cvt_pk_bf16_f32 v101, v82, v83
    v_mfma_f32_16x16x32_bf16 a[116:119], v[56:59], v[244:247], a[116:119]
    ds_read_b64_tr_b16 v[50:51], v25 offset:13184
    v_accvgpr_read_b32 v80, a84
    v_mfma_f32_16x16x32_bf16 a[120:123], v[60:63], v[240:243], a[120:123]
    ds_read_b64_tr_b16 v[52:53], v25 offset:18560
    v_accvgpr_read_b32 v81, a85
    v_mfma_f32_16x16x32_bf16 a[124:127], v[60:63], v[244:247], a[124:127]
    ds_read_b64_tr_b16 v[54:55], v25 offset:19328
    s_waitcnt lgkmcnt(8)
    v_mfma_f32_16x16x32_bf16 a[128:131], v[64:67], v[240:243], a[128:131]
    ds_read_b64_tr_b16 v[56:57], v26 offset:12448
    s_waitcnt vmcnt(7)
    v_mfma_f32_16x16x32_bf16 a[132:135], v[64:67], v[244:247], a[132:135]
    ds_read_b64_tr_b16 v[58:59], v26 offset:13216
    v_accvgpr_read_b32 v82, a86
    v_mfma_f32_16x16x32_bf16 a[136:139], v[68:71], v[240:243], a[136:139]
    ds_read_b64_tr_b16 v[60:61], v26 offset:18592
    s_barrier
    v_mfma_f32_16x16x32_bf16 a[140:143], v[68:71], v[244:247], a[140:143]
    ds_read_b64_tr_b16 v[62:63], v26 offset:19360
    s_waitcnt lgkmcnt(8)
    v_mfma_f32_16x16x32_bf16 a[144:147], v[72:75], v[240:243], a[144:147]
    ds_read_b64_tr_b16 v[64:65], v23 offset:0
    s_add_u32 m0, s38, 49152
    v_mfma_f32_16x16x32_bf16 a[148:151], v[72:75], v[244:247], a[148:151]
    ds_read_b64_tr_b16 v[66:67], v23 offset:768
    buffer_load_dwordx4 v20, s[8:11], s23 offen offset:0  lds
    v_mfma_f32_16x16x32_bf16 a[152:155], v[76:79], v[240:243], a[152:155]
    ds_read_b64_tr_b16 v[68:69], v23 offset:6144
    v_accvgpr_read_b32 v83, a87
    v_mfma_f32_16x16x32_bf16 a[156:159], v[76:79], v[244:247], a[156:159]
    ds_read_b64_tr_b16 v[70:71], v23 offset:6912
    s_waitcnt lgkmcnt(8)
    v_mfma_f32_16x16x32_bf16 a[160:163], v[48:51], v[240:243], a[160:163]
    ds_read_b64_tr_b16 v[72:73], v24 offset:32
    buffer_load_dwordx4 v21, s[8:11], s23 offen offset:1024  lds
    v_mfma_f32_16x16x32_bf16 a[164:167], v[48:51], v[244:247], a[164:167]
    ds_read_b64_tr_b16 v[74:75], v24 offset:800
    v_accvgpr_read_b32 v84, a92
    v_mfma_f32_16x16x32_bf16 a[168:171], v[52:55], v[240:243], a[168:171]
    ds_read_b64_tr_b16 v[76:77], v24 offset:6176
    v_accvgpr_read_b32 v85, a93
    v_mfma_f32_16x16x32_bf16 a[172:175], v[52:55], v[244:247], a[172:175]
    ds_read_b64_tr_b16 v[78:79], v24 offset:6944
    s_waitcnt lgkmcnt(8)
    v_mfma_f32_16x16x32_bf16 a[176:179], v[56:59], v[240:243], a[176:179]
    ds_read_b64_tr_b16 v[48:49], v23 offset:64
    buffer_load_dwordx4 v22, s[8:11], s23 offen offset:2048  lds
    v_mfma_f32_16x16x32_bf16 a[180:183], v[56:59], v[244:247], a[180:183]
    ds_read_b64_tr_b16 v[50:51], v23 offset:832
    v_accvgpr_read_b32 v86, a94
    v_mfma_f32_16x16x32_bf16 a[184:187], v[60:63], v[240:243], a[184:187]
    ds_read_b64_tr_b16 v[52:53], v23 offset:6208
    v_accvgpr_read_b32 v87, a95
    v_mfma_f32_16x16x32_bf16 a[188:191], v[60:63], v[244:247], a[188:191]
    ds_read_b64_tr_b16 v[54:55], v23 offset:6976
    s_waitcnt lgkmcnt(8)
    v_mfma_f32_16x16x32_bf16 a[96:99], v[64:67], v[248:251], a[96:99]
    ds_read_b64_tr_b16 v[56:57], v24 offset:96
    s_add_u32 m0, s38, 61440
    v_mfma_f32_16x16x32_bf16 a[100:103], v[64:67], v[252:255], a[100:103]
    ds_read_b64_tr_b16 v[58:59], v24 offset:864
    buffer_load_dwordx4 v20, s[8:11], s24 offen offset:0  lds
    v_mfma_f32_16x16x32_bf16 a[104:107], v[68:71], v[248:251], a[104:107]
    ds_read_b64_tr_b16 v[60:61], v24 offset:6240
    v_mul_f32 v80, v80, v31
    v_mfma_f32_16x16x32_bf16 a[108:111], v[68:71], v[252:255], a[108:111]
    ds_read_b64_tr_b16 v[62:63], v24 offset:7008
    s_waitcnt lgkmcnt(8)
    v_mfma_f32_16x16x32_bf16 a[112:115], v[72:75], v[248:251], a[112:115]
    ds_read_b64_tr_b16 v[64:65], v23 offset:128
    buffer_load_dwordx4 v21, s[8:11], s24 offen offset:1024  lds
    v_mfma_f32_16x16x32_bf16 a[116:119], v[72:75], v[252:255], a[116:119]
    ds_read_b64_tr_b16 v[66:67], v23 offset:896
    v_mul_f32 v81, v81, v31
    v_mfma_f32_16x16x32_bf16 a[120:123], v[76:79], v[248:251], a[120:123]
    ds_read_b64_tr_b16 v[68:69], v23 offset:6272
    v_mul_f32 v82, v82, v31
    v_mfma_f32_16x16x32_bf16 a[124:127], v[76:79], v[252:255], a[124:127]
    ds_read_b64_tr_b16 v[70:71], v23 offset:7040
    s_waitcnt lgkmcnt(8)
    v_mfma_f32_16x16x32_bf16 a[128:131], v[48:51], v[248:251], a[128:131]
    ds_read_b64_tr_b16 v[72:73], v24 offset:160
    buffer_load_dwordx4 v22, s[8:11], s24 offen offset:2048  lds
    v_mfma_f32_16x16x32_bf16 a[132:135], v[48:51], v[252:255], a[132:135]
    ds_read_b64_tr_b16 v[74:75], v24 offset:928
    v_mul_f32 v83, v83, v31
    v_mfma_f32_16x16x32_bf16 a[136:139], v[52:55], v[248:251], a[136:139]
    ds_read_b64_tr_b16 v[76:77], v24 offset:6304
    v_mul_f32 v80, v80, v84
    v_mfma_f32_16x16x32_bf16 a[140:143], v[52:55], v[252:255], a[140:143]
    ds_read_b64_tr_b16 v[78:79], v24 offset:7072
    s_waitcnt lgkmcnt(8)
    v_mfma_f32_16x16x32_bf16 a[144:147], v[56:59], v[248:251], a[144:147]
    ds_read_b64_tr_b16 v[48:49], v23 offset:12288
    v_mul_f32 v81, v81, v85
    v_mfma_f32_16x16x32_bf16 a[148:151], v[56:59], v[252:255], a[148:151]
    ds_read_b64_tr_b16 v[50:51], v23 offset:13056
    v_mul_f32 v82, v82, v86
    v_mfma_f32_16x16x32_bf16 a[152:155], v[60:63], v[248:251], a[152:155]
    ds_read_b64_tr_b16 v[52:53], v23 offset:18432
    v_mul_f32 v83, v83, v87
    v_mfma_f32_16x16x32_bf16 a[156:159], v[60:63], v[252:255], a[156:159]
    ds_read_b64_tr_b16 v[54:55], v23 offset:19200
    s_waitcnt lgkmcnt(8)
    v_mfma_f32_16x16x32_bf16 a[160:163], v[64:67], v[248:251], a[160:163]
    ds_read_b64_tr_b16 v[56:57], v24 offset:12320
    v_cvt_pk_bf16_f32 v102, v80, v81
    v_mfma_f32_16x16x32_bf16 a[164:167], v[64:67], v[252:255], a[164:167]
    ds_read_b64_tr_b16 v[58:59], v24 offset:13088
    v_cvt_pk_bf16_f32 v103, v82, v83
    v_mfma_f32_16x16x32_bf16 a[168:171], v[68:71], v[248:251], a[168:171]
    ds_read_b64_tr_b16 v[60:61], v24 offset:18464
    buffer_store_dwordx4 v[100:103], v29, s[12:15], s61 offen offset:1024 sc1
    v_mfma_f32_16x16x32_bf16 a[172:175], v[68:71], v[252:255], a[172:175]
    ds_read_b64_tr_b16 v[62:63], v24 offset:19232
    s_waitcnt lgkmcnt(8)
    v_mfma_f32_16x16x32_bf16 a[176:179], v[72:75], v[248:251], a[176:179]
    ds_read_b64_tr_b16 v[64:65], v23 offset:12352
    v_mfma_f32_16x16x32_bf16 a[180:183], v[72:75], v[252:255], a[180:183]
    ds_read_b64_tr_b16 v[66:67], v23 offset:13120
    v_mfma_f32_16x16x32_bf16 a[184:187], v[76:79], v[248:251], a[184:187]
    ds_read_b64_tr_b16 v[68:69], v23 offset:18496
    v_mfma_f32_16x16x32_bf16 a[188:191], v[76:79], v[252:255], a[188:191]
    ds_read_b64_tr_b16 v[70:71], v23 offset:19264
    s_waitcnt lgkmcnt(8)
    v_mfma_f32_16x16x32_bf16 a[0:3], v[48:51], v[112:115], 0
    ds_read_b64_tr_b16 v[72:73], v24 offset:12384
    v_mfma_f32_16x16x32_bf16 a[4:7], v[48:51], v[116:119], 0
    ds_read_b64_tr_b16 v[74:75], v24 offset:13152
    v_mfma_f32_16x16x32_bf16 a[8:11], v[52:55], v[112:115], 0
    ds_read_b64_tr_b16 v[76:77], v24 offset:18528
    v_mfma_f32_16x16x32_bf16 a[12:15], v[52:55], v[116:119], 0
    ds_read_b64_tr_b16 v[78:79], v24 offset:19296
    s_waitcnt lgkmcnt(8)
    v_mfma_f32_16x16x32_bf16 a[16:19], v[56:59], v[112:115], 0
    ds_read_b64_tr_b16 v[48:49], v23 offset:12416
    v_accvgpr_read_b32 v80, a96
    v_mfma_f32_16x16x32_bf16 a[20:23], v[56:59], v[116:119], 0
    ds_read_b64_tr_b16 v[50:51], v23 offset:13184
    v_accvgpr_read_b32 v81, a97
    v_mfma_f32_16x16x32_bf16 a[24:27], v[60:63], v[112:115], 0
    ds_read_b64_tr_b16 v[52:53], v23 offset:18560
    v_accvgpr_read_b32 v82, a98
    v_mfma_f32_16x16x32_bf16 a[28:31], v[60:63], v[116:119], 0
    ds_read_b64_tr_b16 v[54:55], v23 offset:19328
    s_waitcnt lgkmcnt(8)
    v_mfma_f32_16x16x32_bf16 a[32:35], v[64:67], v[112:115], 0
    ds_read_b64_tr_b16 v[56:57], v24 offset:12448
    s_waitcnt vmcnt(8)
    v_mfma_f32_16x16x32_bf16 a[36:39], v[64:67], v[116:119], 0
    ds_read_b64_tr_b16 v[58:59], v24 offset:13216
    v_accvgpr_read_b32 v83, a99
    v_mfma_f32_16x16x32_bf16 a[40:43], v[68:71], v[112:115], 0
    ds_read_b64_tr_b16 v[60:61], v24 offset:18592
    s_barrier
    v_mfma_f32_16x16x32_bf16 a[44:47], v[68:71], v[116:119], 0
    ds_read_b64_tr_b16 v[62:63], v24 offset:19360
    s_waitcnt lgkmcnt(8)
    v_mfma_f32_16x16x32_bf16 a[48:51], v[72:75], v[112:115], 0
    ds_read_b64_tr_b16 v[64:65], v23 offset:24576
    s_add_u32 m0, s38, 73728
    v_mfma_f32_16x16x32_bf16 a[52:55], v[72:75], v[116:119], 0
    ds_read_b64_tr_b16 v[66:67], v23 offset:25344
    buffer_load_dwordx4 v20, s[8:11], s25 offen offset:0  lds
    v_mfma_f32_16x16x32_bf16 a[56:59], v[76:79], v[112:115], 0
    ds_read_b64_tr_b16 v[68:69], v23 offset:30720
    v_accvgpr_read_b32 v84, a104
    v_mfma_f32_16x16x32_bf16 a[60:63], v[76:79], v[116:119], 0
    ds_read_b64_tr_b16 v[70:71], v23 offset:31488
    s_waitcnt lgkmcnt(8)
    v_mfma_f32_16x16x32_bf16 a[64:67], v[48:51], v[112:115], 0
    ds_read_b64_tr_b16 v[72:73], v24 offset:24608
    buffer_load_dwordx4 v21, s[8:11], s25 offen offset:1024  lds
    v_mfma_f32_16x16x32_bf16 a[68:71], v[48:51], v[116:119], 0
    ds_read_b64_tr_b16 v[74:75], v24 offset:25376
    v_accvgpr_read_b32 v85, a105
    v_mfma_f32_16x16x32_bf16 a[72:75], v[52:55], v[112:115], 0
    ds_read_b64_tr_b16 v[76:77], v24 offset:30752
    v_accvgpr_read_b32 v86, a106
    v_mfma_f32_16x16x32_bf16 a[76:79], v[52:55], v[116:119], 0
    ds_read_b64_tr_b16 v[78:79], v24 offset:31520
    s_waitcnt lgkmcnt(8)
    v_mfma_f32_16x16x32_bf16 a[80:83], v[56:59], v[112:115], 0
    ds_read_b64_tr_b16 v[48:49], v23 offset:24640
    buffer_load_dwordx4 v22, s[8:11], s25 offen offset:2048  lds
    v_mfma_f32_16x16x32_bf16 a[84:87], v[56:59], v[116:119], 0
    ds_read_b64_tr_b16 v[50:51], v23 offset:25408
    v_accvgpr_read_b32 v87, a107
    v_mfma_f32_16x16x32_bf16 a[88:91], v[60:63], v[112:115], 0
    ds_read_b64_tr_b16 v[52:53], v23 offset:30784
    v_mul_f32 v80, v80, v30
    v_mfma_f32_16x16x32_bf16 a[92:95], v[60:63], v[116:119], 0
    ds_read_b64_tr_b16 v[54:55], v23 offset:31552
    s_waitcnt lgkmcnt(8)
    v_mfma_f32_16x16x32_bf16 a[0:3], v[64:67], v[120:123], a[0:3]
    ds_read_b64_tr_b16 v[56:57], v24 offset:24672
    s_add_u32 m0, s38, 0
    v_mfma_f32_16x16x32_bf16 a[4:7], v[64:67], v[124:127], a[4:7]
    ds_read_b64_tr_b16 v[58:59], v24 offset:25440
    buffer_load_dwordx4 v20, s[8:11], s26 offen offset:0  lds
    v_mfma_f32_16x16x32_bf16 a[8:11], v[68:71], v[120:123], a[8:11]
    ds_read_b64_tr_b16 v[60:61], v24 offset:30816
    v_mul_f32 v81, v81, v30
    v_mfma_f32_16x16x32_bf16 a[12:15], v[68:71], v[124:127], a[12:15]
    ds_read_b64_tr_b16 v[62:63], v24 offset:31584
    s_waitcnt lgkmcnt(8)
    v_mfma_f32_16x16x32_bf16 a[16:19], v[72:75], v[120:123], a[16:19]
    ds_read_b64_tr_b16 v[64:65], v23 offset:24704
    buffer_load_dwordx4 v21, s[8:11], s26 offen offset:1024  lds
    v_mfma_f32_16x16x32_bf16 a[20:23], v[72:75], v[124:127], a[20:23]
    ds_read_b64_tr_b16 v[66:67], v23 offset:25472
    v_mul_f32 v82, v82, v30
    v_mfma_f32_16x16x32_bf16 a[24:27], v[76:79], v[120:123], a[24:27]
    ds_read_b64_tr_b16 v[68:69], v23 offset:30848
    v_mul_f32 v83, v83, v30
    v_mfma_f32_16x16x32_bf16 a[28:31], v[76:79], v[124:127], a[28:31]
    ds_read_b64_tr_b16 v[70:71], v23 offset:31616
    s_waitcnt lgkmcnt(8)
    v_mfma_f32_16x16x32_bf16 a[32:35], v[48:51], v[120:123], a[32:35]
    ds_read_b64_tr_b16 v[72:73], v24 offset:24736
    buffer_load_dwordx4 v22, s[8:11], s26 offen offset:2048  lds
    v_mfma_f32_16x16x32_bf16 a[36:39], v[48:51], v[124:127], a[36:39]
    ds_read_b64_tr_b16 v[74:75], v24 offset:25504
    v_mul_f32 v80, v80, v84
    v_mfma_f32_16x16x32_bf16 a[40:43], v[52:55], v[120:123], a[40:43]
    ds_read_b64_tr_b16 v[76:77], v24 offset:30880
    v_mul_f32 v81, v81, v85
    v_mfma_f32_16x16x32_bf16 a[44:47], v[52:55], v[124:127], a[44:47]
    ds_read_b64_tr_b16 v[78:79], v24 offset:31648
    s_waitcnt lgkmcnt(8)
    v_mfma_f32_16x16x32_bf16 a[48:51], v[56:59], v[120:123], a[48:51]
    ds_read_b64_tr_b16 v[48:49], v23 offset:36864
    v_mul_f32 v82, v82, v86
    v_mfma_f32_16x16x32_bf16 a[52:55], v[56:59], v[124:127], a[52:55]
    ds_read_b64_tr_b16 v[50:51], v23 offset:37632
    v_mul_f32 v83, v83, v87
    v_mfma_f32_16x16x32_bf16 a[56:59], v[60:63], v[120:123], a[56:59]
    ds_read_b64_tr_b16 v[52:53], v23 offset:43008
    v_cvt_pk_bf16_f32 v96, v80, v81
    v_mfma_f32_16x16x32_bf16 a[60:63], v[60:63], v[124:127], a[60:63]
    ds_read_b64_tr_b16 v[54:55], v23 offset:43776
    s_waitcnt lgkmcnt(8)
    v_mfma_f32_16x16x32_bf16 a[64:67], v[64:67], v[120:123], a[64:67]
    ds_read_b64_tr_b16 v[56:57], v24 offset:36896
    v_cvt_pk_bf16_f32 v97, v82, v83
    v_mfma_f32_16x16x32_bf16 a[68:71], v[64:67], v[124:127], a[68:71]
    ds_read_b64_tr_b16 v[58:59], v24 offset:37664
    v_accvgpr_read_b32 v80, a112
    v_mfma_f32_16x16x32_bf16 a[72:75], v[68:71], v[120:123], a[72:75]
    ds_read_b64_tr_b16 v[60:61], v24 offset:43040
    v_accvgpr_read_b32 v81, a113
    v_mfma_f32_16x16x32_bf16 a[76:79], v[68:71], v[124:127], a[76:79]
    ds_read_b64_tr_b16 v[62:63], v24 offset:43808
    s_waitcnt lgkmcnt(8)
    v_mfma_f32_16x16x32_bf16 a[80:83], v[72:75], v[120:123], a[80:83]
    ds_read_b64_tr_b16 v[64:65], v23 offset:36928
    v_accvgpr_read_b32 v82, a114
    v_mfma_f32_16x16x32_bf16 a[84:87], v[72:75], v[124:127], a[84:87]
    ds_read_b64_tr_b16 v[66:67], v23 offset:37696
    v_accvgpr_read_b32 v83, a115
    v_mfma_f32_16x16x32_bf16 a[88:91], v[76:79], v[120:123], a[88:91]
    ds_read_b64_tr_b16 v[68:69], v23 offset:43072
    v_accvgpr_read_b32 v84, a120
    v_mfma_f32_16x16x32_bf16 a[92:95], v[76:79], v[124:127], a[92:95]
    ds_read_b64_tr_b16 v[70:71], v23 offset:43840
    s_waitcnt lgkmcnt(8)
    v_mfma_f32_16x16x32_bf16 a[0:3], v[48:51], v[128:131], a[0:3]
    ds_read_b64_tr_b16 v[72:73], v24 offset:36960
    v_accvgpr_read_b32 v85, a121
    v_mfma_f32_16x16x32_bf16 a[4:7], v[48:51], v[132:135], a[4:7]
    ds_read_b64_tr_b16 v[74:75], v24 offset:37728
    v_accvgpr_read_b32 v86, a122
    v_mfma_f32_16x16x32_bf16 a[8:11], v[52:55], v[128:131], a[8:11]
    ds_read_b64_tr_b16 v[76:77], v24 offset:43104
    v_accvgpr_read_b32 v87, a123
    v_mfma_f32_16x16x32_bf16 a[12:15], v[52:55], v[132:135], a[12:15]
    ds_read_b64_tr_b16 v[78:79], v24 offset:43872
    s_waitcnt lgkmcnt(8)
    v_mfma_f32_16x16x32_bf16 a[16:19], v[56:59], v[128:131], a[16:19]
    ds_read_b64_tr_b16 v[48:49], v23 offset:36992
    v_mul_f32 v80, v80, v30
    v_mfma_f32_16x16x32_bf16 a[20:23], v[56:59], v[132:135], a[20:23]
    ds_read_b64_tr_b16 v[50:51], v23 offset:37760
    v_mul_f32 v81, v81, v30
    v_mfma_f32_16x16x32_bf16 a[24:27], v[60:63], v[128:131], a[24:27]
    ds_read_b64_tr_b16 v[52:53], v23 offset:43136
    v_mul_f32 v82, v82, v30
    v_mfma_f32_16x16x32_bf16 a[28:31], v[60:63], v[132:135], a[28:31]
    ds_read_b64_tr_b16 v[54:55], v23 offset:43904
    s_waitcnt lgkmcnt(8)
    v_mfma_f32_16x16x32_bf16 a[32:35], v[64:67], v[128:131], a[32:35]
    ds_read_b64_tr_b16 v[56:57], v24 offset:37024
    s_waitcnt vmcnt(7)
    v_mfma_f32_16x16x32_bf16 a[36:39], v[64:67], v[132:135], a[36:39]
    ds_read_b64_tr_b16 v[58:59], v24 offset:37792
    v_mul_f32 v83, v83, v30
    v_mfma_f32_16x16x32_bf16 a[40:43], v[68:71], v[128:131], a[40:43]
    ds_read_b64_tr_b16 v[60:61], v24 offset:43168
    s_barrier
    v_mfma_f32_16x16x32_bf16 a[44:47], v[68:71], v[132:135], a[44:47]
    ds_read_b64_tr_b16 v[62:63], v24 offset:43936
    s_waitcnt lgkmcnt(8)
    v_mfma_f32_16x16x32_bf16 a[48:51], v[72:75], v[128:131], a[48:51]
    ds_read_b64_tr_b16 v[64:65], v23 offset:49152
    s_add_u32 m0, s38, 12288
    v_mfma_f32_16x16x32_bf16 a[52:55], v[72:75], v[132:135], a[52:55]
    ds_read_b64_tr_b16 v[66:67], v23 offset:49920
    buffer_load_dwordx4 v20, s[8:11], s27 offen offset:0  lds
    v_mfma_f32_16x16x32_bf16 a[56:59], v[76:79], v[128:131], a[56:59]
    ds_read_b64_tr_b16 v[68:69], v23 offset:55296
    v_mul_f32 v80, v80, v84
    v_mfma_f32_16x16x32_bf16 a[60:63], v[76:79], v[132:135], a[60:63]
    ds_read_b64_tr_b16 v[70:71], v23 offset:56064
    s_waitcnt lgkmcnt(8)
    v_mfma_f32_16x16x32_bf16 a[64:67], v[48:51], v[128:131], a[64:67]
    ds_read_b64_tr_b16 v[72:73], v24 offset:49184
    buffer_load_dwordx4 v21, s[8:11], s27 offen offset:1024  lds
    v_mfma_f32_16x16x32_bf16 a[68:71], v[48:51], v[132:135], a[68:71]
    ds_read_b64_tr_b16 v[74:75], v24 offset:49952
    v_mul_f32 v81, v81, v85
    v_mfma_f32_16x16x32_bf16 a[72:75], v[52:55], v[128:131], a[72:75]
    ds_read_b64_tr_b16 v[76:77], v24 offset:55328
    v_mul_f32 v82, v82, v86
    v_mfma_f32_16x16x32_bf16 a[76:79], v[52:55], v[132:135], a[76:79]
    ds_read_b64_tr_b16 v[78:79], v24 offset:56096
    s_waitcnt lgkmcnt(8)
    v_mfma_f32_16x16x32_bf16 a[80:83], v[56:59], v[128:131], a[80:83]
    ds_read_b64_tr_b16 v[48:49], v23 offset:49216
    buffer_load_dwordx4 v22, s[8:11], s27 offen offset:2048  lds
    v_mfma_f32_16x16x32_bf16 a[84:87], v[56:59], v[132:135], a[84:87]
    ds_read_b64_tr_b16 v[50:51], v23 offset:49984
    v_mul_f32 v83, v83, v87
    v_mfma_f32_16x16x32_bf16 a[88:91], v[60:63], v[128:131], a[88:91]
    ds_read_b64_tr_b16 v[52:53], v23 offset:55360
    v_cvt_pk_bf16_f32 v98, v80, v81
    v_mfma_f32_16x16x32_bf16 a[92:95], v[60:63], v[132:135], a[92:95]
    ds_read_b64_tr_b16 v[54:55], v23 offset:56128
    s_waitcnt lgkmcnt(8)
    v_mfma_f32_16x16x32_bf16 a[0:3], v[64:67], v[136:139], a[0:3]
    ds_read_b64_tr_b16 v[56:57], v24 offset:49248
    s_add_u32 m0, s38, 24576
    v_mfma_f32_16x16x32_bf16 a[4:7], v[64:67], v[140:143], a[4:7]
    ds_read_b64_tr_b16 v[58:59], v24 offset:50016
    buffer_load_dwordx4 v20, s[8:11], s28 offen offset:0  lds
    v_mfma_f32_16x16x32_bf16 a[8:11], v[68:71], v[136:139], a[8:11]
    ds_read_b64_tr_b16 v[60:61], v24 offset:55392
    v_cvt_pk_bf16_f32 v99, v82, v83
    v_mfma_f32_16x16x32_bf16 a[12:15], v[68:71], v[140:143], a[12:15]
    ds_read_b64_tr_b16 v[62:63], v24 offset:56160
    s_waitcnt lgkmcnt(8)
    v_mfma_f32_16x16x32_bf16 a[16:19], v[72:75], v[136:139], a[16:19]
    ds_read_b64_tr_b16 v[64:65], v23 offset:49280
    buffer_load_dwordx4 v21, s[8:11], s28 offen offset:1024  lds
    v_mfma_f32_16x16x32_bf16 a[20:23], v[72:75], v[140:143], a[20:23]
    ds_read_b64_tr_b16 v[66:67], v23 offset:50048
    s_add_u32 s63, s43, 24576
    v_mfma_f32_16x16x32_bf16 a[24:27], v[76:79], v[136:139], a[24:27]
    ds_read_b64_tr_b16 v[68:69], v23 offset:55424
    v_accvgpr_read_b32 v80, a100
    v_mfma_f32_16x16x32_bf16 a[28:31], v[76:79], v[140:143], a[28:31]
    ds_read_b64_tr_b16 v[70:71], v23 offset:56192
    s_waitcnt lgkmcnt(8)
    v_mfma_f32_16x16x32_bf16 a[32:35], v[48:51], v[136:139], a[32:35]
    ds_read_b64_tr_b16 v[72:73], v24 offset:49312
    buffer_load_dwordx4 v22, s[8:11], s28 offen offset:2048  lds
    v_mfma_f32_16x16x32_bf16 a[36:39], v[48:51], v[140:143], a[36:39]
    ds_read_b64_tr_b16 v[74:75], v24 offset:50080
    v_accvgpr_read_b32 v81, a101
    v_mfma_f32_16x16x32_bf16 a[40:43], v[52:55], v[136:139], a[40:43]
    ds_read_b64_tr_b16 v[76:77], v24 offset:55456
    buffer_store_dwordx4 v[96:99], v29, s[12:15], s63 offen offset:0 sc1
    v_mfma_f32_16x16x32_bf16 a[44:47], v[52:55], v[140:143], a[44:47]
    ds_read_b64_tr_b16 v[78:79], v24 offset:56224
    s_waitcnt lgkmcnt(8)
    v_mfma_f32_16x16x32_bf16 a[48:51], v[56:59], v[136:139], a[48:51]
    ds_read_b64_tr_b16 v[48:49], v25 offset:0
    v_accvgpr_read_b32 v82, a102
    v_mfma_f32_16x16x32_bf16 a[52:55], v[56:59], v[140:143], a[52:55]
    ds_read_b64_tr_b16 v[50:51], v25 offset:768
    v_accvgpr_read_b32 v83, a103
    v_mfma_f32_16x16x32_bf16 a[56:59], v[60:63], v[136:139], a[56:59]
    ds_read_b64_tr_b16 v[52:53], v25 offset:6144
    v_accvgpr_read_b32 v84, a108
    v_mfma_f32_16x16x32_bf16 a[60:63], v[60:63], v[140:143], a[60:63]
    ds_read_b64_tr_b16 v[54:55], v25 offset:6912
    s_waitcnt lgkmcnt(8)
    v_mfma_f32_16x16x32_bf16 a[64:67], v[64:67], v[136:139], a[64:67]
    ds_read_b64_tr_b16 v[56:57], v26 offset:32
    v_accvgpr_read_b32 v85, a109
    v_mfma_f32_16x16x32_bf16 a[68:71], v[64:67], v[140:143], a[68:71]
    ds_read_b64_tr_b16 v[58:59], v26 offset:800
    v_accvgpr_read_b32 v86, a110
    v_mfma_f32_16x16x32_bf16 a[72:75], v[68:71], v[136:139], a[72:75]
    ds_read_b64_tr_b16 v[60:61], v26 offset:6176
    v_accvgpr_read_b32 v87, a111
    v_mfma_f32_16x16x32_bf16 a[76:79], v[68:71], v[140:143], a[76:79]
    ds_read_b64_tr_b16 v[62:63], v26 offset:6944
    s_waitcnt lgkmcnt(8)
    v_mfma_f32_16x16x32_bf16 a[80:83], v[72:75], v[136:139], a[80:83]
    ds_read_b64_tr_b16 v[64:65], v25 offset:64
    v_mul_f32 v80, v80, v31
    v_mfma_f32_16x16x32_bf16 a[84:87], v[72:75], v[140:143], a[84:87]
    ds_read_b64_tr_b16 v[66:67], v25 offset:832
    v_mul_f32 v81, v81, v31
    v_mfma_f32_16x16x32_bf16 a[88:91], v[76:79], v[136:139], a[88:91]
    ds_read_b64_tr_b16 v[68:69], v25 offset:6208
    v_mul_f32 v82, v82, v31
    v_mfma_f32_16x16x32_bf16 a[92:95], v[76:79], v[140:143], a[92:95]
    ds_read_b64_tr_b16 v[70:71], v25 offset:6976
    s_waitcnt lgkmcnt(8)
    v_mfma_f32_16x16x32_bf16 a[0:3], v[48:51], v[144:147], a[0:3]
    ds_read_b64_tr_b16 v[72:73], v26 offset:96
    v_mul_f32 v83, v83, v31
    v_mfma_f32_16x16x32_bf16 a[4:7], v[48:51], v[148:151], a[4:7]
    ds_read_b64_tr_b16 v[74:75], v26 offset:864
    v_mul_f32 v80, v80, v84
    v_mfma_f32_16x16x32_bf16 a[8:11], v[52:55], v[144:147], a[8:11]
    ds_read_b64_tr_b16 v[76:77], v26 offset:6240
    v_mul_f32 v81, v81, v85
    v_mfma_f32_16x16x32_bf16 a[12:15], v[52:55], v[148:151], a[12:15]
    ds_read_b64_tr_b16 v[78:79], v26 offset:7008
    s_waitcnt lgkmcnt(8)
    v_mfma_f32_16x16x32_bf16 a[16:19], v[56:59], v[144:147], a[16:19]
    ds_read_b64_tr_b16 v[48:49], v25 offset:128
    v_mul_f32 v82, v82, v86
    v_mfma_f32_16x16x32_bf16 a[20:23], v[56:59], v[148:151], a[20:23]
    ds_read_b64_tr_b16 v[50:51], v25 offset:896
    v_mul_f32 v83, v83, v87
    v_mfma_f32_16x16x32_bf16 a[24:27], v[60:63], v[144:147], a[24:27]
    ds_read_b64_tr_b16 v[52:53], v25 offset:6272
    v_cvt_pk_bf16_f32 v100, v80, v81
    v_mfma_f32_16x16x32_bf16 a[28:31], v[60:63], v[148:151], a[28:31]
    ds_read_b64_tr_b16 v[54:55], v25 offset:7040
    s_waitcnt lgkmcnt(8)
    v_mfma_f32_16x16x32_bf16 a[32:35], v[64:67], v[144:147], a[32:35]
    ds_read_b64_tr_b16 v[56:57], v26 offset:160
    s_waitcnt vmcnt(7)
    v_mfma_f32_16x16x32_bf16 a[36:39], v[64:67], v[148:151], a[36:39]
    ds_read_b64_tr_b16 v[58:59], v26 offset:928
    v_cvt_pk_bf16_f32 v101, v82, v83
    v_mfma_f32_16x16x32_bf16 a[40:43], v[68:71], v[144:147], a[40:43]
    ds_read_b64_tr_b16 v[60:61], v26 offset:6304
    s_barrier
    v_mfma_f32_16x16x32_bf16 a[44:47], v[68:71], v[148:151], a[44:47]
    ds_read_b64_tr_b16 v[62:63], v26 offset:7072
    s_waitcnt lgkmcnt(8)
    v_mfma_f32_16x16x32_bf16 a[48:51], v[72:75], v[144:147], a[48:51]
    ds_read_b64_tr_b16 v[64:65], v25 offset:12288
    s_add_u32 m0, s38, 36864
    v_mfma_f32_16x16x32_bf16 a[52:55], v[72:75], v[148:151], a[52:55]
    ds_read_b64_tr_b16 v[66:67], v25 offset:13056
    buffer_load_dwordx4 v20, s[8:11], s29 offen offset:0  lds
    s_lshl_b32 s93, s2, 7
    s_add_u32 s93, s93, 36831232
    s_cmp_eq_u32 s16, 0
    s_cbranch_scc0 L1_SIGF0
    v_mov_b32 v88, s93
    v_mov_b32 v89, s101
    s_mov_b64 exec, 1
    buffer_store_dword v89, v88, s[12:15], 0 offen sc1
    s_mov_b64 exec, -1
L1_SIGF0:
    v_mfma_f32_16x16x32_bf16 a[56:59], v[76:79], v[144:147], a[56:59]
    ds_read_b64_tr_b16 v[68:69], v25 offset:18432
    v_accvgpr_read_b32 v80, a116
    v_mfma_f32_16x16x32_bf16 a[60:63], v[76:79], v[148:151], a[60:63]
    ds_read_b64_tr_b16 v[70:71], v25 offset:19200
    s_waitcnt lgkmcnt(8)
    v_mfma_f32_16x16x32_bf16 a[64:67], v[48:51], v[144:147], a[64:67]
    ds_read_b64_tr_b16 v[72:73], v26 offset:12320
    buffer_load_dwordx4 v21, s[8:11], s29 offen offset:1024  lds
    v_mfma_f32_16x16x32_bf16 a[68:71], v[48:51], v[148:151], a[68:71]
    ds_read_b64_tr_b16 v[74:75], v26 offset:13088
    v_accvgpr_read_b32 v81, a117
    v_mfma_f32_16x16x32_bf16 a[72:75], v[52:55], v[144:147], a[72:75]
    ds_read_b64_tr_b16 v[76:77], v26 offset:18464
    v_accvgpr_read_b32 v82, a118
    v_mfma_f32_16x16x32_bf16 a[76:79], v[52:55], v[148:151], a[76:79]
    ds_read_b64_tr_b16 v[78:79], v26 offset:19232
    s_waitcnt lgkmcnt(8)
    v_mfma_f32_16x16x32_bf16 a[80:83], v[56:59], v[144:147], a[80:83]
    ds_read_b64_tr_b16 v[48:49], v25 offset:12352
    buffer_load_dwordx4 v22, s[8:11], s29 offen offset:2048  lds
    v_mfma_f32_16x16x32_bf16 a[84:87], v[56:59], v[148:151], a[84:87]
    ds_read_b64_tr_b16 v[50:51], v25 offset:13120
    v_accvgpr_read_b32 v83, a119
    v_mfma_f32_16x16x32_bf16 a[88:91], v[60:63], v[144:147], a[88:91]
    ds_read_b64_tr_b16 v[52:53], v25 offset:18496
    v_accvgpr_read_b32 v84, a124
    v_mfma_f32_16x16x32_bf16 a[92:95], v[60:63], v[148:151], a[92:95]
    ds_read_b64_tr_b16 v[54:55], v25 offset:19264
    s_waitcnt lgkmcnt(8)
    v_mfma_f32_16x16x32_bf16 a[0:3], v[64:67], v[152:155], a[0:3]
    ds_read_b64_tr_b16 v[56:57], v26 offset:12384
    s_add_u32 m0, s38, 49152
    v_mfma_f32_16x16x32_bf16 a[4:7], v[64:67], v[156:159], a[4:7]
    ds_read_b64_tr_b16 v[58:59], v26 offset:13152
    buffer_load_dwordx4 v20, s[8:11], s30 offen offset:0  lds
    v_mfma_f32_16x16x32_bf16 a[8:11], v[68:71], v[152:155], a[8:11]
    ds_read_b64_tr_b16 v[60:61], v26 offset:18528
    v_accvgpr_read_b32 v85, a125
    v_mfma_f32_16x16x32_bf16 a[12:15], v[68:71], v[156:159], a[12:15]
    ds_read_b64_tr_b16 v[62:63], v26 offset:19296
    s_waitcnt lgkmcnt(8)
    v_mfma_f32_16x16x32_bf16 a[16:19], v[72:75], v[152:155], a[16:19]
    ds_read_b64_tr_b16 v[64:65], v25 offset:12416
    buffer_load_dwordx4 v21, s[8:11], s30 offen offset:1024  lds
    v_mfma_f32_16x16x32_bf16 a[20:23], v[72:75], v[156:159], a[20:23]
    ds_read_b64_tr_b16 v[66:67], v25 offset:13184
    v_accvgpr_read_b32 v86, a126
    v_mfma_f32_16x16x32_bf16 a[24:27], v[76:79], v[152:155], a[24:27]
    ds_read_b64_tr_b16 v[68:69], v25 offset:18560
    v_accvgpr_read_b32 v87, a127
    v_mfma_f32_16x16x32_bf16 a[28:31], v[76:79], v[156:159], a[28:31]
    ds_read_b64_tr_b16 v[70:71], v25 offset:19328
    s_waitcnt lgkmcnt(8)
    v_mfma_f32_16x16x32_bf16 a[32:35], v[48:51], v[152:155], a[32:35]
    ds_read_b64_tr_b16 v[72:73], v26 offset:12448
    buffer_load_dwordx4 v22, s[8:11], s30 offen offset:2048  lds
    v_mfma_f32_16x16x32_bf16 a[36:39], v[48:51], v[156:159], a[36:39]
    ds_read_b64_tr_b16 v[74:75], v26 offset:13216
    v_mul_f32 v80, v80, v31
    v_mfma_f32_16x16x32_bf16 a[40:43], v[52:55], v[152:155], a[40:43]
    ds_read_b64_tr_b16 v[76:77], v26 offset:18592
    v_mul_f32 v81, v81, v31
    v_mfma_f32_16x16x32_bf16 a[44:47], v[52:55], v[156:159], a[44:47]
    ds_read_b64_tr_b16 v[78:79], v26 offset:19360
    s_waitcnt lgkmcnt(8)
    v_mfma_f32_16x16x32_bf16 a[48:51], v[56:59], v[152:155], a[48:51]
    ds_read_b64_tr_b16 v[48:49], v23 offset:0
    v_mul_f32 v82, v82, v31
    v_mfma_f32_16x16x32_bf16 a[52:55], v[56:59], v[156:159], a[52:55]
    ds_read_b64_tr_b16 v[50:51], v23 offset:768
    v_mul_f32 v83, v83, v31
    v_mfma_f32_16x16x32_bf16 a[56:59], v[60:63], v[152:155], a[56:59]
    ds_read_b64_tr_b16 v[52:53], v23 offset:6144
    v_mul_f32 v80, v80, v84
    v_mfma_f32_16x16x32_bf16 a[60:63], v[60:63], v[156:159], a[60:63]
    ds_read_b64_tr_b16 v[54:55], v23 offset:6912
    s_waitcnt lgkmcnt(8)
    v_mfma_f32_16x16x32_bf16 a[64:67], v[64:67], v[152:155], a[64:67]
    ds_read_b64_tr_b16 v[56:57], v24 offset:32
    v_mul_f32 v81, v81, v85
    v_mfma_f32_16x16x32_bf16 a[68:71], v[64:67], v[156:159], a[68:71]
    ds_read_b64_tr_b16 v[58:59], v24 offset:800
    v_mul_f32 v82, v82, v86
    v_mfma_f32_16x16x32_bf16 a[72:75], v[68:71], v[152:155], a[72:75]
    ds_read_b64_tr_b16 v[60:61], v24 offset:6176
    v_mul_f32 v83, v83, v87
    v_mfma_f32_16x16x32_bf16 a[76:79], v[68:71], v[156:159], a[76:79]
    ds_read_b64_tr_b16 v[62:63], v24 offset:6944
    s_waitcnt lgkmcnt(8)
    v_mfma_f32_16x16x32_bf16 a[80:83], v[72:75], v[152:155], a[80:83]
    ds_read_b64_tr_b16 v[64:65], v23 offset:64
    v_cvt_pk_bf16_f32 v102, v80, v81
    v_mfma_f32_16x16x32_bf16 a[84:87], v[72:75], v[156:159], a[84:87]
    ds_read_b64_tr_b16 v[66:67], v23 offset:832
    v_cvt_pk_bf16_f32 v103, v82, v83
    v_mfma_f32_16x16x32_bf16 a[88:91], v[76:79], v[152:155], a[88:91]
    ds_read_b64_tr_b16 v[68:69], v23 offset:6208
    buffer_store_dwordx4 v[100:103], v29, s[12:15], s63 offen offset:1024 sc1
    v_mfma_f32_16x16x32_bf16 a[92:95], v[76:79], v[156:159], a[92:95]
    ds_read_b64_tr_b16 v[70:71], v23 offset:6976
    s_waitcnt lgkmcnt(8)
    v_mfma_f32_16x16x32_bf16 a[0:3], v[48:51], v[160:163], a[0:3]
    ds_read_b64_tr_b16 v[72:73], v24 offset:96
    v_accvgpr_read_b32 v80, a128
    v_mfma_f32_16x16x32_bf16 a[4:7], v[48:51], v[164:167], a[4:7]
    ds_read_b64_tr_b16 v[74:75], v24 offset:864
    v_accvgpr_read_b32 v81, a129
    v_mfma_f32_16x16x32_bf16 a[8:11], v[52:55], v[160:163], a[8:11]
    ds_read_b64_tr_b16 v[76:77], v24 offset:6240
    v_accvgpr_read_b32 v82, a130
    v_mfma_f32_16x16x32_bf16 a[12:15], v[52:55], v[164:167], a[12:15]
    ds_read_b64_tr_b16 v[78:79], v24 offset:7008
    s_waitcnt lgkmcnt(8)
    v_mfma_f32_16x16x32_bf16 a[16:19], v[56:59], v[160:163], a[16:19]
    ds_read_b64_tr_b16 v[48:49], v23 offset:128
    v_accvgpr_read_b32 v83, a131
    v_mfma_f32_16x16x32_bf16 a[20:23], v[56:59], v[164:167], a[20:23]
    ds_read_b64_tr_b16 v[50:51], v23 offset:896
    v_accvgpr_read_b32 v84, a136
    v_mfma_f32_16x16x32_bf16 a[24:27], v[60:63], v[160:163], a[24:27]
    ds_read_b64_tr_b16 v[52:53], v23 offset:6272
    v_accvgpr_read_b32 v85, a137
    v_mfma_f32_16x16x32_bf16 a[28:31], v[60:63], v[164:167], a[28:31]
    ds_read_b64_tr_b16 v[54:55], v23 offset:7040
    s_waitcnt lgkmcnt(8)
    v_mfma_f32_16x16x32_bf16 a[32:35], v[64:67], v[160:163], a[32:35]
    ds_read_b64_tr_b16 v[56:57], v24 offset:160
    s_waitcnt vmcnt(8)
    v_mfma_f32_16x16x32_bf16 a[36:39], v[64:67], v[164:167], a[36:39]
    ds_read_b64_tr_b16 v[58:59], v24 offset:928
    v_accvgpr_read_b32 v86, a138
    v_mfma_f32_16x16x32_bf16 a[40:43], v[68:71], v[160:163], a[40:43]
    ds_read_b64_tr_b16 v[60:61], v24 offset:6304
    s_barrier
    v_mfma_f32_16x16x32_bf16 a[44:47], v[68:71], v[164:167], a[44:47]
    ds_read_b64_tr_b16 v[62:63], v24 offset:7072
    s_waitcnt lgkmcnt(8)
    v_mfma_f32_16x16x32_bf16 a[48:51], v[72:75], v[160:163], a[48:51]
    ds_read_b64_tr_b16 v[64:65], v23 offset:12288
    s_add_u32 m0, s38, 61440
    v_mfma_f32_16x16x32_bf16 a[52:55], v[72:75], v[164:167], a[52:55]
    ds_read_b64_tr_b16 v[66:67], v23 offset:13056
    buffer_load_dwordx4 v20, s[8:11], s31 offen offset:0  lds
    v_mfma_f32_16x16x32_bf16 a[56:59], v[76:79], v[160:163], a[56:59]
    ds_read_b64_tr_b16 v[68:69], v23 offset:18432
    v_accvgpr_read_b32 v87, a139
    v_mfma_f32_16x16x32_bf16 a[60:63], v[76:79], v[164:167], a[60:63]
    ds_read_b64_tr_b16 v[70:71], v23 offset:19200
    s_waitcnt lgkmcnt(8)
    v_mfma_f32_16x16x32_bf16 a[64:67], v[48:51], v[160:163], a[64:67]
    ds_read_b64_tr_b16 v[72:73], v24 offset:12320
    buffer_load_dwordx4 v21, s[8:11], s31 offen offset:1024  lds
    v_mfma_f32_16x16x32_bf16 a[68:71], v[48:51], v[164:167], a[68:71]
    ds_read_b64_tr_b16 v[74:75], v24 offset:13088
    v_mul_f32 v80, v80, v30
    v_mfma_f32_16x16x32_bf16 a[72:75], v[52:55], v[160:163], a[72:75]
    ds_read_b64_tr_b16 v[76:77], v24 offset:18464
    v_mul_f32 v81, v81, v30
    v_mfma_f32_16x16x32_bf16 a[76:79], v[52:55], v[164:167], a[76:79]
    ds_read_b64_tr_b16 v[78:79], v24 offset:19232
    s_waitcnt lgkmcnt(8)
    v_mfma_f32_16x16x32_bf16 a[80:83], v[56:59], v[160:163], a[80:83]
    ds_read_b64_tr_b16 v[48:49], v23 offset:12352
    buffer_load_dwordx4 v22, s[8:11], s31 offen offset:2048  lds
    v_mfma_f32_16x16x32_bf16 a[84:87], v[56:59], v[164:167], a[84:87]
    ds_read_b64_tr_b16 v[50:51], v23 offset:13120
    v_mul_f32 v82, v82, v30
    v_mfma_f32_16x16x32_bf16 a[88:91], v[60:63], v[160:163], a[88:91]
    ds_read_b64_tr_b16 v[52:53], v23 offset:18496
    v_mul_f32 v83, v83, v30
    v_mfma_f32_16x16x32_bf16 a[92:95], v[60:63], v[164:167], a[92:95]
    ds_read_b64_tr_b16 v[54:55], v23 offset:19264
    s_waitcnt lgkmcnt(8)
    v_mfma_f32_16x16x32_bf16 a[0:3], v[64:67], v[168:171], a[0:3]
    ds_read_b64_tr_b16 v[56:57], v24 offset:12384
    s_add_u32 m0, s38, 73728
    v_mfma_f32_16x16x32_bf16 a[4:7], v[64:67], v[172:175], a[4:7]
    ds_read_b64_tr_b16 v[58:59], v24 offset:13152
    buffer_load_dwordx4 v20, s[8:11], s32 offen offset:0  lds
    v_mfma_f32_16x16x32_bf16 a[8:11], v[68:71], v[168:171], a[8:11]
    ds_read_b64_tr_b16 v[60:61], v24 offset:18528
    v_mul_f32 v80, v80, v84
    v_mfma_f32_16x16x32_bf16 a[12:15], v[68:71], v[172:175], a[12:15]
    ds_read_b64_tr_b16 v[62:63], v24 offset:19296
    s_waitcnt lgkmcnt(8)
    v_mfma_f32_16x16x32_bf16 a[16:19], v[72:75], v[168:171], a[16:19]
    ds_read_b64_tr_b16 v[64:65], v23 offset:12416
    buffer_load_dwordx4 v21, s[8:11], s32 offen offset:1024  lds
    v_mfma_f32_16x16x32_bf16 a[20:23], v[72:75], v[172:175], a[20:23]
    ds_read_b64_tr_b16 v[66:67], v23 offset:13184
    v_mul_f32 v81, v81, v85
    v_mfma_f32_16x16x32_bf16 a[24:27], v[76:79], v[168:171], a[24:27]
    ds_read_b64_tr_b16 v[68:69], v23 offset:18560
    v_mul_f32 v82, v82, v86
    v_mfma_f32_16x16x32_bf16 a[28:31], v[76:79], v[172:175], a[28:31]
    ds_read_b64_tr_b16 v[70:71], v23 offset:19328
    s_waitcnt lgkmcnt(8)
    v_mfma_f32_16x16x32_bf16 a[32:35], v[48:51], v[168:171], a[32:35]
    ds_read_b64_tr_b16 v[72:73], v24 offset:12448
    buffer_load_dwordx4 v22, s[8:11], s32 offen offset:2048  lds
    v_mfma_f32_16x16x32_bf16 a[36:39], v[48:51], v[172:175], a[36:39]
    ds_read_b64_tr_b16 v[74:75], v24 offset:13216
    v_mul_f32 v83, v83, v87
    v_mfma_f32_16x16x32_bf16 a[40:43], v[52:55], v[168:171], a[40:43]
    ds_read_b64_tr_b16 v[76:77], v24 offset:18592
    v_cvt_pk_bf16_f32 v96, v80, v81
    v_mfma_f32_16x16x32_bf16 a[44:47], v[52:55], v[172:175], a[44:47]
    ds_read_b64_tr_b16 v[78:79], v24 offset:19360
    s_waitcnt lgkmcnt(8)
    v_mfma_f32_16x16x32_bf16 a[48:51], v[56:59], v[168:171], a[48:51]
    ds_read_b64_tr_b16 v[48:49], v23 offset:24576
    v_cvt_pk_bf16_f32 v97, v82, v83
    v_mfma_f32_16x16x32_bf16 a[52:55], v[56:59], v[172:175], a[52:55]
    ds_read_b64_tr_b16 v[50:51], v23 offset:25344
    v_accvgpr_read_b32 v80, a144
    v_mfma_f32_16x16x32_bf16 a[56:59], v[60:63], v[168:171], a[56:59]
    ds_read_b64_tr_b16 v[52:53], v23 offset:30720
    v_accvgpr_read_b32 v81, a145
    v_mfma_f32_16x16x32_bf16 a[60:63], v[60:63], v[172:175], a[60:63]
    ds_read_b64_tr_b16 v[54:55], v23 offset:31488
    s_waitcnt lgkmcnt(8)
    v_mfma_f32_16x16x32_bf16 a[64:67], v[64:67], v[168:171], a[64:67]
    ds_read_b64_tr_b16 v[56:57], v24 offset:24608
    v_accvgpr_read_b32 v82, a146
    v_mfma_f32_16x16x32_bf16 a[68:71], v[64:67], v[172:175], a[68:71]
    ds_read_b64_tr_b16 v[58:59], v24 offset:25376
    v_accvgpr_read_b32 v83, a147
    v_mfma_f32_16x16x32_bf16 a[72:75], v[68:71], v[168:171], a[72:75]
    ds_read_b64_tr_b16 v[60:61], v24 offset:30752
    v_accvgpr_read_b32 v84, a152
    v_mfma_f32_16x16x32_bf16 a[76:79], v[68:71], v[172:175], a[76:79]
    ds_read_b64_tr_b16 v[62:63], v24 offset:31520
    s_waitcnt lgkmcnt(8)
    v_mfma_f32_16x16x32_bf16 a[80:83], v[72:75], v[168:171], a[80:83]
    ds_read_b64_tr_b16 v[64:65], v23 offset:24640
    v_accvgpr_read_b32 v85, a153
    v_mfma_f32_16x16x32_bf16 a[84:87], v[72:75], v[172:175], a[84:87]
    ds_read_b64_tr_b16 v[66:67], v23 offset:25408
    v_accvgpr_read_b32 v86, a154
    v_mfma_f32_16x16x32_bf16 a[88:91], v[76:79], v[168:171], a[88:91]
    ds_read_b64_tr_b16 v[68:69], v23 offset:30784
    v_accvgpr_read_b32 v87, a155
    v_mfma_f32_16x16x32_bf16 a[92:95], v[76:79], v[172:175], a[92:95]
    ds_read_b64_tr_b16 v[70:71], v23 offset:31552
    s_waitcnt lgkmcnt(8)
    v_mfma_f32_16x16x32_bf16 a[0:3], v[48:51], v[176:179], a[0:3]
    ds_read_b64_tr_b16 v[72:73], v24 offset:24672
    v_mul_f32 v80, v80, v30
    v_mfma_f32_16x16x32_bf16 a[4:7], v[48:51], v[180:183], a[4:7]
    ds_read_b64_tr_b16 v[74:75], v24 offset:25440
    v_mul_f32 v81, v81, v30
    v_mfma_f32_16x16x32_bf16 a[8:11], v[52:55], v[176:179], a[8:11]
    ds_read_b64_tr_b16 v[76:77], v24 offset:30816
    v_mul_f32 v82, v82, v30
    v_mfma_f32_16x16x32_bf16 a[12:15], v[52:55], v[180:183], a[12:15]
    ds_read_b64_tr_b16 v[78:79], v24 offset:31584
    s_waitcnt lgkmcnt(8)
    v_mfma_f32_16x16x32_bf16 a[16:19], v[56:59], v[176:179], a[16:19]
    ds_read_b64_tr_b16 v[48:49], v23 offset:24704
    v_mul_f32 v83, v83, v30
    v_mfma_f32_16x16x32_bf16 a[20:23], v[56:59], v[180:183], a[20:23]
    ds_read_b64_tr_b16 v[50:51], v23 offset:25472
    v_mul_f32 v80, v80, v84
    v_mfma_f32_16x16x32_bf16 a[24:27], v[60:63], v[176:179], a[24:27]
    ds_read_b64_tr_b16 v[52:53], v23 offset:30848
    v_mul_f32 v81, v81, v85
    v_mfma_f32_16x16x32_bf16 a[28:31], v[60:63], v[180:183], a[28:31]
    ds_read_b64_tr_b16 v[54:55], v23 offset:31616
    s_waitcnt lgkmcnt(8)
    v_mfma_f32_16x16x32_bf16 a[32:35], v[64:67], v[176:179], a[32:35]
    ds_read_b64_tr_b16 v[56:57], v24 offset:24736
    s_waitcnt vmcnt(7)
    v_mfma_f32_16x16x32_bf16 a[36:39], v[64:67], v[180:183], a[36:39]
    ds_read_b64_tr_b16 v[58:59], v24 offset:25504
    v_mul_f32 v82, v82, v86
    v_mfma_f32_16x16x32_bf16 a[40:43], v[68:71], v[176:179], a[40:43]
    ds_read_b64_tr_b16 v[60:61], v24 offset:30880
    s_barrier
    v_mfma_f32_16x16x32_bf16 a[44:47], v[68:71], v[180:183], a[44:47]
    ds_read_b64_tr_b16 v[62:63], v24 offset:31648
    s_waitcnt lgkmcnt(8)
    v_mfma_f32_16x16x32_bf16 a[48:51], v[72:75], v[176:179], a[48:51]
    ds_read_b64_tr_b16 v[64:65], v23 offset:36864
    s_add_u32 m0, s38, 0
    v_mfma_f32_16x16x32_bf16 a[52:55], v[72:75], v[180:183], a[52:55]
    ds_read_b64_tr_b16 v[66:67], v23 offset:37632
    buffer_load_dwordx4 v20, s[8:11], s33 offen offset:0  lds
    v_mfma_f32_16x16x32_bf16 a[56:59], v[76:79], v[176:179], a[56:59]
    ds_read_b64_tr_b16 v[68:69], v23 offset:43008
    v_mul_f32 v83, v83, v87
    v_mfma_f32_16x16x32_bf16 a[60:63], v[76:79], v[180:183], a[60:63]
    ds_read_b64_tr_b16 v[70:71], v23 offset:43776
    s_waitcnt lgkmcnt(8)
    v_mfma_f32_16x16x32_bf16 a[64:67], v[48:51], v[176:179], a[64:67]
    ds_read_b64_tr_b16 v[72:73], v24 offset:36896
    buffer_load_dwordx4 v21, s[8:11], s33 offen offset:1024  lds
    v_mfma_f32_16x16x32_bf16 a[68:71], v[48:51], v[180:183], a[68:71]
    ds_read_b64_tr_b16 v[74:75], v24 offset:37664
    v_cvt_pk_bf16_f32 v98, v80, v81
    v_mfma_f32_16x16x32_bf16 a[72:75], v[52:55], v[176:179], a[72:75]
    ds_read_b64_tr_b16 v[76:77], v24 offset:43040
    v_cvt_pk_bf16_f32 v99, v82, v83
    v_mfma_f32_16x16x32_bf16 a[76:79], v[52:55], v[180:183], a[76:79]
    ds_read_b64_tr_b16 v[78:79], v24 offset:43808
    s_waitcnt lgkmcnt(8)
    v_mfma_f32_16x16x32_bf16 a[80:83], v[56:59], v[176:179], a[80:83]
    ds_read_b64_tr_b16 v[48:49], v23 offset:36928
    buffer_load_dwordx4 v22, s[8:11], s33 offen offset:2048  lds
    v_mfma_f32_16x16x32_bf16 a[84:87], v[56:59], v[180:183], a[84:87]
    ds_read_b64_tr_b16 v[50:51], v23 offset:37696
    s_add_u32 s61, s43, 32768
    v_mfma_f32_16x16x32_bf16 a[88:91], v[60:63], v[176:179], a[88:91]
    ds_read_b64_tr_b16 v[52:53], v23 offset:43072
    v_accvgpr_read_b32 v80, a132
    v_mfma_f32_16x16x32_bf16 a[92:95], v[60:63], v[180:183], a[92:95]
    ds_read_b64_tr_b16 v[54:55], v23 offset:43840
    s_waitcnt lgkmcnt(8)
    v_mfma_f32_16x16x32_bf16 a[0:3], v[64:67], v[184:187], a[0:3]
    ds_read_b64_tr_b16 v[56:57], v24 offset:36960
    s_add_u32 m0, s38, 12288
    v_mfma_f32_16x16x32_bf16 a[4:7], v[64:67], v[188:191], a[4:7]
    ds_read_b64_tr_b16 v[58:59], v24 offset:37728
    buffer_load_dwordx4 v20, s[8:11], s34 offen offset:0  lds
    v_mfma_f32_16x16x32_bf16 a[8:11], v[68:71], v[184:187], a[8:11]
    ds_read_b64_tr_b16 v[60:61], v24 offset:43104
    v_accvgpr_read_b32 v81, a133
    v_mfma_f32_16x16x32_bf16 a[12:15], v[68:71], v[188:191], a[12:15]
    ds_read_b64_tr_b16 v[62:63], v24 offset:43872
    s_waitcnt lgkmcnt(8)
    v_mfma_f32_16x16x32_bf16 a[16:19], v[72:75], v[184:187], a[16:19]
    ds_read_b64_tr_b16 v[64:65], v23 offset:36992
    buffer_load_dwordx4 v21, s[8:11], s34 offen offset:1024  lds
    v_mfma_f32_16x16x32_bf16 a[20:23], v[72:75], v[188:191], a[20:23]
    ds_read_b64_tr_b16 v[66:67], v23 offset:37760
    v_accvgpr_read_b32 v82, a134
    v_mfma_f32_16x16x32_bf16 a[24:27], v[76:79], v[184:187], a[24:27]
    ds_read_b64_tr_b16 v[68:69], v23 offset:43136
    v_accvgpr_read_b32 v83, a135
    v_mfma_f32_16x16x32_bf16 a[28:31], v[76:79], v[188:191], a[28:31]
    ds_read_b64_tr_b16 v[70:71], v23 offset:43904
    s_waitcnt lgkmcnt(8)
    v_mfma_f32_16x16x32_bf16 a[32:35], v[48:51], v[184:187], a[32:35]
    ds_read_b64_tr_b16 v[72:73], v24 offset:37024
    buffer_load_dwordx4 v22, s[8:11], s34 offen offset:2048  lds
    v_mfma_f32_16x16x32_bf16 a[36:39], v[48:51], v[188:191], a[36:39]
    ds_read_b64_tr_b16 v[74:75], v24 offset:37792
    v_accvgpr_read_b32 v84, a140
    v_mfma_f32_16x16x32_bf16 a[40:43], v[52:55], v[184:187], a[40:43]
    ds_read_b64_tr_b16 v[76:77], v24 offset:43168
    buffer_store_dwordx4 v[96:99], v29, s[12:15], s61 offen offset:0 sc1
    v_mfma_f32_16x16x32_bf16 a[44:47], v[52:55], v[188:191], a[44:47]
    ds_read_b64_tr_b16 v[78:79], v24 offset:43936
    s_waitcnt lgkmcnt(8)
    v_mfma_f32_16x16x32_bf16 a[48:51], v[56:59], v[184:187], a[48:51]
    ds_read_b64_tr_b16 v[48:49], v23 offset:49152
    v_accvgpr_read_b32 v85, a141
    v_mfma_f32_16x16x32_bf16 a[52:55], v[56:59], v[188:191], a[52:55]
    ds_read_b64_tr_b16 v[50:51], v23 offset:49920
    v_accvgpr_read_b32 v86, a142
    v_mfma_f32_16x16x32_bf16 a[56:59], v[60:63], v[184:187], a[56:59]
    ds_read_b64_tr_b16 v[52:53], v23 offset:55296
    v_accvgpr_read_b32 v87, a143
    v_mfma_f32_16x16x32_bf16 a[60:63], v[60:63], v[188:191], a[60:63]
    ds_read_b64_tr_b16 v[54:55], v23 offset:56064
    s_waitcnt lgkmcnt(8)
    v_mfma_f32_16x16x32_bf16 a[64:67], v[64:67], v[184:187], a[64:67]
    ds_read_b64_tr_b16 v[56:57], v24 offset:49184
    v_mul_f32 v80, v80, v31
    v_mfma_f32_16x16x32_bf16 a[68:71], v[64:67], v[188:191], a[68:71]
    ds_read_b64_tr_b16 v[58:59], v24 offset:49952
    v_mul_f32 v81, v81, v31
    v_mfma_f32_16x16x32_bf16 a[72:75], v[68:71], v[184:187], a[72:75]
    ds_read_b64_tr_b16 v[60:61], v24 offset:55328
    v_mul_f32 v82, v82, v31
    v_mfma_f32_16x16x32_bf16 a[76:79], v[68:71], v[188:191], a[76:79]
    ds_read_b64_tr_b16 v[62:63], v24 offset:56096
    s_waitcnt lgkmcnt(8)
    v_mfma_f32_16x16x32_bf16 a[80:83], v[72:75], v[184:187], a[80:83]
    ds_read_b64_tr_b16 v[64:65], v23 offset:49216
    v_mul_f32 v83, v83, v31
    v_mfma_f32_16x16x32_bf16 a[84:87], v[72:75], v[188:191], a[84:87]
    ds_read_b64_tr_b16 v[66:67], v23 offset:49984
    v_mul_f32 v80, v80, v84
    v_mfma_f32_16x16x32_bf16 a[88:91], v[76:79], v[184:187], a[88:91]
    ds_read_b64_tr_b16 v[68:69], v23 offset:55360
    v_mul_f32 v81, v81, v85
    v_mfma_f32_16x16x32_bf16 a[92:95], v[76:79], v[188:191], a[92:95]
    ds_read_b64_tr_b16 v[70:71], v23 offset:56128
    s_waitcnt lgkmcnt(8)
    v_mfma_f32_16x16x32_bf16 a[0:3], v[48:51], v[192:195], a[0:3]
    ds_read_b64_tr_b16 v[72:73], v24 offset:49248
    v_mul_f32 v82, v82, v86
    v_mfma_f32_16x16x32_bf16 a[4:7], v[48:51], v[196:199], a[4:7]
    ds_read_b64_tr_b16 v[74:75], v24 offset:50016
    v_mul_f32 v83, v83, v87
    v_mfma_f32_16x16x32_bf16 a[8:11], v[52:55], v[192:195], a[8:11]
    ds_read_b64_tr_b16 v[76:77], v24 offset:55392
    v_cvt_pk_bf16_f32 v100, v80, v81
    v_mfma_f32_16x16x32_bf16 a[12:15], v[52:55], v[196:199], a[12:15]
    ds_read_b64_tr_b16 v[78:79], v24 offset:56160
    s_waitcnt lgkmcnt(8)
    v_mfma_f32_16x16x32_bf16 a[16:19], v[56:59], v[192:195], a[16:19]
    ds_read_b64_tr_b16 v[48:49], v23 offset:49280
    v_cvt_pk_bf16_f32 v101, v82, v83
    v_mfma_f32_16x16x32_bf16 a[20:23], v[56:59], v[196:199], a[20:23]
    ds_read_b64_tr_b16 v[50:51], v23 offset:50048
    v_accvgpr_read_b32 v80, a148
    v_mfma_f32_16x16x32_bf16 a[24:27], v[60:63], v[192:195], a[24:27]
    ds_read_b64_tr_b16 v[52:53], v23 offset:55424
    v_accvgpr_read_b32 v81, a149
    v_mfma_f32_16x16x32_bf16 a[28:31], v[60:63], v[196:199], a[28:31]
    ds_read_b64_tr_b16 v[54:55], v23 offset:56192
    s_waitcnt lgkmcnt(8)
    v_mfma_f32_16x16x32_bf16 a[32:35], v[64:67], v[192:195], a[32:35]
    ds_read_b64_tr_b16 v[56:57], v24 offset:49312
    s_waitcnt vmcnt(7)
    v_mfma_f32_16x16x32_bf16 a[36:39], v[64:67], v[196:199], a[36:39]
    ds_read_b64_tr_b16 v[58:59], v24 offset:50080
    v_accvgpr_read_b32 v82, a150
    v_mfma_f32_16x16x32_bf16 a[40:43], v[68:71], v[192:195], a[40:43]
    ds_read_b64_tr_b16 v[60:61], v24 offset:55456
    s_barrier
    v_mfma_f32_16x16x32_bf16 a[44:47], v[68:71], v[196:199], a[44:47]
    ds_read_b64_tr_b16 v[62:63], v24 offset:56224
    s_waitcnt lgkmcnt(8)
    v_mfma_f32_16x16x32_bf16 a[48:51], v[72:75], v[192:195], a[48:51]
    ds_read_b64_tr_b16 v[64:65], v25 offset:0
    s_add_u32 m0, s38, 24576
    v_mfma_f32_16x16x32_bf16 a[52:55], v[72:75], v[196:199], a[52:55]
    ds_read_b64_tr_b16 v[66:67], v25 offset:768
    buffer_load_dwordx4 v20, s[8:11], s35 offen offset:0  lds
    v_mfma_f32_16x16x32_bf16 a[56:59], v[76:79], v[192:195], a[56:59]
    ds_read_b64_tr_b16 v[68:69], v25 offset:6144
    v_accvgpr_read_b32 v83, a151
    v_mfma_f32_16x16x32_bf16 a[60:63], v[76:79], v[196:199], a[60:63]
    ds_read_b64_tr_b16 v[70:71], v25 offset:6912
    s_waitcnt lgkmcnt(8)
    v_mfma_f32_16x16x32_bf16 a[64:67], v[48:51], v[192:195], a[64:67]
    ds_read_b64_tr_b16 v[72:73], v26 offset:32
    buffer_load_dwordx4 v21, s[8:11], s35 offen offset:1024  lds
    v_mfma_f32_16x16x32_bf16 a[68:71], v[48:51], v[196:199], a[68:71]
    ds_read_b64_tr_b16 v[74:75], v26 offset:800
    v_accvgpr_read_b32 v84, a156
    v_mfma_f32_16x16x32_bf16 a[72:75], v[52:55], v[192:195], a[72:75]
    ds_read_b64_tr_b16 v[76:77], v26 offset:6176
    v_accvgpr_read_b32 v85, a157
    v_mfma_f32_16x16x32_bf16 a[76:79], v[52:55], v[196:199], a[76:79]
    ds_read_b64_tr_b16 v[78:79], v26 offset:6944
    s_waitcnt lgkmcnt(8)
    v_mfma_f32_16x16x32_bf16 a[80:83], v[56:59], v[192:195], a[80:83]
    ds_read_b64_tr_b16 v[48:49], v25 offset:64
    buffer_load_dwordx4 v22, s[8:11], s35 offen offset:2048  lds
    v_mfma_f32_16x16x32_bf16 a[84:87], v[56:59], v[196:199], a[84:87]
    ds_read_b64_tr_b16 v[50:51], v25 offset:832
    v_accvgpr_read_b32 v86, a158
    v_mfma_f32_16x16x32_bf16 a[88:91], v[60:63], v[192:195], a[88:91]
    ds_read_b64_tr_b16 v[52:53], v25 offset:6208
    v_accvgpr_read_b32 v87, a159
    v_mfma_f32_16x16x32_bf16 a[92:95], v[60:63], v[196:199], a[92:95]
    ds_read_b64_tr_b16 v[54:55], v25 offset:6976
    s_waitcnt lgkmcnt(8)
    v_mfma_f32_16x16x32_bf16 a[0:3], v[64:67], v[200:203], a[0:3]
    ds_read_b64_tr_b16 v[56:57], v26 offset:96
    s_add_u32 m0, s38, 36864
    v_mfma_f32_16x16x32_bf16 a[4:7], v[64:67], v[204:207], a[4:7]
    ds_read_b64_tr_b16 v[58:59], v26 offset:864
    buffer_load_dwordx4 v20, s[8:11], s36 offen offset:0  lds
    v_mfma_f32_16x16x32_bf16 a[8:11], v[68:71], v[200:203], a[8:11]
    ds_read_b64_tr_b16 v[60:61], v26 offset:6240
    v_mul_f32 v80, v80, v31
    v_mfma_f32_16x16x32_bf16 a[12:15], v[68:71], v[204:207], a[12:15]
    ds_read_b64_tr_b16 v[62:63], v26 offset:7008
    s_waitcnt lgkmcnt(8)
    v_mfma_f32_16x16x32_bf16 a[16:19], v[72:75], v[200:203], a[16:19]
    ds_read_b64_tr_b16 v[64:65], v25 offset:128
    buffer_load_dwordx4 v21, s[8:11], s36 offen offset:1024  lds
    v_mfma_f32_16x16x32_bf16 a[20:23], v[72:75], v[204:207], a[20:23]
    ds_read_b64_tr_b16 v[66:67], v25 offset:896
    v_mul_f32 v81, v81, v31
    v_mfma_f32_16x16x32_bf16 a[24:27], v[76:79], v[200:203], a[24:27]
    ds_read_b64_tr_b16 v[68:69], v25 offset:6272
    v_mul_f32 v82, v82, v31
    v_mfma_f32_16x16x32_bf16 a[28:31], v[76:79], v[204:207], a[28:31]
    ds_read_b64_tr_b16 v[70:71], v25 offset:7040
    s_waitcnt lgkmcnt(8)
    v_mfma_f32_16x16x32_bf16 a[32:35], v[48:51], v[200:203], a[32:35]
    ds_read_b64_tr_b16 v[72:73], v26 offset:160
    buffer_load_dwordx4 v22, s[8:11], s36 offen offset:2048  lds
    v_mfma_f32_16x16x32_bf16 a[36:39], v[48:51], v[204:207], a[36:39]
    ds_read_b64_tr_b16 v[74:75], v26 offset:928
    v_mul_f32 v83, v83, v31
    v_mfma_f32_16x16x32_bf16 a[40:43], v[52:55], v[200:203], a[40:43]
    ds_read_b64_tr_b16 v[76:77], v26 offset:6304
    v_mul_f32 v80, v80, v84
    v_mfma_f32_16x16x32_bf16 a[44:47], v[52:55], v[204:207], a[44:47]
    ds_read_b64_tr_b16 v[78:79], v26 offset:7072
    s_waitcnt lgkmcnt(8)
    v_mfma_f32_16x16x32_bf16 a[48:51], v[56:59], v[200:203], a[48:51]
    ds_read_b64_tr_b16 v[48:49], v25 offset:12288
    s_cmp_eq_u32 s94, 2
    s_cbranch_scc0 L1_LDG
    v_mov_b32 v106, 0
    v_mov_b32 v107, 64
    global_load_dword v104, v106, s[90:91] sc1
    global_load_dword v105, v107, s[90:91] sc1
    s_branch L1_NOLD
L1_LDG:
    s_lshr_b32 s93, s2, 5
    s_lshl_b32 s93, s93, 5
    s_and_b32 s95, s2, 7
    s_add_u32 s93, s93, s95
    v_and_b32 v106, 3, v0
    v_cmp_eq_u32 vcc, 2, v106
    v_mov_b32 v107, 0
    s_nop 0
    v_cndmask_b32 v106, v106, v107, vcc
    v_lshlrev_b32 v106, 3, v106
    v_add_u32 v106, s93, v106
    v_lshlrev_b32 v106, 7, v106
    v_add_u32 v106, 36831232, v106
    buffer_load_dword v104, v106, s[12:15], 0 offen sc1
L1_NOLD:
    v_mfma_f32_16x16x32_bf16 a[52:55], v[56:59], v[204:207], a[52:55]
    ds_read_b64_tr_b16 v[50:51], v25 offset:13056
    v_mul_f32 v81, v81, v85
    v_mfma_f32_16x16x32_bf16 a[56:59], v[60:63], v[200:203], a[56:59]
    ds_read_b64_tr_b16 v[52:53], v25 offset:18432
    v_mul_f32 v82, v82, v86
    v_mfma_f32_16x16x32_bf16 a[60:63], v[60:63], v[204:207], a[60:63]
    ds_read_b64_tr_b16 v[54:55], v25 offset:19200
    s_waitcnt lgkmcnt(8)
    v_mfma_f32_16x16x32_bf16 a[64:67], v[64:67], v[200:203], a[64:67]
    ds_read_b64_tr_b16 v[56:57], v26 offset:12320
    v_mul_f32 v83, v83, v87
    v_mfma_f32_16x16x32_bf16 a[68:71], v[64:67], v[204:207], a[68:71]
    ds_read_b64_tr_b16 v[58:59], v26 offset:13088
    v_cvt_pk_bf16_f32 v102, v80, v81
    v_mfma_f32_16x16x32_bf16 a[72:75], v[68:71], v[200:203], a[72:75]
    ds_read_b64_tr_b16 v[60:61], v26 offset:18464
    v_cvt_pk_bf16_f32 v103, v82, v83
    v_mfma_f32_16x16x32_bf16 a[76:79], v[68:71], v[204:207], a[76:79]
    ds_read_b64_tr_b16 v[62:63], v26 offset:19232
    s_waitcnt lgkmcnt(8)
    v_mfma_f32_16x16x32_bf16 a[80:83], v[72:75], v[200:203], a[80:83]
    ds_read_b64_tr_b16 v[64:65], v25 offset:12352
    buffer_store_dwordx4 v[100:103], v29, s[12:15], s61 offen offset:1024 sc1
    v_mfma_f32_16x16x32_bf16 a[84:87], v[72:75], v[204:207], a[84:87]
    ds_read_b64_tr_b16 v[66:67], v25 offset:13120
    v_accvgpr_read_b32 v80, a160
    v_mfma_f32_16x16x32_bf16 a[88:91], v[76:79], v[200:203], a[88:91]
    ds_read_b64_tr_b16 v[68:69], v25 offset:18496
    v_accvgpr_read_b32 v81, a161
    v_mfma_f32_16x16x32_bf16 a[92:95], v[76:79], v[204:207], a[92:95]
    ds_read_b64_tr_b16 v[70:71], v25 offset:19264
    s_waitcnt lgkmcnt(8)
    v_mfma_f32_16x16x32_bf16 a[0:3], v[48:51], v[208:211], a[0:3]
    ds_read_b64_tr_b16 v[72:73], v26 offset:12384
    v_accvgpr_read_b32 v82, a162
    v_mfma_f32_16x16x32_bf16 a[4:7], v[48:51], v[212:215], a[4:7]
    ds_read_b64_tr_b16 v[74:75], v26 offset:13152
    v_accvgpr_read_b32 v83, a163
    v_mfma_f32_16x16x32_bf16 a[8:11], v[52:55], v[208:211], a[8:11]
    ds_read_b64_tr_b16 v[76:77], v26 offset:18528
    v_accvgpr_read_b32 v84, a168
    v_mfma_f32_16x16x32_bf16 a[12:15], v[52:55], v[212:215], a[12:15]
    ds_read_b64_tr_b16 v[78:79], v26 offset:19296
    s_waitcnt lgkmcnt(8)
    v_mfma_f32_16x16x32_bf16 a[16:19], v[56:59], v[208:211], a[16:19]
    ds_read_b64_tr_b16 v[48:49], v25 offset:12416
    v_accvgpr_read_b32 v85, a169
    v_mfma_f32_16x16x32_bf16 a[20:23], v[56:59], v[212:215], a[20:23]
    ds_read_b64_tr_b16 v[50:51], v25 offset:13184
    v_accvgpr_read_b32 v86, a170
    v_mfma_f32_16x16x32_bf16 a[24:27], v[60:63], v[208:211], a[24:27]
    ds_read_b64_tr_b16 v[52:53], v25 offset:18560
    v_accvgpr_read_b32 v87, a171
    v_mfma_f32_16x16x32_bf16 a[28:31], v[60:63], v[212:215], a[28:31]
    ds_read_b64_tr_b16 v[54:55], v25 offset:19328
    s_waitcnt lgkmcnt(8)
    v_mfma_f32_16x16x32_bf16 a[32:35], v[64:67], v[208:211], a[32:35]
    ds_read_b64_tr_b16 v[56:57], v26 offset:12448
    s_waitcnt vmcnt(8)
    v_mfma_f32_16x16x32_bf16 a[36:39], v[64:67], v[212:215], a[36:39]
    ds_read_b64_tr_b16 v[58:59], v26 offset:13216
    v_mul_f32 v80, v80, v30
    v_mfma_f32_16x16x32_bf16 a[40:43], v[68:71], v[208:211], a[40:43]
    ds_read_b64_tr_b16 v[60:61], v26 offset:18592
    s_barrier
    v_mfma_f32_16x16x32_bf16 a[44:47], v[68:71], v[212:215], a[44:47]
    ds_read_b64_tr_b16 v[62:63], v26 offset:19360
    s_waitcnt lgkmcnt(8)
    v_mfma_f32_16x16x32_bf16 a[48:51], v[72:75], v[208:211], a[48:51]
    ds_read_b64_tr_b16 v[64:65], v23 offset:0
    s_add_u32 m0, s38, 49152
    v_mfma_f32_16x16x32_bf16 a[52:55], v[72:75], v[212:215], a[52:55]
    ds_read_b64_tr_b16 v[66:67], v23 offset:768
    buffer_load_dwordx4 v20, s[8:11], s37 offen offset:0  lds
    v_mfma_f32_16x16x32_bf16 a[56:59], v[76:79], v[208:211], a[56:59]
    ds_read_b64_tr_b16 v[68:69], v23 offset:6144
    v_mul_f32 v81, v81, v30
    v_mfma_f32_16x16x32_bf16 a[60:63], v[76:79], v[212:215], a[60:63]
    ds_read_b64_tr_b16 v[70:71], v23 offset:6912
    s_waitcnt lgkmcnt(8)
    v_mfma_f32_16x16x32_bf16 a[64:67], v[48:51], v[208:211], a[64:67]
    ds_read_b64_tr_b16 v[72:73], v24 offset:32
    buffer_load_dwordx4 v21, s[8:11], s37 offen offset:1024  lds
    v_mfma_f32_16x16x32_bf16 a[68:71], v[48:51], v[212:215], a[68:71]
    ds_read_b64_tr_b16 v[74:75], v24 offset:800
    v_mul_f32 v82, v82, v30
    v_mfma_f32_16x16x32_bf16 a[72:75], v[52:55], v[208:211], a[72:75]
    ds_read_b64_tr_b16 v[76:77], v24 offset:6176
    v_mul_f32 v83, v83, v30
    v_mfma_f32_16x16x32_bf16 a[76:79], v[52:55], v[212:215], a[76:79]
    ds_read_b64_tr_b16 v[78:79], v24 offset:6944
    s_waitcnt lgkmcnt(8)
    v_mfma_f32_16x16x32_bf16 a[80:83], v[56:59], v[208:211], a[80:83]
    ds_read_b64_tr_b16 v[48:49], v23 offset:64
    buffer_load_dwordx4 v22, s[8:11], s37 offen offset:2048  lds
    v_mfma_f32_16x16x32_bf16 a[84:87], v[56:59], v[212:215], a[84:87]
    ds_read_b64_tr_b16 v[50:51], v23 offset:832
    v_mul_f32 v80, v80, v84
    v_mfma_f32_16x16x32_bf16 a[88:91], v[60:63], v[208:211], a[88:91]
    ds_read_b64_tr_b16 v[52:53], v23 offset:6208
    v_mul_f32 v81, v81, v85
    v_mfma_f32_16x16x32_bf16 a[92:95], v[60:63], v[212:215], a[92:95]
    ds_read_b64_tr_b16 v[54:55], v23 offset:6976
    s_waitcnt lgkmcnt(8)
    v_mfma_f32_16x16x32_bf16 a[0:3], v[64:67], v[216:219], a[0:3]
    ds_read_b64_tr_b16 v[56:57], v24 offset:96
    v_mul_f32 v82, v82, v86
    v_mfma_f32_16x16x32_bf16 a[4:7], v[64:67], v[220:223], a[4:7]
    ds_read_b64_tr_b16 v[58:59], v24 offset:864
    v_mul_f32 v83, v83, v87
    v_mfma_f32_16x16x32_bf16 a[8:11], v[68:71], v[216:219], a[8:11]
    ds_read_b64_tr_b16 v[60:61], v24 offset:6240
    v_cvt_pk_bf16_f32 v96, v80, v81
    v_mfma_f32_16x16x32_bf16 a[12:15], v[68:71], v[220:223], a[12:15]
    ds_read_b64_tr_b16 v[62:63], v24 offset:7008
    s_waitcnt lgkmcnt(8)
    v_mfma_f32_16x16x32_bf16 a[16:19], v[72:75], v[216:219], a[16:19]
    ds_read_b64_tr_b16 v[64:65], v23 offset:128
    v_cvt_pk_bf16_f32 v97, v82, v83
    v_mfma_f32_16x16x32_bf16 a[20:23], v[72:75], v[220:223], a[20:23]
    ds_read_b64_tr_b16 v[66:67], v23 offset:896
    v_accvgpr_read_b32 v80, a176
    v_mfma_f32_16x16x32_bf16 a[24:27], v[76:79], v[216:219], a[24:27]
    ds_read_b64_tr_b16 v[68:69], v23 offset:6272
    v_accvgpr_read_b32 v81, a177
    v_mfma_f32_16x16x32_bf16 a[28:31], v[76:79], v[220:223], a[28:31]
    ds_read_b64_tr_b16 v[70:71], v23 offset:7040
    s_waitcnt lgkmcnt(8)
    v_mfma_f32_16x16x32_bf16 a[32:35], v[48:51], v[216:219], a[32:35]
    ds_read_b64_tr_b16 v[72:73], v24 offset:160
    v_accvgpr_read_b32 v82, a178
    v_mfma_f32_16x16x32_bf16 a[36:39], v[48:51], v[220:223], a[36:39]
    ds_read_b64_tr_b16 v[74:75], v24 offset:928
    v_accvgpr_read_b32 v83, a179
    v_mfma_f32_16x16x32_bf16 a[40:43], v[52:55], v[216:219], a[40:43]
    ds_read_b64_tr_b16 v[76:77], v24 offset:6304
    v_accvgpr_read_b32 v84, a184
    v_mfma_f32_16x16x32_bf16 a[44:47], v[52:55], v[220:223], a[44:47]
    ds_read_b64_tr_b16 v[78:79], v24 offset:7072
    s_waitcnt lgkmcnt(8)
    v_mfma_f32_16x16x32_bf16 a[48:51], v[56:59], v[216:219], a[48:51]
    ds_read_b64_tr_b16 v[48:49], v23 offset:12288
    v_accvgpr_read_b32 v85, a185
    v_mfma_f32_16x16x32_bf16 a[52:55], v[56:59], v[220:223], a[52:55]
    ds_read_b64_tr_b16 v[50:51], v23 offset:13056
    v_accvgpr_read_b32 v86, a186
    v_mfma_f32_16x16x32_bf16 a[56:59], v[60:63], v[216:219], a[56:59]
    ds_read_b64_tr_b16 v[52:53], v23 offset:18432
    v_accvgpr_read_b32 v87, a187
    v_mfma_f32_16x16x32_bf16 a[60:63], v[60:63], v[220:223], a[60:63]
    ds_read_b64_tr_b16 v[54:55], v23 offset:19200
    s_waitcnt lgkmcnt(8)
    v_mfma_f32_16x16x32_bf16 a[64:67], v[64:67], v[216:219], a[64:67]
    ds_read_b64_tr_b16 v[56:57], v24 offset:12320
    v_mul_f32 v80, v80, v30
    v_mfma_f32_16x16x32_bf16 a[68:71], v[64:67], v[220:223], a[68:71]
    ds_read_b64_tr_b16 v[58:59], v24 offset:13088
    v_mul_f32 v81, v81, v30
    v_mfma_f32_16x16x32_bf16 a[72:75], v[68:71], v[216:219], a[72:75]
    ds_read_b64_tr_b16 v[60:61], v24 offset:18464
    v_mul_f32 v82, v82, v30
    v_mfma_f32_16x16x32_bf16 a[76:79], v[68:71], v[220:223], a[76:79]
    ds_read_b64_tr_b16 v[62:63], v24 offset:19232
    s_waitcnt lgkmcnt(8)
    v_mfma_f32_16x16x32_bf16 a[80:83], v[72:75], v[216:219], a[80:83]
    ds_read_b64_tr_b16 v[64:65], v23 offset:12352
    v_mul_f32 v83, v83, v30
    v_mfma_f32_16x16x32_bf16 a[84:87], v[72:75], v[220:223], a[84:87]
    ds_read_b64_tr_b16 v[66:67], v23 offset:13120
    v_mul_f32 v80, v80, v84
    v_mfma_f32_16x16x32_bf16 a[88:91], v[76:79], v[216:219], a[88:91]
    ds_read_b64_tr_b16 v[68:69], v23 offset:18496
    v_mul_f32 v81, v81, v85
    v_mfma_f32_16x16x32_bf16 a[92:95], v[76:79], v[220:223], a[92:95]
    ds_read_b64_tr_b16 v[70:71], v23 offset:19264
    s_waitcnt lgkmcnt(8)
    v_mfma_f32_16x16x32_bf16 a[0:3], v[48:51], v[224:227], a[0:3]
    ds_read_b64_tr_b16 v[72:73], v24 offset:12384
    v_mul_f32 v82, v82, v86
    v_mfma_f32_16x16x32_bf16 a[4:7], v[48:51], v[228:231], a[4:7]
    ds_read_b64_tr_b16 v[74:75], v24 offset:13152
    v_mul_f32 v83, v83, v87
    v_mfma_f32_16x16x32_bf16 a[8:11], v[52:55], v[224:227], a[8:11]
    ds_read_b64_tr_b16 v[76:77], v24 offset:18528
    v_cvt_pk_bf16_f32 v98, v80, v81
    v_mfma_f32_16x16x32_bf16 a[12:15], v[52:55], v[228:231], a[12:15]
    ds_read_b64_tr_b16 v[78:79], v24 offset:19296
    s_waitcnt lgkmcnt(8)
    v_mfma_f32_16x16x32_bf16 a[16:19], v[56:59], v[224:227], a[16:19]
    ds_read_b64_tr_b16 v[48:49], v23 offset:12416
    v_cvt_pk_bf16_f32 v99, v82, v83
    v_mfma_f32_16x16x32_bf16 a[20:23], v[56:59], v[228:231], a[20:23]
    ds_read_b64_tr_b16 v[50:51], v23 offset:13184
    s_add_u32 s63, s43, 40960
    v_mfma_f32_16x16x32_bf16 a[24:27], v[60:63], v[224:227], a[24:27]
    ds_read_b64_tr_b16 v[52:53], v23 offset:18560
    v_accvgpr_read_b32 v80, a164
    v_mfma_f32_16x16x32_bf16 a[28:31], v[60:63], v[228:231], a[28:31]
    ds_read_b64_tr_b16 v[54:55], v23 offset:19328
    s_waitcnt lgkmcnt(8)
    v_mfma_f32_16x16x32_bf16 a[32:35], v[64:67], v[224:227], a[32:35]
    ds_read_b64_tr_b16 v[56:57], v24 offset:12448
    s_waitcnt vmcnt(4)
    v_mfma_f32_16x16x32_bf16 a[36:39], v[64:67], v[228:231], a[36:39]
    ds_read_b64_tr_b16 v[58:59], v24 offset:13216
    v_accvgpr_read_b32 v81, a165
    v_mfma_f32_16x16x32_bf16 a[40:43], v[68:71], v[224:227], a[40:43]
    ds_read_b64_tr_b16 v[60:61], v24 offset:18592
    s_barrier
    v_mfma_f32_16x16x32_bf16 a[44:47], v[68:71], v[228:231], a[44:47]
    ds_read_b64_tr_b16 v[62:63], v24 offset:19360
    s_waitcnt lgkmcnt(8)
    v_mfma_f32_16x16x32_bf16 a[48:51], v[72:75], v[224:227], a[48:51]
    ds_read_b64_tr_b16 v[64:65], v23 offset:24576
    v_accvgpr_read_b32 v82, a166
    v_mfma_f32_16x16x32_bf16 a[52:55], v[72:75], v[228:231], a[52:55]
    ds_read_b64_tr_b16 v[66:67], v23 offset:25344
    v_accvgpr_read_b32 v83, a167
    v_mfma_f32_16x16x32_bf16 a[56:59], v[76:79], v[224:227], a[56:59]
    ds_read_b64_tr_b16 v[68:69], v23 offset:30720
    v_accvgpr_read_b32 v84, a172
    v_mfma_f32_16x16x32_bf16 a[60:63], v[76:79], v[228:231], a[60:63]
    ds_read_b64_tr_b16 v[70:71], v23 offset:31488
    s_waitcnt lgkmcnt(8)
    v_mfma_f32_16x16x32_bf16 a[64:67], v[48:51], v[224:227], a[64:67]
    ds_read_b64_tr_b16 v[72:73], v24 offset:24608
    v_accvgpr_read_b32 v85, a173
    v_mfma_f32_16x16x32_bf16 a[68:71], v[48:51], v[228:231], a[68:71]
    ds_read_b64_tr_b16 v[74:75], v24 offset:25376
    v_accvgpr_read_b32 v86, a174
    v_mfma_f32_16x16x32_bf16 a[72:75], v[52:55], v[224:227], a[72:75]
    ds_read_b64_tr_b16 v[76:77], v24 offset:30752
    v_accvgpr_read_b32 v87, a175
    v_mfma_f32_16x16x32_bf16 a[76:79], v[52:55], v[228:231], a[76:79]
    ds_read_b64_tr_b16 v[78:79], v24 offset:31520
    s_waitcnt lgkmcnt(8)
    v_mfma_f32_16x16x32_bf16 a[80:83], v[56:59], v[224:227], a[80:83]
    ds_read_b64_tr_b16 v[48:49], v23 offset:24640
    v_mul_f32 v80, v80, v31
    v_mfma_f32_16x16x32_bf16 a[84:87], v[56:59], v[228:231], a[84:87]
    ds_read_b64_tr_b16 v[50:51], v23 offset:25408
    v_mul_f32 v81, v81, v31
    v_mfma_f32_16x16x32_bf16 a[88:91], v[60:63], v[224:227], a[88:91]
    ds_read_b64_tr_b16 v[52:53], v23 offset:30784
    v_mul_f32 v82, v82, v31
    v_mfma_f32_16x16x32_bf16 a[92:95], v[60:63], v[228:231], a[92:95]
    ds_read_b64_tr_b16 v[54:55], v23 offset:31552
    s_waitcnt lgkmcnt(8)
    v_mfma_f32_16x16x32_bf16 a[0:3], v[64:67], v[232:235], a[0:3]
    ds_read_b64_tr_b16 v[56:57], v24 offset:24672
    v_mul_f32 v83, v83, v31
    v_mfma_f32_16x16x32_bf16 a[4:7], v[64:67], v[236:239], a[4:7]
    ds_read_b64_tr_b16 v[58:59], v24 offset:25440
    v_mul_f32 v80, v80, v84
    v_mfma_f32_16x16x32_bf16 a[8:11], v[68:71], v[232:235], a[8:11]
    ds_read_b64_tr_b16 v[60:61], v24 offset:30816
    v_mul_f32 v81, v81, v85
    v_mfma_f32_16x16x32_bf16 a[12:15], v[68:71], v[236:239], a[12:15]
    ds_read_b64_tr_b16 v[62:63], v24 offset:31584
    s_waitcnt lgkmcnt(8)
    v_mfma_f32_16x16x32_bf16 a[16:19], v[72:75], v[232:235], a[16:19]
    ds_read_b64_tr_b16 v[64:65], v23 offset:24704
    v_mul_f32 v82, v82, v86
    v_mfma_f32_16x16x32_bf16 a[20:23], v[72:75], v[236:239], a[20:23]
    ds_read_b64_tr_b16 v[66:67], v23 offset:25472
    v_mul_f32 v83, v83, v87
    v_mfma_f32_16x16x32_bf16 a[24:27], v[76:79], v[232:235], a[24:27]
    ds_read_b64_tr_b16 v[68:69], v23 offset:30848
    v_cvt_pk_bf16_f32 v100, v80, v81
    v_mfma_f32_16x16x32_bf16 a[28:31], v[76:79], v[236:239], a[28:31]
    ds_read_b64_tr_b16 v[70:71], v23 offset:31616
    s_waitcnt lgkmcnt(8)
    v_mfma_f32_16x16x32_bf16 a[32:35], v[48:51], v[232:235], a[32:35]
    ds_read_b64_tr_b16 v[72:73], v24 offset:24736
    v_cvt_pk_bf16_f32 v101, v82, v83
    v_mfma_f32_16x16x32_bf16 a[36:39], v[48:51], v[236:239], a[36:39]
    ds_read_b64_tr_b16 v[74:75], v24 offset:25504
    v_accvgpr_read_b32 v80, a180
    v_mfma_f32_16x16x32_bf16 a[40:43], v[52:55], v[232:235], a[40:43]
    ds_read_b64_tr_b16 v[76:77], v24 offset:30880
    buffer_store_dwordx4 v[96:99], v29, s[12:15], s63 offen offset:0 sc1
    v_mfma_f32_16x16x32_bf16 a[44:47], v[52:55], v[236:239], a[44:47]
    ds_read_b64_tr_b16 v[78:79], v24 offset:31648
    s_waitcnt lgkmcnt(8)
    v_mfma_f32_16x16x32_bf16 a[48:51], v[56:59], v[232:235], a[48:51]
    ds_read_b64_tr_b16 v[48:49], v23 offset:36864
    v_accvgpr_read_b32 v81, a181
    v_mfma_f32_16x16x32_bf16 a[52:55], v[56:59], v[236:239], a[52:55]
    ds_read_b64_tr_b16 v[50:51], v23 offset:37632
    v_accvgpr_read_b32 v82, a182
    v_mfma_f32_16x16x32_bf16 a[56:59], v[60:63], v[232:235], a[56:59]
    ds_read_b64_tr_b16 v[52:53], v23 offset:43008
    v_accvgpr_read_b32 v83, a183
    v_mfma_f32_16x16x32_bf16 a[60:63], v[60:63], v[236:239], a[60:63]
    ds_read_b64_tr_b16 v[54:55], v23 offset:43776
    s_waitcnt lgkmcnt(8)
    v_mfma_f32_16x16x32_bf16 a[64:67], v[64:67], v[232:235], a[64:67]
    ds_read_b64_tr_b16 v[56:57], v24 offset:36896
    v_accvgpr_read_b32 v84, a188
    v_mfma_f32_16x16x32_bf16 a[68:71], v[64:67], v[236:239], a[68:71]
    ds_read_b64_tr_b16 v[58:59], v24 offset:37664
    v_accvgpr_read_b32 v85, a189
    v_mfma_f32_16x16x32_bf16 a[72:75], v[68:71], v[232:235], a[72:75]
    ds_read_b64_tr_b16 v[60:61], v24 offset:43040
    v_accvgpr_read_b32 v86, a190
    v_mfma_f32_16x16x32_bf16 a[76:79], v[68:71], v[236:239], a[76:79]
    ds_read_b64_tr_b16 v[62:63], v24 offset:43808
    s_waitcnt lgkmcnt(8)
    v_mfma_f32_16x16x32_bf16 a[80:83], v[72:75], v[232:235], a[80:83]
    ds_read_b64_tr_b16 v[64:65], v23 offset:36928
    v_accvgpr_read_b32 v87, a191
    v_mfma_f32_16x16x32_bf16 a[84:87], v[72:75], v[236:239], a[84:87]
    ds_read_b64_tr_b16 v[66:67], v23 offset:37696
    v_mul_f32 v80, v80, v31
    v_mfma_f32_16x16x32_bf16 a[88:91], v[76:79], v[232:235], a[88:91]
    ds_read_b64_tr_b16 v[68:69], v23 offset:43072
    v_mul_f32 v81, v81, v31
    v_mfma_f32_16x16x32_bf16 a[92:95], v[76:79], v[236:239], a[92:95]
    ds_read_b64_tr_b16 v[70:71], v23 offset:43840
    s_waitcnt lgkmcnt(8)
    v_mfma_f32_16x16x32_bf16 a[0:3], v[48:51], v[240:243], a[0:3]
    ds_read_b64_tr_b16 v[72:73], v24 offset:36960
    v_mul_f32 v82, v82, v31
    v_mfma_f32_16x16x32_bf16 a[4:7], v[48:51], v[244:247], a[4:7]
    ds_read_b64_tr_b16 v[74:75], v24 offset:37728
    v_mul_f32 v83, v83, v31
    v_mfma_f32_16x16x32_bf16 a[8:11], v[52:55], v[240:243], a[8:11]
    ds_read_b64_tr_b16 v[76:77], v24 offset:43104
    v_mul_f32 v80, v80, v84
    v_mfma_f32_16x16x32_bf16 a[12:15], v[52:55], v[244:247], a[12:15]
    ds_read_b64_tr_b16 v[78:79], v24 offset:43872
    s_waitcnt lgkmcnt(8)
    v_mfma_f32_16x16x32_bf16 a[16:19], v[56:59], v[240:243], a[16:19]
    ds_read_b64_tr_b16 v[48:49], v23 offset:36992
    v_mul_f32 v81, v81, v85
    v_mfma_f32_16x16x32_bf16 a[20:23], v[56:59], v[244:247], a[20:23]
    ds_read_b64_tr_b16 v[50:51], v23 offset:37760
    v_mul_f32 v82, v82, v86
    v_mfma_f32_16x16x32_bf16 a[24:27], v[60:63], v[240:243], a[24:27]
    ds_read_b64_tr_b16 v[52:53], v23 offset:43136
    v_mul_f32 v83, v83, v87
    v_mfma_f32_16x16x32_bf16 a[28:31], v[60:63], v[244:247], a[28:31]
    ds_read_b64_tr_b16 v[54:55], v23 offset:43904
    s_waitcnt lgkmcnt(8)
    v_mfma_f32_16x16x32_bf16 a[32:35], v[64:67], v[240:243], a[32:35]
    ds_read_b64_tr_b16 v[56:57], v24 offset:37024
    s_waitcnt vmcnt(1)
    v_mfma_f32_16x16x32_bf16 a[36:39], v[64:67], v[244:247], a[36:39]
    ds_read_b64_tr_b16 v[58:59], v24 offset:37792
    v_cvt_pk_bf16_f32 v102, v80, v81
    v_mfma_f32_16x16x32_bf16 a[40:43], v[68:71], v[240:243], a[40:43]
    ds_read_b64_tr_b16 v[60:61], v24 offset:43168
    s_barrier
    v_mfma_f32_16x16x32_bf16 a[44:47], v[68:71], v[244:247], a[44:47]
    ds_read_b64_tr_b16 v[62:63], v24 offset:43936
    s_waitcnt lgkmcnt(8)
    v_mfma_f32_16x16x32_bf16 a[48:51], v[72:75], v[240:243], a[48:51]
    ds_read_b64_tr_b16 v[64:65], v23 offset:49152
    v_cvt_pk_bf16_f32 v103, v82, v83
    v_mfma_f32_16x16x32_bf16 a[52:55], v[72:75], v[244:247], a[52:55]
    ds_read_b64_tr_b16 v[66:67], v23 offset:49920
    v_mfma_f32_16x16x32_bf16 a[56:59], v[76:79], v[240:243], a[56:59]
    ds_read_b64_tr_b16 v[68:69], v23 offset:55296
    s_lshr_b32 s93, s2, 3
    s_lshl_b32 s93, s93, 2
    s_add_u32 s93, s93, s16
    s_getpc_b64 s[96:97]
L1_PC2:
    s_add_u32 s96, s96, G2_ENTRY-L1_PC2
    s_addc_u32 s97, s97, 0
    s_mov_b32 s98, CODE_END-G2_ENTRY
    s_mov_b32 s99, 0x00020000
    s_lshl_b32 s93, s93, 10
    buffer_load_dwordx4 a[224:227], v29, s[96:99], s93 offen
    v_mfma_f32_16x16x32_bf16 a[60:63], v[76:79], v[244:247], a[60:63]
    ds_read_b64_tr_b16 v[70:71], v23 offset:56064
    s_waitcnt lgkmcnt(8)
    v_mfma_f32_16x16x32_bf16 a[64:67], v[48:51], v[240:243], a[64:67]
    ds_read_b64_tr_b16 v[72:73], v24 offset:49184
    v_mfma_f32_16x16x32_bf16 a[68:71], v[48:51], v[244:247], a[68:71]
    ds_read_b64_tr_b16 v[74:75], v24 offset:49952
    v_mfma_f32_16x16x32_bf16 a[72:75], v[52:55], v[240:243], a[72:75]
    ds_read_b64_tr_b16 v[76:77], v24 offset:55328
    v_mfma_f32_16x16x32_bf16 a[76:79], v[52:55], v[244:247], a[76:79]
    ds_read_b64_tr_b16 v[78:79], v24 offset:56096
    s_waitcnt lgkmcnt(8)
    v_mfma_f32_16x16x32_bf16 a[80:83], v[56:59], v[240:243], a[80:83]
    ds_read_b64_tr_b16 v[48:49], v23 offset:49216
    v_mfma_f32_16x16x32_bf16 a[84:87], v[56:59], v[244:247], a[84:87]
    ds_read_b64_tr_b16 v[50:51], v23 offset:49984
    v_mfma_f32_16x16x32_bf16 a[88:91], v[60:63], v[240:243], a[88:91]
    ds_read_b64_tr_b16 v[52:53], v23 offset:55360
    v_mfma_f32_16x16x32_bf16 a[92:95], v[60:63], v[244:247], a[92:95]
    ds_read_b64_tr_b16 v[54:55], v23 offset:56128
    s_waitcnt lgkmcnt(8)
    v_mfma_f32_16x16x32_bf16 a[0:3], v[64:67], v[248:251], a[0:3]
    ds_read_b64_tr_b16 v[56:57], v24 offset:49248
    v_mfma_f32_16x16x32_bf16 a[4:7], v[64:67], v[252:255], a[4:7]
    ds_read_b64_tr_b16 v[58:59], v24 offset:50016
    v_mfma_f32_16x16x32_bf16 a[8:11], v[68:71], v[248:251], a[8:11]
    ds_read_b64_tr_b16 v[60:61], v24 offset:55392
    v_mfma_f32_16x16x32_bf16 a[12:15], v[68:71], v[252:255], a[12:15]
    ds_read_b64_tr_b16 v[62:63], v24 offset:56160
    s_waitcnt lgkmcnt(8)
    v_mfma_f32_16x16x32_bf16 a[16:19], v[72:75], v[248:251], a[16:19]
    ds_read_b64_tr_b16 v[64:65], v23 offset:49280
    v_mfma_f32_16x16x32_bf16 a[20:23], v[72:75], v[252:255], a[20:23]
    ds_read_b64_tr_b16 v[66:67], v23 offset:50048
    v_mfma_f32_16x16x32_bf16 a[24:27], v[76:79], v[248:251], a[24:27]
    ds_read_b64_tr_b16 v[68:69], v23 offset:55424
    v_mfma_f32_16x16x32_bf16 a[28:31], v[76:79], v[252:255], a[28:31]
    ds_read_b64_tr_b16 v[70:71], v23 offset:56192
    s_waitcnt lgkmcnt(8)
    v_mfma_f32_16x16x32_bf16 a[32:35], v[48:51], v[248:251], a[32:35]
    ds_read_b64_tr_b16 v[72:73], v24 offset:49312
    v_mfma_f32_16x16x32_bf16 a[36:39], v[48:51], v[252:255], a[36:39]
    ds_read_b64_tr_b16 v[74:75], v24 offset:50080
    v_mfma_f32_16x16x32_bf16 a[40:43], v[52:55], v[248:251], a[40:43]
    ds_read_b64_tr_b16 v[76:77], v24 offset:55456
    buffer_store_dwordx4 v[100:103], v29, s[12:15], s63 offen offset:1024 sc1
    v_mfma_f32_16x16x32_bf16 a[44:47], v[52:55], v[252:255], a[44:47]
    ds_read_b64_tr_b16 v[78:79], v24 offset:56224
    s_waitcnt lgkmcnt(8)
    v_mfma_f32_16x16x32_bf16 a[48:51], v[56:59], v[248:251], a[48:51]
    v_mfma_f32_16x16x32_bf16 a[52:55], v[56:59], v[252:255], a[52:55]
    v_mfma_f32_16x16x32_bf16 a[56:59], v[60:63], v[248:251], a[56:59]
    v_mfma_f32_16x16x32_bf16 a[60:63], v[60:63], v[252:255], a[60:63]
    s_waitcnt lgkmcnt(4)
    v_mfma_f32_16x16x32_bf16 a[64:67], v[64:67], v[248:251], a[64:67]
    v_mfma_f32_16x16x32_bf16 a[68:71], v[64:67], v[252:255], a[68:71]
    v_mfma_f32_16x16x32_bf16 a[72:75], v[68:71], v[248:251], a[72:75]
    v_mfma_f32_16x16x32_bf16 a[76:79], v[68:71], v[252:255], a[76:79]
    s_waitcnt lgkmcnt(0)
    v_mfma_f32_16x16x32_bf16 a[80:83], v[72:75], v[248:251], a[80:83]
    v_mfma_f32_16x16x32_bf16 a[84:87], v[72:75], v[252:255], a[84:87]
    v_mfma_f32_16x16x32_bf16 a[88:91], v[76:79], v[248:251], a[88:91]
    v_mfma_f32_16x16x32_bf16 a[92:95], v[76:79], v[252:255], a[92:95]
    s_cmp_eq_u32 s94, 2
    s_cbranch_scc0 L1_CKG
    v_cmp_gt_u32 vcc, 192, v104
    s_nop 4
    s_cbranch_vccnz L1_SLOWCK
    v_cmp_gt_u32 vcc, 64, v105
    s_nop 4
    s_cbranch_vccz L1_NOCK
L1_SLOWCK:
    s_mov_b32 s93, 262144
    v_mov_b32 v88, 0
L1_CKZ:
    global_load_dword v89, v88, s[90:91] sc1
    s_waitcnt vmcnt(0)
    v_cmp_gt_u32 vcc, 192, v89
    s_nop 4
    s_cbranch_vccz L1_CKZ_OK
    s_sleep 1
    s_sub_u32 s93, s93, 1
    s_cmp_lg_u32 s93, 0
    s_cbranch_scc1 L1_CKZ
L1_CKZ_OK:
    s_mov_b32 s93, 262144
    v_mov_b32 v88, 64
L1_CKW:
    global_load_dword v89, v88, s[90:91] sc1
    s_waitcnt vmcnt(0)
    v_cmp_gt_u32 vcc, 64, v89
    s_nop 4
    s_cbranch_vccz L1_CKW_OK
    s_sleep 1
    s_sub_u32 s93, s93, 1
    s_cmp_lg_u32 s93, 0
    s_cbranch_scc1 L1_CKW
L1_CKW_OK:
    s_branch L1_NOCK
L1_CKG:
    v_cmp_ne_u32 vcc, s101, v104
    s_nop 4
    s_cbranch_vccz L1_NOCK
    s_mov_b32 s93, 262144
L1_CKF0:
    buffer_load_dword v88, v106, s[12:15], 0 offen sc1
    s_waitcnt vmcnt(0)
    v_xor_b32 v88, s101, v88
    v_cmp_ne_u32 vcc, 0, v88
    s_nop 4
    s_cbranch_vccz L1_CKF0_OK
    s_sleep 1
    s_sub_u32 s93, s93, 1
    s_cmp_lg_u32 s93, 0
    s_cbranch_scc1 L1_CKF0
L1_CKF0_OK:
L1_NOCK:
    s_nop 7
    v_accvgpr_read_b32 v80, a0
    v_accvgpr_read_b32 v81, a1
    v_accvgpr_read_b32 v82, a2
    v_accvgpr_read_b32 v83, a3
    v_accvgpr_read_b32 v84, a8
    v_accvgpr_read_b32 v85, a9
    v_accvgpr_read_b32 v86, a10
    v_accvgpr_read_b32 v87, a11
    v_mul_f32 v80, v80, v30
    v_mul_f32 v81, v81, v30
    v_mul_f32 v82, v82, v30
    v_mul_f32 v83, v83, v30
    v_mul_f32 v80, v80, v84
    v_mul_f32 v81, v81, v85
    v_mul_f32 v82, v82, v86
    v_mul_f32 v83, v83, v87
    v_cvt_pk_bf16_f32 v96, v80, v81
    v_cvt_pk_bf16_f32 v97, v82, v83
    v_accvgpr_read_b32 v80, a16
    v_accvgpr_read_b32 v81, a17
    v_accvgpr_read_b32 v82, a18
    v_accvgpr_read_b32 v83, a19
    v_accvgpr_read_b32 v84, a24
    v_accvgpr_read_b32 v85, a25
    v_accvgpr_read_b32 v86, a26
    v_accvgpr_read_b32 v87, a27
    v_mul_f32 v80, v80, v30
    v_mul_f32 v81, v81, v30
    v_mul_f32 v82, v82, v30
    v_mul_f32 v83, v83, v30
    v_mul_f32 v80, v80, v84
    v_mul_f32 v81, v81, v85
    v_mul_f32 v82, v82, v86
    v_mul_f32 v83, v83, v87
    v_cvt_pk_bf16_f32 v98, v80, v81
    v_cvt_pk_bf16_f32 v99, v82, v83
    s_add_u32 s61, s43, 49152
    buffer_store_dwordx4 v[96:99], v29, s[12:15], s61 offen offset:0 sc1
    v_accvgpr_read_b32 v80, a4
    v_accvgpr_read_b32 v81, a5
    v_accvgpr_read_b32 v82, a6
    v_accvgpr_read_b32 v83, a7
    v_accvgpr_read_b32 v84, a12
    v_accvgpr_read_b32 v85, a13
    v_accvgpr_read_b32 v86, a14
    v_accvgpr_read_b32 v87, a15
    v_mul_f32 v80, v80, v31
    v_mul_f32 v81, v81, v31
    v_mul_f32 v82, v82, v31
    v_mul_f32 v83, v83, v31
    v_mul_f32 v80, v80, v84
    v_mul_f32 v81, v81, v85
    v_mul_f32 v82, v82, v86
    v_mul_f32 v83, v83, v87
    v_cvt_pk_bf16_f32 v100, v80, v81
    v_cvt_pk_bf16_f32 v101, v82, v83
    v_accvgpr_read_b32 v80, a20
    v_accvgpr_read_b32 v81, a21
    v_accvgpr_read_b32 v82, a22
    v_accvgpr_read_b32 v83, a23
    v_accvgpr_read_b32 v84, a28
    v_accvgpr_read_b32 v85, a29
    v_accvgpr_read_b32 v86, a30
    v_accvgpr_read_b32 v87, a31
    v_mul_f32 v80, v80, v31
    v_mul_f32 v81, v81, v31
    v_mul_f32 v82, v82, v31
    v_mul_f32 v83, v83, v31
    v_mul_f32 v80, v80, v84
    v_mul_f32 v81, v81, v85
    v_mul_f32 v82, v82, v86
    v_mul_f32 v83, v83, v87
    v_cvt_pk_bf16_f32 v102, v80, v81
    v_cvt_pk_bf16_f32 v103, v82, v83
    buffer_store_dwordx4 v[100:103], v29, s[12:15], s61 offen offset:1024 sc1
    v_accvgpr_read_b32 v80, a32
    v_accvgpr_read_b32 v81, a33
    v_accvgpr_read_b32 v82, a34
    v_accvgpr_read_b32 v83, a35
    v_accvgpr_read_b32 v84, a40
    v_accvgpr_read_b32 v85, a41
    v_accvgpr_read_b32 v86, a42
    v_accvgpr_read_b32 v87, a43
    v_mul_f32 v80, v80, v30
    v_mul_f32 v81, v81, v30
    v_mul_f32 v82, v82, v30
    v_mul_f32 v83, v83, v30
    v_mul_f32 v80, v80, v84
    v_mul_f32 v81, v81, v85
    v_mul_f32 v82, v82, v86
    v_mul_f32 v83, v83, v87
    v_cvt_pk_bf16_f32 v96, v80, v81
    v_cvt_pk_bf16_f32 v97, v82, v83
    v_accvgpr_read_b32 v80, a48
    v_accvgpr_read_b32 v81, a49
    v_accvgpr_read_b32 v82, a50
    v_accvgpr_read_b32 v83, a51
    v_accvgpr_read_b32 v84, a56
    v_accvgpr_read_b32 v85, a57
    v_accvgpr_read_b32 v86, a58
    v_accvgpr_read_b32 v87, a59
    v_mul_f32 v80, v80, v30
    v_mul_f32 v81, v81, v30
    v_mul_f32 v82, v82, v30
    v_mul_f32 v83, v83, v30
    v_mul_f32 v80, v80, v84
    v_mul_f32 v81, v81, v85
    v_mul_f32 v82, v82, v86
    v_mul_f32 v83, v83, v87
    v_cvt_pk_bf16_f32 v98, v80, v81
    v_cvt_pk_bf16_f32 v99, v82, v83
    s_add_u32 s63, s43, 57344
    buffer_store_dwordx4 v[96:99], v29, s[12:15], s63 offen offset:0 sc1
    v_accvgpr_read_b32 v80, a36
    v_accvgpr_read_b32 v81, a37
    v_accvgpr_read_b32 v82, a38
    v_accvgpr_read_b32 v83, a39
    v_accvgpr_read_b32 v84, a44
    v_accvgpr_read_b32 v85, a45
    v_accvgpr_read_b32 v86, a46
    v_accvgpr_read_b32 v87, a47
    v_mul_f32 v80, v80, v31
    v_mul_f32 v81, v81, v31
    v_mul_f32 v82, v82, v31
    v_mul_f32 v83, v83, v31
    v_mul_f32 v80, v80, v84
    v_mul_f32 v81, v81, v85
    v_mul_f32 v82, v82, v86
    v_mul_f32 v83, v83, v87
    v_cvt_pk_bf16_f32 v100, v80, v81
    v_cvt_pk_bf16_f32 v101, v82, v83
    v_accvgpr_read_b32 v80, a52
    v_accvgpr_read_b32 v81, a53
    v_accvgpr_read_b32 v82, a54
    v_accvgpr_read_b32 v83, a55
    v_accvgpr_read_b32 v84, a60
    v_accvgpr_read_b32 v85, a61
    v_accvgpr_read_b32 v86, a62
    v_accvgpr_read_b32 v87, a63
    v_mul_f32 v80, v80, v31
    v_mul_f32 v81, v81, v31
    v_mul_f32 v82, v82, v31
    v_mul_f32 v83, v83, v31
    v_mul_f32 v80, v80, v84
    v_mul_f32 v81, v81, v85
    v_mul_f32 v82, v82, v86
    v_mul_f32 v83, v83, v87
    v_cvt_pk_bf16_f32 v102, v80, v81
    v_cvt_pk_bf16_f32 v103, v82, v83
    buffer_store_dwordx4 v[100:103], v29, s[12:15], s63 offen offset:1024 sc1
    v_accvgpr_read_b32 v80, a64
    v_accvgpr_read_b32 v81, a65
    v_accvgpr_read_b32 v82, a66
    v_accvgpr_read_b32 v83, a67
    v_accvgpr_read_b32 v84, a72
    v_accvgpr_read_b32 v85, a73
    v_accvgpr_read_b32 v86, a74
    v_accvgpr_read_b32 v87, a75
    v_mul_f32 v80, v80, v30
    v_mul_f32 v81, v81, v30
    v_mul_f32 v82, v82, v30
    v_mul_f32 v83, v83, v30
    v_mul_f32 v80, v80, v84
    v_mul_f32 v81, v81, v85
    v_mul_f32 v82, v82, v86
    v_mul_f32 v83, v83, v87
    v_cvt_pk_bf16_f32 v96, v80, v81
    v_cvt_pk_bf16_f32 v97, v82, v83
    v_accvgpr_read_b32 v80, a80
    v_accvgpr_read_b32 v81, a81
    v_accvgpr_read_b32 v82, a82
    v_accvgpr_read_b32 v83, a83
    v_accvgpr_read_b32 v84, a88
    v_accvgpr_read_b32 v85, a89
    v_accvgpr_read_b32 v86, a90
    v_accvgpr_read_b32 v87, a91
    v_mul_f32 v80, v80, v30
    v_mul_f32 v81, v81, v30
    v_mul_f32 v82, v82, v30
    v_mul_f32 v83, v83, v30
    v_mul_f32 v80, v80, v84
    v_mul_f32 v81, v81, v85
    v_mul_f32 v82, v82, v86
    v_mul_f32 v83, v83, v87
    v_cvt_pk_bf16_f32 v98, v80, v81
    v_cvt_pk_bf16_f32 v99, v82, v83
    s_add_u32 s61, s43, 65536
    buffer_store_dwordx4 v[96:99], v29, s[12:15], s61 offen offset:0 sc1
    v_accvgpr_read_b32 v80, a68
    v_accvgpr_read_b32 v81, a69
    v_accvgpr_read_b32 v82, a70
    v_accvgpr_read_b32 v83, a71
    v_accvgpr_read_b32 v84, a76
    v_accvgpr_read_b32 v85, a77
    v_accvgpr_read_b32 v86, a78
    v_accvgpr_read_b32 v87, a79
    v_mul_f32 v80, v80, v31
    v_mul_f32 v81, v81, v31
    v_mul_f32 v82, v82, v31
    v_mul_f32 v83, v83, v31
    v_mul_f32 v80, v80, v84
    v_mul_f32 v81, v81, v85
    v_mul_f32 v82, v82, v86
    v_mul_f32 v83, v83, v87
    v_cvt_pk_bf16_f32 v100, v80, v81
    v_cvt_pk_bf16_f32 v101, v82, v83
    v_accvgpr_read_b32 v80, a84
    v_accvgpr_read_b32 v81, a85
    v_accvgpr_read_b32 v82, a86
    v_accvgpr_read_b32 v83, a87
    v_accvgpr_read_b32 v84, a92
    v_accvgpr_read_b32 v85, a93
    v_accvgpr_read_b32 v86, a94
    v_accvgpr_read_b32 v87, a95
    v_mul_f32 v80, v80, v31
    v_mul_f32 v81, v81, v31
    v_mul_f32 v82, v82, v31
    v_mul_f32 v83, v83, v31
    v_mul_f32 v80, v80, v84
    v_mul_f32 v81, v81, v85
    v_mul_f32 v82, v82, v86
    v_mul_f32 v83, v83, v87
    v_cvt_pk_bf16_f32 v102, v80, v81
    v_cvt_pk_bf16_f32 v103, v82, v83
    buffer_store_dwordx4 v[100:103], v29, s[12:15], s61 offen offset:1024 sc1
    s_cmp_eq_u32 s94, 2
    s_cbranch_scc1 F_ENTRY
    s_branch G2_ENTRY
L1_END:
    s_endpgm
G2_ENTRY:
    s_load_dwordx2 s[48:49], s[0:1], 48
    s_load_dwordx2 s[30:31], s[0:1], 64
    s_bfe_u32 s18, s2, 0x20003
    s_min_u32 s18, s18, 2
    s_lshr_b32 s47, s2, 5
    s_mul_i32 s42, s47, 3
    s_add_u32 s42, s42, s18
    s_getpc_b64 s[40:41]
G2_PCT:
    s_mul_i32 s42, s42, 144
    s_add_u32 s42, s42, G2_TAB-G2_PCT
    s_add_u32 s40, s40, s42
    s_addc_u32 s41, s41, 0
    s_load_dwordx16 s[52:67], s[40:41], 0
    s_load_dwordx16 s[68:83], s[40:41], 64
    s_load_dwordx4 s[84:87], s[40:41], 128
    s_and_b32 s45, s2, 7
    s_and_b32 s19, s45, 3
    s_lshr_b32 s17, s45, 2
    s_lshl_b32 s17, s17, 3
    s_add_u32 s17, s17, s47
    v_lshlrev_b32 v32, 4, v0
    s_mul_i32 s26, s19, 1152
    s_lshl_b32 s45, s16, 3
    s_add_u32 s26, s26, s45
    s_mul_i32 s26, s26, 1152
    s_mul_i32 s45, s18, 384
    s_add_u32 s26, s26, s45
    s_mul_i32 s27, s17, 144
    s_mul_i32 s45, s19, 36
    s_add_u32 s27, s27, s45
    s_lshl_b32 s27, s27, 3
    s_lshl_b32 s45, s16, 1
    s_add_u32 s27, s27, s45
    s_lshl_b32 s27, s27, 10
    s_add_u32 s27, s27, 0
    s_mul_i32 s21, s16, 3072
    s_add_u32 s32, s21, 0
    s_add_u32 s33, s21, 12288
    s_add_u32 s34, s21, 24576
    s_add_u32 s35, s21, 36864
    s_add_u32 s36, s21, 49152
    s_add_u32 s37, s21, 61440
    s_add_u32 s38, s21, 73728
    v_add_u32 v1, 0, v0
    v_mul_u32_u24 v2, 2731, v1
    v_lshrrev_b32 v2, 16, v2
    v_mul_u32_u24 v3, 24, v2
    v_sub_u32 v3, v1, v3
    v_bfe_u32 v4, v2, 1, 2
    v_lshrrev_b32 v5, 1, v3
    v_xor_b32 v5, v5, v4
    v_and_b32 v3, 1, v3
    v_lshlrev_b32 v5, 5, v5
    v_lshlrev_b32 v3, 4, v3
    v_mul_u32_u24 v2, 1152, v2
    v_add3_u32 v2, v2, v5, v3
    v_subrev_u32 v20, 0, v2
    v_add_u32 v1, 64, v0
    v_mul_u32_u24 v2, 2731, v1
    v_lshrrev_b32 v2, 16, v2
    v_mul_u32_u24 v3, 24, v2
    v_sub_u32 v3, v1, v3
    v_bfe_u32 v4, v2, 1, 2
    v_lshrrev_b32 v5, 1, v3
    v_xor_b32 v5, v5, v4
    v_and_b32 v3, 1, v3
    v_lshlrev_b32 v5, 5, v5
    v_lshlrev_b32 v3, 4, v3
    v_mul_u32_u24 v2, 1152, v2
    v_add3_u32 v2, v2, v5, v3
    v_subrev_u32 v21, 1024, v2
    v_add_u32 v1, 128, v0
    v_mul_u32_u24 v2, 2731, v1
    v_lshrrev_b32 v2, 16, v2
    v_mul_u32_u24 v3, 24, v2
    v_sub_u32 v3, v1, v3
    v_bfe_u32 v4, v2, 1, 2
    v_lshrrev_b32 v5, 1, v3
    v_xor_b32 v5, v5, v4
    v_and_b32 v3, 1, v3
    v_lshlrev_b32 v5, 5, v5
    v_lshlrev_b32 v3, 4, v3
    v_mul_u32_u24 v2, 1152, v2
    v_add3_u32 v2, v2, v5, v3
    v_subrev_u32 v22, 2048, v2
    s_waitcnt lgkmcnt(0)
    s_barrier
    s_add_u32 s8, s48, s26
    s_addc_u32 s9, s49, 0
    s_sub_u32 s10, 5308416, s26
    s_mov_b32 s11, 0x00020000
    s_add_u32 s4, s12, s27
    s_addc_u32 s5, s13, 0
    s_sub_u32 s6, 268435456, s27
    s_mov_b32 s7, 0x00020000
    s_mov_b32 m0, s32
    s_mul_i32 s22, s52, 36864
    buffer_load_dwordx4 v20, s[8:11], s22 offen offset:0 lds
    buffer_load_dwordx4 v21, s[8:11], s22 offen offset:1024 lds
    buffer_load_dwordx4 v22, s[8:11], s22 offen offset:2048 lds
    s_mov_b32 m0, s33
    s_mul_i32 s22, s53, 36864
    buffer_load_dwordx4 v20, s[8:11], s22 offen offset:0 lds
    buffer_load_dwordx4 v21, s[8:11], s22 offen offset:1024 lds
    buffer_load_dwordx4 v22, s[8:11], s22 offen offset:2048 lds
    s_mov_b32 m0, s34
    s_mul_i32 s22, s54, 36864
    buffer_load_dwordx4 v20, s[8:11], s22 offen offset:0 lds
    buffer_load_dwordx4 v21, s[8:11], s22 offen offset:1024 lds
    buffer_load_dwordx4 v22, s[8:11], s22 offen offset:2048 lds
    s_mov_b32 m0, s35
    s_mul_i32 s22, s55, 36864
    buffer_load_dwordx4 v20, s[8:11], s22 offen offset:0 lds
    buffer_load_dwordx4 v21, s[8:11], s22 offen offset:1024 lds
    buffer_load_dwordx4 v22, s[8:11], s22 offen offset:2048 lds
    s_lshr_b32 s45, s2, 5
    s_lshl_b32 s45, s45, 5
    s_and_b32 s46, s2, 7
    s_add_u32 s45, s45, s46
    v_and_b32 v39, 3, v0
    v_cmp_eq_u32 vcc, 2, v39
    v_mov_b32 v43, 0
    s_add_u32 s46, s45, 16
    v_cndmask_b32 v39, v39, v43, vcc
    v_lshlrev_b32 v39, 3, v39
    v_add_u32 v39, s45, v39
    v_lshlrev_b32 v39, 7, v39
    v_add_u32 v39, 36700160, v39
    s_lshl_b32 s46, s46, 7
    s_add_u32 s46, s46, 36700160
    v_mov_b32 v37, s46
    s_lshl_b32 s43, s2, 7
    s_add_u32 s43, s43, 36700160
    s_lshl_b32 s23, s52, 13
    buffer_load_dwordx4 v[80:83], v32, s[4:7], s23 offen offset:0 sc1
    buffer_load_dwordx4 v[84:87], v32, s[4:7], s23 offen offset:1024 sc1
    s_lshl_b32 s23, s53, 13
    buffer_load_dwordx4 v[88:91], v32, s[4:7], s23 offen offset:0 sc1
    buffer_load_dwordx4 v[92:95], v32, s[4:7], s23 offen offset:1024 sc1
    s_lshl_b32 s23, s54, 13
    buffer_load_dwordx4 v[96:99], v32, s[4:7], s23 offen offset:0 sc1
    buffer_load_dwordx4 v[100:103], v32, s[4:7], s23 offen offset:1024 sc1
    s_lshl_b32 s23, s55, 13
    buffer_load_dwordx4 v[104:107], v32, s[4:7], s23 offen offset:0 sc1
    buffer_load_dwordx4 v[108:111], v32, s[4:7], s23 offen offset:1024 sc1
    v_lshrrev_b32 v1, 4, v0
    v_bfe_u32 v2, v0, 2, 2
    v_lshlrev_b32 v3, 2, v1
    v_add_u32 v3, v3, v2
    v_mul_u32_u24 v3, 384, v3
    v_and_b32 v4, 3, v0
    v_lshlrev_b32 v4, 3, v4
    v_add_u32 v3, v3, v4
    v_and_b32 v4, 1, v1
    v_lshlrev_b32 v4, 1, v4
    v_lshrrev_b32 v5, 1, v2
    v_add_u32 v4, v4, v5
    v_xor_b32 v5, 0, v4
    v_lshlrev_b32 v5, 5, v5
    v_add_u32 v24, v3, v5
    v_add_u32 v28, 61440, v24
    v_xor_b32 v5, 1, v4
    v_lshlrev_b32 v5, 5, v5
    v_add_u32 v25, v3, v5
    v_add_u32 v29, 61440, v25
    v_xor_b32 v5, 2, v4
    v_lshlrev_b32 v5, 5, v5
    v_add_u32 v26, v3, v5
    v_add_u32 v30, 61440, v26
    v_xor_b32 v5, 3, v4
    v_lshlrev_b32 v5, 5, v5
    v_add_u32 v27, v3, v5
    v_add_u32 v31, 61440, v27
    s_lshl_b32 s29, s19, 4
    s_add_u32 s29, s29, s17
    s_lshl_b32 s29, s29, 2
    s_add_u32 s29, s29, s16
    s_mul_i32 s29, s29, 36
    s_mul_i32 s45, s18, 12
    s_add_u32 s29, s29, s45
    s_lshl_b32 s29, s29, 10
    s_add_u32 s29, s29, 26869760
    s_mul_i32 s24, s19, 144
    s_mul_i32 s45, s18, 12
    s_add_u32 s24, s24, s45
    s_lshl_b32 s24, s24, 10
    s_mul_i32 s45, s16, 3072
    s_add_u32 s24, s24, s45
    s_add_u32 s24, s24, 23658496
    s_lshl_b32 s20, s17, 3
    s_lshl_b32 s45, s16, 1
    s_add_u32 s20, s20, s45
    s_mul_i32 s20, s20, 19456
    s_lshl_b32 s45, s19, 12
    s_add_u32 s20, s20, s45
    s_add_u32 s20, s20, 24379392
    s_add_u32 s45, s19, 15
    s_mul_i32 s25, s45, 36
    s_mul_i32 s46, s18, 12
    s_add_u32 s25, s25, s46
    s_lshl_b32 s25, s25, 10
    s_mul_i32 s46, s16, 3072
    s_add_u32 s25, s25, s46
    s_add_u32 s25, s25, 23658496
    s_lshl_b32 s28, s19, 12
    s_sub_u32 s28, s20, s28
    s_lshl_b32 s45, s45, 10
    s_add_u32 s28, s28, s45
    s_cmp_eq_u32 s19, 0
    s_cselect_b32 s28, 0x10000000, s28
    v_add_u32 v33, 19456, v32
    v_add_u32 v34, 61440, v32
    v_mov_b32 v36, 128
    v_mov_b32 v44, 192
    s_mul_i32 s44, s18, 12
    s_mul_i32 s45, s19, 3
    s_add_u32 s44, s44, s45
    s_add_u32 s46, s44, 576
    s_lshl_b32 s46, s46, 10
    s_add_u32 s46, s46, 23658496
    s_lshl_b32 s45, s17, 2
    s_add_u32 s45, s45, s16
    s_mul_i32 s47, s45, 36864
    s_lshl_b32 s45, s44, 5
    s_add_u32 s47, s47, s45
    s_mul_i32 s21, s16, 3072
    s_add_u32 s21, s21, 95232
    v_and_b32 v6, 15, v0
    v_bfe_u32 v7, v0, 4, 1
    v_lshlrev_b32 v7, 4, v7
    v_add_u32 v6, v6, v7
    v_mul_u32_u24 v6, 1152, v6
    v_lshrrev_b32 v7, 5, v0
    v_lshlrev_b32 v7, 4, v7
    v_add_u32 v8, v6, v7
    s_load_dwordx2 s[92:93], s[0:1], 0
    s_waitcnt lgkmcnt(0)
    s_waitcnt vmcnt(17)
    s_barrier
    ds_read_b64_tr_b16 v[48:49], v24 offset:0
    ds_read_b64_tr_b16 v[50:51], v24 offset:6144
    ds_read_b64_tr_b16 v[52:53], v25 offset:0
    ds_read_b64_tr_b16 v[54:55], v25 offset:6144
    ds_read_b64_tr_b16 v[56:57], v26 offset:0
    ds_read_b64_tr_b16 v[58:59], v26 offset:6144
    ds_read_b64_tr_b16 v[60:61], v27 offset:0
    ds_read_b64_tr_b16 v[62:63], v27 offset:6144
    ds_read_b64_tr_b16 v[64:65], v24 offset:128
    ds_read_b64_tr_b16 v[66:67], v24 offset:6272
    ds_read_b64_tr_b16 v[68:69], v25 offset:128
    ds_read_b64_tr_b16 v[70:71], v25 offset:6272
    s_waitcnt vmcnt(6)
    s_waitcnt lgkmcnt(8)
    v_mfma_f32_16x16x32_bf16 v[136:139], v[48:51], v[80:83], 0
    ds_read_b64_tr_b16 v[72:73], v26 offset:128
    s_mul_i32 s22, s56, 36864
    v_mfma_f32_16x16x32_bf16 v[140:143], v[48:51], v[84:87], 0
    ds_read_b64_tr_b16 v[74:75], v26 offset:6272
    s_mov_b32 m0, s36
    v_mfma_f32_16x16x32_bf16 v[144:147], v[52:55], v[80:83], 0
    ds_read_b64_tr_b16 v[76:77], v27 offset:128
    buffer_load_dwordx4 v20, s[8:11], s22 offen offset:0 lds
    v_mfma_f32_16x16x32_bf16 v[148:151], v[52:55], v[84:87], 0
    ds_read_b64_tr_b16 v[78:79], v27 offset:6272
    s_waitcnt lgkmcnt(8)
    v_mfma_f32_16x16x32_bf16 v[152:155], v[56:59], v[80:83], 0
    ds_read_b64_tr_b16 v[48:49], v24 offset:256
    buffer_load_dwordx4 v21, s[8:11], s22 offen offset:1024 lds
    v_mfma_f32_16x16x32_bf16 v[156:159], v[56:59], v[84:87], 0
    ds_read_b64_tr_b16 v[50:51], v24 offset:6400
    v_mfma_f32_16x16x32_bf16 v[160:163], v[60:63], v[80:83], 0
    ds_read_b64_tr_b16 v[52:53], v25 offset:256
    buffer_load_dwordx4 v22, s[8:11], s22 offen offset:2048 lds
    v_mfma_f32_16x16x32_bf16 v[164:167], v[60:63], v[84:87], 0
    ds_read_b64_tr_b16 v[54:55], v25 offset:6400
    s_waitcnt lgkmcnt(8)
    v_mfma_f32_16x16x32_bf16 v[168:171], v[64:67], v[80:83], 0
    ds_read_b64_tr_b16 v[56:57], v26 offset:256
    v_mfma_f32_16x16x32_bf16 v[172:175], v[64:67], v[84:87], 0
    ds_read_b64_tr_b16 v[58:59], v26 offset:6400
    v_mfma_f32_16x16x32_bf16 v[176:179], v[68:71], v[80:83], 0
    ds_read_b64_tr_b16 v[60:61], v27 offset:256
    s_barrier
    v_mfma_f32_16x16x32_bf16 v[180:183], v[68:71], v[84:87], 0
    ds_read_b64_tr_b16 v[62:63], v27 offset:6400
    s_waitcnt lgkmcnt(8)
    v_mfma_f32_16x16x32_bf16 v[184:187], v[72:75], v[80:83], 0
    ds_read_b64_tr_b16 v[64:65], v24 offset:12288
    v_mfma_f32_16x16x32_bf16 v[188:191], v[72:75], v[84:87], 0
    ds_read_b64_tr_b16 v[66:67], v24 offset:18432
    s_cmp_eq_u32 s16, 0
    s_cbranch_scc0 G2_SIG1
    v_mov_b32 v41, s43
    v_mov_b32 v42, s101
    s_mov_b64 exec, 1
    buffer_store_dword v42, v41, s[12:15], 0 offen sc1
    s_mov_b64 exec, -1
G2_SIG1:
    v_mfma_f32_16x16x32_bf16 v[192:195], v[76:79], v[80:83], 0
    ds_read_b64_tr_b16 v[68:69], v25 offset:12288
    v_mfma_f32_16x16x32_bf16 v[196:199], v[76:79], v[84:87], 0
    ds_read_b64_tr_b16 v[70:71], v25 offset:18432
    s_waitcnt lgkmcnt(8)
    v_mfma_f32_16x16x32_bf16 v[200:203], v[48:51], v[80:83], 0
    ds_read_b64_tr_b16 v[72:73], v26 offset:12288
    v_mfma_f32_16x16x32_bf16 v[204:207], v[48:51], v[84:87], 0
    ds_read_b64_tr_b16 v[74:75], v26 offset:18432
    v_mfma_f32_16x16x32_bf16 v[208:211], v[52:55], v[80:83], 0
    ds_read_b64_tr_b16 v[76:77], v27 offset:12288
    v_mfma_f32_16x16x32_bf16 v[212:215], v[52:55], v[84:87], 0
    ds_read_b64_tr_b16 v[78:79], v27 offset:18432
    s_waitcnt lgkmcnt(8)
    v_mfma_f32_16x16x32_bf16 v[216:219], v[56:59], v[80:83], 0
    ds_read_b64_tr_b16 v[48:49], v24 offset:12416
    v_mfma_f32_16x16x32_bf16 v[220:223], v[56:59], v[84:87], 0
    ds_read_b64_tr_b16 v[50:51], v24 offset:18560
    s_waitcnt vmcnt(7)
    v_mfma_f32_16x16x32_bf16 v[224:227], v[60:63], v[80:83], 0
    ds_read_b64_tr_b16 v[52:53], v25 offset:12416
    v_mfma_f32_16x16x32_bf16 v[228:231], v[60:63], v[84:87], 0
    ds_read_b64_tr_b16 v[54:55], v25 offset:18560
    s_waitcnt lgkmcnt(8)
    v_mfma_f32_16x16x32_bf16 v[136:139], v[64:67], v[88:91], v[136:139]
    ds_read_b64_tr_b16 v[56:57], v26 offset:12416
    s_lshl_b32 s23, s56, 13
    v_mfma_f32_16x16x32_bf16 v[140:143], v[64:67], v[92:95], v[140:143]
    ds_read_b64_tr_b16 v[58:59], v26 offset:18560
    buffer_load_dwordx4 v[112:115], v32, s[4:7], s23 offen offset:0 sc1
    v_mfma_f32_16x16x32_bf16 v[144:147], v[68:71], v[88:91], v[144:147]
    ds_read_b64_tr_b16 v[60:61], v27 offset:12416
    v_mfma_f32_16x16x32_bf16 v[148:151], v[68:71], v[92:95], v[148:151]
    ds_read_b64_tr_b16 v[62:63], v27 offset:18560
    s_waitcnt lgkmcnt(8)
    v_mfma_f32_16x16x32_bf16 v[152:155], v[72:75], v[88:91], v[152:155]
    ds_read_b64_tr_b16 v[64:65], v24 offset:12544
    buffer_load_dwordx4 v[116:119], v32, s[4:7], s23 offen offset:1024 sc1
    v_mfma_f32_16x16x32_bf16 v[156:159], v[72:75], v[92:95], v[156:159]
    ds_read_b64_tr_b16 v[66:67], v24 offset:18688
    s_mul_i32 s22, s57, 36864
    v_mfma_f32_16x16x32_bf16 v[160:163], v[76:79], v[88:91], v[160:163]
    ds_read_b64_tr_b16 v[68:69], v25 offset:12544
    s_mov_b32 m0, s37
    v_mfma_f32_16x16x32_bf16 v[164:167], v[76:79], v[92:95], v[164:167]
    ds_read_b64_tr_b16 v[70:71], v25 offset:18688
    s_waitcnt lgkmcnt(8)
    v_mfma_f32_16x16x32_bf16 v[168:171], v[48:51], v[88:91], v[168:171]
    ds_read_b64_tr_b16 v[72:73], v26 offset:12544
    buffer_load_dwordx4 v20, s[8:11], s22 offen offset:0 lds
    v_mfma_f32_16x16x32_bf16 v[172:175], v[48:51], v[92:95], v[172:175]
    ds_read_b64_tr_b16 v[74:75], v26 offset:18688
    v_mfma_f32_16x16x32_bf16 v[176:179], v[52:55], v[88:91], v[176:179]
    ds_read_b64_tr_b16 v[76:77], v27 offset:12544
    buffer_load_dwordx4 v21, s[8:11], s22 offen offset:1024 lds
    v_mfma_f32_16x16x32_bf16 v[180:183], v[52:55], v[92:95], v[180:183]
    ds_read_b64_tr_b16 v[78:79], v27 offset:18688
    s_waitcnt lgkmcnt(8)
    v_mfma_f32_16x16x32_bf16 v[184:187], v[56:59], v[88:91], v[184:187]
    ds_read_b64_tr_b16 v[48:49], v24 offset:24576
    buffer_load_dwordx4 v22, s[8:11], s22 offen offset:2048 lds
    v_mfma_f32_16x16x32_bf16 v[188:191], v[56:59], v[92:95], v[188:191]
    ds_read_b64_tr_b16 v[50:51], v24 offset:30720
    v_mfma_f32_16x16x32_bf16 v[192:195], v[60:63], v[88:91], v[192:195]
    ds_read_b64_tr_b16 v[52:53], v25 offset:24576
    v_mfma_f32_16x16x32_bf16 v[196:199], v[60:63], v[92:95], v[196:199]
    ds_read_b64_tr_b16 v[54:55], v25 offset:30720
    s_waitcnt lgkmcnt(8)
    v_mfma_f32_16x16x32_bf16 v[200:203], v[64:67], v[88:91], v[200:203]
    ds_read_b64_tr_b16 v[56:57], v26 offset:24576
    v_mfma_f32_16x16x32_bf16 v[204:207], v[64:67], v[92:95], v[204:207]
    ds_read_b64_tr_b16 v[58:59], v26 offset:30720
    v_mfma_f32_16x16x32_bf16 v[208:211], v[68:71], v[88:91], v[208:211]
    ds_read_b64_tr_b16 v[60:61], v27 offset:24576
    v_mfma_f32_16x16x32_bf16 v[212:215], v[68:71], v[92:95], v[212:215]
    ds_read_b64_tr_b16 v[62:63], v27 offset:30720
    s_waitcnt lgkmcnt(8)
    v_mfma_f32_16x16x32_bf16 v[216:219], v[72:75], v[88:91], v[216:219]
    ds_read_b64_tr_b16 v[64:65], v24 offset:24704
    v_mfma_f32_16x16x32_bf16 v[220:223], v[72:75], v[92:95], v[220:223]
    ds_read_b64_tr_b16 v[66:67], v24 offset:30848
    s_waitcnt vmcnt(10)
    v_mfma_f32_16x16x32_bf16 v[224:227], v[76:79], v[88:91], v[224:227]
    ds_read_b64_tr_b16 v[68:69], v25 offset:24704
    v_mfma_f32_16x16x32_bf16 v[228:231], v[76:79], v[92:95], v[228:231]
    ds_read_b64_tr_b16 v[70:71], v25 offset:30848
    s_waitcnt lgkmcnt(8)
    v_mfma_f32_16x16x32_bf16 v[136:139], v[48:51], v[96:99], v[136:139]
    ds_read_b64_tr_b16 v[72:73], v26 offset:24704
    s_lshl_b32 s23, s57, 13
    v_mfma_f32_16x16x32_bf16 v[140:143], v[48:51], v[100:103], v[140:143]
    ds_read_b64_tr_b16 v[74:75], v26 offset:30848
    buffer_load_dwordx4 v[120:123], v32, s[4:7], s23 offen offset:0 sc1
    v_mfma_f32_16x16x32_bf16 v[144:147], v[52:55], v[96:99], v[144:147]
    ds_read_b64_tr_b16 v[76:77], v27 offset:24704
    v_mfma_f32_16x16x32_bf16 v[148:151], v[52:55], v[100:103], v[148:151]
    ds_read_b64_tr_b16 v[78:79], v27 offset:30848
    s_waitcnt lgkmcnt(8)
    v_mfma_f32_16x16x32_bf16 v[152:155], v[56:59], v[96:99], v[152:155]
    ds_read_b64_tr_b16 v[48:49], v24 offset:24832
    buffer_load_dwordx4 v[124:127], v32, s[4:7], s23 offen offset:1024 sc1
    v_mfma_f32_16x16x32_bf16 v[156:159], v[56:59], v[100:103], v[156:159]
    ds_read_b64_tr_b16 v[50:51], v24 offset:30976
    s_mul_i32 s22, s58, 36864
    v_mfma_f32_16x16x32_bf16 v[160:163], v[60:63], v[96:99], v[160:163]
    ds_read_b64_tr_b16 v[52:53], v25 offset:24832
    s_mov_b32 m0, s38
    v_mfma_f32_16x16x32_bf16 v[164:167], v[60:63], v[100:103], v[164:167]
    ds_read_b64_tr_b16 v[54:55], v25 offset:30976
    s_waitcnt lgkmcnt(8)
    v_mfma_f32_16x16x32_bf16 v[168:171], v[64:67], v[96:99], v[168:171]
    ds_read_b64_tr_b16 v[56:57], v26 offset:24832
    s_waitcnt vmcnt(7)
    v_mfma_f32_16x16x32_bf16 v[172:175], v[64:67], v[100:103], v[172:175]
    ds_read_b64_tr_b16 v[58:59], v26 offset:30976
    buffer_load_dwordx4 v20, s[8:11], s22 offen offset:0 lds
    v_mfma_f32_16x16x32_bf16 v[176:179], v[68:71], v[96:99], v[176:179]
    ds_read_b64_tr_b16 v[60:61], v27 offset:24832
    s_barrier
    v_mfma_f32_16x16x32_bf16 v[180:183], v[68:71], v[100:103], v[180:183]
    ds_read_b64_tr_b16 v[62:63], v27 offset:30976
    s_waitcnt lgkmcnt(8)
    v_mfma_f32_16x16x32_bf16 v[184:187], v[72:75], v[96:99], v[184:187]
    ds_read_b64_tr_b16 v[64:65], v24 offset:36864
    buffer_load_dwordx4 v21, s[8:11], s22 offen offset:1024 lds
    v_mfma_f32_16x16x32_bf16 v[188:191], v[72:75], v[100:103], v[188:191]
    ds_read_b64_tr_b16 v[66:67], v24 offset:43008
    v_mfma_f32_16x16x32_bf16 v[192:195], v[76:79], v[96:99], v[192:195]
    ds_read_b64_tr_b16 v[68:69], v25 offset:36864
    buffer_load_dwordx4 v22, s[8:11], s22 offen offset:2048 lds
    v_mfma_f32_16x16x32_bf16 v[196:199], v[76:79], v[100:103], v[196:199]
    ds_read_b64_tr_b16 v[70:71], v25 offset:43008
    s_waitcnt lgkmcnt(8)
    v_mfma_f32_16x16x32_bf16 v[200:203], v[48:51], v[96:99], v[200:203]
    ds_read_b64_tr_b16 v[72:73], v26 offset:36864
    v_mfma_f32_16x16x32_bf16 v[204:207], v[48:51], v[100:103], v[204:207]
    ds_read_b64_tr_b16 v[74:75], v26 offset:43008
    v_mfma_f32_16x16x32_bf16 v[208:211], v[52:55], v[96:99], v[208:211]
    ds_read_b64_tr_b16 v[76:77], v27 offset:36864
    v_mfma_f32_16x16x32_bf16 v[212:215], v[52:55], v[100:103], v[212:215]
    ds_read_b64_tr_b16 v[78:79], v27 offset:43008
    s_waitcnt lgkmcnt(8)
    v_mfma_f32_16x16x32_bf16 v[216:219], v[56:59], v[96:99], v[216:219]
    ds_read_b64_tr_b16 v[48:49], v24 offset:36992
    v_mfma_f32_16x16x32_bf16 v[220:223], v[56:59], v[100:103], v[220:223]
    ds_read_b64_tr_b16 v[50:51], v24 offset:43136
    v_mfma_f32_16x16x32_bf16 v[224:227], v[60:63], v[96:99], v[224:227]
    ds_read_b64_tr_b16 v[52:53], v25 offset:36992
    v_mfma_f32_16x16x32_bf16 v[228:231], v[60:63], v[100:103], v[228:231]
    ds_read_b64_tr_b16 v[54:55], v25 offset:43136
    s_waitcnt lgkmcnt(8)
    v_mfma_f32_16x16x32_bf16 v[136:139], v[64:67], v[104:107], v[136:139]
    ds_read_b64_tr_b16 v[56:57], v26 offset:36992
    s_lshl_b32 s23, s58, 13
    v_mfma_f32_16x16x32_bf16 v[140:143], v[64:67], v[108:111], v[140:143]
    ds_read_b64_tr_b16 v[58:59], v26 offset:43136
    buffer_load_dwordx4 v[128:131], v32, s[4:7], s23 offen offset:0 sc1
    v_mfma_f32_16x16x32_bf16 v[144:147], v[68:71], v[104:107], v[144:147]
    ds_read_b64_tr_b16 v[60:61], v27 offset:36992
    v_mfma_f32_16x16x32_bf16 v[148:151], v[68:71], v[108:111], v[148:151]
    ds_read_b64_tr_b16 v[62:63], v27 offset:43136
    s_waitcnt lgkmcnt(8)
    v_mfma_f32_16x16x32_bf16 v[152:155], v[72:75], v[104:107], v[152:155]
    ds_read_b64_tr_b16 v[64:65], v24 offset:37120
    buffer_load_dwordx4 v[132:135], v32, s[4:7], s23 offen offset:1024 sc1
    v_mfma_f32_16x16x32_bf16 v[156:159], v[72:75], v[108:111], v[156:159]
    ds_read_b64_tr_b16 v[66:67], v24 offset:43264
    s_mul_i32 s22, s59, 36864
    v_mfma_f32_16x16x32_bf16 v[160:163], v[76:79], v[104:107], v[160:163]
    ds_read_b64_tr_b16 v[68:69], v25 offset:37120
    s_mov_b32 m0, s32
    v_mfma_f32_16x16x32_bf16 v[164:167], v[76:79], v[108:111], v[164:167]
    ds_read_b64_tr_b16 v[70:71], v25 offset:43264
    s_waitcnt lgkmcnt(8)
    v_mfma_f32_16x16x32_bf16 v[168:171], v[48:51], v[104:107], v[168:171]
    ds_read_b64_tr_b16 v[72:73], v26 offset:37120
    buffer_load_dwordx4 v20, s[8:11], s22 offen offset:0 lds
    v_mfma_f32_16x16x32_bf16 v[172:175], v[48:51], v[108:111], v[172:175]
    ds_read_b64_tr_b16 v[74:75], v26 offset:43264
    v_mfma_f32_16x16x32_bf16 v[176:179], v[52:55], v[104:107], v[176:179]
    ds_read_b64_tr_b16 v[76:77], v27 offset:37120
    buffer_load_dwordx4 v21, s[8:11], s22 offen offset:1024 lds
    v_mfma_f32_16x16x32_bf16 v[180:183], v[52:55], v[108:111], v[180:183]
    ds_read_b64_tr_b16 v[78:79], v27 offset:43264
    s_waitcnt lgkmcnt(8)
    v_mfma_f32_16x16x32_bf16 v[184:187], v[56:59], v[104:107], v[184:187]
    ds_read_b64_tr_b16 v[48:49], v24 offset:49152
    buffer_load_dwordx4 v22, s[8:11], s22 offen offset:2048 lds
    v_mfma_f32_16x16x32_bf16 v[188:191], v[56:59], v[108:111], v[188:191]
    ds_read_b64_tr_b16 v[50:51], v24 offset:55296
    v_mfma_f32_16x16x32_bf16 v[192:195], v[60:63], v[104:107], v[192:195]
    ds_read_b64_tr_b16 v[52:53], v25 offset:49152
    v_mfma_f32_16x16x32_bf16 v[196:199], v[60:63], v[108:111], v[196:199]
    ds_read_b64_tr_b16 v[54:55], v25 offset:55296
    s_waitcnt lgkmcnt(8)
    v_mfma_f32_16x16x32_bf16 v[200:203], v[64:67], v[104:107], v[200:203]
    ds_read_b64_tr_b16 v[56:57], v26 offset:49152
    v_mfma_f32_16x16x32_bf16 v[204:207], v[64:67], v[108:111], v[204:207]
    ds_read_b64_tr_b16 v[58:59], v26 offset:55296
    v_mfma_f32_16x16x32_bf16 v[208:211], v[68:71], v[104:107], v[208:211]
    ds_read_b64_tr_b16 v[60:61], v27 offset:49152
    v_mfma_f32_16x16x32_bf16 v[212:215], v[68:71], v[108:111], v[212:215]
    ds_read_b64_tr_b16 v[62:63], v27 offset:55296
    s_waitcnt lgkmcnt(8)
    v_mfma_f32_16x16x32_bf16 v[216:219], v[72:75], v[104:107], v[216:219]
    ds_read_b64_tr_b16 v[64:65], v24 offset:49280
    v_mfma_f32_16x16x32_bf16 v[220:223], v[72:75], v[108:111], v[220:223]
    ds_read_b64_tr_b16 v[66:67], v24 offset:55424
    s_waitcnt vmcnt(13)
    v_mfma_f32_16x16x32_bf16 v[224:227], v[76:79], v[104:107], v[224:227]
    ds_read_b64_tr_b16 v[68:69], v25 offset:49280
    v_mfma_f32_16x16x32_bf16 v[228:231], v[76:79], v[108:111], v[228:231]
    ds_read_b64_tr_b16 v[70:71], v25 offset:55424
    s_waitcnt lgkmcnt(8)
    v_mfma_f32_16x16x32_bf16 v[136:139], v[48:51], v[112:115], v[136:139]
    ds_read_b64_tr_b16 v[72:73], v26 offset:49280
    s_lshl_b32 s23, s59, 13
    v_mfma_f32_16x16x32_bf16 v[140:143], v[48:51], v[116:119], v[140:143]
    ds_read_b64_tr_b16 v[74:75], v26 offset:55424
    buffer_load_dwordx4 v[80:83], v32, s[4:7], s23 offen offset:0 sc1
    v_mfma_f32_16x16x32_bf16 v[144:147], v[52:55], v[112:115], v[144:147]
    ds_read_b64_tr_b16 v[76:77], v27 offset:49280
    v_mfma_f32_16x16x32_bf16 v[148:151], v[52:55], v[116:119], v[148:151]
    ds_read_b64_tr_b16 v[78:79], v27 offset:55424
    s_waitcnt lgkmcnt(8)
    v_mfma_f32_16x16x32_bf16 v[152:155], v[56:59], v[112:115], v[152:155]
    ds_read_b64_tr_b16 v[48:49], v24 offset:49408
    buffer_load_dwordx4 v[84:87], v32, s[4:7], s23 offen offset:1024 sc1
    v_mfma_f32_16x16x32_bf16 v[156:159], v[56:59], v[116:119], v[156:159]
    ds_read_b64_tr_b16 v[50:51], v24 offset:55552
    s_mul_i32 s22, s60, 36864
    v_mfma_f32_16x16x32_bf16 v[160:163], v[60:63], v[112:115], v[160:163]
    ds_read_b64_tr_b16 v[52:53], v25 offset:49408
    s_mov_b32 m0, s33
    v_mfma_f32_16x16x32_bf16 v[164:167], v[60:63], v[116:119], v[164:167]
    ds_read_b64_tr_b16 v[54:55], v25 offset:55552
    s_waitcnt lgkmcnt(8)
    v_mfma_f32_16x16x32_bf16 v[168:171], v[64:67], v[112:115], v[168:171]
    ds_read_b64_tr_b16 v[56:57], v26 offset:49408
    s_waitcnt vmcnt(7)
    v_mfma_f32_16x16x32_bf16 v[172:175], v[64:67], v[116:119], v[172:175]
    ds_read_b64_tr_b16 v[58:59], v26 offset:55552
    buffer_load_dwordx4 v20, s[8:11], s22 offen offset:0 lds
    v_mfma_f32_16x16x32_bf16 v[176:179], v[68:71], v[112:115], v[176:179]
    ds_read_b64_tr_b16 v[60:61], v27 offset:49408
    s_barrier
    v_mfma_f32_16x16x32_bf16 v[180:183], v[68:71], v[116:119], v[180:183]
    ds_read_b64_tr_b16 v[62:63], v27 offset:55552
    s_waitcnt lgkmcnt(8)
    v_mfma_f32_16x16x32_bf16 v[184:187], v[72:75], v[112:115], v[184:187]
    ds_read_b64_tr_b16 v[64:65], v28 offset:0
    buffer_load_dwordx4 v21, s[8:11], s22 offen offset:1024 lds
    v_mfma_f32_16x16x32_bf16 v[188:191], v[72:75], v[116:119], v[188:191]
    ds_read_b64_tr_b16 v[66:67], v28 offset:6144
    v_mfma_f32_16x16x32_bf16 v[192:195], v[76:79], v[112:115], v[192:195]
    ds_read_b64_tr_b16 v[68:69], v29 offset:0
    buffer_load_dwordx4 v22, s[8:11], s22 offen offset:2048 lds
    v_mfma_f32_16x16x32_bf16 v[196:199], v[76:79], v[116:119], v[196:199]
    ds_read_b64_tr_b16 v[70:71], v29 offset:6144
    s_waitcnt lgkmcnt(8)
    v_mfma_f32_16x16x32_bf16 v[200:203], v[48:51], v[112:115], v[200:203]
    ds_read_b64_tr_b16 v[72:73], v30 offset:0
    v_mfma_f32_16x16x32_bf16 v[204:207], v[48:51], v[116:119], v[204:207]
    ds_read_b64_tr_b16 v[74:75], v30 offset:6144
    v_mfma_f32_16x16x32_bf16 v[208:211], v[52:55], v[112:115], v[208:211]
    ds_read_b64_tr_b16 v[76:77], v31 offset:0
    v_mfma_f32_16x16x32_bf16 v[212:215], v[52:55], v[116:119], v[212:215]
    ds_read_b64_tr_b16 v[78:79], v31 offset:6144
    s_waitcnt lgkmcnt(8)
    v_mfma_f32_16x16x32_bf16 v[216:219], v[56:59], v[112:115], v[216:219]
    ds_read_b64_tr_b16 v[48:49], v28 offset:128
    v_mfma_f32_16x16x32_bf16 v[220:223], v[56:59], v[116:119], v[220:223]
    ds_read_b64_tr_b16 v[50:51], v28 offset:6272
    v_mfma_f32_16x16x32_bf16 v[224:227], v[60:63], v[112:115], v[224:227]
    ds_read_b64_tr_b16 v[52:53], v29 offset:128
    v_mfma_f32_16x16x32_bf16 v[228:231], v[60:63], v[116:119], v[228:231]
    ds_read_b64_tr_b16 v[54:55], v29 offset:6272
    s_waitcnt lgkmcnt(8)
    v_mfma_f32_16x16x32_bf16 v[136:139], v[64:67], v[120:123], v[136:139]
    ds_read_b64_tr_b16 v[56:57], v30 offset:128
    s_lshl_b32 s23, s60, 13
    v_mfma_f32_16x16x32_bf16 v[140:143], v[64:67], v[124:127], v[140:143]
    ds_read_b64_tr_b16 v[58:59], v30 offset:6272
    buffer_load_dwordx4 v[88:91], v32, s[4:7], s23 offen offset:0 sc1
    v_mfma_f32_16x16x32_bf16 v[144:147], v[68:71], v[120:123], v[144:147]
    ds_read_b64_tr_b16 v[60:61], v31 offset:128
    v_mfma_f32_16x16x32_bf16 v[148:151], v[68:71], v[124:127], v[148:151]
    ds_read_b64_tr_b16 v[62:63], v31 offset:6272
    s_waitcnt lgkmcnt(8)
    v_mfma_f32_16x16x32_bf16 v[152:155], v[72:75], v[120:123], v[152:155]
    ds_read_b64_tr_b16 v[64:65], v28 offset:256
    buffer_load_dwordx4 v[92:95], v32, s[4:7], s23 offen offset:1024 sc1
    v_mfma_f32_16x16x32_bf16 v[156:159], v[72:75], v[124:127], v[156:159]
    ds_read_b64_tr_b16 v[66:67], v28 offset:6400
    s_mul_i32 s22, s61, 36864
    v_mfma_f32_16x16x32_bf16 v[160:163], v[76:79], v[120:123], v[160:163]
    ds_read_b64_tr_b16 v[68:69], v29 offset:256
    s_mov_b32 m0, s34
    v_mfma_f32_16x16x32_bf16 v[164:167], v[76:79], v[124:127], v[164:167]
    ds_read_b64_tr_b16 v[70:71], v29 offset:6400
    s_waitcnt lgkmcnt(8)
    v_mfma_f32_16x16x32_bf16 v[168:171], v[48:51], v[120:123], v[168:171]
    ds_read_b64_tr_b16 v[72:73], v30 offset:256
    buffer_load_dwordx4 v20, s[8:11], s22 offen offset:0 lds
    v_mfma_f32_16x16x32_bf16 v[172:175], v[48:51], v[124:127], v[172:175]
    ds_read_b64_tr_b16 v[74:75], v30 offset:6400
    v_mfma_f32_16x16x32_bf16 v[176:179], v[52:55], v[120:123], v[176:179]
    ds_read_b64_tr_b16 v[76:77], v31 offset:256
    buffer_load_dwordx4 v21, s[8:11], s22 offen offset:1024 lds
    v_mfma_f32_16x16x32_bf16 v[180:183], v[52:55], v[124:127], v[180:183]
    ds_read_b64_tr_b16 v[78:79], v31 offset:6400
    s_waitcnt lgkmcnt(8)
    v_mfma_f32_16x16x32_bf16 v[184:187], v[56:59], v[120:123], v[184:187]
    ds_read_b64_tr_b16 v[48:49], v28 offset:12288
    buffer_load_dwordx4 v22, s[8:11], s22 offen offset:2048 lds
    v_mfma_f32_16x16x32_bf16 v[188:191], v[56:59], v[124:127], v[188:191]
    ds_read_b64_tr_b16 v[50:51], v28 offset:18432
    v_mfma_f32_16x16x32_bf16 v[192:195], v[60:63], v[120:123], v[192:195]
    ds_read_b64_tr_b16 v[52:53], v29 offset:12288
    v_mfma_f32_16x16x32_bf16 v[196:199], v[60:63], v[124:127], v[196:199]
    ds_read_b64_tr_b16 v[54:55], v29 offset:18432
    s_waitcnt lgkmcnt(8)
    v_mfma_f32_16x16x32_bf16 v[200:203], v[64:67], v[120:123], v[200:203]
    ds_read_b64_tr_b16 v[56:57], v30 offset:12288
    v_mfma_f32_16x16x32_bf16 v[204:207], v[64:67], v[124:127], v[204:207]
    ds_read_b64_tr_b16 v[58:59], v30 offset:18432
    v_mfma_f32_16x16x32_bf16 v[208:211], v[68:71], v[120:123], v[208:211]
    ds_read_b64_tr_b16 v[60:61], v31 offset:12288
    v_mfma_f32_16x16x32_bf16 v[212:215], v[68:71], v[124:127], v[212:215]
    ds_read_b64_tr_b16 v[62:63], v31 offset:18432
    s_waitcnt lgkmcnt(8)
    v_mfma_f32_16x16x32_bf16 v[216:219], v[72:75], v[120:123], v[216:219]
    ds_read_b64_tr_b16 v[64:65], v28 offset:12416
    v_mfma_f32_16x16x32_bf16 v[220:223], v[72:75], v[124:127], v[220:223]
    ds_read_b64_tr_b16 v[66:67], v28 offset:18560
    s_waitcnt vmcnt(13)
    v_mfma_f32_16x16x32_bf16 v[224:227], v[76:79], v[120:123], v[224:227]
    ds_read_b64_tr_b16 v[68:69], v29 offset:12416
    v_mfma_f32_16x16x32_bf16 v[228:231], v[76:79], v[124:127], v[228:231]
    ds_read_b64_tr_b16 v[70:71], v29 offset:18560
    s_waitcnt lgkmcnt(8)
    v_mfma_f32_16x16x32_bf16 v[136:139], v[48:51], v[128:131], v[136:139]
    ds_read_b64_tr_b16 v[72:73], v30 offset:12416
    s_lshl_b32 s23, s61, 13
    v_mfma_f32_16x16x32_bf16 v[140:143], v[48:51], v[132:135], v[140:143]
    ds_read_b64_tr_b16 v[74:75], v30 offset:18560
    buffer_load_dwordx4 v[96:99], v32, s[4:7], s23 offen offset:0 sc1
    v_mfma_f32_16x16x32_bf16 v[144:147], v[52:55], v[128:131], v[144:147]
    ds_read_b64_tr_b16 v[76:77], v31 offset:12416
    v_mfma_f32_16x16x32_bf16 v[148:151], v[52:55], v[132:135], v[148:151]
    ds_read_b64_tr_b16 v[78:79], v31 offset:18560
    s_waitcnt lgkmcnt(8)
    v_mfma_f32_16x16x32_bf16 v[152:155], v[56:59], v[128:131], v[152:155]
    ds_read_b64_tr_b16 v[48:49], v28 offset:12544
    buffer_load_dwordx4 v[100:103], v32, s[4:7], s23 offen offset:1024 sc1
    v_mfma_f32_16x16x32_bf16 v[156:159], v[56:59], v[132:135], v[156:159]
    ds_read_b64_tr_b16 v[50:51], v28 offset:18688
    s_mul_i32 s22, s62, 36864
    v_mfma_f32_16x16x32_bf16 v[160:163], v[60:63], v[128:131], v[160:163]
    ds_read_b64_tr_b16 v[52:53], v29 offset:12544
    s_mov_b32 m0, s35
    v_mfma_f32_16x16x32_bf16 v[164:167], v[60:63], v[132:135], v[164:167]
    ds_read_b64_tr_b16 v[54:55], v29 offset:18688
    s_waitcnt lgkmcnt(8)
    v_mfma_f32_16x16x32_bf16 v[168:171], v[64:67], v[128:131], v[168:171]
    ds_read_b64_tr_b16 v[56:57], v30 offset:12544
    s_waitcnt vmcnt(7)
    v_mfma_f32_16x16x32_bf16 v[172:175], v[64:67], v[132:135], v[172:175]
    ds_read_b64_tr_b16 v[58:59], v30 offset:18688
    buffer_load_dwordx4 v20, s[8:11], s22 offen offset:0 lds
    v_mfma_f32_16x16x32_bf16 v[176:179], v[68:71], v[128:131], v[176:179]
    ds_read_b64_tr_b16 v[60:61], v31 offset:12544
    s_barrier
    v_mfma_f32_16x16x32_bf16 v[180:183], v[68:71], v[132:135], v[180:183]
    ds_read_b64_tr_b16 v[62:63], v31 offset:18688
    s_waitcnt lgkmcnt(8)
    v_mfma_f32_16x16x32_bf16 v[184:187], v[72:75], v[128:131], v[184:187]
    ds_read_b64_tr_b16 v[64:65], v24 offset:0
    buffer_load_dwordx4 v21, s[8:11], s22 offen offset:1024 lds
    v_mfma_f32_16x16x32_bf16 v[188:191], v[72:75], v[132:135], v[188:191]
    ds_read_b64_tr_b16 v[66:67], v24 offset:6144
    v_mfma_f32_16x16x32_bf16 v[192:195], v[76:79], v[128:131], v[192:195]
    ds_read_b64_tr_b16 v[68:69], v25 offset:0
    buffer_load_dwordx4 v22, s[8:11], s22 offen offset:2048 lds
    v_mfma_f32_16x16x32_bf16 v[196:199], v[76:79], v[132:135], v[196:199]
    ds_read_b64_tr_b16 v[70:71], v25 offset:6144
    s_waitcnt lgkmcnt(8)
    v_mfma_f32_16x16x32_bf16 v[200:203], v[48:51], v[128:131], v[200:203]
    ds_read_b64_tr_b16 v[72:73], v26 offset:0
    v_mfma_f32_16x16x32_bf16 v[204:207], v[48:51], v[132:135], v[204:207]
    ds_read_b64_tr_b16 v[74:75], v26 offset:6144
    v_mfma_f32_16x16x32_bf16 v[208:211], v[52:55], v[128:131], v[208:211]
    ds_read_b64_tr_b16 v[76:77], v27 offset:0
    v_mfma_f32_16x16x32_bf16 v[212:215], v[52:55], v[132:135], v[212:215]
    ds_read_b64_tr_b16 v[78:79], v27 offset:6144
    s_waitcnt lgkmcnt(8)
    v_mfma_f32_16x16x32_bf16 v[216:219], v[56:59], v[128:131], v[216:219]
    ds_read_b64_tr_b16 v[48:49], v24 offset:128
    v_mfma_f32_16x16x32_bf16 v[220:223], v[56:59], v[132:135], v[220:223]
    ds_read_b64_tr_b16 v[50:51], v24 offset:6272
    v_mfma_f32_16x16x32_bf16 v[224:227], v[60:63], v[128:131], v[224:227]
    ds_read_b64_tr_b16 v[52:53], v25 offset:128
    v_mfma_f32_16x16x32_bf16 v[228:231], v[60:63], v[132:135], v[228:231]
    ds_read_b64_tr_b16 v[54:55], v25 offset:6272
    s_waitcnt lgkmcnt(8)
    v_mfma_f32_16x16x32_bf16 v[136:139], v[64:67], v[80:83], v[136:139]
    ds_read_b64_tr_b16 v[56:57], v26 offset:128
    s_lshl_b32 s23, s62, 13
    v_mfma_f32_16x16x32_bf16 v[140:143], v[64:67], v[84:87], v[140:143]
    ds_read_b64_tr_b16 v[58:59], v26 offset:6272
    buffer_load_dwordx4 v[104:107], v32, s[4:7], s23 offen offset:0 sc1
    v_mfma_f32_16x16x32_bf16 v[144:147], v[68:71], v[80:83], v[144:147]
    ds_read_b64_tr_b16 v[60:61], v27 offset:128
    v_mfma_f32_16x16x32_bf16 v[148:151], v[68:71], v[84:87], v[148:151]
    ds_read_b64_tr_b16 v[62:63], v27 offset:6272
    s_waitcnt lgkmcnt(8)
    v_mfma_f32_16x16x32_bf16 v[152:155], v[72:75], v[80:83], v[152:155]
    ds_read_b64_tr_b16 v[64:65], v24 offset:256
    buffer_load_dwordx4 v[108:111], v32, s[4:7], s23 offen offset:1024 sc1
    v_mfma_f32_16x16x32_bf16 v[156:159], v[72:75], v[84:87], v[156:159]
    ds_read_b64_tr_b16 v[66:67], v24 offset:6400
    s_mul_i32 s22, s63, 36864
    v_mfma_f32_16x16x32_bf16 v[160:163], v[76:79], v[80:83], v[160:163]
    ds_read_b64_tr_b16 v[68:69], v25 offset:256
    s_mov_b32 m0, s36
    v_mfma_f32_16x16x32_bf16 v[164:167], v[76:79], v[84:87], v[164:167]
    ds_read_b64_tr_b16 v[70:71], v25 offset:6400
    s_waitcnt lgkmcnt(8)
    v_mfma_f32_16x16x32_bf16 v[168:171], v[48:51], v[80:83], v[168:171]
    ds_read_b64_tr_b16 v[72:73], v26 offset:256
    buffer_load_dwordx4 v20, s[8:11], s22 offen offset:0 lds
    v_mfma_f32_16x16x32_bf16 v[172:175], v[48:51], v[84:87], v[172:175]
    ds_read_b64_tr_b16 v[74:75], v26 offset:6400
    v_mfma_f32_16x16x32_bf16 v[176:179], v[52:55], v[80:83], v[176:179]
    ds_read_b64_tr_b16 v[76:77], v27 offset:256
    buffer_load_dwordx4 v21, s[8:11], s22 offen offset:1024 lds
    v_mfma_f32_16x16x32_bf16 v[180:183], v[52:55], v[84:87], v[180:183]
    ds_read_b64_tr_b16 v[78:79], v27 offset:6400
    s_waitcnt lgkmcnt(8)
    v_mfma_f32_16x16x32_bf16 v[184:187], v[56:59], v[80:83], v[184:187]
    ds_read_b64_tr_b16 v[48:49], v24 offset:12288
    buffer_load_dwordx4 v22, s[8:11], s22 offen offset:2048 lds
    v_mfma_f32_16x16x32_bf16 v[188:191], v[56:59], v[84:87], v[188:191]
    ds_read_b64_tr_b16 v[50:51], v24 offset:18432
    v_mfma_f32_16x16x32_bf16 v[192:195], v[60:63], v[80:83], v[192:195]
    ds_read_b64_tr_b16 v[52:53], v25 offset:12288
    v_mfma_f32_16x16x32_bf16 v[196:199], v[60:63], v[84:87], v[196:199]
    ds_read_b64_tr_b16 v[54:55], v25 offset:18432
    s_waitcnt lgkmcnt(8)
    v_mfma_f32_16x16x32_bf16 v[200:203], v[64:67], v[80:83], v[200:203]
    ds_read_b64_tr_b16 v[56:57], v26 offset:12288
    v_mfma_f32_16x16x32_bf16 v[204:207], v[64:67], v[84:87], v[204:207]
    ds_read_b64_tr_b16 v[58:59], v26 offset:18432
    v_mfma_f32_16x16x32_bf16 v[208:211], v[68:71], v[80:83], v[208:211]
    ds_read_b64_tr_b16 v[60:61], v27 offset:12288
    v_mfma_f32_16x16x32_bf16 v[212:215], v[68:71], v[84:87], v[212:215]
    ds_read_b64_tr_b16 v[62:63], v27 offset:18432
    s_waitcnt lgkmcnt(8)
    v_mfma_f32_16x16x32_bf16 v[216:219], v[72:75], v[80:83], v[216:219]
    ds_read_b64_tr_b16 v[64:65], v24 offset:12416
    v_mfma_f32_16x16x32_bf16 v[220:223], v[72:75], v[84:87], v[220:223]
    ds_read_b64_tr_b16 v[66:67], v24 offset:18560
    s_waitcnt vmcnt(13)
    v_mfma_f32_16x16x32_bf16 v[224:227], v[76:79], v[80:83], v[224:227]
    ds_read_b64_tr_b16 v[68:69], v25 offset:12416
    v_mfma_f32_16x16x32_bf16 v[228:231], v[76:79], v[84:87], v[228:231]
    ds_read_b64_tr_b16 v[70:71], v25 offset:18560
    s_waitcnt lgkmcnt(8)
    v_mfma_f32_16x16x32_bf16 v[136:139], v[48:51], v[88:91], v[136:139]
    ds_read_b64_tr_b16 v[72:73], v26 offset:12416
    s_lshl_b32 s23, s63, 13
    v_mfma_f32_16x16x32_bf16 v[140:143], v[48:51], v[92:95], v[140:143]
    ds_read_b64_tr_b16 v[74:75], v26 offset:18560
    buffer_load_dwordx4 v[112:115], v32, s[4:7], s23 offen offset:0 sc1
    v_mfma_f32_16x16x32_bf16 v[144:147], v[52:55], v[88:91], v[144:147]
    ds_read_b64_tr_b16 v[76:77], v27 offset:12416
    v_mfma_f32_16x16x32_bf16 v[148:151], v[52:55], v[92:95], v[148:151]
    ds_read_b64_tr_b16 v[78:79], v27 offset:18560
    s_waitcnt lgkmcnt(8)
    v_mfma_f32_16x16x32_bf16 v[152:155], v[56:59], v[88:91], v[152:155]
    ds_read_b64_tr_b16 v[48:49], v24 offset:12544
    buffer_load_dwordx4 v[116:119], v32, s[4:7], s23 offen offset:1024 sc1
    v_mfma_f32_16x16x32_bf16 v[156:159], v[56:59], v[92:95], v[156:159]
    ds_read_b64_tr_b16 v[50:51], v24 offset:18688
    s_mul_i32 s22, s64, 36864
    v_mfma_f32_16x16x32_bf16 v[160:163], v[60:63], v[88:91], v[160:163]
    ds_read_b64_tr_b16 v[52:53], v25 offset:12544
    s_mov_b32 m0, s37
    v_mfma_f32_16x16x32_bf16 v[164:167], v[60:63], v[92:95], v[164:167]
    ds_read_b64_tr_b16 v[54:55], v25 offset:18688
    s_waitcnt lgkmcnt(8)
    v_mfma_f32_16x16x32_bf16 v[168:171], v[64:67], v[88:91], v[168:171]
    ds_read_b64_tr_b16 v[56:57], v26 offset:12544
    s_waitcnt vmcnt(7)
    v_mfma_f32_16x16x32_bf16 v[172:175], v[64:67], v[92:95], v[172:175]
    ds_read_b64_tr_b16 v[58:59], v26 offset:18688
    buffer_load_dwordx4 v20, s[8:11], s22 offen offset:0 lds
    v_mfma_f32_16x16x32_bf16 v[176:179], v[68:71], v[88:91], v[176:179]
    ds_read_b64_tr_b16 v[60:61], v27 offset:12544
    s_barrier
    v_mfma_f32_16x16x32_bf16 v[180:183], v[68:71], v[92:95], v[180:183]
    ds_read_b64_tr_b16 v[62:63], v27 offset:18688
    s_waitcnt lgkmcnt(8)
    v_mfma_f32_16x16x32_bf16 v[184:187], v[72:75], v[88:91], v[184:187]
    ds_read_b64_tr_b16 v[64:65], v24 offset:24576
    buffer_load_dwordx4 v21, s[8:11], s22 offen offset:1024 lds
    v_mfma_f32_16x16x32_bf16 v[188:191], v[72:75], v[92:95], v[188:191]
    ds_read_b64_tr_b16 v[66:67], v24 offset:30720
    v_mfma_f32_16x16x32_bf16 v[192:195], v[76:79], v[88:91], v[192:195]
    ds_read_b64_tr_b16 v[68:69], v25 offset:24576
    buffer_load_dwordx4 v22, s[8:11], s22 offen offset:2048 lds
    v_mfma_f32_16x16x32_bf16 v[196:199], v[76:79], v[92:95], v[196:199]
    ds_read_b64_tr_b16 v[70:71], v25 offset:30720
    s_waitcnt lgkmcnt(8)
    v_mfma_f32_16x16x32_bf16 v[200:203], v[48:51], v[88:91], v[200:203]
    ds_read_b64_tr_b16 v[72:73], v26 offset:24576
    v_mfma_f32_16x16x32_bf16 v[204:207], v[48:51], v[92:95], v[204:207]
    ds_read_b64_tr_b16 v[74:75], v26 offset:30720
    v_mfma_f32_16x16x32_bf16 v[208:211], v[52:55], v[88:91], v[208:211]
    ds_read_b64_tr_b16 v[76:77], v27 offset:24576
    v_mfma_f32_16x16x32_bf16 v[212:215], v[52:55], v[92:95], v[212:215]
    ds_read_b64_tr_b16 v[78:79], v27 offset:30720
    s_waitcnt lgkmcnt(8)
    v_mfma_f32_16x16x32_bf16 v[216:219], v[56:59], v[88:91], v[216:219]
    ds_read_b64_tr_b16 v[48:49], v24 offset:24704
    v_mfma_f32_16x16x32_bf16 v[220:223], v[56:59], v[92:95], v[220:223]
    ds_read_b64_tr_b16 v[50:51], v24 offset:30848
    v_mfma_f32_16x16x32_bf16 v[224:227], v[60:63], v[88:91], v[224:227]
    ds_read_b64_tr_b16 v[52:53], v25 offset:24704
    v_mfma_f32_16x16x32_bf16 v[228:231], v[60:63], v[92:95], v[228:231]
    ds_read_b64_tr_b16 v[54:55], v25 offset:30848
    s_waitcnt lgkmcnt(8)
    v_mfma_f32_16x16x32_bf16 v[136:139], v[64:67], v[96:99], v[136:139]
    ds_read_b64_tr_b16 v[56:57], v26 offset:24704
    s_lshl_b32 s23, s64, 13
    v_mfma_f32_16x16x32_bf16 v[140:143], v[64:67], v[100:103], v[140:143]
    ds_read_b64_tr_b16 v[58:59], v26 offset:30848
    buffer_load_dwordx4 v[120:123], v32, s[4:7], s23 offen offset:0 sc1
    v_mfma_f32_16x16x32_bf16 v[144:147], v[68:71], v[96:99], v[144:147]
    ds_read_b64_tr_b16 v[60:61], v27 offset:24704
    v_mfma_f32_16x16x32_bf16 v[148:151], v[68:71], v[100:103], v[148:151]
    ds_read_b64_tr_b16 v[62:63], v27 offset:30848
    s_waitcnt lgkmcnt(8)
    v_mfma_f32_16x16x32_bf16 v[152:155], v[72:75], v[96:99], v[152:155]
    ds_read_b64_tr_b16 v[64:65], v24 offset:24832
    buffer_load_dword v40, v39, s[12:15], 0 offen sc1
    v_mfma_f32_16x16x32_bf16 v[156:159], v[72:75], v[100:103], v[156:159]
    ds_read_b64_tr_b16 v[66:67], v24 offset:30976
    buffer_load_dwordx4 v[124:127], v32, s[4:7], s23 offen offset:1024 sc1
    v_mfma_f32_16x16x32_bf16 v[160:163], v[76:79], v[96:99], v[160:163]
    ds_read_b64_tr_b16 v[68:69], v25 offset:24832
    s_mul_i32 s22, s65, 36864
    v_mfma_f32_16x16x32_bf16 v[164:167], v[76:79], v[100:103], v[164:167]
    ds_read_b64_tr_b16 v[70:71], v25 offset:30976
    s_waitcnt lgkmcnt(8)
    v_mfma_f32_16x16x32_bf16 v[168:171], v[48:51], v[96:99], v[168:171]
    ds_read_b64_tr_b16 v[72:73], v26 offset:24832
    s_mov_b32 m0, s38
    v_mfma_f32_16x16x32_bf16 v[172:175], v[48:51], v[100:103], v[172:175]
    ds_read_b64_tr_b16 v[74:75], v26 offset:30976
    buffer_load_dwordx4 v20, s[8:11], s22 offen offset:0 lds
    v_mfma_f32_16x16x32_bf16 v[176:179], v[52:55], v[96:99], v[176:179]
    ds_read_b64_tr_b16 v[76:77], v27 offset:24832
    v_mfma_f32_16x16x32_bf16 v[180:183], v[52:55], v[100:103], v[180:183]
    ds_read_b64_tr_b16 v[78:79], v27 offset:30976
    s_waitcnt lgkmcnt(8)
    v_mfma_f32_16x16x32_bf16 v[184:187], v[56:59], v[96:99], v[184:187]
    ds_read_b64_tr_b16 v[48:49], v24 offset:36864
    buffer_load_dwordx4 v21, s[8:11], s22 offen offset:1024 lds
    v_mfma_f32_16x16x32_bf16 v[188:191], v[56:59], v[100:103], v[188:191]
    ds_read_b64_tr_b16 v[50:51], v24 offset:43008
    v_mfma_f32_16x16x32_bf16 v[192:195], v[60:63], v[96:99], v[192:195]
    ds_read_b64_tr_b16 v[52:53], v25 offset:36864
    buffer_load_dwordx4 v22, s[8:11], s22 offen offset:2048 lds
    v_mfma_f32_16x16x32_bf16 v[196:199], v[60:63], v[100:103], v[196:199]
    ds_read_b64_tr_b16 v[54:55], v25 offset:43008
    s_waitcnt lgkmcnt(8)
    v_mfma_f32_16x16x32_bf16 v[200:203], v[64:67], v[96:99], v[200:203]
    ds_read_b64_tr_b16 v[56:57], v26 offset:36864
    v_mfma_f32_16x16x32_bf16 v[204:207], v[64:67], v[100:103], v[204:207]
    ds_read_b64_tr_b16 v[58:59], v26 offset:43008
    v_mfma_f32_16x16x32_bf16 v[208:211], v[68:71], v[96:99], v[208:211]
    ds_read_b64_tr_b16 v[60:61], v27 offset:36864
    v_mfma_f32_16x16x32_bf16 v[212:215], v[68:71], v[100:103], v[212:215]
    ds_read_b64_tr_b16 v[62:63], v27 offset:43008
    s_waitcnt lgkmcnt(8)
    v_mfma_f32_16x16x32_bf16 v[216:219], v[72:75], v[96:99], v[216:219]
    ds_read_b64_tr_b16 v[64:65], v24 offset:36992
    v_mfma_f32_16x16x32_bf16 v[220:223], v[72:75], v[100:103], v[220:223]
    ds_read_b64_tr_b16 v[66:67], v24 offset:43136
    s_waitcnt vmcnt(14)
    v_mfma_f32_16x16x32_bf16 v[224:227], v[76:79], v[96:99], v[224:227]
    ds_read_b64_tr_b16 v[68:69], v25 offset:36992
    v_mfma_f32_16x16x32_bf16 v[228:231], v[76:79], v[100:103], v[228:231]
    ds_read_b64_tr_b16 v[70:71], v25 offset:43136
    s_waitcnt lgkmcnt(8)
    v_mfma_f32_16x16x32_bf16 v[136:139], v[48:51], v[104:107], v[136:139]
    ds_read_b64_tr_b16 v[72:73], v26 offset:36992
    s_lshl_b32 s23, s65, 13
    v_mfma_f32_16x16x32_bf16 v[140:143], v[48:51], v[108:111], v[140:143]
    ds_read_b64_tr_b16 v[74:75], v26 offset:43136
    buffer_load_dwordx4 v[128:131], v32, s[4:7], s23 offen offset:0 sc1
    v_mfma_f32_16x16x32_bf16 v[144:147], v[52:55], v[104:107], v[144:147]
    ds_read_b64_tr_b16 v[76:77], v27 offset:36992
    v_mfma_f32_16x16x32_bf16 v[148:151], v[52:55], v[108:111], v[148:151]
    ds_read_b64_tr_b16 v[78:79], v27 offset:43136
    s_waitcnt lgkmcnt(8)
    v_mfma_f32_16x16x32_bf16 v[152:155], v[56:59], v[104:107], v[152:155]
    ds_read_b64_tr_b16 v[48:49], v24 offset:37120
    buffer_load_dwordx4 v[132:135], v32, s[4:7], s23 offen offset:1024 sc1
    v_mfma_f32_16x16x32_bf16 v[156:159], v[56:59], v[108:111], v[156:159]
    ds_read_b64_tr_b16 v[50:51], v24 offset:43264
    s_mul_i32 s22, s66, 36864
    v_mfma_f32_16x16x32_bf16 v[160:163], v[60:63], v[104:107], v[160:163]
    ds_read_b64_tr_b16 v[52:53], v25 offset:37120
    s_mov_b32 m0, s32
    v_mfma_f32_16x16x32_bf16 v[164:167], v[60:63], v[108:111], v[164:167]
    ds_read_b64_tr_b16 v[54:55], v25 offset:43264
    s_waitcnt lgkmcnt(8)
    v_mfma_f32_16x16x32_bf16 v[168:171], v[64:67], v[104:107], v[168:171]
    ds_read_b64_tr_b16 v[56:57], v26 offset:37120
    s_waitcnt vmcnt(8)
    v_mfma_f32_16x16x32_bf16 v[172:175], v[64:67], v[108:111], v[172:175]
    ds_read_b64_tr_b16 v[58:59], v26 offset:43264
    buffer_load_dwordx4 v20, s[8:11], s22 offen offset:0 lds
    v_mfma_f32_16x16x32_bf16 v[176:179], v[68:71], v[104:107], v[176:179]
    ds_read_b64_tr_b16 v[60:61], v27 offset:37120
    s_barrier
    v_mfma_f32_16x16x32_bf16 v[180:183], v[68:71], v[108:111], v[180:183]
    ds_read_b64_tr_b16 v[62:63], v27 offset:43264
    s_waitcnt lgkmcnt(8)
    v_mfma_f32_16x16x32_bf16 v[184:187], v[72:75], v[104:107], v[184:187]
    ds_read_b64_tr_b16 v[64:65], v24 offset:49152
    buffer_load_dwordx4 v21, s[8:11], s22 offen offset:1024 lds
    v_mfma_f32_16x16x32_bf16 v[188:191], v[72:75], v[108:111], v[188:191]
    ds_read_b64_tr_b16 v[66:67], v24 offset:55296
    v_mfma_f32_16x16x32_bf16 v[192:195], v[76:79], v[104:107], v[192:195]
    ds_read_b64_tr_b16 v[68:69], v25 offset:49152
    buffer_load_dwordx4 v22, s[8:11], s22 offen offset:2048 lds
    v_mfma_f32_16x16x32_bf16 v[196:199], v[76:79], v[108:111], v[196:199]
    ds_read_b64_tr_b16 v[70:71], v25 offset:55296
    s_waitcnt lgkmcnt(8)
    v_mfma_f32_16x16x32_bf16 v[200:203], v[48:51], v[104:107], v[200:203]
    ds_read_b64_tr_b16 v[72:73], v26 offset:49152
    v_mfma_f32_16x16x32_bf16 v[204:207], v[48:51], v[108:111], v[204:207]
    ds_read_b64_tr_b16 v[74:75], v26 offset:55296
    v_mfma_f32_16x16x32_bf16 v[208:211], v[52:55], v[104:107], v[208:211]
    ds_read_b64_tr_b16 v[76:77], v27 offset:49152
    v_mfma_f32_16x16x32_bf16 v[212:215], v[52:55], v[108:111], v[212:215]
    ds_read_b64_tr_b16 v[78:79], v27 offset:55296
    s_waitcnt lgkmcnt(8)
    v_mfma_f32_16x16x32_bf16 v[216:219], v[56:59], v[104:107], v[216:219]
    ds_read_b64_tr_b16 v[48:49], v24 offset:49280
    v_mfma_f32_16x16x32_bf16 v[220:223], v[56:59], v[108:111], v[220:223]
    ds_read_b64_tr_b16 v[50:51], v24 offset:55424
    v_mfma_f32_16x16x32_bf16 v[224:227], v[60:63], v[104:107], v[224:227]
    ds_read_b64_tr_b16 v[52:53], v25 offset:49280
    v_mfma_f32_16x16x32_bf16 v[228:231], v[60:63], v[108:111], v[228:231]
    ds_read_b64_tr_b16 v[54:55], v25 offset:55424
    s_waitcnt lgkmcnt(8)
    v_mfma_f32_16x16x32_bf16 v[136:139], v[64:67], v[112:115], v[136:139]
    ds_read_b64_tr_b16 v[56:57], v26 offset:49280
    s_lshl_b32 s23, s66, 13
    v_mfma_f32_16x16x32_bf16 v[140:143], v[64:67], v[116:119], v[140:143]
    ds_read_b64_tr_b16 v[58:59], v26 offset:55424
    buffer_load_dwordx4 v[80:83], v32, s[4:7], s23 offen offset:0 sc1
    v_mfma_f32_16x16x32_bf16 v[144:147], v[68:71], v[112:115], v[144:147]
    ds_read_b64_tr_b16 v[60:61], v27 offset:49280
    v_mfma_f32_16x16x32_bf16 v[148:151], v[68:71], v[116:119], v[148:151]
    ds_read_b64_tr_b16 v[62:63], v27 offset:55424
    s_waitcnt lgkmcnt(8)
    v_mfma_f32_16x16x32_bf16 v[152:155], v[72:75], v[112:115], v[152:155]
    ds_read_b64_tr_b16 v[64:65], v24 offset:49408
    buffer_load_dwordx4 v[84:87], v32, s[4:7], s23 offen offset:1024 sc1
    v_mfma_f32_16x16x32_bf16 v[156:159], v[72:75], v[116:119], v[156:159]
    ds_read_b64_tr_b16 v[66:67], v24 offset:55552
    s_mul_i32 s22, s67, 36864
    v_mfma_f32_16x16x32_bf16 v[160:163], v[76:79], v[112:115], v[160:163]
    ds_read_b64_tr_b16 v[68:69], v25 offset:49408
    s_mov_b32 m0, s33
    v_mfma_f32_16x16x32_bf16 v[164:167], v[76:79], v[116:119], v[164:167]
    ds_read_b64_tr_b16 v[70:71], v25 offset:55552
    s_waitcnt lgkmcnt(8)
    v_mfma_f32_16x16x32_bf16 v[168:171], v[48:51], v[112:115], v[168:171]
    ds_read_b64_tr_b16 v[72:73], v26 offset:49408
    buffer_load_dwordx4 v20, s[8:11], s22 offen offset:0 lds
    v_mfma_f32_16x16x32_bf16 v[172:175], v[48:51], v[116:119], v[172:175]
    ds_read_b64_tr_b16 v[74:75], v26 offset:55552
    v_mfma_f32_16x16x32_bf16 v[176:179], v[52:55], v[112:115], v[176:179]
    ds_read_b64_tr_b16 v[76:77], v27 offset:49408
    buffer_load_dwordx4 v21, s[8:11], s22 offen offset:1024 lds
    v_mfma_f32_16x16x32_bf16 v[180:183], v[52:55], v[116:119], v[180:183]
    ds_read_b64_tr_b16 v[78:79], v27 offset:55552
    s_waitcnt lgkmcnt(8)
    v_mfma_f32_16x16x32_bf16 v[184:187], v[56:59], v[112:115], v[184:187]
    ds_read_b64_tr_b16 v[48:49], v28 offset:0
    buffer_load_dwordx4 v22, s[8:11], s22 offen offset:2048 lds
    v_mfma_f32_16x16x32_bf16 v[188:191], v[56:59], v[116:119], v[188:191]
    ds_read_b64_tr_b16 v[50:51], v28 offset:6144
    v_mfma_f32_16x16x32_bf16 v[192:195], v[60:63], v[112:115], v[192:195]
    ds_read_b64_tr_b16 v[52:53], v29 offset:0
    v_mfma_f32_16x16x32_bf16 v[196:199], v[60:63], v[116:119], v[196:199]
    ds_read_b64_tr_b16 v[54:55], v29 offset:6144
    s_waitcnt lgkmcnt(8)
    v_mfma_f32_16x16x32_bf16 v[200:203], v[64:67], v[112:115], v[200:203]
    ds_read_b64_tr_b16 v[56:57], v30 offset:0
    s_waitcnt vmcnt(14)
    v_cmp_ne_u32 vcc, s101, v40
    s_nop 4
    s_cbranch_vccnz G2_SPINM
G2_CONTM:
    v_mfma_f32_16x16x32_bf16 v[204:207], v[64:67], v[116:119], v[204:207]
    ds_read_b64_tr_b16 v[58:59], v30 offset:6144
    v_mfma_f32_16x16x32_bf16 v[208:211], v[68:71], v[112:115], v[208:211]
    ds_read_b64_tr_b16 v[60:61], v31 offset:0
    v_mfma_f32_16x16x32_bf16 v[212:215], v[68:71], v[116:119], v[212:215]
    ds_read_b64_tr_b16 v[62:63], v31 offset:6144
    s_waitcnt lgkmcnt(8)
    v_mfma_f32_16x16x32_bf16 v[216:219], v[72:75], v[112:115], v[216:219]
    ds_read_b64_tr_b16 v[64:65], v28 offset:128
    v_mfma_f32_16x16x32_bf16 v[220:223], v[72:75], v[116:119], v[220:223]
    ds_read_b64_tr_b16 v[66:67], v28 offset:6272
    s_waitcnt vmcnt(13)
    v_mfma_f32_16x16x32_bf16 v[224:227], v[76:79], v[112:115], v[224:227]
    ds_read_b64_tr_b16 v[68:69], v29 offset:128
    v_mfma_f32_16x16x32_bf16 v[228:231], v[76:79], v[116:119], v[228:231]
    ds_read_b64_tr_b16 v[70:71], v29 offset:6272
    s_waitcnt lgkmcnt(8)
    v_mfma_f32_16x16x32_bf16 v[136:139], v[48:51], v[120:123], v[136:139]
    ds_read_b64_tr_b16 v[72:73], v30 offset:128
    s_lshl_b32 s23, s67, 13
    v_mfma_f32_16x16x32_bf16 v[140:143], v[48:51], v[124:127], v[140:143]
    ds_read_b64_tr_b16 v[74:75], v30 offset:6272
    buffer_load_dwordx4 v[88:91], v32, s[4:7], s23 offen offset:0 sc1
    v_mfma_f32_16x16x32_bf16 v[144:147], v[52:55], v[120:123], v[144:147]
    ds_read_b64_tr_b16 v[76:77], v31 offset:128
    v_mfma_f32_16x16x32_bf16 v[148:151], v[52:55], v[124:127], v[148:151]
    ds_read_b64_tr_b16 v[78:79], v31 offset:6272
    s_waitcnt lgkmcnt(8)
    v_mfma_f32_16x16x32_bf16 v[152:155], v[56:59], v[120:123], v[152:155]
    ds_read_b64_tr_b16 v[48:49], v28 offset:256
    buffer_load_dwordx4 v[92:95], v32, s[4:7], s23 offen offset:1024 sc1
    v_mfma_f32_16x16x32_bf16 v[156:159], v[56:59], v[124:127], v[156:159]
    ds_read_b64_tr_b16 v[50:51], v28 offset:6400
    s_mul_i32 s22, s68, 36864
    v_mfma_f32_16x16x32_bf16 v[160:163], v[60:63], v[120:123], v[160:163]
    ds_read_b64_tr_b16 v[52:53], v29 offset:256
    s_mov_b32 m0, s34
    v_mfma_f32_16x16x32_bf16 v[164:167], v[60:63], v[124:127], v[164:167]
    ds_read_b64_tr_b16 v[54:55], v29 offset:6400
    s_waitcnt lgkmcnt(8)
    v_mfma_f32_16x16x32_bf16 v[168:171], v[64:67], v[120:123], v[168:171]
    ds_read_b64_tr_b16 v[56:57], v30 offset:256
    s_waitcnt vmcnt(7)
    v_mfma_f32_16x16x32_bf16 v[172:175], v[64:67], v[124:127], v[172:175]
    ds_read_b64_tr_b16 v[58:59], v30 offset:6400
    buffer_load_dwordx4 v20, s[8:11], s22 offen offset:0 lds
    v_mfma_f32_16x16x32_bf16 v[176:179], v[68:71], v[120:123], v[176:179]
    ds_read_b64_tr_b16 v[60:61], v31 offset:256
    s_barrier
    v_mfma_f32_16x16x32_bf16 v[180:183], v[68:71], v[124:127], v[180:183]
    ds_read_b64_tr_b16 v[62:63], v31 offset:6400
    s_waitcnt lgkmcnt(8)
    v_mfma_f32_16x16x32_bf16 v[184:187], v[72:75], v[120:123], v[184:187]
    ds_read_b64_tr_b16 v[64:65], v28 offset:12288
    buffer_load_dwordx4 v21, s[8:11], s22 offen offset:1024 lds
    v_mfma_f32_16x16x32_bf16 v[188:191], v[72:75], v[124:127], v[188:191]
    ds_read_b64_tr_b16 v[66:67], v28 offset:18432
    v_mfma_f32_16x16x32_bf16 v[192:195], v[76:79], v[120:123], v[192:195]
    ds_read_b64_tr_b16 v[68:69], v29 offset:12288
    buffer_load_dwordx4 v22, s[8:11], s22 offen offset:2048 lds
    v_mfma_f32_16x16x32_bf16 v[196:199], v[76:79], v[124:127], v[196:199]
    ds_read_b64_tr_b16 v[70:71], v29 offset:18432
    s_waitcnt lgkmcnt(8)
    v_mfma_f32_16x16x32_bf16 v[200:203], v[48:51], v[120:123], v[200:203]
    ds_read_b64_tr_b16 v[72:73], v30 offset:12288
    v_mfma_f32_16x16x32_bf16 v[204:207], v[48:51], v[124:127], v[204:207]
    ds_read_b64_tr_b16 v[74:75], v30 offset:18432
    v_mfma_f32_16x16x32_bf16 v[208:211], v[52:55], v[120:123], v[208:211]
    ds_read_b64_tr_b16 v[76:77], v31 offset:12288
    v_mfma_f32_16x16x32_bf16 v[212:215], v[52:55], v[124:127], v[212:215]
    ds_read_b64_tr_b16 v[78:79], v31 offset:18432
    s_waitcnt lgkmcnt(8)
    v_mfma_f32_16x16x32_bf16 v[216:219], v[56:59], v[120:123], v[216:219]
    ds_read_b64_tr_b16 v[48:49], v28 offset:12416
    v_mfma_f32_16x16x32_bf16 v[220:223], v[56:59], v[124:127], v[220:223]
    ds_read_b64_tr_b16 v[50:51], v28 offset:18560
    v_mfma_f32_16x16x32_bf16 v[224:227], v[60:63], v[120:123], v[224:227]
    ds_read_b64_tr_b16 v[52:53], v29 offset:12416
    v_mfma_f32_16x16x32_bf16 v[228:231], v[60:63], v[124:127], v[228:231]
    ds_read_b64_tr_b16 v[54:55], v29 offset:18560
    s_waitcnt lgkmcnt(8)
    v_mfma_f32_16x16x32_bf16 v[136:139], v[64:67], v[128:131], v[136:139]
    ds_read_b64_tr_b16 v[56:57], v30 offset:12416
    s_lshl_b32 s23, s68, 13
    v_mfma_f32_16x16x32_bf16 v[140:143], v[64:67], v[132:135], v[140:143]
    ds_read_b64_tr_b16 v[58:59], v30 offset:18560
    buffer_load_dwordx4 v[96:99], v32, s[4:7], s23 offen offset:0 sc1
    v_mfma_f32_16x16x32_bf16 v[144:147], v[68:71], v[128:131], v[144:147]
    ds_read_b64_tr_b16 v[60:61], v31 offset:12416
    v_mfma_f32_16x16x32_bf16 v[148:151], v[68:71], v[132:135], v[148:151]
    ds_read_b64_tr_b16 v[62:63], v31 offset:18560
    s_waitcnt lgkmcnt(8)
    v_mfma_f32_16x16x32_bf16 v[152:155], v[72:75], v[128:131], v[152:155]
    ds_read_b64_tr_b16 v[64:65], v28 offset:12544
    buffer_load_dwordx4 v[100:103], v32, s[4:7], s23 offen offset:1024 sc1
    v_mfma_f32_16x16x32_bf16 v[156:159], v[72:75], v[132:135], v[156:159]
    ds_read_b64_tr_b16 v[66:67], v28 offset:18688
    s_mul_i32 s22, s69, 36864
    v_mfma_f32_16x16x32_bf16 v[160:163], v[76:79], v[128:131], v[160:163]
    ds_read_b64_tr_b16 v[68:69], v29 offset:12544
    s_mov_b32 m0, s35
    v_mfma_f32_16x16x32_bf16 v[164:167], v[76:79], v[132:135], v[164:167]
    ds_read_b64_tr_b16 v[70:71], v29 offset:18688
    s_waitcnt lgkmcnt(8)
    v_mfma_f32_16x16x32_bf16 v[168:171], v[48:51], v[128:131], v[168:171]
    ds_read_b64_tr_b16 v[72:73], v30 offset:12544
    buffer_load_dwordx4 v20, s[8:11], s22 offen offset:0 lds
    v_mfma_f32_16x16x32_bf16 v[172:175], v[48:51], v[132:135], v[172:175]
    ds_read_b64_tr_b16 v[74:75], v30 offset:18688
    v_mfma_f32_16x16x32_bf16 v[176:179], v[52:55], v[128:131], v[176:179]
    ds_read_b64_tr_b16 v[76:77], v31 offset:12544
    buffer_load_dwordx4 v21, s[8:11], s22 offen offset:1024 lds
    v_mfma_f32_16x16x32_bf16 v[180:183], v[52:55], v[132:135], v[180:183]
    ds_read_b64_tr_b16 v[78:79], v31 offset:18688
    s_waitcnt lgkmcnt(8)
    v_mfma_f32_16x16x32_bf16 v[184:187], v[56:59], v[128:131], v[184:187]
    ds_read_b64_tr_b16 v[48:49], v24 offset:0
    buffer_load_dwordx4 v22, s[8:11], s22 offen offset:2048 lds
    v_mfma_f32_16x16x32_bf16 v[188:191], v[56:59], v[132:135], v[188:191]
    ds_read_b64_tr_b16 v[50:51], v24 offset:6144
    v_mfma_f32_16x16x32_bf16 v[192:195], v[60:63], v[128:131], v[192:195]
    ds_read_b64_tr_b16 v[52:53], v25 offset:0
    v_mfma_f32_16x16x32_bf16 v[196:199], v[60:63], v[132:135], v[196:199]
    ds_read_b64_tr_b16 v[54:55], v25 offset:6144
    s_waitcnt lgkmcnt(8)
    v_mfma_f32_16x16x32_bf16 v[200:203], v[64:67], v[128:131], v[200:203]
    ds_read_b64_tr_b16 v[56:57], v26 offset:0
    v_mfma_f32_16x16x32_bf16 v[204:207], v[64:67], v[132:135], v[204:207]
    ds_read_b64_tr_b16 v[58:59], v26 offset:6144
    v_mfma_f32_16x16x32_bf16 v[208:211], v[68:71], v[128:131], v[208:211]
    ds_read_b64_tr_b16 v[60:61], v27 offset:0
    v_mfma_f32_16x16x32_bf16 v[212:215], v[68:71], v[132:135], v[212:215]
    ds_read_b64_tr_b16 v[62:63], v27 offset:6144
    s_waitcnt lgkmcnt(8)
    v_mfma_f32_16x16x32_bf16 v[216:219], v[72:75], v[128:131], v[216:219]
    ds_read_b64_tr_b16 v[64:65], v24 offset:128
    v_mfma_f32_16x16x32_bf16 v[220:223], v[72:75], v[132:135], v[220:223]
    ds_read_b64_tr_b16 v[66:67], v24 offset:6272
    s_waitcnt vmcnt(13)
    v_mfma_f32_16x16x32_bf16 v[224:227], v[76:79], v[128:131], v[224:227]
    ds_read_b64_tr_b16 v[68:69], v25 offset:128
    v_mfma_f32_16x16x32_bf16 v[228:231], v[76:79], v[132:135], v[228:231]
    ds_read_b64_tr_b16 v[70:71], v25 offset:6272
    s_waitcnt lgkmcnt(8)
    v_mfma_f32_16x16x32_bf16 v[136:139], v[48:51], v[80:83], v[136:139]
    ds_read_b64_tr_b16 v[72:73], v26 offset:128
    s_lshl_b32 s23, s69, 13
    v_mfma_f32_16x16x32_bf16 v[140:143], v[48:51], v[84:87], v[140:143]
    ds_read_b64_tr_b16 v[74:75], v26 offset:6272
    buffer_load_dwordx4 v[104:107], v32, s[4:7], s23 offen offset:0 sc1
    v_mfma_f32_16x16x32_bf16 v[144:147], v[52:55], v[80:83], v[144:147]
    ds_read_b64_tr_b16 v[76:77], v27 offset:128
    v_mfma_f32_16x16x32_bf16 v[148:151], v[52:55], v[84:87], v[148:151]
    ds_read_b64_tr_b16 v[78:79], v27 offset:6272
    s_waitcnt lgkmcnt(8)
    v_mfma_f32_16x16x32_bf16 v[152:155], v[56:59], v[80:83], v[152:155]
    ds_read_b64_tr_b16 v[48:49], v24 offset:256
    buffer_load_dwordx4 v[108:111], v32, s[4:7], s23 offen offset:1024 sc1
    v_mfma_f32_16x16x32_bf16 v[156:159], v[56:59], v[84:87], v[156:159]
    ds_read_b64_tr_b16 v[50:51], v24 offset:6400
    s_mul_i32 s22, s70, 36864
    v_mfma_f32_16x16x32_bf16 v[160:163], v[60:63], v[80:83], v[160:163]
    ds_read_b64_tr_b16 v[52:53], v25 offset:256
    s_mov_b32 m0, s36
    v_mfma_f32_16x16x32_bf16 v[164:167], v[60:63], v[84:87], v[164:167]
    ds_read_b64_tr_b16 v[54:55], v25 offset:6400
    s_waitcnt lgkmcnt(8)
    v_mfma_f32_16x16x32_bf16 v[168:171], v[64:67], v[80:83], v[168:171]
    ds_read_b64_tr_b16 v[56:57], v26 offset:256
    s_waitcnt vmcnt(7)
    v_mfma_f32_16x16x32_bf16 v[172:175], v[64:67], v[84:87], v[172:175]
    ds_read_b64_tr_b16 v[58:59], v26 offset:6400
    buffer_load_dwordx4 v20, s[8:11], s22 offen offset:0 lds
    v_mfma_f32_16x16x32_bf16 v[176:179], v[68:71], v[80:83], v[176:179]
    ds_read_b64_tr_b16 v[60:61], v27 offset:256
    s_barrier
    v_mfma_f32_16x16x32_bf16 v[180:183], v[68:71], v[84:87], v[180:183]
    ds_read_b64_tr_b16 v[62:63], v27 offset:6400
    s_waitcnt lgkmcnt(8)
    v_mfma_f32_16x16x32_bf16 v[184:187], v[72:75], v[80:83], v[184:187]
    ds_read_b64_tr_b16 v[64:65], v24 offset:12288
    buffer_load_dwordx4 v21, s[8:11], s22 offen offset:1024 lds
    v_mfma_f32_16x16x32_bf16 v[188:191], v[72:75], v[84:87], v[188:191]
    ds_read_b64_tr_b16 v[66:67], v24 offset:18432
    v_mfma_f32_16x16x32_bf16 v[192:195], v[76:79], v[80:83], v[192:195]
    ds_read_b64_tr_b16 v[68:69], v25 offset:12288
    buffer_load_dwordx4 v22, s[8:11], s22 offen offset:2048 lds
    v_mfma_f32_16x16x32_bf16 v[196:199], v[76:79], v[84:87], v[196:199]
    ds_read_b64_tr_b16 v[70:71], v25 offset:18432
    s_waitcnt lgkmcnt(8)
    v_mfma_f32_16x16x32_bf16 v[200:203], v[48:51], v[80:83], v[200:203]
    ds_read_b64_tr_b16 v[72:73], v26 offset:12288
    v_mfma_f32_16x16x32_bf16 v[204:207], v[48:51], v[84:87], v[204:207]
    ds_read_b64_tr_b16 v[74:75], v26 offset:18432
    v_mfma_f32_16x16x32_bf16 v[208:211], v[52:55], v[80:83], v[208:211]
    ds_read_b64_tr_b16 v[76:77], v27 offset:12288
    v_mfma_f32_16x16x32_bf16 v[212:215], v[52:55], v[84:87], v[212:215]
    ds_read_b64_tr_b16 v[78:79], v27 offset:18432
    s_waitcnt lgkmcnt(8)
    v_mfma_f32_16x16x32_bf16 v[216:219], v[56:59], v[80:83], v[216:219]
    ds_read_b64_tr_b16 v[48:49], v24 offset:12416
    v_mfma_f32_16x16x32_bf16 v[220:223], v[56:59], v[84:87], v[220:223]
    ds_read_b64_tr_b16 v[50:51], v24 offset:18560
    v_mfma_f32_16x16x32_bf16 v[224:227], v[60:63], v[80:83], v[224:227]
    ds_read_b64_tr_b16 v[52:53], v25 offset:12416
    v_mfma_f32_16x16x32_bf16 v[228:231], v[60:63], v[84:87], v[228:231]
    ds_read_b64_tr_b16 v[54:55], v25 offset:18560
    s_waitcnt lgkmcnt(8)
    v_mfma_f32_16x16x32_bf16 v[136:139], v[64:67], v[88:91], v[136:139]
    ds_read_b64_tr_b16 v[56:57], v26 offset:12416
    s_lshl_b32 s23, s70, 13
    v_mfma_f32_16x16x32_bf16 v[140:143], v[64:67], v[92:95], v[140:143]
    ds_read_b64_tr_b16 v[58:59], v26 offset:18560
    buffer_load_dwordx4 v[112:115], v32, s[4:7], s23 offen offset:0 sc1
    v_mfma_f32_16x16x32_bf16 v[144:147], v[68:71], v[88:91], v[144:147]
    ds_read_b64_tr_b16 v[60:61], v27 offset:12416
    v_mfma_f32_16x16x32_bf16 v[148:151], v[68:71], v[92:95], v[148:151]
    ds_read_b64_tr_b16 v[62:63], v27 offset:18560
    s_waitcnt lgkmcnt(8)
    v_mfma_f32_16x16x32_bf16 v[152:155], v[72:75], v[88:91], v[152:155]
    ds_read_b64_tr_b16 v[64:65], v24 offset:12544
    buffer_load_dwordx4 v[116:119], v32, s[4:7], s23 offen offset:1024 sc1
    v_mfma_f32_16x16x32_bf16 v[156:159], v[72:75], v[92:95], v[156:159]
    ds_read_b64_tr_b16 v[66:67], v24 offset:18688
    s_mul_i32 s22, s71, 36864
    v_mfma_f32_16x16x32_bf16 v[160:163], v[76:79], v[88:91], v[160:163]
    ds_read_b64_tr_b16 v[68:69], v25 offset:12544
    s_mov_b32 m0, s37
    v_mfma_f32_16x16x32_bf16 v[164:167], v[76:79], v[92:95], v[164:167]
    ds_read_b64_tr_b16 v[70:71], v25 offset:18688
    s_waitcnt lgkmcnt(8)
    v_mfma_f32_16x16x32_bf16 v[168:171], v[48:51], v[88:91], v[168:171]
    ds_read_b64_tr_b16 v[72:73], v26 offset:12544
    buffer_load_dwordx4 v20, s[8:11], s22 offen offset:0 lds
    v_mfma_f32_16x16x32_bf16 v[172:175], v[48:51], v[92:95], v[172:175]
    ds_read_b64_tr_b16 v[74:75], v26 offset:18688
    v_mfma_f32_16x16x32_bf16 v[176:179], v[52:55], v[88:91], v[176:179]
    ds_read_b64_tr_b16 v[76:77], v27 offset:12544
    buffer_load_dwordx4 v21, s[8:11], s22 offen offset:1024 lds
    v_mfma_f32_16x16x32_bf16 v[180:183], v[52:55], v[92:95], v[180:183]
    ds_read_b64_tr_b16 v[78:79], v27 offset:18688
    s_waitcnt lgkmcnt(8)
    v_mfma_f32_16x16x32_bf16 v[184:187], v[56:59], v[88:91], v[184:187]
    ds_read_b64_tr_b16 v[48:49], v24 offset:24576
    buffer_load_dwordx4 v22, s[8:11], s22 offen offset:2048 lds
    v_mfma_f32_16x16x32_bf16 v[188:191], v[56:59], v[92:95], v[188:191]
    ds_read_b64_tr_b16 v[50:51], v24 offset:30720
    v_mfma_f32_16x16x32_bf16 v[192:195], v[60:63], v[88:91], v[192:195]
    ds_read_b64_tr_b16 v[52:53], v25 offset:24576
    v_mfma_f32_16x16x32_bf16 v[196:199], v[60:63], v[92:95], v[196:199]
    ds_read_b64_tr_b16 v[54:55], v25 offset:30720
    s_waitcnt lgkmcnt(8)
    v_mfma_f32_16x16x32_bf16 v[200:203], v[64:67], v[88:91], v[200:203]
    ds_read_b64_tr_b16 v[56:57], v26 offset:24576
    v_mfma_f32_16x16x32_bf16 v[204:207], v[64:67], v[92:95], v[204:207]
    ds_read_b64_tr_b16 v[58:59], v26 offset:30720
    v_mfma_f32_16x16x32_bf16 v[208:211], v[68:71], v[88:91], v[208:211]
    ds_read_b64_tr_b16 v[60:61], v27 offset:24576
    v_mfma_f32_16x16x32_bf16 v[212:215], v[68:71], v[92:95], v[212:215]
    ds_read_b64_tr_b16 v[62:63], v27 offset:30720
    s_waitcnt lgkmcnt(8)
    v_mfma_f32_16x16x32_bf16 v[216:219], v[72:75], v[88:91], v[216:219]
    ds_read_b64_tr_b16 v[64:65], v24 offset:24704
    v_mfma_f32_16x16x32_bf16 v[220:223], v[72:75], v[92:95], v[220:223]
    ds_read_b64_tr_b16 v[66:67], v24 offset:30848
    s_waitcnt vmcnt(13)
    v_mfma_f32_16x16x32_bf16 v[224:227], v[76:79], v[88:91], v[224:227]
    ds_read_b64_tr_b16 v[68:69], v25 offset:24704
    v_mfma_f32_16x16x32_bf16 v[228:231], v[76:79], v[92:95], v[228:231]
    ds_read_b64_tr_b16 v[70:71], v25 offset:30848
    s_waitcnt lgkmcnt(8)
    v_mfma_f32_16x16x32_bf16 v[136:139], v[48:51], v[96:99], v[136:139]
    ds_read_b64_tr_b16 v[72:73], v26 offset:24704
    s_lshl_b32 s23, s71, 13
    v_mfma_f32_16x16x32_bf16 v[140:143], v[48:51], v[100:103], v[140:143]
    ds_read_b64_tr_b16 v[74:75], v26 offset:30848
    buffer_load_dwordx4 v[120:123], v32, s[4:7], s23 offen offset:0 sc1
    v_mfma_f32_16x16x32_bf16 v[144:147], v[52:55], v[96:99], v[144:147]
    ds_read_b64_tr_b16 v[76:77], v27 offset:24704
    v_mfma_f32_16x16x32_bf16 v[148:151], v[52:55], v[100:103], v[148:151]
    ds_read_b64_tr_b16 v[78:79], v27 offset:30848
    s_waitcnt lgkmcnt(8)
    v_mfma_f32_16x16x32_bf16 v[152:155], v[56:59], v[96:99], v[152:155]
    ds_read_b64_tr_b16 v[48:49], v24 offset:24832
    buffer_load_dwordx4 v[124:127], v32, s[4:7], s23 offen offset:1024 sc1
    v_mfma_f32_16x16x32_bf16 v[156:159], v[56:59], v[100:103], v[156:159]
    ds_read_b64_tr_b16 v[50:51], v24 offset:30976
    s_mul_i32 s22, s72, 36864
    v_mfma_f32_16x16x32_bf16 v[160:163], v[60:63], v[96:99], v[160:163]
    ds_read_b64_tr_b16 v[52:53], v25 offset:24832
    s_mov_b32 m0, s38
    v_mfma_f32_16x16x32_bf16 v[164:167], v[60:63], v[100:103], v[164:167]
    ds_read_b64_tr_b16 v[54:55], v25 offset:30976
    s_waitcnt lgkmcnt(8)
    v_mfma_f32_16x16x32_bf16 v[168:171], v[64:67], v[96:99], v[168:171]
    ds_read_b64_tr_b16 v[56:57], v26 offset:24832
    s_waitcnt vmcnt(7)
    v_mfma_f32_16x16x32_bf16 v[172:175], v[64:67], v[100:103], v[172:175]
    ds_read_b64_tr_b16 v[58:59], v26 offset:30976
    buffer_load_dwordx4 v20, s[8:11], s22 offen offset:0 lds
    v_mfma_f32_16x16x32_bf16 v[176:179], v[68:71], v[96:99], v[176:179]
    ds_read_b64_tr_b16 v[60:61], v27 offset:24832
    s_barrier
    v_mfma_f32_16x16x32_bf16 v[180:183], v[68:71], v[100:103], v[180:183]
    ds_read_b64_tr_b16 v[62:63], v27 offset:30976
    s_waitcnt lgkmcnt(8)
    v_mfma_f32_16x16x32_bf16 v[184:187], v[72:75], v[96:99], v[184:187]
    ds_read_b64_tr_b16 v[64:65], v24 offset:36864
    buffer_load_dwordx4 v21, s[8:11], s22 offen offset:1024 lds
    v_mfma_f32_16x16x32_bf16 v[188:191], v[72:75], v[100:103], v[188:191]
    ds_read_b64_tr_b16 v[66:67], v24 offset:43008
    v_mfma_f32_16x16x32_bf16 v[192:195], v[76:79], v[96:99], v[192:195]
    ds_read_b64_tr_b16 v[68:69], v25 offset:36864
    buffer_load_dwordx4 v22, s[8:11], s22 offen offset:2048 lds
    v_mfma_f32_16x16x32_bf16 v[196:199], v[76:79], v[100:103], v[196:199]
    ds_read_b64_tr_b16 v[70:71], v25 offset:43008
    s_waitcnt lgkmcnt(8)
    v_mfma_f32_16x16x32_bf16 v[200:203], v[48:51], v[96:99], v[200:203]
    ds_read_b64_tr_b16 v[72:73], v26 offset:36864
    v_mfma_f32_16x16x32_bf16 v[204:207], v[48:51], v[100:103], v[204:207]
    ds_read_b64_tr_b16 v[74:75], v26 offset:43008
    v_mfma_f32_16x16x32_bf16 v[208:211], v[52:55], v[96:99], v[208:211]
    ds_read_b64_tr_b16 v[76:77], v27 offset:36864
    v_mfma_f32_16x16x32_bf16 v[212:215], v[52:55], v[100:103], v[212:215]
    ds_read_b64_tr_b16 v[78:79], v27 offset:43008
    s_waitcnt lgkmcnt(8)
    v_mfma_f32_16x16x32_bf16 v[216:219], v[56:59], v[96:99], v[216:219]
    ds_read_b64_tr_b16 v[48:49], v24 offset:36992
    v_mfma_f32_16x16x32_bf16 v[220:223], v[56:59], v[100:103], v[220:223]
    ds_read_b64_tr_b16 v[50:51], v24 offset:43136
    v_mfma_f32_16x16x32_bf16 v[224:227], v[60:63], v[96:99], v[224:227]
    ds_read_b64_tr_b16 v[52:53], v25 offset:36992
    v_mfma_f32_16x16x32_bf16 v[228:231], v[60:63], v[100:103], v[228:231]
    ds_read_b64_tr_b16 v[54:55], v25 offset:43136
    s_waitcnt lgkmcnt(8)
    v_mfma_f32_16x16x32_bf16 v[136:139], v[64:67], v[104:107], v[136:139]
    ds_read_b64_tr_b16 v[56:57], v26 offset:36992
    s_lshl_b32 s23, s72, 13
    v_mfma_f32_16x16x32_bf16 v[140:143], v[64:67], v[108:111], v[140:143]
    ds_read_b64_tr_b16 v[58:59], v26 offset:43136
    buffer_load_dwordx4 v[128:131], v32, s[4:7], s23 offen offset:0 sc1
    v_mfma_f32_16x16x32_bf16 v[144:147], v[68:71], v[104:107], v[144:147]
    ds_read_b64_tr_b16 v[60:61], v27 offset:36992
    v_mfma_f32_16x16x32_bf16 v[148:151], v[68:71], v[108:111], v[148:151]
    ds_read_b64_tr_b16 v[62:63], v27 offset:43136
    s_waitcnt lgkmcnt(8)
    v_mfma_f32_16x16x32_bf16 v[152:155], v[72:75], v[104:107], v[152:155]
    ds_read_b64_tr_b16 v[64:65], v24 offset:37120
    buffer_load_dwordx4 v[132:135], v32, s[4:7], s23 offen offset:1024 sc1
    v_mfma_f32_16x16x32_bf16 v[156:159], v[72:75], v[108:111], v[156:159]
    ds_read_b64_tr_b16 v[66:67], v24 offset:43264
    s_mul_i32 s22, s73, 36864
    v_mfma_f32_16x16x32_bf16 v[160:163], v[76:79], v[104:107], v[160:163]
    ds_read_b64_tr_b16 v[68:69], v25 offset:37120
    s_mov_b32 m0, s32
    v_mfma_f32_16x16x32_bf16 v[164:167], v[76:79], v[108:111], v[164:167]
    ds_read_b64_tr_b16 v[70:71], v25 offset:43264
    s_waitcnt lgkmcnt(8)
    v_mfma_f32_16x16x32_bf16 v[168:171], v[48:51], v[104:107], v[168:171]
    ds_read_b64_tr_b16 v[72:73], v26 offset:37120
    buffer_load_dwordx4 v20, s[8:11], s22 offen offset:0 lds
    v_mfma_f32_16x16x32_bf16 v[172:175], v[48:51], v[108:111], v[172:175]
    ds_read_b64_tr_b16 v[74:75], v26 offset:43264
    v_mfma_f32_16x16x32_bf16 v[176:179], v[52:55], v[104:107], v[176:179]
    ds_read_b64_tr_b16 v[76:77], v27 offset:37120
    buffer_load_dwordx4 v21, s[8:11], s22 offen offset:1024 lds
    v_mfma_f32_16x16x32_bf16 v[180:183], v[52:55], v[108:111], v[180:183]
    ds_read_b64_tr_b16 v[78:79], v27 offset:43264
    s_waitcnt lgkmcnt(8)
    v_mfma_f32_16x16x32_bf16 v[184:187], v[56:59], v[104:107], v[184:187]
    ds_read_b64_tr_b16 v[48:49], v24 offset:49152
    buffer_load_dwordx4 v22, s[8:11], s22 offen offset:2048 lds
    v_mfma_f32_16x16x32_bf16 v[188:191], v[56:59], v[108:111], v[188:191]
    ds_read_b64_tr_b16 v[50:51], v24 offset:55296
    v_mfma_f32_16x16x32_bf16 v[192:195], v[60:63], v[104:107], v[192:195]
    ds_read_b64_tr_b16 v[52:53], v25 offset:49152
    v_mfma_f32_16x16x32_bf16 v[196:199], v[60:63], v[108:111], v[196:199]
    ds_read_b64_tr_b16 v[54:55], v25 offset:55296
    s_waitcnt lgkmcnt(8)
    v_mfma_f32_16x16x32_bf16 v[200:203], v[64:67], v[104:107], v[200:203]
    ds_read_b64_tr_b16 v[56:57], v26 offset:49152
    v_mfma_f32_16x16x32_bf16 v[204:207], v[64:67], v[108:111], v[204:207]
    ds_read_b64_tr_b16 v[58:59], v26 offset:55296
    v_mfma_f32_16x16x32_bf16 v[208:211], v[68:71], v[104:107], v[208:211]
    ds_read_b64_tr_b16 v[60:61], v27 offset:49152
    v_mfma_f32_16x16x32_bf16 v[212:215], v[68:71], v[108:111], v[212:215]
    ds_read_b64_tr_b16 v[62:63], v27 offset:55296
    s_waitcnt lgkmcnt(8)
    v_mfma_f32_16x16x32_bf16 v[216:219], v[72:75], v[104:107], v[216:219]
    ds_read_b64_tr_b16 v[64:65], v24 offset:49280
    v_mfma_f32_16x16x32_bf16 v[220:223], v[72:75], v[108:111], v[220:223]
    ds_read_b64_tr_b16 v[66:67], v24 offset:55424
    s_waitcnt vmcnt(13)
    v_mfma_f32_16x16x32_bf16 v[224:227], v[76:79], v[104:107], v[224:227]
    ds_read_b64_tr_b16 v[68:69], v25 offset:49280
    v_mfma_f32_16x16x32_bf16 v[228:231], v[76:79], v[108:111], v[228:231]
    ds_read_b64_tr_b16 v[70:71], v25 offset:55424
    s_waitcnt lgkmcnt(8)
    v_mfma_f32_16x16x32_bf16 v[136:139], v[48:51], v[112:115], v[136:139]
    ds_read_b64_tr_b16 v[72:73], v26 offset:49280
    s_lshl_b32 s23, s73, 13
    v_mfma_f32_16x16x32_bf16 v[140:143], v[48:51], v[116:119], v[140:143]
    ds_read_b64_tr_b16 v[74:75], v26 offset:55424
    buffer_load_dwordx4 v[80:83], v32, s[4:7], s23 offen offset:0 sc1
    v_mfma_f32_16x16x32_bf16 v[144:147], v[52:55], v[112:115], v[144:147]
    ds_read_b64_tr_b16 v[76:77], v27 offset:49280
    v_mfma_f32_16x16x32_bf16 v[148:151], v[52:55], v[116:119], v[148:151]
    ds_read_b64_tr_b16 v[78:79], v27 offset:55424
    s_waitcnt lgkmcnt(8)
    v_mfma_f32_16x16x32_bf16 v[152:155], v[56:59], v[112:115], v[152:155]
    ds_read_b64_tr_b16 v[48:49], v24 offset:49408
    buffer_load_dwordx4 v[84:87], v32, s[4:7], s23 offen offset:1024 sc1
    v_mfma_f32_16x16x32_bf16 v[156:159], v[56:59], v[116:119], v[156:159]
    ds_read_b64_tr_b16 v[50:51], v24 offset:55552
    s_mul_i32 s22, s74, 36864
    v_mfma_f32_16x16x32_bf16 v[160:163], v[60:63], v[112:115], v[160:163]
    ds_read_b64_tr_b16 v[52:53], v25 offset:49408
    s_mov_b32 m0, s33
    v_mfma_f32_16x16x32_bf16 v[164:167], v[60:63], v[116:119], v[164:167]
    ds_read_b64_tr_b16 v[54:55], v25 offset:55552
    s_waitcnt lgkmcnt(8)
    v_mfma_f32_16x16x32_bf16 v[168:171], v[64:67], v[112:115], v[168:171]
    ds_read_b64_tr_b16 v[56:57], v26 offset:49408
    s_waitcnt vmcnt(7)
    v_mfma_f32_16x16x32_bf16 v[172:175], v[64:67], v[116:119], v[172:175]
    ds_read_b64_tr_b16 v[58:59], v26 offset:55552
    buffer_load_dwordx4 v20, s[8:11], s22 offen offset:0 lds
    v_mfma_f32_16x16x32_bf16 v[176:179], v[68:71], v[112:115], v[176:179]
    ds_read_b64_tr_b16 v[60:61], v27 offset:49408
    s_barrier
    v_mfma_f32_16x16x32_bf16 v[180:183], v[68:71], v[116:119], v[180:183]
    ds_read_b64_tr_b16 v[62:63], v27 offset:55552
    s_waitcnt lgkmcnt(8)
    v_mfma_f32_16x16x32_bf16 v[184:187], v[72:75], v[112:115], v[184:187]
    ds_read_b64_tr_b16 v[64:65], v28 offset:0
    buffer_load_dwordx4 v21, s[8:11], s22 offen offset:1024 lds
    v_mfma_f32_16x16x32_bf16 v[188:191], v[72:75], v[116:119], v[188:191]
    ds_read_b64_tr_b16 v[66:67], v28 offset:6144
    v_mfma_f32_16x16x32_bf16 v[192:195], v[76:79], v[112:115], v[192:195]
    ds_read_b64_tr_b16 v[68:69], v29 offset:0
    buffer_load_dwordx4 v22, s[8:11], s22 offen offset:2048 lds
    v_mfma_f32_16x16x32_bf16 v[196:199], v[76:79], v[116:119], v[196:199]
    ds_read_b64_tr_b16 v[70:71], v29 offset:6144
    s_waitcnt lgkmcnt(8)
    v_mfma_f32_16x16x32_bf16 v[200:203], v[48:51], v[112:115], v[200:203]
    ds_read_b64_tr_b16 v[72:73], v30 offset:0
    v_mfma_f32_16x16x32_bf16 v[204:207], v[48:51], v[116:119], v[204:207]
    ds_read_b64_tr_b16 v[74:75], v30 offset:6144
    v_mfma_f32_16x16x32_bf16 v[208:211], v[52:55], v[112:115], v[208:211]
    ds_read_b64_tr_b16 v[76:77], v31 offset:0
    v_mfma_f32_16x16x32_bf16 v[212:215], v[52:55], v[116:119], v[212:215]
    ds_read_b64_tr_b16 v[78:79], v31 offset:6144
    s_waitcnt lgkmcnt(8)
    v_mfma_f32_16x16x32_bf16 v[216:219], v[56:59], v[112:115], v[216:219]
    ds_read_b64_tr_b16 v[48:49], v28 offset:128
    v_mfma_f32_16x16x32_bf16 v[220:223], v[56:59], v[116:119], v[220:223]
    ds_read_b64_tr_b16 v[50:51], v28 offset:6272
    v_mfma_f32_16x16x32_bf16 v[224:227], v[60:63], v[112:115], v[224:227]
    ds_read_b64_tr_b16 v[52:53], v29 offset:128
    v_mfma_f32_16x16x32_bf16 v[228:231], v[60:63], v[116:119], v[228:231]
    ds_read_b64_tr_b16 v[54:55], v29 offset:6272
    s_waitcnt lgkmcnt(8)
    v_mfma_f32_16x16x32_bf16 v[136:139], v[64:67], v[120:123], v[136:139]
    ds_read_b64_tr_b16 v[56:57], v30 offset:128
    s_lshl_b32 s23, s74, 13
    v_mfma_f32_16x16x32_bf16 v[140:143], v[64:67], v[124:127], v[140:143]
    ds_read_b64_tr_b16 v[58:59], v30 offset:6272
    buffer_load_dwordx4 v[88:91], v32, s[4:7], s23 offen offset:0 sc1
    v_mfma_f32_16x16x32_bf16 v[144:147], v[68:71], v[120:123], v[144:147]
    ds_read_b64_tr_b16 v[60:61], v31 offset:128
    v_mfma_f32_16x16x32_bf16 v[148:151], v[68:71], v[124:127], v[148:151]
    ds_read_b64_tr_b16 v[62:63], v31 offset:6272
    s_waitcnt lgkmcnt(8)
    v_mfma_f32_16x16x32_bf16 v[152:155], v[72:75], v[120:123], v[152:155]
    ds_read_b64_tr_b16 v[64:65], v28 offset:256
    buffer_load_dword v38, v37, s[12:15], 0 offen sc1
    v_mfma_f32_16x16x32_bf16 v[156:159], v[72:75], v[124:127], v[156:159]
    ds_read_b64_tr_b16 v[66:67], v28 offset:6400
    buffer_load_dwordx4 v[92:95], v32, s[4:7], s23 offen offset:1024 sc1
    v_mfma_f32_16x16x32_bf16 v[160:163], v[76:79], v[120:123], v[160:163]
    ds_read_b64_tr_b16 v[68:69], v29 offset:256
    s_mul_i32 s22, s75, 36864
    v_mfma_f32_16x16x32_bf16 v[164:167], v[76:79], v[124:127], v[164:167]
    ds_read_b64_tr_b16 v[70:71], v29 offset:6400
    s_waitcnt lgkmcnt(8)
    v_mfma_f32_16x16x32_bf16 v[168:171], v[48:51], v[120:123], v[168:171]
    ds_read_b64_tr_b16 v[72:73], v30 offset:256
    s_mov_b32 m0, s34
    v_mfma_f32_16x16x32_bf16 v[172:175], v[48:51], v[124:127], v[172:175]
    ds_read_b64_tr_b16 v[74:75], v30 offset:6400
    buffer_load_dwordx4 v20, s[8:11], s22 offen offset:0 lds
    v_mfma_f32_16x16x32_bf16 v[176:179], v[52:55], v[120:123], v[176:179]
    ds_read_b64_tr_b16 v[76:77], v31 offset:256
    v_mfma_f32_16x16x32_bf16 v[180:183], v[52:55], v[124:127], v[180:183]
    ds_read_b64_tr_b16 v[78:79], v31 offset:6400
    s_waitcnt lgkmcnt(8)
    v_mfma_f32_16x16x32_bf16 v[184:187], v[56:59], v[120:123], v[184:187]
    ds_read_b64_tr_b16 v[48:49], v28 offset:12288
    buffer_load_dwordx4 v21, s[8:11], s22 offen offset:1024 lds
    v_mfma_f32_16x16x32_bf16 v[188:191], v[56:59], v[124:127], v[188:191]
    ds_read_b64_tr_b16 v[50:51], v28 offset:18432
    v_mfma_f32_16x16x32_bf16 v[192:195], v[60:63], v[120:123], v[192:195]
    ds_read_b64_tr_b16 v[52:53], v29 offset:12288
    buffer_load_dwordx4 v22, s[8:11], s22 offen offset:2048 lds
    v_mfma_f32_16x16x32_bf16 v[196:199], v[60:63], v[124:127], v[196:199]
    ds_read_b64_tr_b16 v[54:55], v29 offset:18432
    s_waitcnt lgkmcnt(8)
    v_mfma_f32_16x16x32_bf16 v[200:203], v[64:67], v[120:123], v[200:203]
    ds_read_b64_tr_b16 v[56:57], v30 offset:12288
    v_mfma_f32_16x16x32_bf16 v[204:207], v[64:67], v[124:127], v[204:207]
    ds_read_b64_tr_b16 v[58:59], v30 offset:18432
    v_mfma_f32_16x16x32_bf16 v[208:211], v[68:71], v[120:123], v[208:211]
    ds_read_b64_tr_b16 v[60:61], v31 offset:12288
    v_mfma_f32_16x16x32_bf16 v[212:215], v[68:71], v[124:127], v[212:215]
    ds_read_b64_tr_b16 v[62:63], v31 offset:18432
    s_waitcnt lgkmcnt(8)
    v_mfma_f32_16x16x32_bf16 v[216:219], v[72:75], v[120:123], v[216:219]
    ds_read_b64_tr_b16 v[64:65], v28 offset:12416
    v_mfma_f32_16x16x32_bf16 v[220:223], v[72:75], v[124:127], v[220:223]
    ds_read_b64_tr_b16 v[66:67], v28 offset:18560
    s_waitcnt vmcnt(14)
    v_mfma_f32_16x16x32_bf16 v[224:227], v[76:79], v[120:123], v[224:227]
    ds_read_b64_tr_b16 v[68:69], v29 offset:12416
    v_mfma_f32_16x16x32_bf16 v[228:231], v[76:79], v[124:127], v[228:231]
    ds_read_b64_tr_b16 v[70:71], v29 offset:18560
    s_waitcnt lgkmcnt(8)
    v_mfma_f32_16x16x32_bf16 v[136:139], v[48:51], v[128:131], v[136:139]
    ds_read_b64_tr_b16 v[72:73], v30 offset:12416
    s_lshl_b32 s23, s75, 13
    v_mfma_f32_16x16x32_bf16 v[140:143], v[48:51], v[132:135], v[140:143]
    ds_read_b64_tr_b16 v[74:75], v30 offset:18560
    buffer_load_dwordx4 v[96:99], v32, s[4:7], s23 offen offset:0 sc1
    v_mfma_f32_16x16x32_bf16 v[144:147], v[52:55], v[128:131], v[144:147]
    ds_read_b64_tr_b16 v[76:77], v31 offset:12416
    v_mfma_f32_16x16x32_bf16 v[148:151], v[52:55], v[132:135], v[148:151]
    ds_read_b64_tr_b16 v[78:79], v31 offset:18560
    s_waitcnt lgkmcnt(8)
    v_mfma_f32_16x16x32_bf16 v[152:155], v[56:59], v[128:131], v[152:155]
    ds_read_b64_tr_b16 v[48:49], v28 offset:12544
    buffer_load_dwordx4 v[100:103], v32, s[4:7], s23 offen offset:1024 sc1
    v_mfma_f32_16x16x32_bf16 v[156:159], v[56:59], v[132:135], v[156:159]
    ds_read_b64_tr_b16 v[50:51], v28 offset:18688
    s_mul_i32 s22, s76, 36864
    v_mfma_f32_16x16x32_bf16 v[160:163], v[60:63], v[128:131], v[160:163]
    ds_read_b64_tr_b16 v[52:53], v29 offset:12544
    s_mov_b32 m0, s35
    v_mfma_f32_16x16x32_bf16 v[164:167], v[60:63], v[132:135], v[164:167]
    ds_read_b64_tr_b16 v[54:55], v29 offset:18688
    s_waitcnt lgkmcnt(8)
    v_mfma_f32_16x16x32_bf16 v[168:171], v[64:67], v[128:131], v[168:171]
    ds_read_b64_tr_b16 v[56:57], v30 offset:12544
    s_waitcnt vmcnt(8)
    v_mfma_f32_16x16x32_bf16 v[172:175], v[64:67], v[132:135], v[172:175]
    ds_read_b64_tr_b16 v[58:59], v30 offset:18688
    buffer_load_dwordx4 v20, s[8:11], s22 offen offset:0 lds
    v_mfma_f32_16x16x32_bf16 v[176:179], v[68:71], v[128:131], v[176:179]
    ds_read_b64_tr_b16 v[60:61], v31 offset:12544
    s_barrier
    v_mfma_f32_16x16x32_bf16 v[180:183], v[68:71], v[132:135], v[180:183]
    ds_read_b64_tr_b16 v[62:63], v31 offset:18688
    s_waitcnt lgkmcnt(8)
    v_mfma_f32_16x16x32_bf16 v[184:187], v[72:75], v[128:131], v[184:187]
    ds_read_b64_tr_b16 v[64:65], v24 offset:0
    buffer_load_dwordx4 v21, s[8:11], s22 offen offset:1024 lds
    v_mfma_f32_16x16x32_bf16 v[188:191], v[72:75], v[132:135], v[188:191]
    ds_read_b64_tr_b16 v[66:67], v24 offset:6144
    v_mfma_f32_16x16x32_bf16 v[192:195], v[76:79], v[128:131], v[192:195]
    ds_read_b64_tr_b16 v[68:69], v25 offset:0
    buffer_load_dwordx4 v22, s[8:11], s22 offen offset:2048 lds
    v_mfma_f32_16x16x32_bf16 v[196:199], v[76:79], v[132:135], v[196:199]
    ds_read_b64_tr_b16 v[70:71], v25 offset:6144
    s_waitcnt lgkmcnt(8)
    v_mfma_f32_16x16x32_bf16 v[200:203], v[48:51], v[128:131], v[200:203]
    ds_read_b64_tr_b16 v[72:73], v26 offset:0
    v_mfma_f32_16x16x32_bf16 v[204:207], v[48:51], v[132:135], v[204:207]
    ds_read_b64_tr_b16 v[74:75], v26 offset:6144
    v_mfma_f32_16x16x32_bf16 v[208:211], v[52:55], v[128:131], v[208:211]
    ds_read_b64_tr_b16 v[76:77], v27 offset:0
    v_mfma_f32_16x16x32_bf16 v[212:215], v[52:55], v[132:135], v[212:215]
    ds_read_b64_tr_b16 v[78:79], v27 offset:6144
    s_waitcnt lgkmcnt(8)
    v_mfma_f32_16x16x32_bf16 v[216:219], v[56:59], v[128:131], v[216:219]
    ds_read_b64_tr_b16 v[48:49], v24 offset:128
    v_mfma_f32_16x16x32_bf16 v[220:223], v[56:59], v[132:135], v[220:223]
    ds_read_b64_tr_b16 v[50:51], v24 offset:6272
    v_mfma_f32_16x16x32_bf16 v[224:227], v[60:63], v[128:131], v[224:227]
    ds_read_b64_tr_b16 v[52:53], v25 offset:128
    v_mfma_f32_16x16x32_bf16 v[228:231], v[60:63], v[132:135], v[228:231]
    ds_read_b64_tr_b16 v[54:55], v25 offset:6272
    s_waitcnt lgkmcnt(8)
    v_mfma_f32_16x16x32_bf16 v[136:139], v[64:67], v[80:83], v[136:139]
    ds_read_b64_tr_b16 v[56:57], v26 offset:128
    s_lshl_b32 s23, s76, 13
    v_mfma_f32_16x16x32_bf16 v[140:143], v[64:67], v[84:87], v[140:143]
    ds_read_b64_tr_b16 v[58:59], v26 offset:6272
    buffer_load_dwordx4 v[104:107], v32, s[4:7], s23 offen offset:0 sc1
    v_mfma_f32_16x16x32_bf16 v[144:147], v[68:71], v[80:83], v[144:147]
    ds_read_b64_tr_b16 v[60:61], v27 offset:128
    v_mfma_f32_16x16x32_bf16 v[148:151], v[68:71], v[84:87], v[148:151]
    ds_read_b64_tr_b16 v[62:63], v27 offset:6272
    s_waitcnt lgkmcnt(8)
    v_mfma_f32_16x16x32_bf16 v[152:155], v[72:75], v[80:83], v[152:155]
    ds_read_b64_tr_b16 v[64:65], v24 offset:256
    buffer_load_dwordx4 v[108:111], v32, s[4:7], s23 offen offset:1024 sc1
    v_mfma_f32_16x16x32_bf16 v[156:159], v[72:75], v[84:87], v[156:159]
    ds_read_b64_tr_b16 v[66:67], v24 offset:6400
    s_mul_i32 s22, s77, 36864
    v_mfma_f32_16x16x32_bf16 v[160:163], v[76:79], v[80:83], v[160:163]
    ds_read_b64_tr_b16 v[68:69], v25 offset:256
    s_mov_b32 m0, s36
    v_mfma_f32_16x16x32_bf16 v[164:167], v[76:79], v[84:87], v[164:167]
    ds_read_b64_tr_b16 v[70:71], v25 offset:6400
    s_waitcnt lgkmcnt(8)
    v_mfma_f32_16x16x32_bf16 v[168:171], v[48:51], v[80:83], v[168:171]
    ds_read_b64_tr_b16 v[72:73], v26 offset:256
    buffer_load_dwordx4 v20, s[8:11], s22 offen offset:0 lds
    v_mfma_f32_16x16x32_bf16 v[172:175], v[48:51], v[84:87], v[172:175]
    ds_read_b64_tr_b16 v[74:75], v26 offset:6400
    v_mfma_f32_16x16x32_bf16 v[176:179], v[52:55], v[80:83], v[176:179]
    ds_read_b64_tr_b16 v[76:77], v27 offset:256
    buffer_load_dwordx4 v21, s[8:11], s22 offen offset:1024 lds
    v_mfma_f32_16x16x32_bf16 v[180:183], v[52:55], v[84:87], v[180:183]
    ds_read_b64_tr_b16 v[78:79], v27 offset:6400
    s_waitcnt lgkmcnt(8)
    v_mfma_f32_16x16x32_bf16 v[184:187], v[56:59], v[80:83], v[184:187]
    ds_read_b64_tr_b16 v[48:49], v24 offset:12288
    buffer_load_dwordx4 v22, s[8:11], s22 offen offset:2048 lds
    v_mfma_f32_16x16x32_bf16 v[188:191], v[56:59], v[84:87], v[188:191]
    ds_read_b64_tr_b16 v[50:51], v24 offset:18432
    v_mfma_f32_16x16x32_bf16 v[192:195], v[60:63], v[80:83], v[192:195]
    ds_read_b64_tr_b16 v[52:53], v25 offset:12288
    v_mfma_f32_16x16x32_bf16 v[196:199], v[60:63], v[84:87], v[196:199]
    ds_read_b64_tr_b16 v[54:55], v25 offset:18432
    s_waitcnt lgkmcnt(8)
    v_mfma_f32_16x16x32_bf16 v[200:203], v[64:67], v[80:83], v[200:203]
    ds_read_b64_tr_b16 v[56:57], v26 offset:12288
    s_waitcnt vmcnt(14)
    v_cmp_ne_u32 vcc, s101, v38
    s_nop 4
    s_cbranch_vccnz G2_SPINL
G2_CONTL:
    v_mfma_f32_16x16x32_bf16 v[204:207], v[64:67], v[84:87], v[204:207]
    ds_read_b64_tr_b16 v[58:59], v26 offset:18432
    v_mfma_f32_16x16x32_bf16 v[208:211], v[68:71], v[80:83], v[208:211]
    ds_read_b64_tr_b16 v[60:61], v27 offset:12288
    v_mfma_f32_16x16x32_bf16 v[212:215], v[68:71], v[84:87], v[212:215]
    ds_read_b64_tr_b16 v[62:63], v27 offset:18432
    s_waitcnt lgkmcnt(8)
    v_mfma_f32_16x16x32_bf16 v[216:219], v[72:75], v[80:83], v[216:219]
    ds_read_b64_tr_b16 v[64:65], v24 offset:12416
    v_mfma_f32_16x16x32_bf16 v[220:223], v[72:75], v[84:87], v[220:223]
    ds_read_b64_tr_b16 v[66:67], v24 offset:18560
    s_waitcnt vmcnt(13)
    v_mfma_f32_16x16x32_bf16 v[224:227], v[76:79], v[80:83], v[224:227]
    ds_read_b64_tr_b16 v[68:69], v25 offset:12416
    v_mfma_f32_16x16x32_bf16 v[228:231], v[76:79], v[84:87], v[228:231]
    ds_read_b64_tr_b16 v[70:71], v25 offset:18560
    s_waitcnt lgkmcnt(8)
    v_mfma_f32_16x16x32_bf16 v[136:139], v[48:51], v[88:91], v[136:139]
    ds_read_b64_tr_b16 v[72:73], v26 offset:12416
    s_lshl_b32 s23, s77, 13
    v_mfma_f32_16x16x32_bf16 v[140:143], v[48:51], v[92:95], v[140:143]
    ds_read_b64_tr_b16 v[74:75], v26 offset:18560
    buffer_load_dwordx4 v[112:115], v32, s[4:7], s23 offen offset:0 sc1
    v_mfma_f32_16x16x32_bf16 v[144:147], v[52:55], v[88:91], v[144:147]
    ds_read_b64_tr_b16 v[76:77], v27 offset:12416
    v_mfma_f32_16x16x32_bf16 v[148:151], v[52:55], v[92:95], v[148:151]
    ds_read_b64_tr_b16 v[78:79], v27 offset:18560
    s_waitcnt lgkmcnt(8)
    v_mfma_f32_16x16x32_bf16 v[152:155], v[56:59], v[88:91], v[152:155]
    ds_read_b64_tr_b16 v[48:49], v24 offset:12544
    buffer_load_dwordx4 v[116:119], v32, s[4:7], s23 offen offset:1024 sc1
    v_mfma_f32_16x16x32_bf16 v[156:159], v[56:59], v[92:95], v[156:159]
    ds_read_b64_tr_b16 v[50:51], v24 offset:18688
    s_mul_i32 s22, s78, 36864
    v_mfma_f32_16x16x32_bf16 v[160:163], v[60:63], v[88:91], v[160:163]
    ds_read_b64_tr_b16 v[52:53], v25 offset:12544
    s_mov_b32 m0, s37
    v_mfma_f32_16x16x32_bf16 v[164:167], v[60:63], v[92:95], v[164:167]
    ds_read_b64_tr_b16 v[54:55], v25 offset:18688
    s_waitcnt lgkmcnt(8)
    v_mfma_f32_16x16x32_bf16 v[168:171], v[64:67], v[88:91], v[168:171]
    ds_read_b64_tr_b16 v[56:57], v26 offset:12544
    s_waitcnt vmcnt(7)
    v_mfma_f32_16x16x32_bf16 v[172:175], v[64:67], v[92:95], v[172:175]
    ds_read_b64_tr_b16 v[58:59], v26 offset:18688
    buffer_load_dwordx4 v20, s[8:11], s22 offen offset:0 lds
    v_mfma_f32_16x16x32_bf16 v[176:179], v[68:71], v[88:91], v[176:179]
    ds_read_b64_tr_b16 v[60:61], v27 offset:12544
    s_barrier
    v_mfma_f32_16x16x32_bf16 v[180:183], v[68:71], v[92:95], v[180:183]
    ds_read_b64_tr_b16 v[62:63], v27 offset:18688
    s_waitcnt lgkmcnt(8)
    v_mfma_f32_16x16x32_bf16 v[184:187], v[72:75], v[88:91], v[184:187]
    ds_read_b64_tr_b16 v[64:65], v24 offset:24576
    buffer_load_dwordx4 v21, s[8:11], s22 offen offset:1024 lds
    v_mfma_f32_16x16x32_bf16 v[188:191], v[72:75], v[92:95], v[188:191]
    ds_read_b64_tr_b16 v[66:67], v24 offset:30720
    v_mfma_f32_16x16x32_bf16 v[192:195], v[76:79], v[88:91], v[192:195]
    ds_read_b64_tr_b16 v[68:69], v25 offset:24576
    buffer_load_dwordx4 v22, s[8:11], s22 offen offset:2048 lds
    v_mfma_f32_16x16x32_bf16 v[196:199], v[76:79], v[92:95], v[196:199]
    ds_read_b64_tr_b16 v[70:71], v25 offset:30720
    s_waitcnt lgkmcnt(8)
    v_mfma_f32_16x16x32_bf16 v[200:203], v[48:51], v[88:91], v[200:203]
    ds_read_b64_tr_b16 v[72:73], v26 offset:24576
    v_mfma_f32_16x16x32_bf16 v[204:207], v[48:51], v[92:95], v[204:207]
    ds_read_b64_tr_b16 v[74:75], v26 offset:30720
    v_mfma_f32_16x16x32_bf16 v[208:211], v[52:55], v[88:91], v[208:211]
    ds_read_b64_tr_b16 v[76:77], v27 offset:24576
    v_mfma_f32_16x16x32_bf16 v[212:215], v[52:55], v[92:95], v[212:215]
    ds_read_b64_tr_b16 v[78:79], v27 offset:30720
    s_waitcnt lgkmcnt(8)
    v_mfma_f32_16x16x32_bf16 v[216:219], v[56:59], v[88:91], v[216:219]
    ds_read_b64_tr_b16 v[48:49], v24 offset:24704
    v_mfma_f32_16x16x32_bf16 v[220:223], v[56:59], v[92:95], v[220:223]
    ds_read_b64_tr_b16 v[50:51], v24 offset:30848
    v_mfma_f32_16x16x32_bf16 v[224:227], v[60:63], v[88:91], v[224:227]
    ds_read_b64_tr_b16 v[52:53], v25 offset:24704
    v_mfma_f32_16x16x32_bf16 v[228:231], v[60:63], v[92:95], v[228:231]
    ds_read_b64_tr_b16 v[54:55], v25 offset:30848
    s_waitcnt lgkmcnt(8)
    v_mfma_f32_16x16x32_bf16 v[136:139], v[64:67], v[96:99], v[136:139]
    ds_read_b64_tr_b16 v[56:57], v26 offset:24704
    s_lshl_b32 s23, s78, 13
    v_mfma_f32_16x16x32_bf16 v[140:143], v[64:67], v[100:103], v[140:143]
    ds_read_b64_tr_b16 v[58:59], v26 offset:30848
    buffer_load_dwordx4 v[120:123], v32, s[4:7], s23 offen offset:0 sc1
    v_mfma_f32_16x16x32_bf16 v[144:147], v[68:71], v[96:99], v[144:147]
    ds_read_b64_tr_b16 v[60:61], v27 offset:24704
    v_mfma_f32_16x16x32_bf16 v[148:151], v[68:71], v[100:103], v[148:151]
    ds_read_b64_tr_b16 v[62:63], v27 offset:30848
    s_waitcnt lgkmcnt(8)
    v_mfma_f32_16x16x32_bf16 v[152:155], v[72:75], v[96:99], v[152:155]
    ds_read_b64_tr_b16 v[64:65], v24 offset:24832
    buffer_load_dwordx4 v[124:127], v32, s[4:7], s23 offen offset:1024 sc1
    v_mfma_f32_16x16x32_bf16 v[156:159], v[72:75], v[100:103], v[156:159]
    ds_read_b64_tr_b16 v[66:67], v24 offset:30976
    s_mul_i32 s22, s79, 36864
    v_mfma_f32_16x16x32_bf16 v[160:163], v[76:79], v[96:99], v[160:163]
    ds_read_b64_tr_b16 v[68:69], v25 offset:24832
    s_mov_b32 m0, s38
    v_mfma_f32_16x16x32_bf16 v[164:167], v[76:79], v[100:103], v[164:167]
    ds_read_b64_tr_b16 v[70:71], v25 offset:30976
    s_waitcnt lgkmcnt(8)
    v_mfma_f32_16x16x32_bf16 v[168:171], v[48:51], v[96:99], v[168:171]
    ds_read_b64_tr_b16 v[72:73], v26 offset:24832
    buffer_load_dwordx4 v20, s[8:11], s22 offen offset:0 lds
    v_mfma_f32_16x16x32_bf16 v[172:175], v[48:51], v[100:103], v[172:175]
    ds_read_b64_tr_b16 v[74:75], v26 offset:30976
    v_mfma_f32_16x16x32_bf16 v[176:179], v[52:55], v[96:99], v[176:179]
    ds_read_b64_tr_b16 v[76:77], v27 offset:24832
    buffer_load_dwordx4 v21, s[8:11], s22 offen offset:1024 lds
    v_mfma_f32_16x16x32_bf16 v[180:183], v[52:55], v[100:103], v[180:183]
    ds_read_b64_tr_b16 v[78:79], v27 offset:30976
    s_waitcnt lgkmcnt(8)
    v_mfma_f32_16x16x32_bf16 v[184:187], v[56:59], v[96:99], v[184:187]
    ds_read_b64_tr_b16 v[48:49], v24 offset:36864
    buffer_load_dwordx4 v22, s[8:11], s22 offen offset:2048 lds
    v_mfma_f32_16x16x32_bf16 v[188:191], v[56:59], v[100:103], v[188:191]
    ds_read_b64_tr_b16 v[50:51], v24 offset:43008
    v_mfma_f32_16x16x32_bf16 v[192:195], v[60:63], v[96:99], v[192:195]
    ds_read_b64_tr_b16 v[52:53], v25 offset:36864
    v_mfma_f32_16x16x32_bf16 v[196:199], v[60:63], v[100:103], v[196:199]
    ds_read_b64_tr_b16 v[54:55], v25 offset:43008
    s_waitcnt lgkmcnt(8)
    v_mfma_f32_16x16x32_bf16 v[200:203], v[64:67], v[96:99], v[200:203]
    ds_read_b64_tr_b16 v[56:57], v26 offset:36864
    v_mfma_f32_16x16x32_bf16 v[204:207], v[64:67], v[100:103], v[204:207]
    ds_read_b64_tr_b16 v[58:59], v26 offset:43008
    v_mfma_f32_16x16x32_bf16 v[208:211], v[68:71], v[96:99], v[208:211]
    ds_read_b64_tr_b16 v[60:61], v27 offset:36864
    v_mfma_f32_16x16x32_bf16 v[212:215], v[68:71], v[100:103], v[212:215]
    ds_read_b64_tr_b16 v[62:63], v27 offset:43008
    s_waitcnt lgkmcnt(8)
    v_mfma_f32_16x16x32_bf16 v[216:219], v[72:75], v[96:99], v[216:219]
    ds_read_b64_tr_b16 v[64:65], v24 offset:36992
    v_mfma_f32_16x16x32_bf16 v[220:223], v[72:75], v[100:103], v[220:223]
    ds_read_b64_tr_b16 v[66:67], v24 offset:43136
    s_waitcnt vmcnt(13)
    v_mfma_f32_16x16x32_bf16 v[224:227], v[76:79], v[96:99], v[224:227]
    ds_read_b64_tr_b16 v[68:69], v25 offset:36992
    v_mfma_f32_16x16x32_bf16 v[228:231], v[76:79], v[100:103], v[228:231]
    ds_read_b64_tr_b16 v[70:71], v25 offset:43136
    s_waitcnt lgkmcnt(8)
    v_mfma_f32_16x16x32_bf16 v[136:139], v[48:51], v[104:107], v[136:139]
    ds_read_b64_tr_b16 v[72:73], v26 offset:36992
    s_lshl_b32 s23, s79, 13
    v_mfma_f32_16x16x32_bf16 v[140:143], v[48:51], v[108:111], v[140:143]
    ds_read_b64_tr_b16 v[74:75], v26 offset:43136
    buffer_load_dwordx4 v[128:131], v32, s[4:7], s23 offen offset:0 sc1
    v_mfma_f32_16x16x32_bf16 v[144:147], v[52:55], v[104:107], v[144:147]
    ds_read_b64_tr_b16 v[76:77], v27 offset:36992
    v_mfma_f32_16x16x32_bf16 v[148:151], v[52:55], v[108:111], v[148:151]
    ds_read_b64_tr_b16 v[78:79], v27 offset:43136
    s_waitcnt lgkmcnt(8)
    v_mfma_f32_16x16x32_bf16 v[152:155], v[56:59], v[104:107], v[152:155]
    ds_read_b64_tr_b16 v[48:49], v24 offset:37120
    buffer_load_dwordx4 v[132:135], v32, s[4:7], s23 offen offset:1024 sc1
    v_mfma_f32_16x16x32_bf16 v[156:159], v[56:59], v[108:111], v[156:159]
    ds_read_b64_tr_b16 v[50:51], v24 offset:43264
    s_mul_i32 s22, s80, 36864
    v_mfma_f32_16x16x32_bf16 v[160:163], v[60:63], v[104:107], v[160:163]
    ds_read_b64_tr_b16 v[52:53], v25 offset:37120
    s_mov_b32 m0, s32
    v_mfma_f32_16x16x32_bf16 v[164:167], v[60:63], v[108:111], v[164:167]
    ds_read_b64_tr_b16 v[54:55], v25 offset:43264
    s_waitcnt lgkmcnt(8)
    v_mfma_f32_16x16x32_bf16 v[168:171], v[64:67], v[104:107], v[168:171]
    ds_read_b64_tr_b16 v[56:57], v26 offset:37120
    s_waitcnt vmcnt(7)
    v_mfma_f32_16x16x32_bf16 v[172:175], v[64:67], v[108:111], v[172:175]
    ds_read_b64_tr_b16 v[58:59], v26 offset:43264
    buffer_load_dwordx4 v20, s[8:11], s22 offen offset:0 lds
    v_mfma_f32_16x16x32_bf16 v[176:179], v[68:71], v[104:107], v[176:179]
    ds_read_b64_tr_b16 v[60:61], v27 offset:37120
    s_barrier
    v_mfma_f32_16x16x32_bf16 v[180:183], v[68:71], v[108:111], v[180:183]
    ds_read_b64_tr_b16 v[62:63], v27 offset:43264
    s_waitcnt lgkmcnt(8)
    v_mfma_f32_16x16x32_bf16 v[184:187], v[72:75], v[104:107], v[184:187]
    ds_read_b64_tr_b16 v[64:65], v24 offset:49152
    buffer_load_dwordx4 v21, s[8:11], s22 offen offset:1024 lds
    v_mfma_f32_16x16x32_bf16 v[188:191], v[72:75], v[108:111], v[188:191]
    ds_read_b64_tr_b16 v[66:67], v24 offset:55296
    v_mfma_f32_16x16x32_bf16 v[192:195], v[76:79], v[104:107], v[192:195]
    ds_read_b64_tr_b16 v[68:69], v25 offset:49152
    buffer_load_dwordx4 v22, s[8:11], s22 offen offset:2048 lds
    v_mfma_f32_16x16x32_bf16 v[196:199], v[76:79], v[108:111], v[196:199]
    ds_read_b64_tr_b16 v[70:71], v25 offset:55296
    s_waitcnt lgkmcnt(8)
    v_mfma_f32_16x16x32_bf16 v[200:203], v[48:51], v[104:107], v[200:203]
    ds_read_b64_tr_b16 v[72:73], v26 offset:49152
    v_mfma_f32_16x16x32_bf16 v[204:207], v[48:51], v[108:111], v[204:207]
    ds_read_b64_tr_b16 v[74:75], v26 offset:55296
    v_mfma_f32_16x16x32_bf16 v[208:211], v[52:55], v[104:107], v[208:211]
    ds_read_b64_tr_b16 v[76:77], v27 offset:49152
    v_mfma_f32_16x16x32_bf16 v[212:215], v[52:55], v[108:111], v[212:215]
    ds_read_b64_tr_b16 v[78:79], v27 offset:55296
    s_waitcnt lgkmcnt(8)
    v_mfma_f32_16x16x32_bf16 v[216:219], v[56:59], v[104:107], v[216:219]
    ds_read_b64_tr_b16 v[48:49], v24 offset:49280
    v_mfma_f32_16x16x32_bf16 v[220:223], v[56:59], v[108:111], v[220:223]
    ds_read_b64_tr_b16 v[50:51], v24 offset:55424
    v_mfma_f32_16x16x32_bf16 v[224:227], v[60:63], v[104:107], v[224:227]
    ds_read_b64_tr_b16 v[52:53], v25 offset:49280
    v_mfma_f32_16x16x32_bf16 v[228:231], v[60:63], v[108:111], v[228:231]
    ds_read_b64_tr_b16 v[54:55], v25 offset:55424
    s_waitcnt lgkmcnt(8)
    v_mfma_f32_16x16x32_bf16 v[136:139], v[64:67], v[112:115], v[136:139]
    ds_read_b64_tr_b16 v[56:57], v26 offset:49280
    s_lshl_b32 s23, s80, 13
    v_mfma_f32_16x16x32_bf16 v[140:143], v[64:67], v[116:119], v[140:143]
    ds_read_b64_tr_b16 v[58:59], v26 offset:55424
    buffer_load_dwordx4 v[80:83], v32, s[4:7], s23 offen offset:0 sc1
    v_mfma_f32_16x16x32_bf16 v[144:147], v[68:71], v[112:115], v[144:147]
    ds_read_b64_tr_b16 v[60:61], v27 offset:49280
    v_mfma_f32_16x16x32_bf16 v[148:151], v[68:71], v[116:119], v[148:151]
    ds_read_b64_tr_b16 v[62:63], v27 offset:55424
    s_waitcnt lgkmcnt(8)
    v_mfma_f32_16x16x32_bf16 v[152:155], v[72:75], v[112:115], v[152:155]
    ds_read_b64_tr_b16 v[64:65], v24 offset:49408
    buffer_load_dwordx4 v[84:87], v32, s[4:7], s23 offen offset:1024 sc1
    v_mfma_f32_16x16x32_bf16 v[156:159], v[72:75], v[116:119], v[156:159]
    ds_read_b64_tr_b16 v[66:67], v24 offset:55552
    s_mul_i32 s22, s81, 36864
    v_mfma_f32_16x16x32_bf16 v[160:163], v[76:79], v[112:115], v[160:163]
    ds_read_b64_tr_b16 v[68:69], v25 offset:49408
    s_mov_b32 m0, s33
    v_mfma_f32_16x16x32_bf16 v[164:167], v[76:79], v[116:119], v[164:167]
    ds_read_b64_tr_b16 v[70:71], v25 offset:55552
    s_waitcnt lgkmcnt(8)
    v_mfma_f32_16x16x32_bf16 v[168:171], v[48:51], v[112:115], v[168:171]
    ds_read_b64_tr_b16 v[72:73], v26 offset:49408
    buffer_load_dwordx4 v20, s[8:11], s22 offen offset:0 lds
    v_mfma_f32_16x16x32_bf16 v[172:175], v[48:51], v[116:119], v[172:175]
    ds_read_b64_tr_b16 v[74:75], v26 offset:55552
    v_mfma_f32_16x16x32_bf16 v[176:179], v[52:55], v[112:115], v[176:179]
    ds_read_b64_tr_b16 v[76:77], v27 offset:49408
    buffer_load_dwordx4 v21, s[8:11], s22 offen offset:1024 lds
    v_mfma_f32_16x16x32_bf16 v[180:183], v[52:55], v[116:119], v[180:183]
    ds_read_b64_tr_b16 v[78:79], v27 offset:55552
    s_waitcnt lgkmcnt(8)
    v_mfma_f32_16x16x32_bf16 v[184:187], v[56:59], v[112:115], v[184:187]
    ds_read_b64_tr_b16 v[48:49], v28 offset:0
    buffer_load_dwordx4 v22, s[8:11], s22 offen offset:2048 lds
    v_mfma_f32_16x16x32_bf16 v[188:191], v[56:59], v[116:119], v[188:191]
    ds_read_b64_tr_b16 v[50:51], v28 offset:6144
    v_mfma_f32_16x16x32_bf16 v[192:195], v[60:63], v[112:115], v[192:195]
    ds_read_b64_tr_b16 v[52:53], v29 offset:0
    v_mfma_f32_16x16x32_bf16 v[196:199], v[60:63], v[116:119], v[196:199]
    ds_read_b64_tr_b16 v[54:55], v29 offset:6144
    s_waitcnt lgkmcnt(8)
    v_mfma_f32_16x16x32_bf16 v[200:203], v[64:67], v[112:115], v[200:203]
    ds_read_b64_tr_b16 v[56:57], v30 offset:0
    v_mfma_f32_16x16x32_bf16 v[204:207], v[64:67], v[116:119], v[204:207]
    ds_read_b64_tr_b16 v[58:59], v30 offset:6144
    v_mfma_f32_16x16x32_bf16 v[208:211], v[68:71], v[112:115], v[208:211]
    ds_read_b64_tr_b16 v[60:61], v31 offset:0
    v_mfma_f32_16x16x32_bf16 v[212:215], v[68:71], v[116:119], v[212:215]
    ds_read_b64_tr_b16 v[62:63], v31 offset:6144
    s_waitcnt lgkmcnt(8)
    v_mfma_f32_16x16x32_bf16 v[216:219], v[72:75], v[112:115], v[216:219]
    ds_read_b64_tr_b16 v[64:65], v28 offset:128
    v_mfma_f32_16x16x32_bf16 v[220:223], v[72:75], v[116:119], v[220:223]
    ds_read_b64_tr_b16 v[66:67], v28 offset:6272
    s_waitcnt vmcnt(13)
    v_mfma_f32_16x16x32_bf16 v[224:227], v[76:79], v[112:115], v[224:227]
    ds_read_b64_tr_b16 v[68:69], v29 offset:128
    v_mfma_f32_16x16x32_bf16 v[228:231], v[76:79], v[116:119], v[228:231]
    ds_read_b64_tr_b16 v[70:71], v29 offset:6272
    s_waitcnt lgkmcnt(8)
    v_mfma_f32_16x16x32_bf16 v[136:139], v[48:51], v[120:123], v[136:139]
    ds_read_b64_tr_b16 v[72:73], v30 offset:128
    s_lshl_b32 s23, s81, 13
    v_mfma_f32_16x16x32_bf16 v[140:143], v[48:51], v[124:127], v[140:143]
    ds_read_b64_tr_b16 v[74:75], v30 offset:6272
    buffer_load_dwordx4 v[88:91], v32, s[4:7], s23 offen offset:0 sc1
    v_mfma_f32_16x16x32_bf16 v[144:147], v[52:55], v[120:123], v[144:147]
    ds_read_b64_tr_b16 v[76:77], v31 offset:128
    v_mfma_f32_16x16x32_bf16 v[148:151], v[52:55], v[124:127], v[148:151]
    ds_read_b64_tr_b16 v[78:79], v31 offset:6272
    s_waitcnt lgkmcnt(8)
    v_mfma_f32_16x16x32_bf16 v[152:155], v[56:59], v[120:123], v[152:155]
    ds_read_b64_tr_b16 v[48:49], v28 offset:256
    buffer_load_dwordx4 v[92:95], v32, s[4:7], s23 offen offset:1024 sc1
    v_mfma_f32_16x16x32_bf16 v[156:159], v[56:59], v[124:127], v[156:159]
    ds_read_b64_tr_b16 v[50:51], v28 offset:6400
    s_mul_i32 s22, s82, 36864
    v_mfma_f32_16x16x32_bf16 v[160:163], v[60:63], v[120:123], v[160:163]
    ds_read_b64_tr_b16 v[52:53], v29 offset:256
    s_mov_b32 m0, s34
    v_mfma_f32_16x16x32_bf16 v[164:167], v[60:63], v[124:127], v[164:167]
    ds_read_b64_tr_b16 v[54:55], v29 offset:6400
    s_waitcnt lgkmcnt(8)
    v_mfma_f32_16x16x32_bf16 v[168:171], v[64:67], v[120:123], v[168:171]
    ds_read_b64_tr_b16 v[56:57], v30 offset:256
    s_waitcnt vmcnt(7)
    v_mfma_f32_16x16x32_bf16 v[172:175], v[64:67], v[124:127], v[172:175]
    ds_read_b64_tr_b16 v[58:59], v30 offset:6400
    buffer_load_dwordx4 v20, s[8:11], s22 offen offset:0 lds
    v_mfma_f32_16x16x32_bf16 v[176:179], v[68:71], v[120:123], v[176:179]
    ds_read_b64_tr_b16 v[60:61], v31 offset:256
    s_barrier
    v_mfma_f32_16x16x32_bf16 v[180:183], v[68:71], v[124:127], v[180:183]
    ds_read_b64_tr_b16 v[62:63], v31 offset:6400
    s_waitcnt lgkmcnt(8)
    v_mfma_f32_16x16x32_bf16 v[184:187], v[72:75], v[120:123], v[184:187]
    ds_read_b64_tr_b16 v[64:65], v28 offset:12288
    buffer_load_dwordx4 v21, s[8:11], s22 offen offset:1024 lds
    v_mfma_f32_16x16x32_bf16 v[188:191], v[72:75], v[124:127], v[188:191]
    ds_read_b64_tr_b16 v[66:67], v28 offset:18432
    v_mfma_f32_16x16x32_bf16 v[192:195], v[76:79], v[120:123], v[192:195]
    ds_read_b64_tr_b16 v[68:69], v29 offset:12288
    buffer_load_dwordx4 v22, s[8:11], s22 offen offset:2048 lds
    v_mfma_f32_16x16x32_bf16 v[196:199], v[76:79], v[124:127], v[196:199]
    ds_read_b64_tr_b16 v[70:71], v29 offset:18432
    s_waitcnt lgkmcnt(8)
    v_mfma_f32_16x16x32_bf16 v[200:203], v[48:51], v[120:123], v[200:203]
    ds_read_b64_tr_b16 v[72:73], v30 offset:12288
    v_mfma_f32_16x16x32_bf16 v[204:207], v[48:51], v[124:127], v[204:207]
    ds_read_b64_tr_b16 v[74:75], v30 offset:18432
    v_mfma_f32_16x16x32_bf16 v[208:211], v[52:55], v[120:123], v[208:211]
    ds_read_b64_tr_b16 v[76:77], v31 offset:12288
    v_mfma_f32_16x16x32_bf16 v[212:215], v[52:55], v[124:127], v[212:215]
    ds_read_b64_tr_b16 v[78:79], v31 offset:18432
    s_waitcnt lgkmcnt(8)
    v_mfma_f32_16x16x32_bf16 v[216:219], v[56:59], v[120:123], v[216:219]
    ds_read_b64_tr_b16 v[48:49], v28 offset:12416
    v_mfma_f32_16x16x32_bf16 v[220:223], v[56:59], v[124:127], v[220:223]
    ds_read_b64_tr_b16 v[50:51], v28 offset:18560
    v_mfma_f32_16x16x32_bf16 v[224:227], v[60:63], v[120:123], v[224:227]
    ds_read_b64_tr_b16 v[52:53], v29 offset:12416
    v_mfma_f32_16x16x32_bf16 v[228:231], v[60:63], v[124:127], v[228:231]
    ds_read_b64_tr_b16 v[54:55], v29 offset:18560
    s_waitcnt lgkmcnt(8)
    v_mfma_f32_16x16x32_bf16 v[136:139], v[64:67], v[128:131], v[136:139]
    ds_read_b64_tr_b16 v[56:57], v30 offset:12416
    s_lshl_b32 s23, s82, 13
    v_mfma_f32_16x16x32_bf16 v[140:143], v[64:67], v[132:135], v[140:143]
    ds_read_b64_tr_b16 v[58:59], v30 offset:18560
    buffer_load_dwordx4 v[96:99], v32, s[4:7], s23 offen offset:0 sc1
    v_mfma_f32_16x16x32_bf16 v[144:147], v[68:71], v[128:131], v[144:147]
    ds_read_b64_tr_b16 v[60:61], v31 offset:12416
    v_mfma_f32_16x16x32_bf16 v[148:151], v[68:71], v[132:135], v[148:151]
    ds_read_b64_tr_b16 v[62:63], v31 offset:18560
    s_waitcnt lgkmcnt(8)
    v_mfma_f32_16x16x32_bf16 v[152:155], v[72:75], v[128:131], v[152:155]
    ds_read_b64_tr_b16 v[64:65], v28 offset:12544
    buffer_load_dwordx4 v[100:103], v32, s[4:7], s23 offen offset:1024 sc1
    v_mfma_f32_16x16x32_bf16 v[156:159], v[72:75], v[132:135], v[156:159]
    ds_read_b64_tr_b16 v[66:67], v28 offset:18688
    s_mul_i32 s22, s83, 36864
    v_mfma_f32_16x16x32_bf16 v[160:163], v[76:79], v[128:131], v[160:163]
    ds_read_b64_tr_b16 v[68:69], v29 offset:12544
    s_mov_b32 m0, s35
    v_mfma_f32_16x16x32_bf16 v[164:167], v[76:79], v[132:135], v[164:167]
    ds_read_b64_tr_b16 v[70:71], v29 offset:18688
    s_waitcnt lgkmcnt(8)
    v_mfma_f32_16x16x32_bf16 v[168:171], v[48:51], v[128:131], v[168:171]
    ds_read_b64_tr_b16 v[72:73], v30 offset:12544
    buffer_load_dwordx4 v20, s[8:11], s22 offen offset:0 lds
    v_mfma_f32_16x16x32_bf16 v[172:175], v[48:51], v[132:135], v[172:175]
    ds_read_b64_tr_b16 v[74:75], v30 offset:18688
    v_mfma_f32_16x16x32_bf16 v[176:179], v[52:55], v[128:131], v[176:179]
    ds_read_b64_tr_b16 v[76:77], v31 offset:12544
    buffer_load_dwordx4 v21, s[8:11], s22 offen offset:1024 lds
    v_mfma_f32_16x16x32_bf16 v[180:183], v[52:55], v[132:135], v[180:183]
    ds_read_b64_tr_b16 v[78:79], v31 offset:18688
    s_waitcnt lgkmcnt(8)
    v_mfma_f32_16x16x32_bf16 v[184:187], v[56:59], v[128:131], v[184:187]
    ds_read_b64_tr_b16 v[48:49], v24 offset:0
    buffer_load_dwordx4 v22, s[8:11], s22 offen offset:2048 lds
    v_mfma_f32_16x16x32_bf16 v[188:191], v[56:59], v[132:135], v[188:191]
    ds_read_b64_tr_b16 v[50:51], v24 offset:6144
    v_mfma_f32_16x16x32_bf16 v[192:195], v[60:63], v[128:131], v[192:195]
    ds_read_b64_tr_b16 v[52:53], v25 offset:0
    v_mfma_f32_16x16x32_bf16 v[196:199], v[60:63], v[132:135], v[196:199]
    ds_read_b64_tr_b16 v[54:55], v25 offset:6144
    s_waitcnt lgkmcnt(8)
    v_mfma_f32_16x16x32_bf16 v[200:203], v[64:67], v[128:131], v[200:203]
    ds_read_b64_tr_b16 v[56:57], v26 offset:0
    v_mfma_f32_16x16x32_bf16 v[204:207], v[64:67], v[132:135], v[204:207]
    ds_read_b64_tr_b16 v[58:59], v26 offset:6144
    v_mfma_f32_16x16x32_bf16 v[208:211], v[68:71], v[128:131], v[208:211]
    ds_read_b64_tr_b16 v[60:61], v27 offset:0
    v_mfma_f32_16x16x32_bf16 v[212:215], v[68:71], v[132:135], v[212:215]
    ds_read_b64_tr_b16 v[62:63], v27 offset:6144
    s_waitcnt lgkmcnt(8)
    v_mfma_f32_16x16x32_bf16 v[216:219], v[72:75], v[128:131], v[216:219]
    ds_read_b64_tr_b16 v[64:65], v24 offset:128
    v_mfma_f32_16x16x32_bf16 v[220:223], v[72:75], v[132:135], v[220:223]
    ds_read_b64_tr_b16 v[66:67], v24 offset:6272
    s_waitcnt vmcnt(13)
    v_mfma_f32_16x16x32_bf16 v[224:227], v[76:79], v[128:131], v[224:227]
    ds_read_b64_tr_b16 v[68:69], v25 offset:128
    v_mfma_f32_16x16x32_bf16 v[228:231], v[76:79], v[132:135], v[228:231]
    ds_read_b64_tr_b16 v[70:71], v25 offset:6272
    s_waitcnt lgkmcnt(8)
    v_mfma_f32_16x16x32_bf16 v[136:139], v[48:51], v[80:83], v[136:139]
    ds_read_b64_tr_b16 v[72:73], v26 offset:128
    s_lshl_b32 s23, s83, 13
    v_mfma_f32_16x16x32_bf16 v[140:143], v[48:51], v[84:87], v[140:143]
    ds_read_b64_tr_b16 v[74:75], v26 offset:6272
    buffer_load_dwordx4 v[104:107], v32, s[4:7], s23 offen offset:0 sc1
    v_mfma_f32_16x16x32_bf16 v[144:147], v[52:55], v[80:83], v[144:147]
    ds_read_b64_tr_b16 v[76:77], v27 offset:128
    v_mfma_f32_16x16x32_bf16 v[148:151], v[52:55], v[84:87], v[148:151]
    ds_read_b64_tr_b16 v[78:79], v27 offset:6272
    s_waitcnt lgkmcnt(8)
    v_mfma_f32_16x16x32_bf16 v[152:155], v[56:59], v[80:83], v[152:155]
    ds_read_b64_tr_b16 v[48:49], v24 offset:256
    buffer_load_dwordx4 v[108:111], v32, s[4:7], s23 offen offset:1024 sc1
    v_mfma_f32_16x16x32_bf16 v[156:159], v[56:59], v[84:87], v[156:159]
    ds_read_b64_tr_b16 v[50:51], v24 offset:6400
    s_mul_i32 s22, s84, 36864
    v_mfma_f32_16x16x32_bf16 v[160:163], v[60:63], v[80:83], v[160:163]
    ds_read_b64_tr_b16 v[52:53], v25 offset:256
    s_mov_b32 m0, s36
    v_mfma_f32_16x16x32_bf16 v[164:167], v[60:63], v[84:87], v[164:167]
    ds_read_b64_tr_b16 v[54:55], v25 offset:6400
    s_waitcnt lgkmcnt(8)
    v_mfma_f32_16x16x32_bf16 v[168:171], v[64:67], v[80:83], v[168:171]
    ds_read_b64_tr_b16 v[56:57], v26 offset:256
    s_waitcnt vmcnt(7)
    v_mfma_f32_16x16x32_bf16 v[172:175], v[64:67], v[84:87], v[172:175]
    ds_read_b64_tr_b16 v[58:59], v26 offset:6400
    buffer_load_dwordx4 v20, s[8:11], s22 offen offset:0 lds
    v_mfma_f32_16x16x32_bf16 v[176:179], v[68:71], v[80:83], v[176:179]
    ds_read_b64_tr_b16 v[60:61], v27 offset:256
    s_barrier
    v_mfma_f32_16x16x32_bf16 v[180:183], v[68:71], v[84:87], v[180:183]
    ds_read_b64_tr_b16 v[62:63], v27 offset:6400
    s_waitcnt lgkmcnt(8)
    v_mfma_f32_16x16x32_bf16 v[184:187], v[72:75], v[80:83], v[184:187]
    ds_read_b64_tr_b16 v[64:65], v24 offset:12288
    buffer_load_dwordx4 v21, s[8:11], s22 offen offset:1024 lds
    v_mfma_f32_16x16x32_bf16 v[188:191], v[72:75], v[84:87], v[188:191]
    ds_read_b64_tr_b16 v[66:67], v24 offset:18432
    v_mfma_f32_16x16x32_bf16 v[192:195], v[76:79], v[80:83], v[192:195]
    ds_read_b64_tr_b16 v[68:69], v25 offset:12288
    buffer_load_dwordx4 v22, s[8:11], s22 offen offset:2048 lds
    v_mfma_f32_16x16x32_bf16 v[196:199], v[76:79], v[84:87], v[196:199]
    ds_read_b64_tr_b16 v[70:71], v25 offset:18432
    s_waitcnt lgkmcnt(8)
    v_mfma_f32_16x16x32_bf16 v[200:203], v[48:51], v[80:83], v[200:203]
    ds_read_b64_tr_b16 v[72:73], v26 offset:12288
    v_mfma_f32_16x16x32_bf16 v[204:207], v[48:51], v[84:87], v[204:207]
    ds_read_b64_tr_b16 v[74:75], v26 offset:18432
    v_mfma_f32_16x16x32_bf16 v[208:211], v[52:55], v[80:83], v[208:211]
    ds_read_b64_tr_b16 v[76:77], v27 offset:12288
    v_mfma_f32_16x16x32_bf16 v[212:215], v[52:55], v[84:87], v[212:215]
    ds_read_b64_tr_b16 v[78:79], v27 offset:18432
    s_waitcnt lgkmcnt(8)
    v_mfma_f32_16x16x32_bf16 v[216:219], v[56:59], v[80:83], v[216:219]
    ds_read_b64_tr_b16 v[48:49], v24 offset:12416
    v_mfma_f32_16x16x32_bf16 v[220:223], v[56:59], v[84:87], v[220:223]
    ds_read_b64_tr_b16 v[50:51], v24 offset:18560
    v_mfma_f32_16x16x32_bf16 v[224:227], v[60:63], v[80:83], v[224:227]
    ds_read_b64_tr_b16 v[52:53], v25 offset:12416
    v_mfma_f32_16x16x32_bf16 v[228:231], v[60:63], v[84:87], v[228:231]
    ds_read_b64_tr_b16 v[54:55], v25 offset:18560
    s_waitcnt lgkmcnt(8)
    v_mfma_f32_16x16x32_bf16 v[136:139], v[64:67], v[88:91], v[136:139]
    ds_read_b64_tr_b16 v[56:57], v26 offset:12416
    s_lshl_b32 s23, s84, 13
    v_mfma_f32_16x16x32_bf16 v[140:143], v[64:67], v[92:95], v[140:143]
    ds_read_b64_tr_b16 v[58:59], v26 offset:18560
    buffer_load_dwordx4 v[112:115], v32, s[4:7], s23 offen offset:0 sc1
    v_mfma_f32_16x16x32_bf16 v[144:147], v[68:71], v[88:91], v[144:147]
    ds_read_b64_tr_b16 v[60:61], v27 offset:12416
    v_mfma_f32_16x16x32_bf16 v[148:151], v[68:71], v[92:95], v[148:151]
    ds_read_b64_tr_b16 v[62:63], v27 offset:18560
    s_waitcnt lgkmcnt(8)
    v_mfma_f32_16x16x32_bf16 v[152:155], v[72:75], v[88:91], v[152:155]
    ds_read_b64_tr_b16 v[64:65], v24 offset:12544
    buffer_load_dwordx4 v[116:119], v32, s[4:7], s23 offen offset:1024 sc1
    v_mfma_f32_16x16x32_bf16 v[156:159], v[72:75], v[92:95], v[156:159]
    ds_read_b64_tr_b16 v[66:67], v24 offset:18688
    s_mul_i32 s22, s85, 36864
    v_mfma_f32_16x16x32_bf16 v[160:163], v[76:79], v[88:91], v[160:163]
    ds_read_b64_tr_b16 v[68:69], v25 offset:12544
    s_mov_b32 m0, s37
    v_mfma_f32_16x16x32_bf16 v[164:167], v[76:79], v[92:95], v[164:167]
    ds_read_b64_tr_b16 v[70:71], v25 offset:18688
    s_waitcnt lgkmcnt(8)
    v_mfma_f32_16x16x32_bf16 v[168:171], v[48:51], v[88:91], v[168:171]
    ds_read_b64_tr_b16 v[72:73], v26 offset:12544
    buffer_load_dwordx4 v20, s[8:11], s22 offen offset:0 lds
    v_mfma_f32_16x16x32_bf16 v[172:175], v[48:51], v[92:95], v[172:175]
    ds_read_b64_tr_b16 v[74:75], v26 offset:18688
    v_mfma_f32_16x16x32_bf16 v[176:179], v[52:55], v[88:91], v[176:179]
    ds_read_b64_tr_b16 v[76:77], v27 offset:12544
    buffer_load_dwordx4 v21, s[8:11], s22 offen offset:1024 lds
    v_mfma_f32_16x16x32_bf16 v[180:183], v[52:55], v[92:95], v[180:183]
    ds_read_b64_tr_b16 v[78:79], v27 offset:18688
    s_waitcnt lgkmcnt(8)
    v_mfma_f32_16x16x32_bf16 v[184:187], v[56:59], v[88:91], v[184:187]
    ds_read_b64_tr_b16 v[48:49], v24 offset:24576
    buffer_load_dwordx4 v22, s[8:11], s22 offen offset:2048 lds
    v_mfma_f32_16x16x32_bf16 v[188:191], v[56:59], v[92:95], v[188:191]
    ds_read_b64_tr_b16 v[50:51], v24 offset:30720
    v_mfma_f32_16x16x32_bf16 v[192:195], v[60:63], v[88:91], v[192:195]
    ds_read_b64_tr_b16 v[52:53], v25 offset:24576
    v_mfma_f32_16x16x32_bf16 v[196:199], v[60:63], v[92:95], v[196:199]
    ds_read_b64_tr_b16 v[54:55], v25 offset:30720
    s_waitcnt lgkmcnt(8)
    v_mfma_f32_16x16x32_bf16 v[200:203], v[64:67], v[88:91], v[200:203]
    ds_read_b64_tr_b16 v[56:57], v26 offset:24576
    v_mfma_f32_16x16x32_bf16 v[204:207], v[64:67], v[92:95], v[204:207]
    ds_read_b64_tr_b16 v[58:59], v26 offset:30720
    v_mfma_f32_16x16x32_bf16 v[208:211], v[68:71], v[88:91], v[208:211]
    ds_read_b64_tr_b16 v[60:61], v27 offset:24576
    v_mfma_f32_16x16x32_bf16 v[212:215], v[68:71], v[92:95], v[212:215]
    ds_read_b64_tr_b16 v[62:63], v27 offset:30720
    s_waitcnt lgkmcnt(8)
    v_mfma_f32_16x16x32_bf16 v[216:219], v[72:75], v[88:91], v[216:219]
    ds_read_b64_tr_b16 v[64:65], v24 offset:24704
    v_mfma_f32_16x16x32_bf16 v[220:223], v[72:75], v[92:95], v[220:223]
    ds_read_b64_tr_b16 v[66:67], v24 offset:30848
    s_waitcnt vmcnt(13)
    v_mfma_f32_16x16x32_bf16 v[224:227], v[76:79], v[88:91], v[224:227]
    ds_read_b64_tr_b16 v[68:69], v25 offset:24704
    v_mfma_f32_16x16x32_bf16 v[228:231], v[76:79], v[92:95], v[228:231]
    ds_read_b64_tr_b16 v[70:71], v25 offset:30848
    s_waitcnt lgkmcnt(8)
    v_mfma_f32_16x16x32_bf16 v[136:139], v[48:51], v[96:99], v[136:139]
    ds_read_b64_tr_b16 v[72:73], v26 offset:24704
    s_lshl_b32 s23, s85, 13
    v_mfma_f32_16x16x32_bf16 v[140:143], v[48:51], v[100:103], v[140:143]
    ds_read_b64_tr_b16 v[74:75], v26 offset:30848
    buffer_load_dwordx4 v[120:123], v32, s[4:7], s23 offen offset:0 sc1
    v_mfma_f32_16x16x32_bf16 v[144:147], v[52:55], v[96:99], v[144:147]
    ds_read_b64_tr_b16 v[76:77], v27 offset:24704
    v_mfma_f32_16x16x32_bf16 v[148:151], v[52:55], v[100:103], v[148:151]
    ds_read_b64_tr_b16 v[78:79], v27 offset:30848
    s_waitcnt lgkmcnt(8)
    v_mfma_f32_16x16x32_bf16 v[152:155], v[56:59], v[96:99], v[152:155]
    ds_read_b64_tr_b16 v[48:49], v24 offset:24832
    global_load_dword v35, v36, s[30:31] sc1
    v_mfma_f32_16x16x32_bf16 v[156:159], v[56:59], v[100:103], v[156:159]
    ds_read_b64_tr_b16 v[50:51], v24 offset:30976
    buffer_load_dwordx4 v[124:127], v32, s[4:7], s23 offen offset:1024 sc1
    v_mfma_f32_16x16x32_bf16 v[160:163], v[60:63], v[96:99], v[160:163]
    ds_read_b64_tr_b16 v[52:53], v25 offset:24832
    s_mul_i32 s22, s86, 36864
    v_mfma_f32_16x16x32_bf16 v[164:167], v[60:63], v[100:103], v[164:167]
    ds_read_b64_tr_b16 v[54:55], v25 offset:30976
    s_waitcnt lgkmcnt(8)
    v_mfma_f32_16x16x32_bf16 v[168:171], v[64:67], v[96:99], v[168:171]
    ds_read_b64_tr_b16 v[56:57], v26 offset:24832
    s_waitcnt vmcnt(8)
    v_mfma_f32_16x16x32_bf16 v[172:175], v[64:67], v[100:103], v[172:175]
    ds_read_b64_tr_b16 v[58:59], v26 offset:30976
    s_mov_b32 m0, s38
    v_mfma_f32_16x16x32_bf16 v[176:179], v[68:71], v[96:99], v[176:179]
    ds_read_b64_tr_b16 v[60:61], v27 offset:24832
    s_barrier
    v_mfma_f32_16x16x32_bf16 v[180:183], v[68:71], v[100:103], v[180:183]
    ds_read_b64_tr_b16 v[62:63], v27 offset:30976
    s_waitcnt lgkmcnt(8)
    v_mfma_f32_16x16x32_bf16 v[184:187], v[72:75], v[96:99], v[184:187]
    ds_read_b64_tr_b16 v[64:65], v24 offset:36864
    buffer_load_dwordx4 v20, s[8:11], s22 offen offset:0 lds
    v_mfma_f32_16x16x32_bf16 v[188:191], v[72:75], v[100:103], v[188:191]
    ds_read_b64_tr_b16 v[66:67], v24 offset:43008
    v_mfma_f32_16x16x32_bf16 v[192:195], v[76:79], v[96:99], v[192:195]
    ds_read_b64_tr_b16 v[68:69], v25 offset:36864
    buffer_load_dwordx4 v21, s[8:11], s22 offen offset:1024 lds
    v_mfma_f32_16x16x32_bf16 v[196:199], v[76:79], v[100:103], v[196:199]
    ds_read_b64_tr_b16 v[70:71], v25 offset:43008
    s_waitcnt lgkmcnt(8)
    v_mfma_f32_16x16x32_bf16 v[200:203], v[48:51], v[96:99], v[200:203]
    ds_read_b64_tr_b16 v[72:73], v26 offset:36864
    buffer_load_dwordx4 v22, s[8:11], s22 offen offset:2048 lds
    v_mfma_f32_16x16x32_bf16 v[204:207], v[48:51], v[100:103], v[204:207]
    ds_read_b64_tr_b16 v[74:75], v26 offset:43008
    v_mfma_f32_16x16x32_bf16 v[208:211], v[52:55], v[96:99], v[208:211]
    ds_read_b64_tr_b16 v[76:77], v27 offset:36864
    v_mfma_f32_16x16x32_bf16 v[212:215], v[52:55], v[100:103], v[212:215]
    ds_read_b64_tr_b16 v[78:79], v27 offset:43008
    s_waitcnt lgkmcnt(8)
    v_mfma_f32_16x16x32_bf16 v[216:219], v[56:59], v[96:99], v[216:219]
    ds_read_b64_tr_b16 v[48:49], v24 offset:36992
    v_mfma_f32_16x16x32_bf16 v[220:223], v[56:59], v[100:103], v[220:223]
    ds_read_b64_tr_b16 v[50:51], v24 offset:43136
    v_mfma_f32_16x16x32_bf16 v[224:227], v[60:63], v[96:99], v[224:227]
    ds_read_b64_tr_b16 v[52:53], v25 offset:36992
    v_mfma_f32_16x16x32_bf16 v[228:231], v[60:63], v[100:103], v[228:231]
    ds_read_b64_tr_b16 v[54:55], v25 offset:43136
    s_waitcnt lgkmcnt(8)
    v_mfma_f32_16x16x32_bf16 v[136:139], v[64:67], v[104:107], v[136:139]
    ds_read_b64_tr_b16 v[56:57], v26 offset:36992
    s_lshl_b32 s23, s86, 13
    v_mfma_f32_16x16x32_bf16 v[140:143], v[64:67], v[108:111], v[140:143]
    ds_read_b64_tr_b16 v[58:59], v26 offset:43136
    buffer_load_dwordx4 v[128:131], v32, s[4:7], s23 offen offset:0 sc1
    v_mfma_f32_16x16x32_bf16 v[144:147], v[68:71], v[104:107], v[144:147]
    ds_read_b64_tr_b16 v[60:61], v27 offset:36992
    v_mfma_f32_16x16x32_bf16 v[148:151], v[68:71], v[108:111], v[148:151]
    ds_read_b64_tr_b16 v[62:63], v27 offset:43136
    s_waitcnt lgkmcnt(8)
    v_mfma_f32_16x16x32_bf16 v[152:155], v[72:75], v[104:107], v[152:155]
    ds_read_b64_tr_b16 v[64:65], v24 offset:37120
    buffer_load_dwordx4 v[132:135], v32, s[4:7], s23 offen offset:1024 sc1
    v_mfma_f32_16x16x32_bf16 v[156:159], v[72:75], v[108:111], v[156:159]
    ds_read_b64_tr_b16 v[66:67], v24 offset:43264
    s_mul_i32 s22, s87, 36864
    v_mfma_f32_16x16x32_bf16 v[160:163], v[76:79], v[104:107], v[160:163]
    ds_read_b64_tr_b16 v[68:69], v25 offset:37120
    s_mov_b32 m0, s32
    v_mfma_f32_16x16x32_bf16 v[164:167], v[76:79], v[108:111], v[164:167]
    ds_read_b64_tr_b16 v[70:71], v25 offset:43264
    s_waitcnt lgkmcnt(8)
    v_mfma_f32_16x16x32_bf16 v[168:171], v[48:51], v[104:107], v[168:171]
    ds_read_b64_tr_b16 v[72:73], v26 offset:37120
    buffer_load_dwordx4 v20, s[8:11], s22 offen offset:0 lds
    v_mfma_f32_16x16x32_bf16 v[172:175], v[48:51], v[108:111], v[172:175]
    ds_read_b64_tr_b16 v[74:75], v26 offset:43264
    v_mfma_f32_16x16x32_bf16 v[176:179], v[52:55], v[104:107], v[176:179]
    ds_read_b64_tr_b16 v[76:77], v27 offset:37120
    buffer_load_dwordx4 v21, s[8:11], s22 offen offset:1024 lds
    v_mfma_f32_16x16x32_bf16 v[180:183], v[52:55], v[108:111], v[180:183]
    ds_read_b64_tr_b16 v[78:79], v27 offset:43264
    s_waitcnt lgkmcnt(8)
    v_mfma_f32_16x16x32_bf16 v[184:187], v[56:59], v[104:107], v[184:187]
    ds_read_b64_tr_b16 v[48:49], v24 offset:49152
    buffer_load_dwordx4 v22, s[8:11], s22 offen offset:2048 lds
    v_mfma_f32_16x16x32_bf16 v[188:191], v[56:59], v[108:111], v[188:191]
    ds_read_b64_tr_b16 v[50:51], v24 offset:55296
    v_mfma_f32_16x16x32_bf16 v[192:195], v[60:63], v[104:107], v[192:195]
    ds_read_b64_tr_b16 v[52:53], v25 offset:49152
    v_mfma_f32_16x16x32_bf16 v[196:199], v[60:63], v[108:111], v[196:199]
    ds_read_b64_tr_b16 v[54:55], v25 offset:55296
    s_waitcnt lgkmcnt(8)
    v_mfma_f32_16x16x32_bf16 v[200:203], v[64:67], v[104:107], v[200:203]
    ds_read_b64_tr_b16 v[56:57], v26 offset:49152
    v_mfma_f32_16x16x32_bf16 v[204:207], v[64:67], v[108:111], v[204:207]
    ds_read_b64_tr_b16 v[58:59], v26 offset:55296
    v_mfma_f32_16x16x32_bf16 v[208:211], v[68:71], v[104:107], v[208:211]
    ds_read_b64_tr_b16 v[60:61], v27 offset:49152
    v_mfma_f32_16x16x32_bf16 v[212:215], v[68:71], v[108:111], v[212:215]
    ds_read_b64_tr_b16 v[62:63], v27 offset:55296
    s_waitcnt lgkmcnt(8)
    v_mfma_f32_16x16x32_bf16 v[216:219], v[72:75], v[104:107], v[216:219]
    ds_read_b64_tr_b16 v[64:65], v24 offset:49280
    v_mfma_f32_16x16x32_bf16 v[220:223], v[72:75], v[108:111], v[220:223]
    ds_read_b64_tr_b16 v[66:67], v24 offset:55424
    s_waitcnt vmcnt(14)
    v_mfma_f32_16x16x32_bf16 v[224:227], v[76:79], v[104:107], v[224:227]
    ds_read_b64_tr_b16 v[68:69], v25 offset:49280
    v_mfma_f32_16x16x32_bf16 v[228:231], v[76:79], v[108:111], v[228:231]
    ds_read_b64_tr_b16 v[70:71], v25 offset:55424
    s_waitcnt lgkmcnt(8)
    v_mfma_f32_16x16x32_bf16 v[136:139], v[48:51], v[112:115], v[136:139]
    ds_read_b64_tr_b16 v[72:73], v26 offset:49280
    s_lshl_b32 s23, s87, 13
    v_mfma_f32_16x16x32_bf16 v[140:143], v[48:51], v[116:119], v[140:143]
    ds_read_b64_tr_b16 v[74:75], v26 offset:55424
    buffer_load_dwordx4 v[80:83], v32, s[4:7], s23 offen offset:0 sc1
    v_mfma_f32_16x16x32_bf16 v[144:147], v[52:55], v[112:115], v[144:147]
    ds_read_b64_tr_b16 v[76:77], v27 offset:49280
    v_mfma_f32_16x16x32_bf16 v[148:151], v[52:55], v[116:119], v[148:151]
    ds_read_b64_tr_b16 v[78:79], v27 offset:55424
    s_waitcnt lgkmcnt(8)
    v_mfma_f32_16x16x32_bf16 v[152:155], v[56:59], v[112:115], v[152:155]
    ds_read_b64_tr_b16 v[48:49], v24 offset:49408
    buffer_load_dwordx4 v[84:87], v32, s[4:7], s23 offen offset:1024 sc1
    v_mfma_f32_16x16x32_bf16 v[156:159], v[56:59], v[116:119], v[156:159]
    ds_read_b64_tr_b16 v[50:51], v24 offset:55552
    s_add_u32 s22, s24, 0
    v_mfma_f32_16x16x32_bf16 v[160:163], v[60:63], v[112:115], v[160:163]
    ds_read_b64_tr_b16 v[52:53], v25 offset:49408
    s_mov_b32 m0, s33
    v_mfma_f32_16x16x32_bf16 v[164:167], v[60:63], v[116:119], v[164:167]
    ds_read_b64_tr_b16 v[54:55], v25 offset:55552
    s_waitcnt lgkmcnt(8)
    v_mfma_f32_16x16x32_bf16 v[168:171], v[64:67], v[112:115], v[168:171]
    ds_read_b64_tr_b16 v[56:57], v26 offset:49408
    s_waitcnt vmcnt(7)
    v_mfma_f32_16x16x32_bf16 v[172:175], v[64:67], v[116:119], v[172:175]
    ds_read_b64_tr_b16 v[58:59], v26 offset:55552
    buffer_load_dwordx4 v32, s[12:15], s22 offen offset:0 lds
    v_mfma_f32_16x16x32_bf16 v[176:179], v[68:71], v[112:115], v[176:179]
    ds_read_b64_tr_b16 v[60:61], v27 offset:49408
    s_barrier
    v_mfma_f32_16x16x32_bf16 v[180:183], v[68:71], v[116:119], v[180:183]
    ds_read_b64_tr_b16 v[62:63], v27 offset:55552
    s_waitcnt lgkmcnt(8)
    v_mfma_f32_16x16x32_bf16 v[184:187], v[72:75], v[112:115], v[184:187]
    ds_read_b64_tr_b16 v[64:65], v28 offset:0
    buffer_load_dwordx4 v32, s[12:15], s22 offen offset:1024 lds
    v_mfma_f32_16x16x32_bf16 v[188:191], v[72:75], v[116:119], v[188:191]
    ds_read_b64_tr_b16 v[66:67], v28 offset:6144
    v_mfma_f32_16x16x32_bf16 v[192:195], v[76:79], v[112:115], v[192:195]
    ds_read_b64_tr_b16 v[68:69], v29 offset:0
    buffer_load_dwordx4 v32, s[12:15], s22 offen offset:2048 lds
    v_mfma_f32_16x16x32_bf16 v[196:199], v[76:79], v[116:119], v[196:199]
    ds_read_b64_tr_b16 v[70:71], v29 offset:6144
    s_waitcnt lgkmcnt(8)
    v_mfma_f32_16x16x32_bf16 v[200:203], v[48:51], v[112:115], v[200:203]
    ds_read_b64_tr_b16 v[72:73], v30 offset:0
    v_cmp_gt_u32 vcc, 64, v35
    s_nop 4
    s_cbranch_vccnz G2_SPIN
G2_CONT:
    v_mfma_f32_16x16x32_bf16 v[204:207], v[48:51], v[116:119], v[204:207]
    ds_read_b64_tr_b16 v[74:75], v30 offset:6144
    v_mfma_f32_16x16x32_bf16 v[208:211], v[52:55], v[112:115], v[208:211]
    ds_read_b64_tr_b16 v[76:77], v31 offset:0
    v_mfma_f32_16x16x32_bf16 v[212:215], v[52:55], v[116:119], v[212:215]
    ds_read_b64_tr_b16 v[78:79], v31 offset:6144
    s_waitcnt lgkmcnt(8)
    v_mfma_f32_16x16x32_bf16 v[216:219], v[56:59], v[112:115], v[216:219]
    ds_read_b64_tr_b16 v[48:49], v28 offset:128
    v_mfma_f32_16x16x32_bf16 v[220:223], v[56:59], v[116:119], v[220:223]
    ds_read_b64_tr_b16 v[50:51], v28 offset:6272
    v_mfma_f32_16x16x32_bf16 v[224:227], v[60:63], v[112:115], v[224:227]
    ds_read_b64_tr_b16 v[52:53], v29 offset:128
    v_mfma_f32_16x16x32_bf16 v[228:231], v[60:63], v[116:119], v[228:231]
    ds_read_b64_tr_b16 v[54:55], v29 offset:6272
    s_waitcnt lgkmcnt(8)
    v_mfma_f32_16x16x32_bf16 v[136:139], v[64:67], v[120:123], v[136:139]
    ds_read_b64_tr_b16 v[56:57], v30 offset:128
    s_add_u32 s23, s20, 0
    v_mfma_f32_16x16x32_bf16 v[140:143], v[64:67], v[124:127], v[140:143]
    ds_read_b64_tr_b16 v[58:59], v30 offset:6272
    buffer_load_dwordx4 v[88:91], v32, s[12:15], s23 offen sc1
    v_mfma_f32_16x16x32_bf16 v[144:147], v[68:71], v[120:123], v[144:147]
    ds_read_b64_tr_b16 v[60:61], v31 offset:128
    v_mfma_f32_16x16x32_bf16 v[148:151], v[68:71], v[124:127], v[148:151]
    ds_read_b64_tr_b16 v[62:63], v31 offset:6272
    s_waitcnt lgkmcnt(8)
    v_mfma_f32_16x16x32_bf16 v[152:155], v[72:75], v[120:123], v[152:155]
    ds_read_b64_tr_b16 v[64:65], v28 offset:256
    buffer_load_dwordx4 v[92:95], v33, s[12:15], s23 offen sc1
    v_mfma_f32_16x16x32_bf16 v[156:159], v[72:75], v[124:127], v[156:159]
    ds_read_b64_tr_b16 v[66:67], v28 offset:6400
    s_add_u32 s22, s24, 36864
    v_mfma_f32_16x16x32_bf16 v[160:163], v[76:79], v[120:123], v[160:163]
    ds_read_b64_tr_b16 v[68:69], v29 offset:256
    s_mov_b32 m0, s34
    v_mfma_f32_16x16x32_bf16 v[164:167], v[76:79], v[124:127], v[164:167]
    ds_read_b64_tr_b16 v[70:71], v29 offset:6400
    s_waitcnt lgkmcnt(8)
    v_mfma_f32_16x16x32_bf16 v[168:171], v[48:51], v[120:123], v[168:171]
    ds_read_b64_tr_b16 v[72:73], v30 offset:256
    buffer_load_dwordx4 v32, s[12:15], s22 offen offset:0 lds
    v_mfma_f32_16x16x32_bf16 v[172:175], v[48:51], v[124:127], v[172:175]
    ds_read_b64_tr_b16 v[74:75], v30 offset:6400
    v_mfma_f32_16x16x32_bf16 v[176:179], v[52:55], v[120:123], v[176:179]
    ds_read_b64_tr_b16 v[76:77], v31 offset:256
    buffer_load_dwordx4 v32, s[12:15], s22 offen offset:1024 lds
    v_mfma_f32_16x16x32_bf16 v[180:183], v[52:55], v[124:127], v[180:183]
    ds_read_b64_tr_b16 v[78:79], v31 offset:6400
    s_waitcnt lgkmcnt(8)
    v_mfma_f32_16x16x32_bf16 v[184:187], v[56:59], v[120:123], v[184:187]
    ds_read_b64_tr_b16 v[48:49], v28 offset:12288
    buffer_load_dwordx4 v32, s[12:15], s22 offen offset:2048 lds
    v_mfma_f32_16x16x32_bf16 v[188:191], v[56:59], v[124:127], v[188:191]
    ds_read_b64_tr_b16 v[50:51], v28 offset:18432
    v_mfma_f32_16x16x32_bf16 v[192:195], v[60:63], v[120:123], v[192:195]
    ds_read_b64_tr_b16 v[52:53], v29 offset:12288
    v_mfma_f32_16x16x32_bf16 v[196:199], v[60:63], v[124:127], v[196:199]
    ds_read_b64_tr_b16 v[54:55], v29 offset:18432
    s_waitcnt lgkmcnt(8)
    v_mfma_f32_16x16x32_bf16 v[200:203], v[64:67], v[120:123], v[200:203]
    ds_read_b64_tr_b16 v[56:57], v30 offset:12288
    v_mfma_f32_16x16x32_bf16 v[204:207], v[64:67], v[124:127], v[204:207]
    ds_read_b64_tr_b16 v[58:59], v30 offset:18432
    v_mfma_f32_16x16x32_bf16 v[208:211], v[68:71], v[120:123], v[208:211]
    ds_read_b64_tr_b16 v[60:61], v31 offset:12288
    v_mfma_f32_16x16x32_bf16 v[212:215], v[68:71], v[124:127], v[212:215]
    ds_read_b64_tr_b16 v[62:63], v31 offset:18432
    s_waitcnt lgkmcnt(8)
    v_mfma_f32_16x16x32_bf16 v[216:219], v[72:75], v[120:123], v[216:219]
    ds_read_b64_tr_b16 v[64:65], v28 offset:12416
    v_mfma_f32_16x16x32_bf16 v[220:223], v[72:75], v[124:127], v[220:223]
    ds_read_b64_tr_b16 v[66:67], v28 offset:18560
    s_waitcnt vmcnt(13)
    v_mfma_f32_16x16x32_bf16 v[224:227], v[76:79], v[120:123], v[224:227]
    ds_read_b64_tr_b16 v[68:69], v29 offset:12416
    v_mfma_f32_16x16x32_bf16 v[228:231], v[76:79], v[124:127], v[228:231]
    ds_read_b64_tr_b16 v[70:71], v29 offset:18560
    s_waitcnt lgkmcnt(8)
    v_mfma_f32_16x16x32_bf16 v[136:139], v[48:51], v[128:131], v[136:139]
    ds_read_b64_tr_b16 v[72:73], v30 offset:12416
    s_add_u32 s23, s20, 1024
    v_mfma_f32_16x16x32_bf16 v[140:143], v[48:51], v[132:135], v[140:143]
    ds_read_b64_tr_b16 v[74:75], v30 offset:18560
    buffer_load_dwordx4 v[96:99], v32, s[12:15], s23 offen sc1
    v_mfma_f32_16x16x32_bf16 v[144:147], v[52:55], v[128:131], v[144:147]
    ds_read_b64_tr_b16 v[76:77], v31 offset:12416
    v_mfma_f32_16x16x32_bf16 v[148:151], v[52:55], v[132:135], v[148:151]
    ds_read_b64_tr_b16 v[78:79], v31 offset:18560
    s_waitcnt lgkmcnt(8)
    v_mfma_f32_16x16x32_bf16 v[152:155], v[56:59], v[128:131], v[152:155]
    ds_read_b64_tr_b16 v[48:49], v28 offset:12544
    buffer_load_dwordx4 v[100:103], v33, s[12:15], s23 offen sc1
    v_mfma_f32_16x16x32_bf16 v[156:159], v[56:59], v[132:135], v[156:159]
    ds_read_b64_tr_b16 v[50:51], v28 offset:18688
    s_add_u32 s22, s24, 73728
    v_mfma_f32_16x16x32_bf16 v[160:163], v[60:63], v[128:131], v[160:163]
    ds_read_b64_tr_b16 v[52:53], v29 offset:12544
    s_mov_b32 m0, s35
    v_mfma_f32_16x16x32_bf16 v[164:167], v[60:63], v[132:135], v[164:167]
    ds_read_b64_tr_b16 v[54:55], v29 offset:18688
    s_waitcnt lgkmcnt(8)
    v_mfma_f32_16x16x32_bf16 v[168:171], v[64:67], v[128:131], v[168:171]
    ds_read_b64_tr_b16 v[56:57], v30 offset:12544
    s_waitcnt vmcnt(7)
    v_mfma_f32_16x16x32_bf16 v[172:175], v[64:67], v[132:135], v[172:175]
    ds_read_b64_tr_b16 v[58:59], v30 offset:18688
    buffer_load_dwordx4 v32, s[12:15], s22 offen offset:0 lds
    v_mfma_f32_16x16x32_bf16 v[176:179], v[68:71], v[128:131], v[176:179]
    ds_read_b64_tr_b16 v[60:61], v31 offset:12544
    s_barrier
    v_mfma_f32_16x16x32_bf16 v[180:183], v[68:71], v[132:135], v[180:183]
    ds_read_b64_tr_b16 v[62:63], v31 offset:18688
    s_waitcnt lgkmcnt(8)
    v_mfma_f32_16x16x32_bf16 v[184:187], v[72:75], v[128:131], v[184:187]
    ds_read_b64_tr_b16 v[64:65], v24 offset:0
    buffer_load_dwordx4 v32, s[12:15], s22 offen offset:1024 lds
    v_mfma_f32_16x16x32_bf16 v[188:191], v[72:75], v[132:135], v[188:191]
    ds_read_b64_tr_b16 v[66:67], v24 offset:6144
    v_mfma_f32_16x16x32_bf16 v[192:195], v[76:79], v[128:131], v[192:195]
    ds_read_b64_tr_b16 v[68:69], v25 offset:0
    buffer_load_dwordx4 v32, s[12:15], s22 offen offset:2048 lds
    v_mfma_f32_16x16x32_bf16 v[196:199], v[76:79], v[132:135], v[196:199]
    ds_read_b64_tr_b16 v[70:71], v25 offset:6144
    s_waitcnt lgkmcnt(8)
    v_mfma_f32_16x16x32_bf16 v[200:203], v[48:51], v[128:131], v[200:203]
    ds_read_b64_tr_b16 v[72:73], v26 offset:0
    v_mfma_f32_16x16x32_bf16 v[204:207], v[48:51], v[132:135], v[204:207]
    ds_read_b64_tr_b16 v[74:75], v26 offset:6144
    v_mfma_f32_16x16x32_bf16 v[208:211], v[52:55], v[128:131], v[208:211]
    ds_read_b64_tr_b16 v[76:77], v27 offset:0
    v_mfma_f32_16x16x32_bf16 v[212:215], v[52:55], v[132:135], v[212:215]
    ds_read_b64_tr_b16 v[78:79], v27 offset:6144
    s_waitcnt lgkmcnt(8)
    v_mfma_f32_16x16x32_bf16 v[216:219], v[56:59], v[128:131], v[216:219]
    ds_read_b64_tr_b16 v[48:49], v24 offset:128
    v_mfma_f32_16x16x32_bf16 v[220:223], v[56:59], v[132:135], v[220:223]
    ds_read_b64_tr_b16 v[50:51], v24 offset:6272
    v_mfma_f32_16x16x32_bf16 v[224:227], v[60:63], v[128:131], v[224:227]
    ds_read_b64_tr_b16 v[52:53], v25 offset:128
    v_mfma_f32_16x16x32_bf16 v[228:231], v[60:63], v[132:135], v[228:231]
    ds_read_b64_tr_b16 v[54:55], v25 offset:6272
    s_waitcnt lgkmcnt(8)
    v_mfma_f32_16x16x32_bf16 v[136:139], v[64:67], v[80:83], v[136:139]
    ds_read_b64_tr_b16 v[56:57], v26 offset:128
    s_add_u32 s23, s20, 2048
    v_mfma_f32_16x16x32_bf16 v[140:143], v[64:67], v[84:87], v[140:143]
    ds_read_b64_tr_b16 v[58:59], v26 offset:6272
    s_mov_b32 s48, s92
    s_mov_b32 s49, s93
    s_mov_b32 s50, 2359296
    s_mov_b32 s51, 0x00020000
    v_mfma_f32_16x16x32_bf16 v[144:147], v[68:71], v[80:83], v[144:147]
    ds_read_b64_tr_b16 v[60:61], v27 offset:128
    buffer_load_dwordx4 v[104:107], v32, s[12:15], s23 offen sc1
    v_mfma_f32_16x16x32_bf16 v[148:151], v[68:71], v[84:87], v[148:151]
    ds_read_b64_tr_b16 v[62:63], v27 offset:6272
    s_waitcnt lgkmcnt(8)
    v_mfma_f32_16x16x32_bf16 v[152:155], v[72:75], v[80:83], v[152:155]
    ds_read_b64_tr_b16 v[64:65], v24 offset:256
    buffer_load_dwordx4 v[108:111], v33, s[12:15], s23 offen sc1
    v_mfma_f32_16x16x32_bf16 v[156:159], v[72:75], v[84:87], v[156:159]
    ds_read_b64_tr_b16 v[66:67], v24 offset:6400
    s_add_u32 s22, s24, 110592
    v_mfma_f32_16x16x32_bf16 v[160:163], v[76:79], v[80:83], v[160:163]
    ds_read_b64_tr_b16 v[68:69], v25 offset:256
    s_mov_b32 m0, s36
    v_mfma_f32_16x16x32_bf16 v[164:167], v[76:79], v[84:87], v[164:167]
    ds_read_b64_tr_b16 v[70:71], v25 offset:6400
    s_waitcnt lgkmcnt(8)
    v_mfma_f32_16x16x32_bf16 v[168:171], v[48:51], v[80:83], v[168:171]
    ds_read_b64_tr_b16 v[72:73], v26 offset:256
    buffer_load_dwordx4 v32, s[12:15], s22 offen offset:0 lds
    v_mfma_f32_16x16x32_bf16 v[172:175], v[48:51], v[84:87], v[172:175]
    ds_read_b64_tr_b16 v[74:75], v26 offset:6400
    v_mfma_f32_16x16x32_bf16 v[176:179], v[52:55], v[80:83], v[176:179]
    ds_read_b64_tr_b16 v[76:77], v27 offset:256
    buffer_load_dwordx4 v32, s[12:15], s22 offen offset:1024 lds
    v_mfma_f32_16x16x32_bf16 v[180:183], v[52:55], v[84:87], v[180:183]
    ds_read_b64_tr_b16 v[78:79], v27 offset:6400
    s_waitcnt lgkmcnt(8)
    v_mfma_f32_16x16x32_bf16 v[184:187], v[56:59], v[80:83], v[184:187]
    ds_read_b128 v[48:51], v32 offset:12288
    buffer_load_dwordx4 v32, s[12:15], s22 offen offset:2048 lds
    v_mfma_f32_16x16x32_bf16 v[188:191], v[56:59], v[84:87], v[188:191]
    v_mfma_f32_16x16x32_bf16 v[192:195], v[60:63], v[80:83], v[192:195]
    ds_read_b128 v[52:55], v32 offset:13312
    v_mfma_f32_16x16x32_bf16 v[196:199], v[60:63], v[84:87], v[196:199]
    s_waitcnt lgkmcnt(6)
    v_mfma_f32_16x16x32_bf16 v[200:203], v[64:67], v[80:83], v[200:203]
    ds_read_b128 v[56:59], v32 offset:14336
    v_mfma_f32_16x16x32_bf16 v[204:207], v[64:67], v[84:87], v[204:207]
    v_mfma_f32_16x16x32_bf16 v[208:211], v[68:71], v[80:83], v[208:211]
    ds_read_b128 v[60:63], v32 offset:15360
    v_mfma_f32_16x16x32_bf16 v[212:215], v[68:71], v[84:87], v[212:215]
    s_waitcnt lgkmcnt(4)
    v_mfma_f32_16x16x32_bf16 v[216:219], v[72:75], v[80:83], v[216:219]
    ds_read_b128 v[64:67], v32 offset:16384
    v_mfma_f32_16x16x32_bf16 v[220:223], v[72:75], v[84:87], v[220:223]
    s_waitcnt vmcnt(13)
    v_mfma_f32_16x16x32_bf16 v[224:227], v[76:79], v[80:83], v[224:227]
    ds_read_b128 v[68:71], v32 offset:17408
    v_mfma_f32_16x16x32_bf16 v[228:231], v[76:79], v[84:87], v[228:231]
    s_waitcnt lgkmcnt(4)
    v_mfma_f32_16x16x32_bf16 v[136:139], v[48:51], v[88:91], v[136:139]
    ds_read_b128 v[72:75], v32 offset:18432
    s_add_u32 s23, s20, 3072
    v_mfma_f32_16x16x32_bf16 v[140:143], v[48:51], v[92:95], v[140:143]
    buffer_load_dwordx4 v[112:115], v32, s[12:15], s23 offen sc1
    v_mfma_f32_16x16x32_bf16 v[144:147], v[52:55], v[88:91], v[144:147]
    ds_read_b128 v[76:79], v32 offset:19456
    v_mfma_f32_16x16x32_bf16 v[148:151], v[52:55], v[92:95], v[148:151]
    s_waitcnt lgkmcnt(4)
    s_add_u32 m0, s21, 0
    s_nop 0
    buffer_load_dwordx4 v8, s[48:51], s47 offen offset:0 lds
    v_mfma_f32_16x16x32_bf16 v[152:155], v[56:59], v[88:91], v[152:155]
    ds_read_b128 v[48:51], v32 offset:20480
    buffer_load_dwordx4 v[116:119], v33, s[12:15], s23 offen sc1
    v_mfma_f32_16x16x32_bf16 v[156:159], v[56:59], v[92:95], v[156:159]
    v_mfma_f32_16x16x32_bf16 v[160:163], v[60:63], v[88:91], v[160:163]
    ds_read_b128 v[52:55], v32 offset:21504
    v_mfma_f32_16x16x32_bf16 v[164:167], v[60:63], v[92:95], v[164:167]
    s_waitcnt lgkmcnt(4)
    v_mfma_f32_16x16x32_bf16 v[168:171], v[64:67], v[88:91], v[168:171]
    ds_read_b128 v[56:59], v32 offset:22528
    s_waitcnt vmcnt(8)
    v_mfma_f32_16x16x32_bf16 v[172:175], v[64:67], v[92:95], v[172:175]
    s_add_u32 m0, s21, 992
    s_nop 0
    buffer_load_dwordx4 v8, s[48:51], s47 offen offset:32 lds
    v_mfma_f32_16x16x32_bf16 v[176:179], v[68:71], v[88:91], v[176:179]
    ds_read_b128 v[60:63], v32 offset:23552
    s_barrier
    v_mfma_f32_16x16x32_bf16 v[180:183], v[68:71], v[92:95], v[180:183]
    s_waitcnt lgkmcnt(4)
    v_mfma_f32_16x16x32_bf16 v[184:187], v[72:75], v[88:91], v[184:187]
    ds_read_b128 v[64:67], v32 offset:24576
    v_mfma_f32_16x16x32_bf16 v[188:191], v[72:75], v[92:95], v[188:191]
    v_mfma_f32_16x16x32_bf16 v[192:195], v[76:79], v[88:91], v[192:195]
    ds_read_b128 v[68:71], v32 offset:25600
    v_mfma_f32_16x16x32_bf16 v[196:199], v[76:79], v[92:95], v[196:199]
    s_waitcnt lgkmcnt(4)
    s_add_u32 m0, s21, 1984
    s_nop 0
    buffer_load_dwordx4 v8, s[48:51], s47 offen offset:64 lds
    v_mfma_f32_16x16x32_bf16 v[200:203], v[48:51], v[88:91], v[200:203]
    ds_read_b128 v[72:75], v32 offset:26624
    v_mfma_f32_16x16x32_bf16 v[204:207], v[48:51], v[92:95], v[204:207]
    v_mfma_f32_16x16x32_bf16 v[208:211], v[52:55], v[88:91], v[208:211]
    ds_read_b128 v[76:79], v32 offset:27648
    v_mfma_f32_16x16x32_bf16 v[212:215], v[52:55], v[92:95], v[212:215]
    s_waitcnt lgkmcnt(4)
    v_mfma_f32_16x16x32_bf16 v[216:219], v[56:59], v[88:91], v[216:219]
    ds_read_b128 v[48:51], v32 offset:28672
    v_mfma_f32_16x16x32_bf16 v[220:223], v[56:59], v[92:95], v[220:223]
    v_mfma_f32_16x16x32_bf16 v[224:227], v[60:63], v[88:91], v[224:227]
    ds_read_b128 v[52:55], v32 offset:29696
    v_mfma_f32_16x16x32_bf16 v[228:231], v[60:63], v[92:95], v[228:231]
    s_waitcnt lgkmcnt(4)
    v_mfma_f32_16x16x32_bf16 v[136:139], v[64:67], v[96:99], v[136:139]
    ds_read_b128 v[56:59], v32 offset:30720
    v_mfma_f32_16x16x32_bf16 v[140:143], v[64:67], v[100:103], v[140:143]
    v_mfma_f32_16x16x32_bf16 v[144:147], v[68:71], v[96:99], v[144:147]
    ds_read_b128 v[60:63], v32 offset:31744
    v_mfma_f32_16x16x32_bf16 v[148:151], v[68:71], v[100:103], v[148:151]
    s_waitcnt lgkmcnt(4)
    s_add_u32 s45, s16, 0
    s_min_u32 s45, s45, 8
    s_mul_i32 s26, s45, 21846
    s_lshr_b32 s26, s26, 16
    s_mul_i32 s27, s26, 33792
    s_lshl_b32 s45, s45, 10
    s_add_u32 m0, s45, 86016
    s_add_u32 s27, s27, s45
    s_add_u32 s27, s27, s46
    buffer_load_dwordx4 v32, s[12:15], s27 offen lds
    v_mfma_f32_16x16x32_bf16 v[152:155], v[72:75], v[96:99], v[152:155]
    ds_read_b128 v[64:67], v32 offset:32768
    v_mfma_f32_16x16x32_bf16 v[156:159], v[72:75], v[100:103], v[156:159]
    v_mfma_f32_16x16x32_bf16 v[160:163], v[76:79], v[96:99], v[160:163]
    ds_read_b128 v[68:71], v32 offset:33792
    v_mfma_f32_16x16x32_bf16 v[164:167], v[76:79], v[100:103], v[164:167]
    s_waitcnt lgkmcnt(4)
    v_mfma_f32_16x16x32_bf16 v[168:171], v[48:51], v[96:99], v[168:171]
    ds_read_b128 v[72:75], v32 offset:34816
    v_mfma_f32_16x16x32_bf16 v[172:175], v[48:51], v[100:103], v[172:175]
    s_add_u32 s45, s16, 4
    s_min_u32 s45, s45, 8
    s_mul_i32 s26, s45, 21846
    s_lshr_b32 s26, s26, 16
    s_mul_i32 s27, s26, 33792
    s_lshl_b32 s45, s45, 10
    s_add_u32 m0, s45, 86016
    s_add_u32 s27, s27, s45
    s_add_u32 s27, s27, s46
    buffer_load_dwordx4 v32, s[12:15], s27 offen lds
    v_mfma_f32_16x16x32_bf16 v[176:179], v[52:55], v[96:99], v[176:179]
    ds_read_b128 v[76:79], v32 offset:35840
    v_mfma_f32_16x16x32_bf16 v[180:183], v[52:55], v[100:103], v[180:183]
    s_waitcnt lgkmcnt(4)
    v_mfma_f32_16x16x32_bf16 v[184:187], v[56:59], v[96:99], v[184:187]
    ds_read_b128 v[48:51], v32 offset:36864
    v_mfma_f32_16x16x32_bf16 v[188:191], v[56:59], v[100:103], v[188:191]
    v_mfma_f32_16x16x32_bf16 v[192:195], v[60:63], v[96:99], v[192:195]
    ds_read_b128 v[52:55], v32 offset:37888
    v_mfma_f32_16x16x32_bf16 v[196:199], v[60:63], v[100:103], v[196:199]
    s_waitcnt lgkmcnt(4)
    s_add_u32 s45, s16, 8
    s_min_u32 s45, s45, 8
    s_mul_i32 s26, s45, 21846
    s_lshr_b32 s26, s26, 16
    s_mul_i32 s27, s26, 33792
    s_lshl_b32 s45, s45, 10
    s_add_u32 m0, s45, 86016
    s_add_u32 s27, s27, s45
    s_add_u32 s27, s27, s46
    buffer_load_dwordx4 v32, s[12:15], s27 offen lds
    v_mfma_f32_16x16x32_bf16 v[200:203], v[64:67], v[96:99], v[200:203]
    ds_read_b128 v[56:59], v32 offset:38912
    v_mfma_f32_16x16x32_bf16 v[204:207], v[64:67], v[100:103], v[204:207]
    v_mfma_f32_16x16x32_bf16 v[208:211], v[68:71], v[96:99], v[208:211]
    ds_read_b128 v[60:63], v32 offset:39936
    v_mfma_f32_16x16x32_bf16 v[212:215], v[68:71], v[100:103], v[212:215]
    s_waitcnt lgkmcnt(4)
    v_mfma_f32_16x16x32_bf16 v[216:219], v[72:75], v[96:99], v[216:219]
    ds_read_b128 v[64:67], v32 offset:40960
    v_mfma_f32_16x16x32_bf16 v[220:223], v[72:75], v[100:103], v[220:223]
    s_waitcnt vmcnt(11)
    v_mfma_f32_16x16x32_bf16 v[224:227], v[76:79], v[96:99], v[224:227]
    ds_read_b128 v[68:71], v32 offset:41984
    v_mfma_f32_16x16x32_bf16 v[228:231], v[76:79], v[100:103], v[228:231]
    s_waitcnt lgkmcnt(4)
    v_mfma_f32_16x16x32_bf16 v[136:139], v[48:51], v[104:107], v[136:139]
    ds_read_b128 v[72:75], v32 offset:43008
    v_mfma_f32_16x16x32_bf16 v[140:143], v[48:51], v[108:111], v[140:143]
    v_mfma_f32_16x16x32_bf16 v[144:147], v[52:55], v[104:107], v[144:147]
    ds_read_b128 v[76:79], v32 offset:44032
    v_mfma_f32_16x16x32_bf16 v[148:151], v[52:55], v[108:111], v[148:151]
    s_waitcnt lgkmcnt(4)
    v_mfma_f32_16x16x32_bf16 v[152:155], v[56:59], v[104:107], v[152:155]
    ds_read_b128 v[48:51], v32 offset:45056
    v_mfma_f32_16x16x32_bf16 v[156:159], v[56:59], v[108:111], v[156:159]
    v_mfma_f32_16x16x32_bf16 v[160:163], v[60:63], v[104:107], v[160:163]
    ds_read_b128 v[52:55], v32 offset:46080
    v_mfma_f32_16x16x32_bf16 v[164:167], v[60:63], v[108:111], v[164:167]
    s_waitcnt lgkmcnt(4)
    v_mfma_f32_16x16x32_bf16 v[168:171], v[64:67], v[104:107], v[168:171]
    ds_read_b128 v[56:59], v32 offset:47104
    s_waitcnt vmcnt(8)
    v_mfma_f32_16x16x32_bf16 v[172:175], v[64:67], v[108:111], v[172:175]
    v_mfma_f32_16x16x32_bf16 v[176:179], v[68:71], v[104:107], v[176:179]
    ds_read_b128 v[60:63], v32 offset:48128
    s_barrier
    v_mfma_f32_16x16x32_bf16 v[180:183], v[68:71], v[108:111], v[180:183]
    s_waitcnt lgkmcnt(4)
    v_mfma_f32_16x16x32_bf16 v[184:187], v[72:75], v[104:107], v[184:187]
    ds_read_b128 v[64:67], v32 offset:49152
    v_mfma_f32_16x16x32_bf16 v[188:191], v[72:75], v[108:111], v[188:191]
    v_mfma_f32_16x16x32_bf16 v[192:195], v[76:79], v[104:107], v[192:195]
    ds_read_b128 v[68:71], v32 offset:50176
    v_mfma_f32_16x16x32_bf16 v[196:199], v[76:79], v[108:111], v[196:199]
    s_waitcnt lgkmcnt(4)
    v_mfma_f32_16x16x32_bf16 v[200:203], v[48:51], v[104:107], v[200:203]
    ds_read_b128 v[72:75], v32 offset:51200
    v_mfma_f32_16x16x32_bf16 v[204:207], v[48:51], v[108:111], v[204:207]
    v_mfma_f32_16x16x32_bf16 v[208:211], v[52:55], v[104:107], v[208:211]
    ds_read_b128 v[76:79], v32 offset:52224
    v_mfma_f32_16x16x32_bf16 v[212:215], v[52:55], v[108:111], v[212:215]
    s_waitcnt lgkmcnt(4)
    v_mfma_f32_16x16x32_bf16 v[216:219], v[56:59], v[104:107], v[216:219]
    ds_read_b128 v[48:51], v32 offset:53248
    v_mfma_f32_16x16x32_bf16 v[220:223], v[56:59], v[108:111], v[220:223]
    s_waitcnt vmcnt(5)
    v_mfma_f32_16x16x32_bf16 v[224:227], v[60:63], v[104:107], v[224:227]
    ds_read_b128 v[52:55], v32 offset:54272
    v_mfma_f32_16x16x32_bf16 v[228:231], v[60:63], v[108:111], v[228:231]
    s_waitcnt lgkmcnt(4)
    v_mfma_f32_16x16x32_bf16 v[136:139], v[64:67], v[112:115], v[136:139]
    ds_read_b128 v[56:59], v32 offset:55296
    v_mfma_f32_16x16x32_bf16 v[140:143], v[64:67], v[116:119], v[140:143]
    v_mfma_f32_16x16x32_bf16 v[144:147], v[68:71], v[112:115], v[144:147]
    ds_read_b128 v[60:63], v32 offset:56320
    v_mfma_f32_16x16x32_bf16 v[148:151], v[68:71], v[116:119], v[148:151]
    s_waitcnt lgkmcnt(4)
    v_mfma_f32_16x16x32_bf16 v[152:155], v[72:75], v[112:115], v[152:155]
    ds_read_b128 v[64:67], v32 offset:57344
    v_mfma_f32_16x16x32_bf16 v[156:159], v[72:75], v[116:119], v[156:159]
    v_mfma_f32_16x16x32_bf16 v[160:163], v[76:79], v[112:115], v[160:163]
    ds_read_b128 v[68:71], v32 offset:58368
    v_mfma_f32_16x16x32_bf16 v[164:167], v[76:79], v[116:119], v[164:167]
    s_waitcnt lgkmcnt(4)
    v_mfma_f32_16x16x32_bf16 v[168:171], v[48:51], v[112:115], v[168:171]
    ds_read_b128 v[72:75], v32 offset:59392
    v_mfma_f32_16x16x32_bf16 v[172:175], v[48:51], v[116:119], v[172:175]
    v_mfma_f32_16x16x32_bf16 v[176:179], v[52:55], v[112:115], v[176:179]
    ds_read_b128 v[76:79], v32 offset:60416
    v_mfma_f32_16x16x32_bf16 v[180:183], v[52:55], v[116:119], v[180:183]
    s_waitcnt lgkmcnt(4)
    v_mfma_f32_16x16x32_bf16 v[184:187], v[56:59], v[112:115], v[184:187]
    v_mfma_f32_16x16x32_bf16 v[188:191], v[56:59], v[116:119], v[188:191]
    v_mfma_f32_16x16x32_bf16 v[192:195], v[60:63], v[112:115], v[192:195]
    v_mfma_f32_16x16x32_bf16 v[196:199], v[60:63], v[116:119], v[196:199]
    s_waitcnt lgkmcnt(2)
    v_mfma_f32_16x16x32_bf16 v[200:203], v[64:67], v[112:115], v[200:203]
    v_mfma_f32_16x16x32_bf16 v[204:207], v[64:67], v[116:119], v[204:207]
    v_mfma_f32_16x16x32_bf16 v[208:211], v[68:71], v[112:115], v[208:211]
    v_mfma_f32_16x16x32_bf16 v[212:215], v[68:71], v[116:119], v[212:215]
    s_waitcnt lgkmcnt(0)
    v_mfma_f32_16x16x32_bf16 v[216:219], v[72:75], v[112:115], v[216:219]
    v_mfma_f32_16x16x32_bf16 v[220:223], v[72:75], v[116:119], v[220:223]
    v_mfma_f32_16x16x32_bf16 v[224:227], v[76:79], v[112:115], v[224:227]
    v_mfma_f32_16x16x32_bf16 v[228:231], v[76:79], v[116:119], v[228:231]
    s_load_dwordx2 s[54:55], s[0:1], 56
    global_load_dword v45, v44, s[30:31] sc1
    s_nop 4
    s_cmp_eq_u32 s19, 0
    s_cbranch_scc0 P3_C0
    v_cvt_pk_bf16_f32 v48, v160, v161
    v_cvt_pk_bf16_f32 v49, v162, v163
    v_cvt_pk_bf16_f32 v50, v164, v165
    v_cvt_pk_bf16_f32 v51, v166, v167
    buffer_store_dwordx4 v[48:51], v32, s[12:15], s29 offen offset:3072 sc1
    v_cvt_pk_bf16_f32 v52, v168, v169
    v_cvt_pk_bf16_f32 v53, v170, v171
    v_cvt_pk_bf16_f32 v54, v172, v173
    v_cvt_pk_bf16_f32 v55, v174, v175
    s_add_u32 s29, s29, 4096
    buffer_store_dwordx4 v[52:55], v32, s[12:15], s29 offen offset:0 sc1
    v_cvt_pk_bf16_f32 v56, v176, v177
    v_cvt_pk_bf16_f32 v57, v178, v179
    v_cvt_pk_bf16_f32 v58, v180, v181
    v_cvt_pk_bf16_f32 v59, v182, v183
    buffer_store_dwordx4 v[56:59], v32, s[12:15], s29 offen offset:1024 sc1
    v_cvt_pk_bf16_f32 v60, v184, v185
    v_cvt_pk_bf16_f32 v61, v186, v187
    v_cvt_pk_bf16_f32 v62, v188, v189
    v_cvt_pk_bf16_f32 v63, v190, v191
    buffer_store_dwordx4 v[60:63], v32, s[12:15], s29 offen offset:2048 sc1
    v_cvt_pk_bf16_f32 v48, v192, v193
    v_cvt_pk_bf16_f32 v49, v194, v195
    v_cvt_pk_bf16_f32 v50, v196, v197
    v_cvt_pk_bf16_f32 v51, v198, v199
    buffer_store_dwordx4 v[48:51], v32, s[12:15], s29 offen offset:3072 sc1
    v_cvt_pk_bf16_f32 v52, v200, v201
    v_cvt_pk_bf16_f32 v53, v202, v203
    v_cvt_pk_bf16_f32 v54, v204, v205
    v_cvt_pk_bf16_f32 v55, v206, v207
    s_add_u32 s29, s29, 4096
    buffer_store_dwordx4 v[52:55], v32, s[12:15], s29 offen offset:0 sc1
    v_cvt_pk_bf16_f32 v56, v208, v209
    v_cvt_pk_bf16_f32 v57, v210, v211
    v_cvt_pk_bf16_f32 v58, v212, v213
    v_cvt_pk_bf16_f32 v59, v214, v215
    buffer_store_dwordx4 v[56:59], v32, s[12:15], s29 offen offset:1024 sc1
    v_cvt_pk_bf16_f32 v60, v216, v217
    v_cvt_pk_bf16_f32 v61, v218, v219
    v_cvt_pk_bf16_f32 v62, v220, v221
    v_cvt_pk_bf16_f32 v63, v222, v223
    buffer_store_dwordx4 v[60:63], v32, s[12:15], s29 offen offset:2048 sc1
    v_cvt_pk_bf16_f32 v48, v224, v225
    v_cvt_pk_bf16_f32 v49, v226, v227
    v_cvt_pk_bf16_f32 v50, v228, v229
    v_cvt_pk_bf16_f32 v51, v230, v231
    buffer_store_dwordx4 v[48:51], v32, s[12:15], s29 offen offset:3072 sc1
    v_mov_b32 v232, v136
    v_mov_b32 v233, v137
    v_mov_b32 v234, v138
    v_mov_b32 v235, v139
    v_mov_b32 v236, v140
    v_mov_b32 v237, v141
    v_mov_b32 v238, v142
    v_mov_b32 v239, v143
    v_mov_b32 v240, v144
    v_mov_b32 v241, v145
    v_mov_b32 v242, v146
    v_mov_b32 v243, v147
    v_mov_b32 v244, v148
    v_mov_b32 v245, v149
    v_mov_b32 v246, v150
    v_mov_b32 v247, v151
    v_mov_b32 v248, v152
    v_mov_b32 v249, v153
    v_mov_b32 v250, v154
    v_mov_b32 v251, v155
    v_mov_b32 v252, v156
    v_mov_b32 v253, v157
    v_mov_b32 v254, v158
    v_mov_b32 v255, v159
    s_branch P3_CD
P3_C0:
    s_cmp_eq_u32 s19, 1
    s_cbranch_scc0 P3_C1
    v_cvt_pk_bf16_f32 v48, v136, v137
    v_cvt_pk_bf16_f32 v49, v138, v139
    v_cvt_pk_bf16_f32 v50, v140, v141
    v_cvt_pk_bf16_f32 v51, v142, v143
    buffer_store_dwordx4 v[48:51], v32, s[12:15], s29 offen offset:0 sc1
    v_cvt_pk_bf16_f32 v52, v144, v145
    v_cvt_pk_bf16_f32 v53, v146, v147
    v_cvt_pk_bf16_f32 v54, v148, v149
    v_cvt_pk_bf16_f32 v55, v150, v151
    buffer_store_dwordx4 v[52:55], v32, s[12:15], s29 offen offset:1024 sc1
    v_cvt_pk_bf16_f32 v56, v152, v153
    v_cvt_pk_bf16_f32 v57, v154, v155
    v_cvt_pk_bf16_f32 v58, v156, v157
    v_cvt_pk_bf16_f32 v59, v158, v159
    buffer_store_dwordx4 v[56:59], v32, s[12:15], s29 offen offset:2048 sc1
    v_cvt_pk_bf16_f32 v60, v184, v185
    v_cvt_pk_bf16_f32 v61, v186, v187
    v_cvt_pk_bf16_f32 v62, v188, v189
    v_cvt_pk_bf16_f32 v63, v190, v191
    s_add_u32 s29, s29, 4096
    buffer_store_dwordx4 v[60:63], v32, s[12:15], s29 offen offset:2048 sc1
    v_cvt_pk_bf16_f32 v48, v192, v193
    v_cvt_pk_bf16_f32 v49, v194, v195
    v_cvt_pk_bf16_f32 v50, v196, v197
    v_cvt_pk_bf16_f32 v51, v198, v199
    buffer_store_dwordx4 v[48:51], v32, s[12:15], s29 offen offset:3072 sc1
    v_cvt_pk_bf16_f32 v52, v200, v201
    v_cvt_pk_bf16_f32 v53, v202, v203
    v_cvt_pk_bf16_f32 v54, v204, v205
    v_cvt_pk_bf16_f32 v55, v206, v207
    s_add_u32 s29, s29, 4096
    buffer_store_dwordx4 v[52:55], v32, s[12:15], s29 offen offset:0 sc1
    v_cvt_pk_bf16_f32 v56, v208, v209
    v_cvt_pk_bf16_f32 v57, v210, v211
    v_cvt_pk_bf16_f32 v58, v212, v213
    v_cvt_pk_bf16_f32 v59, v214, v215
    buffer_store_dwordx4 v[56:59], v32, s[12:15], s29 offen offset:1024 sc1
    v_cvt_pk_bf16_f32 v60, v216, v217
    v_cvt_pk_bf16_f32 v61, v218, v219
    v_cvt_pk_bf16_f32 v62, v220, v221
    v_cvt_pk_bf16_f32 v63, v222, v223
    buffer_store_dwordx4 v[60:63], v32, s[12:15], s29 offen offset:2048 sc1
    v_cvt_pk_bf16_f32 v48, v224, v225
    v_cvt_pk_bf16_f32 v49, v226, v227
    v_cvt_pk_bf16_f32 v50, v228, v229
    v_cvt_pk_bf16_f32 v51, v230, v231
    buffer_store_dwordx4 v[48:51], v32, s[12:15], s29 offen offset:3072 sc1
    v_mov_b32 v232, v160
    v_mov_b32 v233, v161
    v_mov_b32 v234, v162
    v_mov_b32 v235, v163
    v_mov_b32 v236, v164
    v_mov_b32 v237, v165
    v_mov_b32 v238, v166
    v_mov_b32 v239, v167
    v_mov_b32 v240, v168
    v_mov_b32 v241, v169
    v_mov_b32 v242, v170
    v_mov_b32 v243, v171
    v_mov_b32 v244, v172
    v_mov_b32 v245, v173
    v_mov_b32 v246, v174
    v_mov_b32 v247, v175
    v_mov_b32 v248, v176
    v_mov_b32 v249, v177
    v_mov_b32 v250, v178
    v_mov_b32 v251, v179
    v_mov_b32 v252, v180
    v_mov_b32 v253, v181
    v_mov_b32 v254, v182
    v_mov_b32 v255, v183
    s_branch P3_CD
P3_C1:
    s_cmp_eq_u32 s19, 2
    s_cbranch_scc0 P3_C2
    v_cvt_pk_bf16_f32 v48, v136, v137
    v_cvt_pk_bf16_f32 v49, v138, v139
    v_cvt_pk_bf16_f32 v50, v140, v141
    v_cvt_pk_bf16_f32 v51, v142, v143
    buffer_store_dwordx4 v[48:51], v32, s[12:15], s29 offen offset:0 sc1
    v_cvt_pk_bf16_f32 v52, v144, v145
    v_cvt_pk_bf16_f32 v53, v146, v147
    v_cvt_pk_bf16_f32 v54, v148, v149
    v_cvt_pk_bf16_f32 v55, v150, v151
    buffer_store_dwordx4 v[52:55], v32, s[12:15], s29 offen offset:1024 sc1
    v_cvt_pk_bf16_f32 v56, v152, v153
    v_cvt_pk_bf16_f32 v57, v154, v155
    v_cvt_pk_bf16_f32 v58, v156, v157
    v_cvt_pk_bf16_f32 v59, v158, v159
    buffer_store_dwordx4 v[56:59], v32, s[12:15], s29 offen offset:2048 sc1
    v_cvt_pk_bf16_f32 v60, v160, v161
    v_cvt_pk_bf16_f32 v61, v162, v163
    v_cvt_pk_bf16_f32 v62, v164, v165
    v_cvt_pk_bf16_f32 v63, v166, v167
    buffer_store_dwordx4 v[60:63], v32, s[12:15], s29 offen offset:3072 sc1
    v_cvt_pk_bf16_f32 v48, v168, v169
    v_cvt_pk_bf16_f32 v49, v170, v171
    v_cvt_pk_bf16_f32 v50, v172, v173
    v_cvt_pk_bf16_f32 v51, v174, v175
    s_add_u32 s29, s29, 4096
    buffer_store_dwordx4 v[48:51], v32, s[12:15], s29 offen offset:0 sc1
    v_cvt_pk_bf16_f32 v52, v176, v177
    v_cvt_pk_bf16_f32 v53, v178, v179
    v_cvt_pk_bf16_f32 v54, v180, v181
    v_cvt_pk_bf16_f32 v55, v182, v183
    buffer_store_dwordx4 v[52:55], v32, s[12:15], s29 offen offset:1024 sc1
    v_cvt_pk_bf16_f32 v56, v208, v209
    v_cvt_pk_bf16_f32 v57, v210, v211
    v_cvt_pk_bf16_f32 v58, v212, v213
    v_cvt_pk_bf16_f32 v59, v214, v215
    s_add_u32 s29, s29, 4096
    buffer_store_dwordx4 v[56:59], v32, s[12:15], s29 offen offset:1024 sc1
    v_cvt_pk_bf16_f32 v60, v216, v217
    v_cvt_pk_bf16_f32 v61, v218, v219
    v_cvt_pk_bf16_f32 v62, v220, v221
    v_cvt_pk_bf16_f32 v63, v222, v223
    buffer_store_dwordx4 v[60:63], v32, s[12:15], s29 offen offset:2048 sc1
    v_cvt_pk_bf16_f32 v48, v224, v225
    v_cvt_pk_bf16_f32 v49, v226, v227
    v_cvt_pk_bf16_f32 v50, v228, v229
    v_cvt_pk_bf16_f32 v51, v230, v231
    buffer_store_dwordx4 v[48:51], v32, s[12:15], s29 offen offset:3072 sc1
    v_mov_b32 v232, v184
    v_mov_b32 v233, v185
    v_mov_b32 v234, v186
    v_mov_b32 v235, v187
    v_mov_b32 v236, v188
    v_mov_b32 v237, v189
    v_mov_b32 v238, v190
    v_mov_b32 v239, v191
    v_mov_b32 v240, v192
    v_mov_b32 v241, v193
    v_mov_b32 v242, v194
    v_mov_b32 v243, v195
    v_mov_b32 v244, v196
    v_mov_b32 v245, v197
    v_mov_b32 v246, v198
    v_mov_b32 v247, v199
    v_mov_b32 v248, v200
    v_mov_b32 v249, v201
    v_mov_b32 v250, v202
    v_mov_b32 v251, v203
    v_mov_b32 v252, v204
    v_mov_b32 v253, v205
    v_mov_b32 v254, v206
    v_mov_b32 v255, v207
    s_branch P3_CD
P3_C2:
    v_cvt_pk_bf16_f32 v48, v136, v137
    v_cvt_pk_bf16_f32 v49, v138, v139
    v_cvt_pk_bf16_f32 v50, v140, v141
    v_cvt_pk_bf16_f32 v51, v142, v143
    buffer_store_dwordx4 v[48:51], v32, s[12:15], s29 offen offset:0 sc1
    v_cvt_pk_bf16_f32 v52, v144, v145
    v_cvt_pk_bf16_f32 v53, v146, v147
    v_cvt_pk_bf16_f32 v54, v148, v149
    v_cvt_pk_bf16_f32 v55, v150, v151
    buffer_store_dwordx4 v[52:55], v32, s[12:15], s29 offen offset:1024 sc1
    v_cvt_pk_bf16_f32 v56, v152, v153
    v_cvt_pk_bf16_f32 v57, v154, v155
    v_cvt_pk_bf16_f32 v58, v156, v157
    v_cvt_pk_bf16_f32 v59, v158, v159
    buffer_store_dwordx4 v[56:59], v32, s[12:15], s29 offen offset:2048 sc1
    v_cvt_pk_bf16_f32 v60, v160, v161
    v_cvt_pk_bf16_f32 v61, v162, v163
    v_cvt_pk_bf16_f32 v62, v164, v165
    v_cvt_pk_bf16_f32 v63, v166, v167
    buffer_store_dwordx4 v[60:63], v32, s[12:15], s29 offen offset:3072 sc1
    v_cvt_pk_bf16_f32 v48, v168, v169
    v_cvt_pk_bf16_f32 v49, v170, v171
    v_cvt_pk_bf16_f32 v50, v172, v173
    v_cvt_pk_bf16_f32 v51, v174, v175
    s_add_u32 s29, s29, 4096
    buffer_store_dwordx4 v[48:51], v32, s[12:15], s29 offen offset:0 sc1
    v_cvt_pk_bf16_f32 v52, v176, v177
    v_cvt_pk_bf16_f32 v53, v178, v179
    v_cvt_pk_bf16_f32 v54, v180, v181
    v_cvt_pk_bf16_f32 v55, v182, v183
    buffer_store_dwordx4 v[52:55], v32, s[12:15], s29 offen offset:1024 sc1
    v_cvt_pk_bf16_f32 v56, v184, v185
    v_cvt_pk_bf16_f32 v57, v186, v187
    v_cvt_pk_bf16_f32 v58, v188, v189
    v_cvt_pk_bf16_f32 v59, v190, v191
    buffer_store_dwordx4 v[56:59], v32, s[12:15], s29 offen offset:2048 sc1
    v_cvt_pk_bf16_f32 v60, v192, v193
    v_cvt_pk_bf16_f32 v61, v194, v195
    v_cvt_pk_bf16_f32 v62, v196, v197
    v_cvt_pk_bf16_f32 v63, v198, v199
    buffer_store_dwordx4 v[60:63], v32, s[12:15], s29 offen offset:3072 sc1
    v_cvt_pk_bf16_f32 v48, v200, v201
    v_cvt_pk_bf16_f32 v49, v202, v203
    v_cvt_pk_bf16_f32 v50, v204, v205
    v_cvt_pk_bf16_f32 v51, v206, v207
    s_add_u32 s29, s29, 4096
    buffer_store_dwordx4 v[48:51], v32, s[12:15], s29 offen offset:0 sc1
    v_mov_b32 v232, v208
    v_mov_b32 v233, v209
    v_mov_b32 v234, v210
    v_mov_b32 v235, v211
    v_mov_b32 v236, v212
    v_mov_b32 v237, v213
    v_mov_b32 v238, v214
    v_mov_b32 v239, v215
    v_mov_b32 v240, v216
    v_mov_b32 v241, v217
    v_mov_b32 v242, v218
    v_mov_b32 v243, v219
    v_mov_b32 v244, v220
    v_mov_b32 v245, v221
    v_mov_b32 v246, v222
    v_mov_b32 v247, v223
    v_mov_b32 v248, v224
    v_mov_b32 v249, v225
    v_mov_b32 v250, v226
    v_mov_b32 v251, v227
    v_mov_b32 v252, v228
    v_mov_b32 v253, v229
    v_mov_b32 v254, v230
    v_mov_b32 v255, v231
P3_CD:
    s_lshl_b32 s58, s17, 3
    s_lshl_b32 s45, s16, 1
    s_add_u32 s58, s58, s45
    s_mul_i32 s58, s58, 19456
    s_add_u32 s58, s58, 24395776
    s_lshl_b32 s59, s17, 2
    s_add_u32 s59, s59, s16
    s_mul_i32 s59, s59, 36
    s_add_u32 s59, s59, s44
    s_lshl_b32 s59, s59, 10
    s_add_u32 s59, s59, 26869760
    s_and_b32 s45, s2, 0xfc
    v_and_b32 v9, 3, v0
    v_add_u32 v9, s45, v9
    v_lshlrev_b32 v9, 7, v9
    v_add_u32 v9, 36749312, v9
    s_lshl_b32 s61, s2, 7
    s_add_u32 s61, s61, 36749312
    v_add_u32 v11, 86016, v32
    s_mul_i32 s45, s16, 3072
    s_add_u32 s45, s45, 95232
    v_add_u32 v12, s45, v32
    s_waitcnt vmcnt(0) lgkmcnt(0)
    s_barrier
    s_mov_b32 s8, s54
    s_mov_b32 s9, s55
    s_mov_b32 s10, 2359296
    s_mov_b32 s11, 0x00020000
    s_cmp_eq_u32 s16, 0
    s_cbranch_scc0 P3_SIG
    v_mov_b32 v13, s61
    v_mov_b32 v14, s101
    s_mov_b64 exec, 1
    buffer_store_dword v14, v13, s[12:15], 0 offen sc1
    s_mov_b64 exec, -1
P3_SIG:
    ds_read_b128 v[104:107], v11 offset:0
    ds_read_b128 v[108:111], v11 offset:1024
    ds_read_b128 v[112:115], v11 offset:2048
    ds_read_b128 v[116:119], v11 offset:3072
    ds_read_b128 v[120:123], v11 offset:4096
    ds_read_b128 v[124:127], v11 offset:5120
    ds_read_b128 v[128:131], v11 offset:6144
    ds_read_b128 v[132:135], v11 offset:7168
    ds_read_b128 v[136:139], v11 offset:8192
    ds_read_b128 v[140:143], v12 offset:0
    ds_read_b128 v[144:147], v12 offset:1024
    ds_read_b128 v[148:151], v12 offset:2048
    s_mov_b32 s45, 262144
P3_POLLP:
    buffer_load_dword v13, v9, s[12:15], 0 offen sc1
    s_waitcnt vmcnt(0)
    v_xor_b32 v13, s101, v13
    v_cmp_ne_u32 vcc, 0, v13
    s_nop 4
    s_cbranch_vccz P3_POLLP_OK
    s_sleep 1
    s_sub_u32 s45, s45, 1
    s_cmp_lg_u32 s45, 0
    s_cbranch_scc1 P3_POLLP
P3_POLLP_OK:
    s_add_u32 s45, s19, 1
    s_and_b32 s45, s45, 3
    s_mul_i32 s45, s45, 2359296
    s_add_u32 s45, s45, s59
    buffer_load_dwordx4 v[152:155], v32, s[12:15], s45 offen offset:0 sc1
    buffer_load_dwordx4 v[156:159], v32, s[12:15], s45 offen offset:1024 sc1
    buffer_load_dwordx4 v[160:163], v32, s[12:15], s45 offen offset:2048 sc1
    s_add_u32 s45, s19, 2
    s_and_b32 s45, s45, 3
    s_mul_i32 s45, s45, 2359296
    s_add_u32 s45, s45, s59
    buffer_load_dwordx4 v[164:167], v32, s[12:15], s45 offen offset:0 sc1
    buffer_load_dwordx4 v[168:171], v32, s[12:15], s45 offen offset:1024 sc1
    buffer_load_dwordx4 v[172:175], v32, s[12:15], s45 offen offset:2048 sc1
    s_add_u32 s45, s19, 3
    s_and_b32 s45, s45, 3
    s_mul_i32 s45, s45, 2359296
    s_add_u32 s45, s45, s59
    buffer_load_dwordx4 v[176:179], v32, s[12:15], s45 offen offset:0 sc1
    buffer_load_dwordx4 v[180:183], v32, s[12:15], s45 offen offset:1024 sc1
    buffer_load_dwordx4 v[184:187], v32, s[12:15], s45 offen offset:2048 sc1
    v_cmp_gt_u32 vcc, 9, v45
    s_nop 4
    s_cbranch_vccz P3_Y2OK
    s_mov_b32 s45, 262144
    v_mov_b32 v13, 192
P3_POLLY:
    global_load_dword v14, v13, s[30:31] sc1
    s_waitcnt vmcnt(0)
    v_cmp_gt_u32 vcc, 9, v14
    s_nop 4
    s_cbranch_vccz P3_POLLY_OK
    s_sleep 1
    s_sub_u32 s45, s45, 1
    s_cmp_lg_u32 s45, 0
    s_cbranch_scc1 P3_POLLY
P3_POLLY_OK:
P3_Y2OK:
    buffer_load_dwordx4 v[80:83], v32, s[12:15], s58 offen offset:0 sc1
    buffer_load_dwordx4 v[84:87], v33, s[12:15], s58 offen offset:0 sc1
    buffer_load_dwordx4 v[88:91], v32, s[12:15], s58 offen offset:1024 sc1
    buffer_load_dwordx4 v[92:95], v33, s[12:15], s58 offen offset:1024 sc1
    buffer_load_dwordx4 v[96:99], v32, s[12:15], s58 offen offset:2048 sc1
    buffer_load_dwordx4 v[100:103], v33, s[12:15], s58 offen offset:2048 sc1
    s_waitcnt vmcnt(12)
    v_lshlrev_b32 v6, 16, v152
    v_and_b32 v7, 0xffff0000, v152
    v_add_f32 v232, v232, v6
    v_add_f32 v233, v233, v7
    v_lshlrev_b32 v6, 16, v153
    v_and_b32 v7, 0xffff0000, v153
    v_add_f32 v234, v234, v6
    v_add_f32 v235, v235, v7
    v_lshlrev_b32 v6, 16, v154
    v_and_b32 v7, 0xffff0000, v154
    v_add_f32 v236, v236, v6
    v_add_f32 v237, v237, v7
    v_lshlrev_b32 v6, 16, v155
    v_and_b32 v7, 0xffff0000, v155
    v_add_f32 v238, v238, v6
    v_add_f32 v239, v239, v7
    v_lshlrev_b32 v6, 16, v156
    v_and_b32 v7, 0xffff0000, v156
    v_add_f32 v240, v240, v6
    v_add_f32 v241, v241, v7
    v_lshlrev_b32 v6, 16, v157
    v_and_b32 v7, 0xffff0000, v157
    v_add_f32 v242, v242, v6
    v_add_f32 v243, v243, v7
    v_lshlrev_b32 v6, 16, v158
    v_and_b32 v7, 0xffff0000, v158
    v_add_f32 v244, v244, v6
    v_add_f32 v245, v245, v7
    v_lshlrev_b32 v6, 16, v159
    v_and_b32 v7, 0xffff0000, v159
    v_add_f32 v246, v246, v6
    v_add_f32 v247, v247, v7
    v_lshlrev_b32 v6, 16, v160
    v_and_b32 v7, 0xffff0000, v160
    v_add_f32 v248, v248, v6
    v_add_f32 v249, v249, v7
    v_lshlrev_b32 v6, 16, v161
    v_and_b32 v7, 0xffff0000, v161
    v_add_f32 v250, v250, v6
    v_add_f32 v251, v251, v7
    v_lshlrev_b32 v6, 16, v162
    v_and_b32 v7, 0xffff0000, v162
    v_add_f32 v252, v252, v6
    v_add_f32 v253, v253, v7
    v_lshlrev_b32 v6, 16, v163
    v_and_b32 v7, 0xffff0000, v163
    v_add_f32 v254, v254, v6
    v_add_f32 v255, v255, v7
    s_waitcnt vmcnt(9)
    v_lshlrev_b32 v6, 16, v164
    v_and_b32 v7, 0xffff0000, v164
    v_add_f32 v232, v232, v6
    v_add_f32 v233, v233, v7
    v_lshlrev_b32 v6, 16, v165
    v_and_b32 v7, 0xffff0000, v165
    v_add_f32 v234, v234, v6
    v_add_f32 v235, v235, v7
    v_lshlrev_b32 v6, 16, v166
    v_and_b32 v7, 0xffff0000, v166
    v_add_f32 v236, v236, v6
    v_add_f32 v237, v237, v7
    v_lshlrev_b32 v6, 16, v167
    v_and_b32 v7, 0xffff0000, v167
    v_add_f32 v238, v238, v6
    v_add_f32 v239, v239, v7
    v_lshlrev_b32 v6, 16, v168
    v_and_b32 v7, 0xffff0000, v168
    v_add_f32 v240, v240, v6
    v_add_f32 v241, v241, v7
    v_lshlrev_b32 v6, 16, v169
    v_and_b32 v7, 0xffff0000, v169
    v_add_f32 v242, v242, v6
    v_add_f32 v243, v243, v7
    v_lshlrev_b32 v6, 16, v170
    v_and_b32 v7, 0xffff0000, v170
    v_add_f32 v244, v244, v6
    v_add_f32 v245, v245, v7
    v_lshlrev_b32 v6, 16, v171
    v_and_b32 v7, 0xffff0000, v171
    v_add_f32 v246, v246, v6
    v_add_f32 v247, v247, v7
    v_lshlrev_b32 v6, 16, v172
    v_and_b32 v7, 0xffff0000, v172
    v_add_f32 v248, v248, v6
    v_add_f32 v249, v249, v7
    v_lshlrev_b32 v6, 16, v173
    v_and_b32 v7, 0xffff0000, v173
    v_add_f32 v250, v250, v6
    v_add_f32 v251, v251, v7
    v_lshlrev_b32 v6, 16, v174
    v_and_b32 v7, 0xffff0000, v174
    v_add_f32 v252, v252, v6
    v_add_f32 v253, v253, v7
    v_lshlrev_b32 v6, 16, v175
    v_and_b32 v7, 0xffff0000, v175
    v_add_f32 v254, v254, v6
    v_add_f32 v255, v255, v7
    s_waitcnt vmcnt(6)
    v_lshlrev_b32 v6, 16, v176
    v_and_b32 v7, 0xffff0000, v176
    v_add_f32 v232, v232, v6
    v_add_f32 v233, v233, v7
    v_lshlrev_b32 v6, 16, v177
    v_and_b32 v7, 0xffff0000, v177
    v_add_f32 v234, v234, v6
    v_add_f32 v235, v235, v7
    v_lshlrev_b32 v6, 16, v178
    v_and_b32 v7, 0xffff0000, v178
    v_add_f32 v236, v236, v6
    v_add_f32 v237, v237, v7
    v_lshlrev_b32 v6, 16, v179
    v_and_b32 v7, 0xffff0000, v179
    v_add_f32 v238, v238, v6
    v_add_f32 v239, v239, v7
    v_lshlrev_b32 v6, 16, v180
    v_and_b32 v7, 0xffff0000, v180
    v_add_f32 v240, v240, v6
    v_add_f32 v241, v241, v7
    v_lshlrev_b32 v6, 16, v181
    v_and_b32 v7, 0xffff0000, v181
    v_add_f32 v242, v242, v6
    v_add_f32 v243, v243, v7
    v_lshlrev_b32 v6, 16, v182
    v_and_b32 v7, 0xffff0000, v182
    v_add_f32 v244, v244, v6
    v_add_f32 v245, v245, v7
    v_lshlrev_b32 v6, 16, v183
    v_and_b32 v7, 0xffff0000, v183
    v_add_f32 v246, v246, v6
    v_add_f32 v247, v247, v7
    v_lshlrev_b32 v6, 16, v184
    v_and_b32 v7, 0xffff0000, v184
    v_add_f32 v248, v248, v6
    v_add_f32 v249, v249, v7
    v_lshlrev_b32 v6, 16, v185
    v_and_b32 v7, 0xffff0000, v185
    v_add_f32 v250, v250, v6
    v_add_f32 v251, v251, v7
    v_lshlrev_b32 v6, 16, v186
    v_and_b32 v7, 0xffff0000, v186
    v_add_f32 v252, v252, v6
    v_add_f32 v253, v253, v7
    v_lshlrev_b32 v6, 16, v187
    v_and_b32 v7, 0xffff0000, v187
    v_add_f32 v254, v254, v6
    v_add_f32 v255, v255, v7
    s_waitcnt lgkmcnt(0)
    s_nop 1
    s_waitcnt vmcnt(4)
    v_mfma_f32_16x16x32_bf16 v[232:235], v[104:107], v[80:83], v[232:235]
    v_mfma_f32_16x16x32_bf16 v[236:239], v[104:107], v[84:87], v[236:239]
    v_mfma_f32_16x16x32_bf16 v[240:243], v[108:111], v[80:83], v[240:243]
    v_mfma_f32_16x16x32_bf16 v[244:247], v[108:111], v[84:87], v[244:247]
    v_mfma_f32_16x16x32_bf16 v[248:251], v[112:115], v[80:83], v[248:251]
    v_mfma_f32_16x16x32_bf16 v[252:255], v[112:115], v[84:87], v[252:255]
    s_waitcnt vmcnt(2)
    v_mfma_f32_16x16x32_bf16 v[232:235], v[116:119], v[88:91], v[232:235]
    v_mfma_f32_16x16x32_bf16 v[236:239], v[116:119], v[92:95], v[236:239]
    v_mfma_f32_16x16x32_bf16 v[240:243], v[120:123], v[88:91], v[240:243]
    v_mfma_f32_16x16x32_bf16 v[244:247], v[120:123], v[92:95], v[244:247]
    v_mfma_f32_16x16x32_bf16 v[248:251], v[124:127], v[88:91], v[248:251]
    v_mfma_f32_16x16x32_bf16 v[252:255], v[124:127], v[92:95], v[252:255]
    s_waitcnt vmcnt(0)
    v_mfma_f32_16x16x32_bf16 v[232:235], v[128:131], v[96:99], v[232:235]
    v_mfma_f32_16x16x32_bf16 v[236:239], v[128:131], v[100:103], v[236:239]
    v_mfma_f32_16x16x32_bf16 v[240:243], v[132:135], v[96:99], v[240:243]
    v_mfma_f32_16x16x32_bf16 v[244:247], v[132:135], v[100:103], v[244:247]
    v_mfma_f32_16x16x32_bf16 v[248:251], v[136:139], v[96:99], v[248:251]
    v_mfma_f32_16x16x32_bf16 v[252:255], v[136:139], v[100:103], v[252:255]
    s_nop 7
    s_nop 1
    v_permlane16_swap_b32 v232, v236
    v_permlane16_swap_b32 v233, v237
    v_permlane16_swap_b32 v234, v238
    v_permlane16_swap_b32 v235, v239
    v_permlane16_swap_b32 v240, v244
    v_permlane16_swap_b32 v241, v245
    v_permlane16_swap_b32 v242, v246
    v_permlane16_swap_b32 v243, v247
    v_permlane16_swap_b32 v248, v252
    v_permlane16_swap_b32 v249, v253
    v_permlane16_swap_b32 v250, v254
    v_permlane16_swap_b32 v251, v255
    s_nop 1
    v_lshlrev_b32 v6, 16, v140
    v_and_b32 v7, 0xffff0000, v140
    v_add_f32 v232, v232, v6
    v_add_f32 v233, v233, v7
    v_cvt_pk_bf16_f32 v48, v232, v233
    v_lshlrev_b32 v6, 16, v141
    v_and_b32 v7, 0xffff0000, v141
    v_add_f32 v234, v234, v6
    v_add_f32 v235, v235, v7
    v_cvt_pk_bf16_f32 v49, v234, v235
    v_lshlrev_b32 v6, 16, v142
    v_and_b32 v7, 0xffff0000, v142
    v_add_f32 v236, v236, v6
    v_add_f32 v237, v237, v7
    v_cvt_pk_bf16_f32 v50, v236, v237
    v_lshlrev_b32 v6, 16, v143
    v_and_b32 v7, 0xffff0000, v143
    v_add_f32 v238, v238, v6
    v_add_f32 v239, v239, v7
    v_cvt_pk_bf16_f32 v51, v238, v239
    buffer_store_dwordx4 v[48:51], v8, s[8:11], s47 offen offset:0
    v_lshlrev_b32 v6, 16, v144
    v_and_b32 v7, 0xffff0000, v144
    v_add_f32 v240, v240, v6
    v_add_f32 v241, v241, v7
    v_cvt_pk_bf16_f32 v52, v240, v241
    v_lshlrev_b32 v6, 16, v145
    v_and_b32 v7, 0xffff0000, v145
    v_add_f32 v242, v242, v6
    v_add_f32 v243, v243, v7
    v_cvt_pk_bf16_f32 v53, v242, v243
    v_lshlrev_b32 v6, 16, v146
    v_and_b32 v7, 0xffff0000, v146
    v_add_f32 v244, v244, v6
    v_add_f32 v245, v245, v7
    v_cvt_pk_bf16_f32 v54, v244, v245
    v_lshlrev_b32 v6, 16, v147
    v_and_b32 v7, 0xffff0000, v147
    v_add_f32 v246, v246, v6
    v_add_f32 v247, v247, v7
    v_cvt_pk_bf16_f32 v55, v246, v247
    buffer_store_dwordx4 v[52:55], v8, s[8:11], s47 offen offset:32
    v_lshlrev_b32 v6, 16, v148
    v_and_b32 v7, 0xffff0000, v148
    v_add_f32 v248, v248, v6
    v_add_f32 v249, v249, v7
    v_cvt_pk_bf16_f32 v56, v248, v249
    v_lshlrev_b32 v6, 16, v149
    v_and_b32 v7, 0xffff0000, v149
    v_add_f32 v250, v250, v6
    v_add_f32 v251, v251, v7
    v_cvt_pk_bf16_f32 v57, v250, v251
    v_lshlrev_b32 v6, 16, v150
    v_and_b32 v7, 0xffff0000, v150
    v_add_f32 v252, v252, v6
    v_add_f32 v253, v253, v7
    v_cvt_pk_bf16_f32 v58, v252, v253
    v_lshlrev_b32 v6, 16, v151
    v_and_b32 v7, 0xffff0000, v151
    v_add_f32 v254, v254, v6
    v_add_f32 v255, v255, v7
    v_cvt_pk_bf16_f32 v59, v254, v255
    buffer_store_dwordx4 v[56:59], v8, s[8:11], s47 offen offset:64
    s_cmp_eq_u32 s2, 0
    s_cbranch_scc0 G2_NOE
    s_mov_b32 s45, 36782080
    s_cmp_eq_u32 s16, 0
    s_cbranch_scc0 G2_NOE
    v_mov_b32 v40, s45
    v_mov_b32 v41, s101
    s_mov_b64 exec, 1
    buffer_store_dword v41, v40, s[12:15], 0 offen sc1
    s_mov_b64 exec, -1
G2_NOE:
    s_endpgm
F_ENTRY:
    s_load_dwordx2 s[30:31], s[0:1], 64
    s_lshr_b32 s45, s2, 5
    s_lshl_b32 s45, s45, 3
    s_and_b32 s46, s2, 7
    s_add_u32 s17, s45, s46
    s_mov_b32 s18, s17
    v_lshlrev_b32 v1, 4, v0
    s_lshl_b32 s32, s16, 13
    s_add_u32 s32, s32, 32768
    s_waitcnt lgkmcnt(0)
    s_barrier
    s_cmp_eq_u32 s18, 72
    s_cselect_b32 s20, 0, s18
    s_lshl_b32 s20, s20, 15
    s_lshl_b32 s45, s16, 13
    s_add_u32 s20, s20, s45
    s_add_u32 s20, s20, 18874368
    s_mov_b32 m0, s32
    s_nop 0
    buffer_load_dwordx4 v1, s[12:15], s20 offen offset:0 sc1 lds
    buffer_load_dwordx4 v1, s[12:15], s20 offen offset:1024 sc1 lds
    buffer_load_dwordx4 v1, s[12:15], s20 offen offset:2048 sc1 lds
    buffer_load_dwordx4 v1, s[12:15], s20 offen offset:3072 sc1 lds
    s_add_u32 m0, s32, 4096
    s_add_u32 s20, s20, 4096
    buffer_load_dwordx4 v1, s[12:15], s20 offen offset:0 sc1 lds
    buffer_load_dwordx4 v1, s[12:15], s20 offen offset:1024 sc1 lds
    buffer_load_dwordx4 v1, s[12:15], s20 offen offset:2048 sc1 lds
    buffer_load_dwordx4 v1, s[12:15], s20 offen offset:3072 sc1 lds
    v_and_b32 v9, 31, v0
    v_lshrrev_b32 v10, 5, v0
    v_lshlrev_b32 v3, 4, v9
    v_lshlrev_b32 v11, 12, v10
    v_add_u32 v3, v3, v11
    s_lshl_b32 s45, s16, 2
    v_add_u32 v2, 32768, v3
    v_lshlrev_b32 v3, 2, v9
    v_lshlrev_b32 v11, 10, v10
    v_add_u32 v3, v3, v11
    s_lshl_b32 s45, s16, 13
    s_add_u32 s45, s45, 0
    v_add_u32 v4, s45, v3
    v_add_u32 v13, 128, v4
    s_lshl_b32 s45, s16, 11
    s_add_u32 s45, s45, 0
    v_lshlrev_b32 v3, 2, v0
    v_add_u32 v5, s45, v3
    v_lshrrev_b32 v9, 4, v0
    v_mul_u32_u24 v9, 19456, v9
    v_and_b32 v10, 15, v0
    v_lshlrev_b32 v10, 4, v10
    v_add_u32 v6, v9, v10
    v_add_u32 v12, 126976, v1
    s_waitcnt vmcnt(8)
    s_barrier
    s_lshl_b32 s45, s2, 7
    s_add_u32 s45, s45, 36700160
    s_cmp_eq_u32 s16, 0
    s_cbranch_scc0 F_SIG1
    v_mov_b32 v212, s45
    v_mov_b32 v213, s101
    s_mov_b64 exec, 1
    buffer_store_dword v213, v212, s[12:15], 0 offen sc1
    s_mov_b64 exec, -1
F_SIG1:
    v_and_b32 v208, 31, v0
    v_cvt_f32_u32 v234, v208
    v_lshrrev_b32 v208, 5, v0
    v_lshlrev_b32 v208, 2, v208
    v_cvt_f32_u32 v235, v208
    v_mul_f32 v208, 0x3d000000, v234
    s_lshl_b32 s45, s16, 3
    v_cvt_f32_u32 v209, s45
    v_add_f32 v209, v209, v235
    v_mul_f32 v210, v209, v208
    s_lshl_b32 s46, s16, 10
    s_add_u32 s46, s46, 65536
    v_add_u32 v214, s46, v1
    v_add_u32 v215, 4096, v214
    v_add_f32 v211, v210, v208
    v_add_f32 v212, v211, v208
    v_add_f32 v213, v212, v208
    v_cos_f32 v216, v210
    v_sin_f32 v220, v210
    v_cos_f32 v217, v211
    v_sin_f32 v221, v211
    v_cos_f32 v218, v212
    v_sin_f32 v222, v212
    v_cos_f32 v219, v213
    v_sin_f32 v223, v213
    s_nop 0
    v_cvt_pk_bf16_f32 v224, v216, v220
    v_cvt_pk_bf16_f32 v225, v217, v221
    v_cvt_pk_bf16_f32 v226, v218, v222
    v_cvt_pk_bf16_f32 v227, v219, v223
    v_cvt_pk_bf16_f32 v228, -v220, v216
    v_cvt_pk_bf16_f32 v229, -v221, v217
    v_cvt_pk_bf16_f32 v230, -v222, v218
    v_cvt_pk_bf16_f32 v231, -v223, v219
    ds_write_b128 v214, v[224:227] offset:0
    ds_write_b128 v215, v[228:231] offset:0
    s_and_b32 s45, s16, 1
    s_lshl_b32 s45, s45, 5
    s_cmp_ge_u32 s16, 2
    s_cselect_b32 s46, s45, 0
    s_cselect_b32 s47, 0, s45
    v_cvt_f32_u32 v208, s46
    v_add_f32 v208, v208, v234
    v_mul_f32 v208, 0x3a000000, v208
    v_cvt_f32_u32 v209, s47
    v_add_f32 v209, v209, v235
    v_mul_f32 v209, v209, v208
    v_add_f32 v232, v208, v208
    v_mul_f32 v233, 0x40c00000, v208
    s_lshl_b32 s45, s16, 13
    v_add_u32 v214, s45, v12
    v_add_f32 v211, v209, v208
    v_cos_f32 v216, v209
    v_sin_f32 v218, v209
    v_cos_f32 v217, v211
    v_sin_f32 v219, v211
    v_add_f32 v209, v209, v232
    ds_write_b128 v214, v[216:219] offset:0
    v_add_f32 v211, v209, v208
    v_cos_f32 v220, v209
    v_sin_f32 v222, v209
    v_cos_f32 v221, v211
    v_sin_f32 v223, v211
    v_add_f32 v209, v209, v233
    ds_write_b128 v214, v[220:223] offset:1024
    v_add_f32 v211, v209, v208
    v_cos_f32 v216, v209
    v_sin_f32 v218, v209
    v_cos_f32 v217, v211
    v_sin_f32 v219, v211
    v_add_f32 v209, v209, v232
    ds_write_b128 v214, v[216:219] offset:2048
    v_add_f32 v211, v209, v208
    v_cos_f32 v220, v209
    v_sin_f32 v222, v209
    v_cos_f32 v221, v211
    v_sin_f32 v223, v211
    v_add_f32 v209, v209, v233
    ds_write_b128 v214, v[220:223] offset:3072
    v_add_f32 v211, v209, v208
    v_cos_f32 v216, v209
    v_sin_f32 v218, v209
    v_cos_f32 v217, v211
    v_sin_f32 v219, v211
    v_add_f32 v209, v209, v232
    ds_write_b128 v214, v[216:219] offset:4096
    v_add_f32 v211, v209, v208
    v_cos_f32 v220, v209
    v_sin_f32 v222, v209
    v_cos_f32 v221, v211
    v_sin_f32 v223, v211
    v_add_f32 v209, v209, v233
    ds_write_b128 v214, v[220:223] offset:5120
    v_add_f32 v211, v209, v208
    v_cos_f32 v216, v209
    v_sin_f32 v218, v209
    v_cos_f32 v217, v211
    v_sin_f32 v219, v211
    v_add_f32 v209, v209, v232
    ds_write_b128 v214, v[216:219] offset:6144
    v_add_f32 v211, v209, v208
    v_cos_f32 v220, v209
    v_sin_f32 v222, v209
    v_cos_f32 v221, v211
    v_sin_f32 v223, v211
    s_nop 0
    ds_write_b128 v214, v[220:223] offset:7168
    s_waitcnt lgkmcnt(0)
    s_barrier
    v_add_u32 v236, 65536, v1
    v_add_u32 v237, 86016, v1
    ds_read_b128 a[0:3], v236 offset:0
    ds_read_b128 a[4:7], v236 offset:1024
    ds_read_b128 a[8:11], v236 offset:2048
    ds_read_b128 a[12:15], v236 offset:3072
    ds_read_b128 a[16:19], v236 offset:4096
    ds_read_b128 a[20:23], v236 offset:5120
    ds_read_b128 a[24:27], v236 offset:6144
    ds_read_b128 a[28:31], v236 offset:7168
    s_waitcnt lgkmcnt(4)
    ds_read_b128 a[32:35], v237 offset:0
    ds_read_b128 a[36:39], v237 offset:1024
    ds_read_b128 a[40:43], v237 offset:2048
    ds_read_b128 a[44:47], v237 offset:3072
    ds_read_b128 a[48:51], v237 offset:4096
    ds_read_b128 a[52:55], v237 offset:5120
    ds_read_b128 a[56:59], v237 offset:6144
    ds_read_b128 a[60:63], v237 offset:7168
    s_waitcnt lgkmcnt(4)
    ds_read_b128 a[64:67], v237 offset:8192
    ds_read_b128 a[68:71], v237 offset:9216
    ds_read_b128 a[72:75], v237 offset:10240
    ds_read_b128 a[76:79], v237 offset:11264
    ds_read_b128 a[80:83], v237 offset:12288
    ds_read_b128 a[84:87], v237 offset:13312
    ds_read_b128 a[88:91], v237 offset:14336
    ds_read_b128 a[92:95], v237 offset:15360
    s_waitcnt lgkmcnt(4)
    ds_read_b128 a[96:99], v237 offset:16384
    ds_read_b128 a[100:103], v237 offset:17408
    ds_read_b128 a[104:107], v237 offset:18432
    ds_read_b128 a[108:111], v237 offset:19456
    ds_read_b128 a[112:115], v237 offset:20480
    ds_read_b128 a[116:119], v237 offset:21504
    ds_read_b128 a[120:123], v237 offset:22528
    ds_read_b128 a[124:127], v237 offset:23552
    s_waitcnt lgkmcnt(4)
    ds_read_b128 a[128:131], v237 offset:24576
    ds_read_b128 a[132:135], v237 offset:25600
    ds_read_b128 a[136:139], v237 offset:26624
    ds_read_b128 a[140:143], v237 offset:27648
    ds_read_b128 a[144:147], v237 offset:28672
    ds_read_b128 a[148:151], v237 offset:29696
    ds_read_b128 a[152:155], v237 offset:30720
    ds_read_b128 a[156:159], v237 offset:31744
    s_waitcnt lgkmcnt(4)
    s_waitcnt vmcnt(0)
    s_mov_b32 s39, 0
F_JOB:
    s_lshl_b32 s19, s18, 2
    s_add_u32 s19, s19, s16
    s_cmp_eq_u32 s19, 0
    s_cselect_b32 s23, 1, 0
    s_cmp_eq_u32 s19, 288
    s_cselect_b32 s23, 2, s23
    s_cmp_gt_u32 s19, 288
    s_cselect_b32 s23, 3, s23
    s_cselect_b32 s19, 0, s19
    s_lshl_b32 s21, s19, 13
    s_add_u32 s21, s21, 21233664
    s_waitcnt lgkmcnt(0)
    s_barrier
    buffer_load_dwordx4 v[48:51], v1, s[12:15], s21 offen offset:0 sc1
    buffer_load_dwordx4 v[52:55], v1, s[12:15], s21 offen offset:1024 sc1
    buffer_load_dwordx4 v[56:59], v1, s[12:15], s21 offen offset:2048 sc1
    buffer_load_dwordx4 v[60:63], v1, s[12:15], s21 offen offset:3072 sc1
    s_add_u32 s21, s21, 4096
    buffer_load_dwordx4 v[64:67], v1, s[12:15], s21 offen offset:0 sc1
    buffer_load_dwordx4 v[68:71], v1, s[12:15], s21 offen offset:1024 sc1
    buffer_load_dwordx4 v[72:75], v1, s[12:15], s21 offen offset:2048 sc1
    buffer_load_dwordx4 v[76:79], v1, s[12:15], s21 offen offset:3072 sc1
    s_cmp_ge_u32 s23, 2
    s_cselect_b32 s46, 0, s16
    s_lshr_b32 s45, s46, 1
    s_lshl_b32 s45, s45, 3
    v_add_u32 v3, s45, v2
    s_and_b32 s46, s46, 1
    s_mov_b32 s34, 0x03020100
    s_cmp_eq_u32 s46, 1
    s_cselect_b32 s34, 0x07060504, s34
    s_cmp_eq_u32 s23, 1
    s_cselect_b32 s34, 0x0c0c0100, s34
    s_cmp_ge_u32 s23, 2
    s_cselect_b32 s34, 0x0c0c0302, s34
    ds_read_b64 v[144:145], v3 offset:0
    ds_read_b64 v[146:147], v3 offset:1024
    ds_read_b64 v[148:149], v3 offset:2048
    ds_read_b64 v[150:151], v3 offset:3072
    ds_read_b64 v[152:153], v3 offset:8192
    ds_read_b64 v[154:155], v3 offset:9216
    ds_read_b64 v[156:157], v3 offset:10240
    ds_read_b64 v[158:159], v3 offset:11264
    ds_read_b64 v[160:161], v3 offset:16384
    ds_read_b64 v[162:163], v3 offset:17408
    ds_read_b64 v[164:165], v3 offset:18432
    ds_read_b64 v[166:167], v3 offset:19456
    s_waitcnt lgkmcnt(8)
    v_perm_b32 v16, v145, v144, s34
    ds_read_b64 v[168:169], v3 offset:24576
    v_perm_b32 v17, v147, v146, s34
    ds_read_b64 v[170:171], v3 offset:25600
    v_perm_b32 v18, v149, v148, s34
    ds_read_b64 v[172:173], v3 offset:26624
    v_perm_b32 v19, v151, v150, s34
    ds_read_b64 v[174:175], v3 offset:27648
    s_waitcnt lgkmcnt(8)
    v_perm_b32 v20, v153, v152, s34
    v_perm_b32 v21, v155, v154, s34
    v_perm_b32 v22, v157, v156, s34
    v_perm_b32 v23, v159, v158, s34
    s_waitcnt lgkmcnt(4)
    v_perm_b32 v24, v161, v160, s34
    v_perm_b32 v25, v163, v162, s34
    v_perm_b32 v26, v165, v164, s34
    v_perm_b32 v27, v167, v166, s34
    s_waitcnt lgkmcnt(0)
    v_perm_b32 v28, v169, v168, s34
    v_perm_b32 v29, v171, v170, s34
    v_perm_b32 v30, v173, v172, s34
    v_perm_b32 v31, v175, v174, s34
    s_nop 1
    v_mfma_f32_32x32x16_bf16 v[80:95], v[16:19], a[0:3], 0
    ds_read_b64 v[176:177], v3 offset:512
    ds_read_b64 v[178:179], v3 offset:1536
    ds_read_b64 v[180:181], v3 offset:2560
    ds_read_b64 v[182:183], v3 offset:3584
    ds_read_b64 v[184:185], v3 offset:8704
    v_mfma_f32_32x32x16_bf16 v[80:95], v[20:23], a[4:7], v[80:95]
    ds_read_b64 v[186:187], v3 offset:9728
    ds_read_b64 v[188:189], v3 offset:10752
    ds_read_b64 v[190:191], v3 offset:11776
    s_waitcnt lgkmcnt(4)
    v_perm_b32 v32, v177, v176, s34
    v_mfma_f32_32x32x16_bf16 v[80:95], v[24:27], a[8:11], v[80:95]
    ds_read_b64 v[192:193], v3 offset:16896
    v_perm_b32 v33, v179, v178, s34
    ds_read_b64 v[194:195], v3 offset:17920
    v_perm_b32 v34, v181, v180, s34
    ds_read_b64 v[196:197], v3 offset:18944
    v_mfma_f32_32x32x16_bf16 v[80:95], v[28:31], a[12:15], v[80:95]
    v_perm_b32 v35, v183, v182, s34
    ds_read_b64 v[198:199], v3 offset:19968
    s_waitcnt lgkmcnt(4)
    v_perm_b32 v36, v185, v184, s34
    ds_read_b64 v[200:201], v3 offset:25088
    v_mfma_f32_32x32x16_bf16 v[96:111], v[16:19], a[16:19], 0
    v_perm_b32 v37, v187, v186, s34
    ds_read_b64 v[202:203], v3 offset:26112
    v_perm_b32 v38, v189, v188, s34
    ds_read_b64 v[204:205], v3 offset:27136
    v_perm_b32 v39, v191, v190, s34
    v_mfma_f32_32x32x16_bf16 v[96:111], v[20:23], a[20:23], v[96:111]
    ds_read_b64 v[206:207], v3 offset:28160
    s_waitcnt lgkmcnt(4)
    v_perm_b32 v40, v193, v192, s34
    v_perm_b32 v41, v195, v194, s34
    v_perm_b32 v42, v197, v196, s34
    v_mfma_f32_32x32x16_bf16 v[96:111], v[24:27], a[24:27], v[96:111]
    v_perm_b32 v43, v199, v198, s34
    s_waitcnt lgkmcnt(0)
    v_perm_b32 v44, v201, v200, s34
    v_perm_b32 v45, v203, v202, s34
    v_perm_b32 v46, v205, v204, s34
    v_mfma_f32_32x32x16_bf16 v[96:111], v[28:31], a[28:31], v[96:111]
    v_perm_b32 v47, v207, v206, s34
    ds_read_b128 v[208:211], v12 offset:0
    ds_read_b128 v[212:215], v12 offset:1024
    s_nop 1
    s_cmp_eq_u32 s39, 0
    s_cbranch_scc1 F_NOLATE
    s_waitcnt vmcnt(8)
F_NOLATE:
    s_barrier
    s_cmp_eq_u32 s39, 0
    s_cbranch_scc1 F_NOLATE2
    s_cmp_eq_u32 s16, 0
    s_cbranch_scc0 F_SIGL
    v_mov_b32 v9, 128
    v_mov_b32 v10, 1
    s_mov_b64 exec, 1
    global_atomic_add v9, v10, s[30:31] sc1
    s_mov_b64 exec, -1
F_SIGL:
    s_mov_b32 s39, 0
F_NOLATE2:
    s_add_u32 s33, s18, 64
    s_cmp_gt_u32 s33, 72
    s_cbranch_scc1 F_NOPF
    s_cmp_eq_u32 s33, 72
    s_cselect_b32 s20, 0, s33
    s_lshl_b32 s20, s20, 15
    s_lshl_b32 s45, s16, 13
    s_add_u32 s20, s20, s45
    s_add_u32 s20, s20, 18874368
    s_mov_b32 m0, s32
    s_nop 0
    buffer_load_dwordx4 v1, s[12:15], s20 offen offset:0 sc1 lds
    buffer_load_dwordx4 v1, s[12:15], s20 offen offset:1024 sc1 lds
    buffer_load_dwordx4 v1, s[12:15], s20 offen offset:2048 sc1 lds
    buffer_load_dwordx4 v1, s[12:15], s20 offen offset:3072 sc1 lds
    s_add_u32 m0, s32, 4096
    s_add_u32 s20, s20, 4096
    buffer_load_dwordx4 v1, s[12:15], s20 offen offset:0 sc1 lds
    buffer_load_dwordx4 v1, s[12:15], s20 offen offset:1024 sc1 lds
    buffer_load_dwordx4 v1, s[12:15], s20 offen offset:2048 sc1 lds
    buffer_load_dwordx4 v1, s[12:15], s20 offen offset:3072 sc1 lds
F_NOPF:
    v_mfma_f32_32x32x16_bf16 v[112:127], v[32:35], a[0:3], 0
    s_nop 4
    v_mfma_f32_32x32x16_bf16 v[112:127], v[36:39], a[4:7], v[112:127]
    s_nop 4
    v_mfma_f32_32x32x16_bf16 v[112:127], v[40:43], a[8:11], v[112:127]
    s_waitcnt lgkmcnt(1)
    v_mul_f32 v224, v80, v208
    v_mul_f32 v226, v96, v208
    v_mul_f32 v225, v81, v209
    v_mfma_f32_32x32x16_bf16 v[112:127], v[44:47], a[12:15], v[112:127]
    v_mul_f32 v227, v97, v209
    v_fma_f32 v224, v96, v210, v224
    v_fma_f32 v226, -v80, v210, v226
    v_fma_f32 v225, v97, v211, v225
    v_mfma_f32_32x32x16_bf16 v[128:143], v[32:35], a[16:19], 0
    v_fma_f32 v227, -v81, v211, v227
    v_cvt_pk_bf16_f32 v16, v224, v226
    v_cvt_pk_bf16_f32 v17, v225, v227
    ds_read_b128 v[216:219], v12 offset:2048
    v_mfma_f32_32x32x16_bf16 v[128:143], v[36:39], a[20:23], v[128:143]
    s_waitcnt lgkmcnt(1)
    v_mul_f32 v228, v82, v212
    v_mul_f32 v230, v98, v212
    v_mul_f32 v229, v83, v213
    v_mfma_f32_32x32x16_bf16 v[128:143], v[40:43], a[24:27], v[128:143]
    v_mul_f32 v231, v99, v213
    v_fma_f32 v228, v98, v214, v228
    v_fma_f32 v230, -v82, v214, v230
    v_fma_f32 v229, v99, v215, v229
    v_mfma_f32_32x32x16_bf16 v[128:143], v[44:47], a[28:31], v[128:143]
    v_fma_f32 v231, -v83, v215, v231
    v_cvt_pk_bf16_f32 v18, v228, v230
    v_cvt_pk_bf16_f32 v19, v229, v231
    ds_read_b128 v[220:223], v12 offset:3072
    s_nop 1
    v_mfma_f32_32x32x16_bf16 v[144:159], a[32:35], v[16:19], 0
    s_waitcnt lgkmcnt(1)
    v_mul_f32 v224, v84, v216
    v_mul_f32 v226, v100, v216
    v_mul_f32 v225, v85, v217
    v_mul_f32 v227, v101, v217
    v_mfma_f32_32x32x16_bf16 v[160:175], a[64:67], v[16:19], 0
    v_fma_f32 v224, v100, v218, v224
    v_fma_f32 v226, -v84, v218, v226
    v_fma_f32 v225, v101, v219, v225
    v_fma_f32 v227, -v85, v219, v227
    v_cvt_pk_bf16_f32 v20, v224, v226
    v_mfma_f32_32x32x16_bf16 v[176:191], a[96:99], v[16:19], 0
    v_cvt_pk_bf16_f32 v21, v225, v227
    ds_read_b128 v[208:211], v12 offset:4096
    s_waitcnt lgkmcnt(1)
    v_mul_f32 v228, v86, v220
    v_mul_f32 v230, v102, v220
    v_mfma_f32_32x32x16_bf16 v[192:207], a[128:131], v[16:19], 0
    v_mul_f32 v229, v87, v221
    v_mul_f32 v231, v103, v221
    v_fma_f32 v228, v102, v222, v228
    v_fma_f32 v230, -v86, v222, v230
    v_fma_f32 v229, v103, v223, v229
    v_fma_f32 v231, -v87, v223, v231
    v_cvt_pk_bf16_f32 v22, v228, v230
    v_cvt_pk_bf16_f32 v23, v229, v231
    ds_read_b128 v[212:215], v12 offset:5120
    s_nop 1
    v_mfma_f32_32x32x16_bf16 v[144:159], a[36:39], v[20:23], v[144:159]
    s_waitcnt lgkmcnt(1)
    v_mul_f32 v224, v88, v208
    v_mul_f32 v226, v104, v208
    v_mul_f32 v225, v89, v209
    v_mul_f32 v227, v105, v209
    v_mfma_f32_32x32x16_bf16 v[160:175], a[68:71], v[20:23], v[160:175]
    v_fma_f32 v224, v104, v210, v224
    v_fma_f32 v226, -v88, v210, v226
    v_fma_f32 v225, v105, v211, v225
    v_fma_f32 v227, -v89, v211, v227
    v_cvt_pk_bf16_f32 v24, v224, v226
    v_mfma_f32_32x32x16_bf16 v[176:191], a[100:103], v[20:23], v[176:191]
    v_cvt_pk_bf16_f32 v25, v225, v227
    ds_read_b128 v[216:219], v12 offset:6144
    s_waitcnt lgkmcnt(1)
    v_mul_f32 v228, v90, v212
    v_mul_f32 v230, v106, v212
    v_mfma_f32_32x32x16_bf16 v[192:207], a[132:135], v[20:23], v[192:207]
    v_mul_f32 v229, v91, v213
    v_mul_f32 v231, v107, v213
    v_fma_f32 v228, v106, v214, v228
    v_fma_f32 v230, -v90, v214, v230
    v_fma_f32 v229, v107, v215, v229
    v_fma_f32 v231, -v91, v215, v231
    v_cvt_pk_bf16_f32 v26, v228, v230
    v_cvt_pk_bf16_f32 v27, v229, v231
    ds_read_b128 v[220:223], v12 offset:7168
    s_nop 1
    v_mfma_f32_32x32x16_bf16 v[144:159], a[40:43], v[24:27], v[144:159]
    s_waitcnt lgkmcnt(1)
    v_mul_f32 v224, v92, v216
    v_mul_f32 v226, v108, v216
    v_mul_f32 v225, v93, v217
    v_mul_f32 v227, v109, v217
    v_mfma_f32_32x32x16_bf16 v[160:175], a[72:75], v[24:27], v[160:175]
    v_fma_f32 v224, v108, v218, v224
    v_fma_f32 v226, -v92, v218, v226
    v_fma_f32 v225, v109, v219, v225
    v_fma_f32 v227, -v93, v219, v227
    v_cvt_pk_bf16_f32 v28, v224, v226
    v_mfma_f32_32x32x16_bf16 v[176:191], a[104:107], v[24:27], v[176:191]
    v_cvt_pk_bf16_f32 v29, v225, v227
    ds_read_b128 v[208:211], v12 offset:8192
    s_waitcnt lgkmcnt(1)
    v_mul_f32 v228, v94, v220
    v_mul_f32 v230, v110, v220
    v_mfma_f32_32x32x16_bf16 v[192:207], a[136:139], v[24:27], v[192:207]
    v_mul_f32 v229, v95, v221
    v_mul_f32 v231, v111, v221
    v_fma_f32 v228, v110, v222, v228
    v_fma_f32 v230, -v94, v222, v230
    v_fma_f32 v229, v111, v223, v229
    v_fma_f32 v231, -v95, v223, v231
    v_cvt_pk_bf16_f32 v30, v228, v230
    v_cvt_pk_bf16_f32 v31, v229, v231
    ds_read_b128 v[212:215], v12 offset:9216
    s_nop 1
    s_nop 3
    v_mfma_f32_32x32x16_bf16 v[144:159], a[44:47], v[28:31], v[144:159]
    s_waitcnt lgkmcnt(1)
    v_mul_f32 v224, v112, v208
    v_mul_f32 v226, v128, v208
    v_mul_f32 v225, v113, v209
    v_mul_f32 v227, v129, v209
    v_mfma_f32_32x32x16_bf16 v[160:175], a[76:79], v[28:31], v[160:175]
    v_fma_f32 v224, v128, v210, v224
    v_fma_f32 v226, -v112, v210, v226
    v_fma_f32 v225, v129, v211, v225
    v_fma_f32 v227, -v113, v211, v227
    v_cvt_pk_bf16_f32 v32, v224, v226
    v_mfma_f32_32x32x16_bf16 v[176:191], a[108:111], v[28:31], v[176:191]
    v_cvt_pk_bf16_f32 v33, v225, v227
    ds_read_b128 v[216:219], v12 offset:10240
    s_waitcnt lgkmcnt(1)
    v_mul_f32 v228, v114, v212
    v_mul_f32 v230, v130, v212
    v_mfma_f32_32x32x16_bf16 v[192:207], a[140:143], v[28:31], v[192:207]
    v_mul_f32 v229, v115, v213
    v_mul_f32 v231, v131, v213
    v_fma_f32 v228, v130, v214, v228
    v_fma_f32 v230, -v114, v214, v230
    v_fma_f32 v229, v131, v215, v229
    v_fma_f32 v231, -v115, v215, v231
    v_cvt_pk_bf16_f32 v34, v228, v230
    v_cvt_pk_bf16_f32 v35, v229, v231
    ds_read_b128 v[220:223], v12 offset:11264
    s_nop 1
    v_mfma_f32_32x32x16_bf16 v[144:159], a[48:51], v[32:35], v[144:159]
    s_waitcnt lgkmcnt(1)
    v_mul_f32 v224, v116, v216
    v_mul_f32 v226, v132, v216
    v_mul_f32 v225, v117, v217
    v_mul_f32 v227, v133, v217
    v_mfma_f32_32x32x16_bf16 v[160:175], a[80:83], v[32:35], v[160:175]
    v_fma_f32 v224, v132, v218, v224
    v_fma_f32 v226, -v116, v218, v226
    v_fma_f32 v225, v133, v219, v225
    v_fma_f32 v227, -v117, v219, v227
    v_cvt_pk_bf16_f32 v36, v224, v226
    v_mfma_f32_32x32x16_bf16 v[176:191], a[112:115], v[32:35], v[176:191]
    v_cvt_pk_bf16_f32 v37, v225, v227
    ds_read_b128 v[208:211], v12 offset:12288
    s_waitcnt lgkmcnt(1)
    v_mul_f32 v228, v118, v220
    v_mul_f32 v230, v134, v220
    v_mfma_f32_32x32x16_bf16 v[192:207], a[144:147], v[32:35], v[192:207]
    v_mul_f32 v229, v119, v221
    v_mul_f32 v231, v135, v221
    v_fma_f32 v228, v134, v222, v228
    v_fma_f32 v230, -v118, v222, v230
    v_fma_f32 v229, v135, v223, v229
    v_fma_f32 v231, -v119, v223, v231
    v_cvt_pk_bf16_f32 v38, v228, v230
    v_cvt_pk_bf16_f32 v39, v229, v231
    ds_read_b128 v[212:215], v12 offset:13312
    s_nop 1
    v_mfma_f32_32x32x16_bf16 v[144:159], a[52:55], v[36:39], v[144:159]
    s_waitcnt lgkmcnt(1)
    v_mul_f32 v224, v120, v208
    v_mul_f32 v226, v136, v208
    v_mul_f32 v225, v121, v209
    v_mul_f32 v227, v137, v209
    v_mfma_f32_32x32x16_bf16 v[160:175], a[84:87], v[36:39], v[160:175]
    v_fma_f32 v224, v136, v210, v224
    v_fma_f32 v226, -v120, v210, v226
    v_fma_f32 v225, v137, v211, v225
    v_fma_f32 v227, -v121, v211, v227
    v_cvt_pk_bf16_f32 v40, v224, v226
    v_mfma_f32_32x32x16_bf16 v[176:191], a[116:119], v[36:39], v[176:191]
    v_cvt_pk_bf16_f32 v41, v225, v227
    ds_read_b128 v[216:219], v12 offset:14336
    s_waitcnt lgkmcnt(1)
    v_mul_f32 v228, v122, v212
    v_mul_f32 v230, v138, v212
    v_mfma_f32_32x32x16_bf16 v[192:207], a[148:151], v[36:39], v[192:207]
    v_mul_f32 v229, v123, v213
    v_mul_f32 v231, v139, v213
    v_fma_f32 v228, v138, v214, v228
    v_fma_f32 v230, -v122, v214, v230
    v_fma_f32 v229, v139, v215, v229
    v_fma_f32 v231, -v123, v215, v231
    v_cvt_pk_bf16_f32 v42, v228, v230
    v_cvt_pk_bf16_f32 v43, v229, v231
    ds_read_b128 v[220:223], v12 offset:15360
    s_nop 1
    v_mfma_f32_32x32x16_bf16 v[144:159], a[56:59], v[40:43], v[144:159]
    s_waitcnt lgkmcnt(1)
    v_mul_f32 v224, v124, v216
    v_mul_f32 v226, v140, v216
    v_mul_f32 v225, v125, v217
    v_mul_f32 v227, v141, v217
    v_mfma_f32_32x32x16_bf16 v[160:175], a[88:91], v[40:43], v[160:175]
    v_fma_f32 v224, v140, v218, v224
    v_fma_f32 v226, -v124, v218, v226
    v_fma_f32 v225, v141, v219, v225
    v_fma_f32 v227, -v125, v219, v227
    v_cvt_pk_bf16_f32 v44, v224, v226
    v_mfma_f32_32x32x16_bf16 v[176:191], a[120:123], v[40:43], v[176:191]
    v_cvt_pk_bf16_f32 v45, v225, v227
    s_waitcnt lgkmcnt(0)
    v_mul_f32 v228, v126, v220
    v_mul_f32 v230, v142, v220
    v_mul_f32 v229, v127, v221
    v_mfma_f32_32x32x16_bf16 v[192:207], a[152:155], v[40:43], v[192:207]
    v_mul_f32 v231, v143, v221
    v_fma_f32 v228, v142, v222, v228
    v_fma_f32 v230, -v126, v222, v230
    v_fma_f32 v229, v143, v223, v229
    v_fma_f32 v231, -v127, v223, v231
    v_cvt_pk_bf16_f32 v46, v228, v230
    v_cvt_pk_bf16_f32 v47, v229, v231
    s_nop 1
    v_mfma_f32_32x32x16_bf16 v[144:159], a[60:63], v[44:47], v[144:159]
    v_mfma_f32_32x32x16_bf16 v[160:175], a[92:95], v[44:47], v[160:175]
    v_mfma_f32_32x32x16_bf16 v[176:191], a[124:127], v[44:47], v[176:191]
    v_mfma_f32_32x32x16_bf16 v[192:207], a[156:159], v[44:47], v[192:207]
    s_nop 7
    s_nop 3
    s_waitcnt vmcnt(4)
    v_lshlrev_b32 v208, 16, v48
    v_lshlrev_b32 v209, 16, v49
    v_and_b32 v210, 0xffff0000, v48
    v_and_b32 v211, 0xffff0000, v49
    v_mul_f32 v212, v144, v208
    v_mul_f32 v214, v160, v208
    v_mul_f32 v213, v145, v209
    v_mul_f32 v215, v161, v209
    v_fma_f32 v212, -v160, v210, v212
    v_fma_f32 v214, v144, v210, v214
    v_fma_f32 v213, -v161, v211, v213
    v_fma_f32 v215, v145, v211, v215
    v_cvt_pk_bf16_f32 v16, v212, -v214
    v_cvt_pk_bf16_f32 v17, v213, -v215
    v_lshlrev_b32 v216, 16, v50
    v_lshlrev_b32 v217, 16, v51
    v_and_b32 v218, 0xffff0000, v50
    v_and_b32 v219, 0xffff0000, v51
    v_mul_f32 v220, v146, v216
    v_mul_f32 v222, v162, v216
    v_mul_f32 v221, v147, v217
    v_mul_f32 v223, v163, v217
    v_fma_f32 v220, -v162, v218, v220
    v_fma_f32 v222, v146, v218, v222
    v_fma_f32 v221, -v163, v219, v221
    v_fma_f32 v223, v147, v219, v223
    v_cvt_pk_bf16_f32 v18, v220, -v222
    v_cvt_pk_bf16_f32 v19, v221, -v223
    s_nop 1
    v_mfma_f32_32x32x16_bf16 v[80:95], v[16:19], a[32:35], 0
    v_lshlrev_b32 v208, 16, v52
    v_lshlrev_b32 v209, 16, v53
    v_and_b32 v210, 0xffff0000, v52
    v_and_b32 v211, 0xffff0000, v53
    v_mul_f32 v212, v148, v208
    v_mfma_f32_32x32x16_bf16 v[96:111], v[16:19], a[64:67], 0
    v_mul_f32 v214, v164, v208
    v_mul_f32 v213, v149, v209
    v_mul_f32 v215, v165, v209
    v_fma_f32 v212, -v164, v210, v212
    v_fma_f32 v214, v148, v210, v214
    v_mfma_f32_32x32x16_bf16 v[112:127], v[16:19], a[96:99], 0
    v_fma_f32 v213, -v165, v211, v213
    v_fma_f32 v215, v149, v211, v215
    v_cvt_pk_bf16_f32 v20, v212, -v214
    v_cvt_pk_bf16_f32 v21, v213, -v215
    v_lshlrev_b32 v216, 16, v54
    v_mfma_f32_32x32x16_bf16 v[128:143], v[16:19], a[128:131], 0
    v_lshlrev_b32 v217, 16, v55
    v_and_b32 v218, 0xffff0000, v54
    v_and_b32 v219, 0xffff0000, v55
    v_mul_f32 v220, v150, v216
    v_mul_f32 v222, v166, v216
    v_mul_f32 v221, v151, v217
    v_mul_f32 v223, v167, v217
    v_fma_f32 v220, -v166, v218, v220
    v_fma_f32 v222, v150, v218, v222
    v_fma_f32 v221, -v167, v219, v221
    v_fma_f32 v223, v151, v219, v223
    v_cvt_pk_bf16_f32 v22, v220, -v222
    v_cvt_pk_bf16_f32 v23, v221, -v223
    s_nop 1
    v_mfma_f32_32x32x16_bf16 v[80:95], v[20:23], a[36:39], v[80:95]
    v_lshlrev_b32 v208, 16, v56
    v_lshlrev_b32 v209, 16, v57
    v_and_b32 v210, 0xffff0000, v56
    v_and_b32 v211, 0xffff0000, v57
    v_mul_f32 v212, v152, v208
    v_mfma_f32_32x32x16_bf16 v[96:111], v[20:23], a[68:71], v[96:111]
    v_mul_f32 v214, v168, v208
    v_mul_f32 v213, v153, v209
    v_mul_f32 v215, v169, v209
    v_fma_f32 v212, -v168, v210, v212
    v_fma_f32 v214, v152, v210, v214
    v_mfma_f32_32x32x16_bf16 v[112:127], v[20:23], a[100:103], v[112:127]
    v_fma_f32 v213, -v169, v211, v213
    v_fma_f32 v215, v153, v211, v215
    v_cvt_pk_bf16_f32 v24, v212, -v214
    v_cvt_pk_bf16_f32 v25, v213, -v215
    v_lshlrev_b32 v216, 16, v58
    v_mfma_f32_32x32x16_bf16 v[128:143], v[20:23], a[132:135], v[128:143]
    v_lshlrev_b32 v217, 16, v59
    v_and_b32 v218, 0xffff0000, v58
    v_and_b32 v219, 0xffff0000, v59
    v_mul_f32 v220, v154, v216
    v_mul_f32 v222, v170, v216
    v_mul_f32 v221, v155, v217
    v_mul_f32 v223, v171, v217
    v_fma_f32 v220, -v170, v218, v220
    v_fma_f32 v222, v154, v218, v222
    v_fma_f32 v221, -v171, v219, v221
    v_fma_f32 v223, v155, v219, v223
    v_cvt_pk_bf16_f32 v26, v220, -v222
    v_cvt_pk_bf16_f32 v27, v221, -v223
    s_nop 1
    v_mfma_f32_32x32x16_bf16 v[80:95], v[24:27], a[40:43], v[80:95]
    v_lshlrev_b32 v208, 16, v60
    v_lshlrev_b32 v209, 16, v61
    v_and_b32 v210, 0xffff0000, v60
    v_and_b32 v211, 0xffff0000, v61
    v_mul_f32 v212, v156, v208
    v_mfma_f32_32x32x16_bf16 v[96:111], v[24:27], a[72:75], v[96:111]
    v_mul_f32 v214, v172, v208
    v_mul_f32 v213, v157, v209
    v_mul_f32 v215, v173, v209
    v_fma_f32 v212, -v172, v210, v212
    v_fma_f32 v214, v156, v210, v214
    v_mfma_f32_32x32x16_bf16 v[112:127], v[24:27], a[104:107], v[112:127]
    v_fma_f32 v213, -v173, v211, v213
    v_fma_f32 v215, v157, v211, v215
    v_cvt_pk_bf16_f32 v28, v212, -v214
    v_cvt_pk_bf16_f32 v29, v213, -v215
    v_lshlrev_b32 v216, 16, v62
    v_mfma_f32_32x32x16_bf16 v[128:143], v[24:27], a[136:139], v[128:143]
    v_lshlrev_b32 v217, 16, v63
    v_and_b32 v218, 0xffff0000, v62
    v_and_b32 v219, 0xffff0000, v63
    v_mul_f32 v220, v158, v216
    v_mul_f32 v222, v174, v216
    v_mul_f32 v221, v159, v217
    v_mul_f32 v223, v175, v217
    v_fma_f32 v220, -v174, v218, v220
    v_fma_f32 v222, v158, v218, v222
    v_fma_f32 v221, -v175, v219, v221
    v_fma_f32 v223, v159, v219, v223
    v_cvt_pk_bf16_f32 v30, v220, -v222
    v_cvt_pk_bf16_f32 v31, v221, -v223
    s_nop 1
    v_mfma_f32_32x32x16_bf16 v[80:95], v[28:31], a[44:47], v[80:95]
    s_waitcnt vmcnt(0)
    v_lshlrev_b32 v208, 16, v64
    v_lshlrev_b32 v209, 16, v65
    v_and_b32 v210, 0xffff0000, v64
    v_and_b32 v211, 0xffff0000, v65
    v_mfma_f32_32x32x16_bf16 v[96:111], v[28:31], a[76:79], v[96:111]
    v_mul_f32 v212, v176, v208
    v_mul_f32 v214, v192, v208
    v_mul_f32 v213, v177, v209
    v_mul_f32 v215, v193, v209
    v_fma_f32 v212, -v192, v210, v212
    v_mfma_f32_32x32x16_bf16 v[112:127], v[28:31], a[108:111], v[112:127]
    v_fma_f32 v214, v176, v210, v214
    v_fma_f32 v213, -v193, v211, v213
    v_fma_f32 v215, v177, v211, v215
    v_cvt_pk_bf16_f32 v32, v212, -v214
    v_cvt_pk_bf16_f32 v33, v213, -v215
    v_mfma_f32_32x32x16_bf16 v[128:143], v[28:31], a[140:143], v[128:143]
    v_lshlrev_b32 v216, 16, v66
    v_lshlrev_b32 v217, 16, v67
    v_and_b32 v218, 0xffff0000, v66
    v_and_b32 v219, 0xffff0000, v67
    v_mul_f32 v220, v178, v216
    v_mul_f32 v222, v194, v216
    v_mul_f32 v221, v179, v217
    v_mul_f32 v223, v195, v217
    v_fma_f32 v220, -v194, v218, v220
    v_fma_f32 v222, v178, v218, v222
    v_fma_f32 v221, -v195, v219, v221
    v_fma_f32 v223, v179, v219, v223
    v_cvt_pk_bf16_f32 v34, v220, -v222
    v_cvt_pk_bf16_f32 v35, v221, -v223
    s_nop 1
    v_mfma_f32_32x32x16_bf16 v[80:95], v[32:35], a[48:51], v[80:95]
    v_lshlrev_b32 v208, 16, v68
    v_lshlrev_b32 v209, 16, v69
    v_and_b32 v210, 0xffff0000, v68
    v_and_b32 v211, 0xffff0000, v69
    v_mul_f32 v212, v180, v208
    v_mfma_f32_32x32x16_bf16 v[96:111], v[32:35], a[80:83], v[96:111]
    v_mul_f32 v214, v196, v208
    v_mul_f32 v213, v181, v209
    v_mul_f32 v215, v197, v209
    v_fma_f32 v212, -v196, v210, v212
    v_fma_f32 v214, v180, v210, v214
    v_mfma_f32_32x32x16_bf16 v[112:127], v[32:35], a[112:115], v[112:127]
    v_fma_f32 v213, -v197, v211, v213
    v_fma_f32 v215, v181, v211, v215
    v_cvt_pk_bf16_f32 v36, v212, -v214
    v_cvt_pk_bf16_f32 v37, v213, -v215
    v_lshlrev_b32 v216, 16, v70
    v_mfma_f32_32x32x16_bf16 v[128:143], v[32:35], a[144:147], v[128:143]
    v_lshlrev_b32 v217, 16, v71
    v_and_b32 v218, 0xffff0000, v70
    v_and_b32 v219, 0xffff0000, v71
    v_mul_f32 v220, v182, v216
    v_mul_f32 v222, v198, v216
    v_mul_f32 v221, v183, v217
    v_mul_f32 v223, v199, v217
    v_fma_f32 v220, -v198, v218, v220
    v_fma_f32 v222, v182, v218, v222
    v_fma_f32 v221, -v199, v219, v221
    v_fma_f32 v223, v183, v219, v223
    v_cvt_pk_bf16_f32 v38, v220, -v222
    v_cvt_pk_bf16_f32 v39, v221, -v223
    s_nop 1
    v_mfma_f32_32x32x16_bf16 v[80:95], v[36:39], a[52:55], v[80:95]
    v_lshlrev_b32 v208, 16, v72
    v_lshlrev_b32 v209, 16, v73
    v_and_b32 v210, 0xffff0000, v72
    v_and_b32 v211, 0xffff0000, v73
    v_mul_f32 v212, v184, v208
    v_mfma_f32_32x32x16_bf16 v[96:111], v[36:39], a[84:87], v[96:111]
    v_mul_f32 v214, v200, v208
    v_mul_f32 v213, v185, v209
    v_mul_f32 v215, v201, v209
    v_fma_f32 v212, -v200, v210, v212
    v_fma_f32 v214, v184, v210, v214
    v_mfma_f32_32x32x16_bf16 v[112:127], v[36:39], a[116:119], v[112:127]
    v_fma_f32 v213, -v201, v211, v213
    v_fma_f32 v215, v185, v211, v215
    v_cvt_pk_bf16_f32 v40, v212, -v214
    v_cvt_pk_bf16_f32 v41, v213, -v215
    v_lshlrev_b32 v216, 16, v74
    v_mfma_f32_32x32x16_bf16 v[128:143], v[36:39], a[148:151], v[128:143]
    v_lshlrev_b32 v217, 16, v75
    v_and_b32 v218, 0xffff0000, v74
    v_and_b32 v219, 0xffff0000, v75
    v_mul_f32 v220, v186, v216
    v_mul_f32 v222, v202, v216
    v_mul_f32 v221, v187, v217
    v_mul_f32 v223, v203, v217
    v_fma_f32 v220, -v202, v218, v220
    v_fma_f32 v222, v186, v218, v222
    v_fma_f32 v221, -v203, v219, v221
    v_fma_f32 v223, v187, v219, v223
    v_cvt_pk_bf16_f32 v42, v220, -v222
    v_cvt_pk_bf16_f32 v43, v221, -v223
    s_nop 1
    v_mfma_f32_32x32x16_bf16 v[80:95], v[40:43], a[56:59], v[80:95]
    v_lshlrev_b32 v208, 16, v76
    v_lshlrev_b32 v209, 16, v77
    v_and_b32 v210, 0xffff0000, v76
    v_and_b32 v211, 0xffff0000, v77
    v_mul_f32 v212, v188, v208
    v_mfma_f32_32x32x16_bf16 v[96:111], v[40:43], a[88:91], v[96:111]
    v_mul_f32 v214, v204, v208
    v_mul_f32 v213, v189, v209
    v_mul_f32 v215, v205, v209
    v_fma_f32 v212, -v204, v210, v212
    v_fma_f32 v214, v188, v210, v214
    v_mfma_f32_32x32x16_bf16 v[112:127], v[40:43], a[120:123], v[112:127]
    v_fma_f32 v213, -v205, v211, v213
    v_fma_f32 v215, v189, v211, v215
    v_cvt_pk_bf16_f32 v44, v212, -v214
    v_cvt_pk_bf16_f32 v45, v213, -v215
    v_lshlrev_b32 v216, 16, v78
    v_mfma_f32_32x32x16_bf16 v[128:143], v[40:43], a[152:155], v[128:143]
    v_lshlrev_b32 v217, 16, v79
    v_and_b32 v218, 0xffff0000, v78
    v_and_b32 v219, 0xffff0000, v79
    v_mul_f32 v220, v190, v216
    v_mul_f32 v222, v206, v216
    v_mul_f32 v221, v191, v217
    v_mul_f32 v223, v207, v217
    v_fma_f32 v220, -v206, v218, v220
    v_fma_f32 v222, v190, v218, v222
    v_fma_f32 v221, -v207, v219, v221
    v_fma_f32 v223, v191, v219, v223
    v_cvt_pk_bf16_f32 v46, v220, -v222
    v_cvt_pk_bf16_f32 v47, v221, -v223
    s_nop 1
    v_mfma_f32_32x32x16_bf16 v[80:95], v[44:47], a[60:63], v[80:95]
    ds_read_b128 v[208:211], v12 offset:16384
    v_mfma_f32_32x32x16_bf16 v[96:111], v[44:47], a[92:95], v[96:111]
    ds_read_b128 v[212:215], v12 offset:17408
    v_mfma_f32_32x32x16_bf16 v[112:127], v[44:47], a[124:127], v[112:127]
    v_mfma_f32_32x32x16_bf16 v[128:143], v[44:47], a[156:159], v[128:143]
    s_nop 1
    s_nop 7
    s_nop 3
    s_waitcnt lgkmcnt(1)
    v_mul_f32 v224, v80, v208
    v_mul_f32 v226, v96, v208
    v_mul_f32 v225, v81, v209
    v_mul_f32 v227, v97, v209
    v_fma_f32 v224, v96, v210, v224
    v_fma_f32 v226, -v80, v210, v226
    v_fma_f32 v225, v97, v211, v225
    v_fma_f32 v227, -v81, v211, v227
    v_cvt_pk_bf16_f32 v16, v224, v226
    v_cvt_pk_bf16_f32 v17, v225, v227
    ds_read_b128 v[216:219], v12 offset:18432
    s_waitcnt lgkmcnt(1)
    v_mul_f32 v228, v82, v212
    v_mul_f32 v230, v98, v212
    v_mul_f32 v229, v83, v213
    v_mul_f32 v231, v99, v213
    v_fma_f32 v228, v98, v214, v228
    v_fma_f32 v230, -v82, v214, v230
    v_fma_f32 v229, v99, v215, v229
    v_fma_f32 v231, -v83, v215, v231
    v_cvt_pk_bf16_f32 v18, v228, v230
    v_cvt_pk_bf16_f32 v19, v229, v231
    ds_read_b128 v[220:223], v12 offset:19456
    s_nop 1
    v_mfma_f32_32x32x16_bf16 v[144:159], a[0:3], v[16:19], 0
    s_waitcnt lgkmcnt(1)
    v_mul_f32 v224, v84, v216
    v_mul_f32 v226, v100, v216
    v_mul_f32 v225, v85, v217
    v_mul_f32 v227, v101, v217
    v_mfma_f32_32x32x16_bf16 v[160:175], a[16:19], v[16:19], 0
    v_fma_f32 v224, v100, v218, v224
    v_fma_f32 v226, -v84, v218, v226
    v_fma_f32 v225, v101, v219, v225
    v_fma_f32 v227, -v85, v219, v227
    v_cvt_pk_bf16_f32 v20, v224, v226
    v_cvt_pk_bf16_f32 v21, v225, v227
    ds_read_b128 v[208:211], v12 offset:20480
    s_waitcnt lgkmcnt(1)
    v_mul_f32 v228, v86, v220
    v_mul_f32 v230, v102, v220
    v_mul_f32 v229, v87, v221
    v_mul_f32 v231, v103, v221
    v_fma_f32 v228, v102, v222, v228
    v_fma_f32 v230, -v86, v222, v230
    v_fma_f32 v229, v103, v223, v229
    v_fma_f32 v231, -v87, v223, v231
    v_cvt_pk_bf16_f32 v22, v228, v230
    v_cvt_pk_bf16_f32 v23, v229, v231
    ds_read_b128 v[212:215], v12 offset:21504
    s_nop 1
    v_mfma_f32_32x32x16_bf16 v[144:159], a[4:7], v[20:23], v[144:159]
    s_waitcnt lgkmcnt(1)
    v_mul_f32 v224, v88, v208
    v_mul_f32 v226, v104, v208
    v_mul_f32 v225, v89, v209
    v_mul_f32 v227, v105, v209
    v_mfma_f32_32x32x16_bf16 v[160:175], a[20:23], v[20:23], v[160:175]
    v_fma_f32 v224, v104, v210, v224
    v_fma_f32 v226, -v88, v210, v226
    v_fma_f32 v225, v105, v211, v225
    v_fma_f32 v227, -v89, v211, v227
    v_cvt_pk_bf16_f32 v24, v224, v226
    v_cvt_pk_bf16_f32 v25, v225, v227
    ds_read_b128 v[216:219], v12 offset:22528
    s_waitcnt lgkmcnt(1)
    v_mul_f32 v228, v90, v212
    v_mul_f32 v230, v106, v212
    v_mul_f32 v229, v91, v213
    v_mul_f32 v231, v107, v213
    v_fma_f32 v228, v106, v214, v228
    v_fma_f32 v230, -v90, v214, v230
    v_fma_f32 v229, v107, v215, v229
    v_fma_f32 v231, -v91, v215, v231
    v_cvt_pk_bf16_f32 v26, v228, v230
    v_cvt_pk_bf16_f32 v27, v229, v231
    ds_read_b128 v[220:223], v12 offset:23552
    s_nop 1
    v_mfma_f32_32x32x16_bf16 v[144:159], a[8:11], v[24:27], v[144:159]
    s_waitcnt lgkmcnt(1)
    v_mul_f32 v224, v92, v216
    v_mul_f32 v226, v108, v216
    v_mul_f32 v225, v93, v217
    v_mul_f32 v227, v109, v217
    v_mfma_f32_32x32x16_bf16 v[160:175], a[24:27], v[24:27], v[160:175]
    v_fma_f32 v224, v108, v218, v224
    v_fma_f32 v226, -v92, v218, v226
    v_fma_f32 v225, v109, v219, v225
    v_fma_f32 v227, -v93, v219, v227
    v_cvt_pk_bf16_f32 v28, v224, v226
    v_cvt_pk_bf16_f32 v29, v225, v227
    ds_read_b128 v[208:211], v12 offset:24576
    s_waitcnt lgkmcnt(1)
    v_mul_f32 v228, v94, v220
    v_mul_f32 v230, v110, v220
    v_mul_f32 v229, v95, v221
    v_mul_f32 v231, v111, v221
    v_fma_f32 v228, v110, v222, v228
    v_fma_f32 v230, -v94, v222, v230
    v_fma_f32 v229, v111, v223, v229
    v_fma_f32 v231, -v95, v223, v231
    v_cvt_pk_bf16_f32 v30, v228, v230
    v_cvt_pk_bf16_f32 v31, v229, v231
    ds_read_b128 v[212:215], v12 offset:25600
    s_nop 1
    v_mfma_f32_32x32x16_bf16 v[144:159], a[12:15], v[28:31], v[144:159]
    s_waitcnt lgkmcnt(1)
    v_mul_f32 v224, v112, v208
    v_mul_f32 v226, v128, v208
    v_mul_f32 v225, v113, v209
    v_mul_f32 v227, v129, v209
    v_mfma_f32_32x32x16_bf16 v[160:175], a[28:31], v[28:31], v[160:175]
    v_fma_f32 v224, v128, v210, v224
    v_fma_f32 v226, -v112, v210, v226
    v_fma_f32 v225, v129, v211, v225
    v_fma_f32 v227, -v113, v211, v227
    v_cvt_pk_bf16_f32 v32, v224, v226
    v_cvt_pk_bf16_f32 v33, v225, v227
    ds_read_b128 v[216:219], v12 offset:26624
    s_waitcnt lgkmcnt(1)
    v_mul_f32 v228, v114, v212
    v_mul_f32 v230, v130, v212
    v_mul_f32 v229, v115, v213
    v_mul_f32 v231, v131, v213
    v_fma_f32 v228, v130, v214, v228
    v_fma_f32 v230, -v114, v214, v230
    v_fma_f32 v229, v131, v215, v229
    v_fma_f32 v231, -v115, v215, v231
    v_cvt_pk_bf16_f32 v34, v228, v230
    v_cvt_pk_bf16_f32 v35, v229, v231
    ds_read_b128 v[220:223], v12 offset:27648
    s_nop 1
    v_mfma_f32_32x32x16_bf16 v[176:191], a[0:3], v[32:35], 0
    s_waitcnt lgkmcnt(1)
    v_mul_f32 v224, v116, v216
    v_mul_f32 v226, v132, v216
    v_mul_f32 v225, v117, v217
    v_mul_f32 v227, v133, v217
    v_mfma_f32_32x32x16_bf16 v[192:207], a[16:19], v[32:35], 0
    v_fma_f32 v224, v132, v218, v224
    v_fma_f32 v226, -v116, v218, v226
    v_fma_f32 v225, v133, v219, v225
    v_fma_f32 v227, -v117, v219, v227
    v_cvt_pk_bf16_f32 v36, v224, v226
    v_cvt_pk_bf16_f32 v37, v225, v227
    ds_read_b128 v[208:211], v12 offset:28672
    s_waitcnt lgkmcnt(1)
    v_mul_f32 v228, v118, v220
    v_mul_f32 v230, v134, v220
    v_mul_f32 v229, v119, v221
    v_mul_f32 v231, v135, v221
    v_fma_f32 v228, v134, v222, v228
    v_fma_f32 v230, -v118, v222, v230
    v_fma_f32 v229, v135, v223, v229
    v_fma_f32 v231, -v119, v223, v231
    v_cvt_pk_bf16_f32 v38, v228, v230
    v_cvt_pk_bf16_f32 v39, v229, v231
    ds_read_b128 v[212:215], v12 offset:29696
    s_nop 1
    v_mfma_f32_32x32x16_bf16 v[176:191], a[4:7], v[36:39], v[176:191]
    s_waitcnt lgkmcnt(1)
    v_mul_f32 v224, v120, v208
    v_mul_f32 v226, v136, v208
    v_mul_f32 v225, v121, v209
    v_mul_f32 v227, v137, v209
    v_mfma_f32_32x32x16_bf16 v[192:207], a[20:23], v[36:39], v[192:207]
    v_fma_f32 v224, v136, v210, v224
    v_fma_f32 v226, -v120, v210, v226
    v_fma_f32 v225, v137, v211, v225
    v_fma_f32 v227, -v121, v211, v227
    v_cvt_pk_bf16_f32 v40, v224, v226
    v_cvt_pk_bf16_f32 v41, v225, v227
    ds_read_b128 v[216:219], v12 offset:30720
    s_waitcnt lgkmcnt(1)
    v_mul_f32 v228, v122, v212
    v_mul_f32 v230, v138, v212
    v_mul_f32 v229, v123, v213
    v_mul_f32 v231, v139, v213
    v_fma_f32 v228, v138, v214, v228
    v_fma_f32 v230, -v122, v214, v230
    v_fma_f32 v229, v139, v215, v229
    v_fma_f32 v231, -v123, v215, v231
    v_cvt_pk_bf16_f32 v42, v228, v230
    v_cvt_pk_bf16_f32 v43, v229, v231
    ds_read_b128 v[220:223], v12 offset:31744
    s_nop 1
    v_mfma_f32_32x32x16_bf16 v[176:191], a[8:11], v[40:43], v[176:191]
    s_waitcnt lgkmcnt(1)
    v_mul_f32 v224, v124, v216
    v_mul_f32 v226, v140, v216
    v_mul_f32 v225, v125, v217
    v_mul_f32 v227, v141, v217
    v_mfma_f32_32x32x16_bf16 v[192:207], a[24:27], v[40:43], v[192:207]
    v_fma_f32 v224, v140, v218, v224
    v_fma_f32 v226, -v124, v218, v226
    v_fma_f32 v225, v141, v219, v225
    v_fma_f32 v227, -v125, v219, v227
    v_cvt_pk_bf16_f32 v44, v224, v226
    v_cvt_pk_bf16_f32 v45, v225, v227
    s_waitcnt lgkmcnt(0)
    v_mul_f32 v228, v126, v220
    v_mul_f32 v230, v142, v220
    v_mul_f32 v229, v127, v221
    v_mul_f32 v231, v143, v221
    v_fma_f32 v228, v142, v222, v228
    v_fma_f32 v230, -v126, v222, v230
    v_fma_f32 v229, v143, v223, v229
    v_fma_f32 v231, -v127, v223, v231
    v_cvt_pk_bf16_f32 v46, v228, v230
    v_cvt_pk_bf16_f32 v47, v229, v231
    s_nop 1
    v_mfma_f32_32x32x16_bf16 v[176:191], a[12:15], v[44:47], v[176:191]
    v_mfma_f32_32x32x16_bf16 v[192:207], a[28:31], v[44:47], v[192:207]
    v_cvt_pk_bf16_f32 v48, v144, v160
    v_cvt_pk_bf16_f32 v49, v145, v161
    v_cvt_pk_bf16_f32 v50, v146, v162
    v_cvt_pk_bf16_f32 v51, v147, v163
    v_cvt_pk_bf16_f32 v52, v148, v164
    v_cvt_pk_bf16_f32 v53, v149, v165
    v_cvt_pk_bf16_f32 v54, v150, v166
    v_cvt_pk_bf16_f32 v55, v151, v167
    v_cvt_pk_bf16_f32 v56, v152, v168
    v_cvt_pk_bf16_f32 v57, v153, v169
    v_cvt_pk_bf16_f32 v58, v154, v170
    v_cvt_pk_bf16_f32 v59, v155, v171
    v_cvt_pk_bf16_f32 v60, v156, v172
    v_cvt_pk_bf16_f32 v61, v157, v173
    v_cvt_pk_bf16_f32 v62, v158, v174
    v_cvt_pk_bf16_f32 v63, v159, v175
    s_nop 1
    v_cvt_pk_bf16_f32 v64, v176, v192
    v_cvt_pk_bf16_f32 v65, v177, v193
    v_cvt_pk_bf16_f32 v66, v178, v194
    v_cvt_pk_bf16_f32 v67, v179, v195
    v_cvt_pk_bf16_f32 v68, v180, v196
    v_cvt_pk_bf16_f32 v69, v181, v197
    v_cvt_pk_bf16_f32 v70, v182, v198
    v_cvt_pk_bf16_f32 v71, v183, v199
    v_cvt_pk_bf16_f32 v72, v184, v200
    v_cvt_pk_bf16_f32 v73, v185, v201
    v_cvt_pk_bf16_f32 v74, v186, v202
    v_cvt_pk_bf16_f32 v75, v187, v203
    v_cvt_pk_bf16_f32 v76, v188, v204
    v_cvt_pk_bf16_f32 v77, v189, v205
    v_cvt_pk_bf16_f32 v78, v190, v206
    v_cvt_pk_bf16_f32 v79, v191, v207
    s_cmp_eq_u32 s23, 3
    s_cbranch_scc0 F_NZ
    v_mov_b32 v48, 0
    v_mov_b32 v49, 0
    v_mov_b32 v50, 0
    v_mov_b32 v51, 0
    v_mov_b32 v52, 0
    v_mov_b32 v53, 0
    v_mov_b32 v54, 0
    v_mov_b32 v55, 0
    v_mov_b32 v56, 0
    v_mov_b32 v57, 0
    v_mov_b32 v58, 0
    v_mov_b32 v59, 0
    v_mov_b32 v60, 0
    v_mov_b32 v61, 0
    v_mov_b32 v62, 0
    v_mov_b32 v63, 0
    v_mov_b32 v64, 0
    v_mov_b32 v65, 0
    v_mov_b32 v66, 0
    v_mov_b32 v67, 0
    v_mov_b32 v68, 0
    v_mov_b32 v69, 0
    v_mov_b32 v70, 0
    v_mov_b32 v71, 0
    v_mov_b32 v72, 0
    v_mov_b32 v73, 0
    v_mov_b32 v74, 0
    v_mov_b32 v75, 0
    v_mov_b32 v76, 0
    v_mov_b32 v77, 0
    v_mov_b32 v78, 0
    v_mov_b32 v79, 0
F_NZ:
    ds_write2st64_b32 v4, v48, v49 offset0:0 offset1:1
    ds_write2st64_b32 v4, v50, v51 offset0:2 offset1:3
    ds_write2st64_b32 v4, v52, v53 offset0:8 offset1:9
    ds_write2st64_b32 v4, v54, v55 offset0:10 offset1:11
    ds_write2st64_b32 v4, v56, v57 offset0:16 offset1:17
    ds_write2st64_b32 v4, v58, v59 offset0:18 offset1:19
    ds_write2st64_b32 v4, v60, v61 offset0:24 offset1:25
    ds_write2st64_b32 v4, v62, v63 offset0:26 offset1:27
    ds_write2st64_b32 v13, v64, v65 offset0:0 offset1:1
    ds_write2st64_b32 v13, v66, v67 offset0:2 offset1:3
    ds_write2st64_b32 v13, v68, v69 offset0:8 offset1:9
    ds_write2st64_b32 v13, v70, v71 offset0:10 offset1:11
    ds_write2st64_b32 v13, v72, v73 offset0:16 offset1:17
    ds_write2st64_b32 v13, v74, v75 offset0:18 offset1:19
    ds_write2st64_b32 v13, v76, v77 offset0:24 offset1:25
    ds_write2st64_b32 v13, v78, v79 offset0:26 offset1:27
    s_waitcnt lgkmcnt(0)
    s_barrier
    s_lshr_b32 s45, s18, 2
    s_lshl_b32 s45, s45, 10
    s_and_b32 s46, s18, 3
    s_lshl_b32 s46, s46, 8
    s_add_u32 s45, s45, s46
    s_mul_i32 s22, s16, 622592
    s_add_u32 s22, s22, s45
    s_add_u32 s22, s22, 24379392
    ds_read2st64_b32 v[80:81], v5 offset0:0 offset1:32
    ds_read2st64_b32 v[82:83], v5 offset0:64 offset1:96
    ds_read2st64_b32 v[84:85], v5 offset0:1 offset1:33
    ds_read2st64_b32 v[86:87], v5 offset0:65 offset1:97
    ds_read2st64_b32 v[88:89], v5 offset0:2 offset1:34
    ds_read2st64_b32 v[90:91], v5 offset0:66 offset1:98
    ds_read2st64_b32 v[92:93], v5 offset0:3 offset1:35
    ds_read2st64_b32 v[94:95], v5 offset0:67 offset1:99
    ds_read2st64_b32 v[96:97], v5 offset0:4 offset1:36
    ds_read2st64_b32 v[98:99], v5 offset0:68 offset1:100
    ds_read2st64_b32 v[100:101], v5 offset0:5 offset1:37
    ds_read2st64_b32 v[102:103], v5 offset0:69 offset1:101
    s_waitcnt lgkmcnt(6)
    ds_read2st64_b32 v[104:105], v5 offset0:6 offset1:38
    ds_read2st64_b32 v[106:107], v5 offset0:70 offset1:102
    ds_read2st64_b32 v[108:109], v5 offset0:7 offset1:39
    ds_read2st64_b32 v[110:111], v5 offset0:71 offset1:103
    buffer_store_dwordx4 v[80:83], v6, s[12:15], s22 offen sc1
    s_add_u32 s22, s22, 77824
    buffer_store_dwordx4 v[84:87], v6, s[12:15], s22 offen sc1
    s_add_u32 s22, s22, 77824
    buffer_store_dwordx4 v[88:91], v6, s[12:15], s22 offen sc1
    s_add_u32 s22, s22, 77824
    s_waitcnt lgkmcnt(8)
    buffer_store_dwordx4 v[92:95], v6, s[12:15], s22 offen sc1
    s_add_u32 s22, s22, 77824
    s_waitcnt lgkmcnt(6)
    buffer_store_dwordx4 v[96:99], v6, s[12:15], s22 offen sc1
    s_add_u32 s22, s22, 77824
    s_waitcnt lgkmcnt(4)
    buffer_store_dwordx4 v[100:103], v6, s[12:15], s22 offen sc1
    s_add_u32 s22, s22, 77824
    s_waitcnt lgkmcnt(2)
    buffer_store_dwordx4 v[104:107], v6, s[12:15], s22 offen sc1
    s_add_u32 s22, s22, 77824
    s_waitcnt lgkmcnt(0)
    buffer_store_dwordx4 v[108:111], v6, s[12:15], s22 offen sc1
    s_add_u32 s33, s18, 64
    s_cmp_gt_u32 s33, 72
    s_cbranch_scc1 F_PUB
    s_mov_b32 s18, s33
    s_mov_b32 s39, 1
    s_waitcnt vmcnt(8)
    s_branch F_JOB
F_PUB:
    s_waitcnt vmcnt(0)
    s_barrier
    s_cmp_gt_u32 s18, 63
    s_cbranch_scc1 F_LAST
    s_cmp_eq_u32 s16, 0
    s_cbranch_scc0 F_SIG3
    v_mov_b32 v208, 128
    v_mov_b32 v209, 1
    s_mov_b64 exec, 1
    global_atomic_add v208, v209, s[30:31] sc1
    s_mov_b64 exec, -1
F_SIG3:
    s_branch F_DONE
F_LAST:
    s_cmp_eq_u32 s16, 0
    s_cbranch_scc0 F_SIG4
    v_mov_b32 v208, 192
    v_mov_b32 v209, 1
    s_mov_b64 exec, 1
    global_atomic_add v208, v209, s[30:31] sc1
    s_mov_b64 exec, -1
F_SIG4:
F_DONE:
    s_endpgm
G2_SPINM:
    s_mov_b32 s45, 0x40000
G2_SPINM1:
    s_sleep 1
    buffer_load_dword v40, v39, s[12:15], 0 offen sc1
    s_waitcnt vmcnt(0)
    v_cmp_ne_u32 vcc, s101, v40
    s_nop 4
    s_cbranch_vccz G2_CONTM
    s_sub_u32 s45, s45, 1
    s_cmp_lg_u32 s45, 0
    s_cbranch_scc1 G2_SPINM1
    s_branch G2_CONTM
G2_SPINL:
    s_mov_b32 s45, 0x40000
G2_SPINL1:
    s_sleep 1
    buffer_load_dword v38, v37, s[12:15], 0 offen sc1
    s_waitcnt vmcnt(0)
    v_cmp_ne_u32 vcc, s101, v38
    s_nop 4
    s_cbranch_vccz G2_CONTL
    s_sub_u32 s45, s45, 1
    s_cmp_lg_u32 s45, 0
    s_cbranch_scc1 G2_SPINL1
    s_branch G2_CONTL
G2_SPIN:
    s_mov_b32 s45, 0x40000
G2_SPIN1:
    s_sleep 1
    global_load_dword v35, v36, s[30:31] sc1
    s_waitcnt vmcnt(0)
    v_cmp_gt_u32 vcc, 64, v35
    s_nop 4
    s_cbranch_vccz G2_CONT
    s_sub_u32 s45, s45, 1
    s_cmp_lg_u32 s45, 0
    s_cbranch_scc1 G2_SPIN1
    s_branch G2_CONT
    .p2align 6
G2_TAB:
    .long 0, 1, 2, 9, 10, 11, 27, 28, 29, 3, 4, 5, 6, 7, 8, 12, 13, 14, 15, 16, 17, 30, 31, 32, 33, 34, 35, 18, 19, 20, 21, 22, 23, 24, 25, 26
    .long 9, 10, 11, 27, 28, 29, 0, 1, 2, 12, 13, 14, 15, 16, 17, 3, 4, 5, 6, 7, 8, 30, 31, 32, 33, 34, 35, 21, 22, 23, 24, 25, 26, 18, 19, 20
    .long 27, 28, 29, 0, 1, 2, 9, 10, 11, 30, 31, 32, 33, 34, 35, 3, 4, 5, 6, 7, 8, 12, 13, 14, 15, 16, 17, 24, 25, 26, 18, 19, 20, 21, 22, 23
    .long 1, 2, 9, 10, 11, 27, 28, 29, 0, 4, 5, 6, 7, 8, 3, 13, 14, 15, 16, 17, 30, 31, 32, 33, 34, 35, 12, 19, 20, 21, 22, 23, 24, 25, 26, 18
    .long 10, 11, 27, 28, 29, 0, 1, 2, 9, 13, 14, 15, 16, 17, 12, 4, 5, 6, 7, 8, 30, 31, 32, 33, 34, 35, 3, 22, 23, 24, 25, 26, 18, 19, 20, 21
    .long 28, 29, 0, 1, 2, 9, 10, 11, 27, 31, 32, 33, 34, 35, 30, 4, 5, 6, 7, 8, 12, 13, 14, 15, 16, 17, 3, 25, 26, 18, 19, 20, 21, 22, 23, 24
    .long 2, 9, 10, 11, 27, 28, 29, 0, 1, 5, 6, 7, 8, 3, 4, 15, 16, 17, 30, 31, 32, 33, 34, 35, 12, 13, 14, 20, 21, 22, 23, 24, 25, 26, 18, 19
    .long 11, 27, 28, 29, 0, 1, 2, 9, 10, 14, 15, 16, 17, 12, 13, 6, 7, 8, 30, 31, 32, 33, 34, 35, 3, 4, 5, 23, 24, 25, 26, 18, 19, 20, 21, 22
    .long 29, 0, 1, 2, 9, 10, 11, 27, 28, 32, 33, 34, 35, 30, 31, 6, 7, 8, 12, 13, 14, 15, 16, 17, 3, 4, 5, 26, 18, 19, 20, 21, 22, 23, 24, 25
    .long 9, 10, 11, 27, 28, 29, 0, 1, 2, 6, 7, 8, 3, 4, 5, 16, 17, 30, 31, 32, 33, 34, 35, 12, 13, 14, 15, 21, 22, 23, 24, 25, 26, 18, 19, 20
    .long 27, 28, 29, 0, 1, 2, 9, 10, 11, 15, 16, 17, 12, 13, 14, 7, 8, 30, 31, 32, 33, 34, 35, 3, 4, 5, 6, 24, 25, 26, 18, 19, 20, 21, 22, 23
    .long 0, 1, 2, 9, 10, 11, 27, 28, 29, 33, 34, 35, 30, 31, 32, 7, 8, 12, 13, 14, 15, 16, 17, 3, 4, 5, 6, 18, 19, 20, 21, 22, 23, 24, 25, 26
    .long 10, 11, 27, 28, 29, 0, 1, 2, 9, 7, 8, 3, 4, 5, 6, 30, 31, 32, 33, 34, 35, 12, 13, 14, 15, 16, 17, 22, 23, 24, 25, 26, 18, 19, 20, 21
    .long 28, 29, 0, 1, 2, 9, 10, 11, 27, 16, 17, 12, 13, 14, 15, 30, 31, 32, 33, 34, 35, 3, 4, 5, 6, 7, 8, 25, 26, 18, 19, 20, 21, 22, 23, 24
    .long 1, 2, 9, 10, 11, 27, 28, 29, 0, 34, 35, 30, 31, 32, 33, 12, 13, 14, 15, 16, 17, 3, 4, 5, 6, 7, 8, 19, 20, 21, 22, 23, 24, 25, 26, 18
    .long 11, 27, 28, 29, 0, 1, 2, 9, 10, 8, 3, 4, 5, 6, 7, 31, 32, 33, 34, 35, 12, 13, 14, 15, 16, 17, 30, 23, 24, 25, 26, 18, 19, 20, 21, 22
    .long 29, 0, 1, 2, 9, 10, 11, 27, 28, 17, 12, 13, 14, 15, 16, 31, 32, 33, 34, 35, 3, 4, 5, 6, 7, 8, 30, 26, 18, 19, 20, 21, 22, 23, 24, 25
    .long 2, 9, 10, 11, 27, 28, 29, 0, 1, 35, 30, 31, 32, 33, 34, 13, 14, 15, 16, 17, 3, 4, 5, 6, 7, 8, 12, 20, 21, 22, 23, 24, 25, 26, 18, 19
    .long 27, 28, 29, 0, 1, 2, 9, 10, 11, 3, 4, 5, 6, 7, 8, 33, 34, 35, 12, 13, 14, 15, 16, 17, 30, 31, 32, 24, 25, 26, 18, 19, 20, 21, 22, 23
    .long 0, 1, 2, 9, 10, 11, 27, 28, 29, 12, 13, 14, 15, 16, 17, 33, 34, 35, 3, 4, 5, 6, 7, 8, 30, 31, 32, 18, 19, 20, 21, 22, 23, 24, 25, 26
    .long 9, 10, 11, 27, 28, 29, 0, 1, 2, 30, 31, 32, 33, 34, 35, 15, 16, 17, 3, 4, 5, 6, 7, 8, 12, 13, 14, 21, 22, 23, 24, 25, 26, 18, 19, 20
    .long 28, 29, 0, 1, 2, 9, 10, 11, 27, 4, 5, 6, 7, 8, 3, 34, 35, 12, 13, 14, 15, 16, 17, 30, 31, 32, 33, 25, 26, 18, 19, 20, 21, 22, 23, 24
    .long 1, 2, 9, 10, 11, 27, 28, 29, 0, 13, 14, 15, 16, 17, 12, 34, 35, 3, 4, 5, 6, 7, 8, 30, 31, 32, 33, 19, 20, 21, 22, 23, 24, 25, 26, 18
    .long 10, 11, 27, 28, 29, 0, 1, 2, 9, 31, 32, 33, 34, 35, 30, 16, 17, 3, 4, 5, 6, 7, 8, 12, 13, 14, 15, 22, 23, 24, 25, 26, 18, 19, 20, 21
CODE_END:
    s_endpgm
.section .rodata,"a"
.p2align 6
.amdhsa_kernel parallel_sum__spectral_gfnet__glu_gated_bilinear__prompt_kernel
  .amdhsa_next_free_vgpr 512
  .amdhsa_next_free_sgpr 102
  .amdhsa_accum_offset 256
  .amdhsa_group_segment_fixed_size 0
  .amdhsa_kernarg_size 80
  .amdhsa_user_sgpr_count 2
  .amdhsa_user_sgpr_kernarg_segment_ptr 1
  .amdhsa_system_sgpr_workgroup_id_x 1
.end_amdhsa_kernel
```
